```python
import torch

def _softmax(x, axis=-1):
    return torch.softmax(x, dim=axis)
def _gelu(x):
    return torch.nn.functional.gelu(x, approximate="tanh")
def _silu(x):
    return torch.nn.functional.silu(x)
def _sigmoid(x):
    return torch.sigmoid(x)
def _layernorm(x, axis=-1, eps=1e-5):
    m = x.mean(dim=axis, keepdim=True)
    v = x.var(dim=axis, keepdim=True, unbiased=False)
    return (x - m) / torch.sqrt(v + eps)
def _scatter_add(tgt, idx, src, axis=0):
    return tgt.clone().index_add_(axis, idx, src)
def _segment_sum(src, seg, n):
    out = torch.zeros((n,) + src.shape[1:], dtype=src.dtype)
    return out.index_add_(0, seg, src)
def _pad(x, pw):
    flat = tuple(v for pair in reversed(pw) for v in pair)
    return torch.nn.functional.pad(x, flat)

kernel_name = 'standalone__gqa_block_cached__sampling'

def setup_inputs():

    _w = (lambda a: (lambda t: t.to(torch.bfloat16) if t.is_floating_point() else t)(torch.as_tensor(a)))
    B, Sq, D = 32, 16, 1024
    Hq, Hkv, Sk, Dh = 32, 4, 2048, 128
    assert Hq % Hkv == 0, (Hq, Hkv)
    return {
        "x": _w((lambda *s: torch.randn(*s, dtype=torch.bfloat16) * 0.8)(B, Sq, D)),
        "k_cache": _w((lambda *s: torch.randn(*s, dtype=torch.bfloat16) * 0.8)(B, Hkv, Sk, Dh)),
        "v_cache": _w((lambda *s: torch.randn(*s, dtype=torch.bfloat16) * 0.05)(B, Hkv, Sk, Dh)),
        "wq": _w((lambda *s: torch.randn(*s, dtype=torch.bfloat16) * 0.8)(D, Hq * Dh) * (D ** -0.5)),
        "wo": _w((lambda *s: torch.randn(*s, dtype=torch.bfloat16) * 0.05)(Hq * Dh, D) * ((Hq * Dh) ** -0.5)),
    }

def reference(x, k_cache, v_cache, wq, wo):
    B, Sq, D = x.shape
    Hq, Dh = 32, 128
    Hkv = k_cache.shape[1]
    rep = Hq // Hkv
    q = (lambda x, *d: x.permute(*d))((x @ wq).reshape(B, Sq, Hq, Dh), 0, 2, 1, 3)
    k = (lambda x, n, axis: torch.repeat_interleave(x, n, dim=axis))(k_cache, rep, axis=1)
    v = (lambda x, n, axis: torch.repeat_interleave(x, n, dim=axis))(v_cache, rep, axis=1)
    scores = torch.einsum("bhqd,bhkd->bhqk", q, k) * (Dh ** -0.5)
    p = _softmax(scores, axis=-1)
    o = torch.einsum("bhqk,bhkd->bhqd", p, v)
    return (lambda x, *d: x.permute(*d))(o, 0, 2, 1, 3).reshape(B, Sq, Hq * Dh) @ wo
```

```asm
; @launch grid=(256,1,1) block=(256,1,1) lds=163840
.amdgcn_target "amdgcn-amd-amdhsa--gfx950"
.text
.globl standalone__gqa_block_cached__sampling_kernel
.p2align 8
.type standalone__gqa_block_cached__sampling_kernel,@function
standalone__gqa_block_cached__sampling_kernel:
    s_load_dwordx2 s[16:17], s[0:1], 24
    s_load_dwordx2 s[4:5], s[0:1], 0
    s_cmp_ge_u32 s2, 256
    s_cbranch_scc1 L_done
    s_mov_b32 s19, 0x20000
    s_lshl_b32 s18, s19, 6
    s_mov_b32 s7, s19
    s_lshl_b32 s6, s19, 3
    s_bitcmp1_b32 s2, 3
    s_cbranch_scc1 L_P
    v_and_b32 v28, 15, v0
    v_lshlrev_b32 v29, 7, v28
    v_bfe_u32 v30, v0, 4, 2
    v_lshl_add_u32 v29, v30, 13, v29
    v_lshrrev_b32 v31, 6, v0
    v_lshl_add_u32 v29, v31, 19, v29
    s_lshr_b32 s62, s2, 4
    s_lshl_b32 s62, s62, 15
    s_and_b32 s61, s2, 6
    s_lshl_b32 s61, s61, 10
    s_add_u32 s61, s61, s62
    v_lshrrev_b32 v30, 4, v0
    v_lshlrev_b32 v28, 11, v28
    v_lshl_add_u32 v28, v30, 7, v28
    s_and_b32 s60, s2, 1
    s_lshl_b32 s60, s60, 19
    s_add_u32 s60, s60, s62
    s_waitcnt lgkmcnt(0)
    buffer_load_dword v211, v29, s[16:19], s61 offen
    s_load_dwordx2 s[8:9], s[0:1], 8
    s_load_dwordx2 s[12:13], s[0:1], 16
    s_load_dwordx2 s[20:21], s[0:1], 32
    s_load_dwordx2 s[24:25], s[0:1], 40
    s_load_dwordx2 s[32:33], s[0:1], 48
    s_load_dwordx2 s[28:29], s[0:1], 56
    s_getpc_b64 s[64:65]
L_pcs:
    v_lshrrev_b32 v254, 3, v0
    v_and_b32 v254, 0x18, v254
    v_and_or_b32 v254, v0, 7, v254
    s_lshr_b32 s62, s2, 3
    s_lshl_b32 s62, s62, 5
    v_add_lshl_u32 v254, v254, s62, 7
    s_sub_u32 s64, s64, L_pcs-standalone__gqa_block_cached__sampling_kernel
    s_subb_u32 s65, s65, 0
    v_min_u32 v254, L_end-standalone__gqa_block_cached__sampling_kernel-4, v254
    global_load_dword v255, v254, s[64:65]
    v_lshrrev_b32 v2, 6, v0
    v_and_b32 v1, 63, v0
    v_readfirstlane_b32 s34, v2
    s_and_b32 s35, s2, 7
    s_lshr_b32 s36, s2, 3
    s_and_b32 s37, s36, 1
    s_lshr_b32 s38, s36, 1
    s_mov_b32 s10, 0x4000000
    s_mov_b32 s11, 0x20000
    s_mov_b32 s14, 0x4000000
    s_mov_b32 s15, 0x20000
    s_mov_b32 s22, 0x800000
    s_mov_b32 s23, 0x20000
    s_mov_b32 s26, 0x100000
    s_mov_b32 s27, 0x20000
    s_mov_b32 s30, 0x10000000
    s_mov_b32 s31, 0x20000
    s_waitcnt lgkmcnt(0)
    s_mov_b64 s[0:1], s[64:65]
    s_or_b32 s62, s2, s34
    s_cmp_lg_u32 s62, 0
    s_cbranch_scc1 Ln_np
    s_memrealtime s[62:63]
    s_waitcnt lgkmcnt(0)
    s_or_b32 s62, s62, 1
    s_or_b32 s63, s63, 0x80000000
    v_mov_b32 v24, s62
    v_mov_b32 v25, s63
    v_mov_b32 v26, 0
    s_mov_b64 exec, 1
    global_store_dwordx2 v26, v[24:25], s[32:33] sc1
    s_mov_b64 exec, -1
Ln_np:
    buffer_load_dword v210, v28, s[4:7], s60 offen
    s_add_u32 s61, s61, 0x200000
    buffer_load_dword v212, v29, s[16:19], s61 offen
    s_add_u32 s61, s61, 0x200000
    buffer_load_dword v213, v29, s[16:19], s61 offen
    s_add_u32 s61, s61, 0x200000
    buffer_load_dword v214, v29, s[16:19], s61 offen
    s_branch L_S
L_P:
    s_getpc_b64 s[64:65]
L_pcp:
    v_lshrrev_b32 v254, 3, v0
    v_and_b32 v254, 0x18, v254
    v_and_or_b32 v254, v0, 7, v254
    s_lshr_b32 s62, s2, 3
    s_lshl_b32 s62, s62, 5
    v_add_lshl_u32 v254, v254, s62, 7
    s_sub_u32 s64, s64, L_pcp-standalone__gqa_block_cached__sampling_kernel
    s_subb_u32 s65, s65, 0
    v_min_u32 v254, L_end-standalone__gqa_block_cached__sampling_kernel-4, v254
    global_load_dword v255, v254, s[64:65]
    v_lshrrev_b32 v2, 6, v0
    v_and_b32 v1, 63, v0
    v_readfirstlane_b32 s34, v2
    s_and_b32 s35, s2, 7
    s_lshr_b32 s36, s2, 3
    s_and_b32 s37, s36, 1
    s_lshr_b32 s38, s36, 1
    v_lshrrev_b32 v2, 4, v1
    v_and_b32 v3, 7, v1
    v_xor_b32 v3, v3, v2
    v_lshlrev_b32 v3, 4, v3
    v_lshrrev_b32 v12, 3, v1
    v_lshl_add_u32 v3, v12, 11, v3
    v_add_u32 v4, 0, v3
    v_xor_b32 v5, 64, v3
    v_add_u32 v5, 15360, v5
    v_add_u32 v6, 30720, v3
    v_xor_b32 v7, 64, v3
    v_add_u32 v7, 46080, v7
    v_and_b32 v3, 15, v1
    v_lshlrev_b32 v12, 2, v2
    v_xor_b32 v3, v3, v12
    v_lshlrev_b32 v3, 4, v3
    v_lshl_add_u32 v3, v2, 13, v3
    v_xor_b32 v12, 32, v3
    v_add_u32 v8, 0, v3
    v_add_u32 v9, 31744, v3
    v_add_u32 v10, 63488, v12
    v_add_u32 v11, 95232, v12
    s_and_b32 s47, s35, 1
    s_lshl_b32 s47, s47, 1
    s_and_b32 s50, s38, 1
    s_add_u32 s47, s47, s50
    s_lshr_b32 s48, s38, 1
    s_lshr_b32 s49, s35, 1
    s_lshl_b32 s49, s49, 3
    s_add_u32 s49, s49, s48
    s_lshl_b32 s54, s47, 2
    s_add_u32 s54, s54, s34
    s_lshl_b32 s54, s54, 16
    s_lshl_b32 s55, s34, 17
    s_lshl_b32 s56, s49, 8
    s_add_u32 s55, s55, s56
    s_lshl_b32 s59, s34, 12
    s_waitcnt lgkmcnt(0)
    s_add_u32 m0, s59, 16384
    s_add_u32 s53, s55, 0
    buffer_load_dwordx4 v8, s[16:19], s53 offen offset:0 lds
    buffer_load_dwordx4 v9, s[16:19], s53 offen offset:1024 lds
    buffer_load_dwordx4 v10, s[16:19], s53 offen offset:2048 lds
    buffer_load_dwordx4 v11, s[16:19], s53 offen offset:3072 lds
    s_add_u32 m0, s59, 0
    s_add_u32 s51, s54, 0
    buffer_load_dwordx4 v4, s[4:7], s51 offen offset:0 lds
    buffer_load_dwordx4 v5, s[4:7], s51 offen offset:1024 lds
    buffer_load_dwordx4 v6, s[4:7], s51 offen offset:2048 lds
    buffer_load_dwordx4 v7, s[4:7], s51 offen offset:3072 lds
    s_load_dwordx2 s[8:9], s[0:1], 8
    s_load_dwordx2 s[12:13], s[0:1], 16
    s_load_dwordx2 s[20:21], s[0:1], 32
    s_load_dwordx2 s[24:25], s[0:1], 40
    s_load_dwordx2 s[32:33], s[0:1], 48
    s_load_dwordx2 s[28:29], s[0:1], 56
    s_mov_b32 s10, 0x4000000
    s_mov_b32 s11, 0x20000
    s_mov_b32 s14, 0x4000000
    s_mov_b32 s15, 0x20000
    s_mov_b32 s22, 0x800000
    s_mov_b32 s23, 0x20000
    s_mov_b32 s26, 0x100000
    s_mov_b32 s27, 0x20000
    s_mov_b32 s30, 0x10000000
    s_mov_b32 s31, 0x20000
    s_waitcnt lgkmcnt(0)
    s_mov_b64 s[0:1], s[64:65]
    s_and_b32 s42, s34, 1
    s_lshr_b32 s43, s34, 1
    v_and_b32 v2, 15, v1
    v_lshrrev_b32 v3, 4, v1
    v_lshrrev_b32 v12, 1, v2
    v_xor_b32 v12, v12, v3
    v_lshlrev_b32 v12, 4, v12
    v_lshl_add_u32 v12, v2, 7, v12
    s_lshl_b32 s56, s43, 13
    v_add_u32 v16, s56, v12
    v_xor_b32 v17, 64, v16
    v_add_u32 v18, 0x10000, v16
    v_add_u32 v19, 0x10000, v17
    v_bfe_u32 v12, v1, 2, 2
    v_lshl_add_u32 v13, v3, 3, v12
    v_lshlrev_b32 v13, 8, v13
    v_and_b32 v14, 3, v1
    v_lshl_add_u32 v13, v14, 3, v13
    v_add_u32 v13, 16384, v13
    v_lshlrev_b32 v12, 1, v12
    v_and_b32 v14, 1, v3
    v_or_b32 v12, v12, v14
    s_lshl_b32 s56, s42, 2
    s_add_u32 s57, s56, 0
    v_xor_b32 v14, s57, v12
    v_lshl_add_u32 v20, v14, 5, v13
    v_add_u32 v24, 0x10000, v20
    s_add_u32 s57, s56, 1
    v_xor_b32 v14, s57, v12
    v_lshl_add_u32 v21, v14, 5, v13
    v_add_u32 v25, 0x10000, v21
    s_add_u32 s57, s56, 2
    v_xor_b32 v14, s57, v12
    v_lshl_add_u32 v22, v14, 5, v13
    v_add_u32 v26, 0x10000, v22
    s_add_u32 s57, s56, 3
    v_xor_b32 v14, s57, v12
    v_lshl_add_u32 v23, v14, 5, v13
    v_add_u32 v27, 0x10000, v23
    s_add_u32 m0, s59, 49152
    s_add_u32 s53, s55, 524288
    buffer_load_dwordx4 v8, s[16:19], s53 offen offset:0 lds
    buffer_load_dwordx4 v9, s[16:19], s53 offen offset:1024 lds
    buffer_load_dwordx4 v10, s[16:19], s53 offen offset:2048 lds
    buffer_load_dwordx4 v11, s[16:19], s53 offen offset:3072 lds
    s_add_u32 m0, s59, 32768
    s_add_u32 s51, s54, 128
    buffer_load_dwordx4 v4, s[4:7], s51 offen offset:0 lds
    buffer_load_dwordx4 v5, s[4:7], s51 offen offset:1024 lds
    buffer_load_dwordx4 v6, s[4:7], s51 offen offset:2048 lds
    buffer_load_dwordx4 v7, s[4:7], s51 offen offset:3072 lds
    s_waitcnt vmcnt(8)
    s_barrier
    ds_read_b64_tr_b16 v[96:97], v20 offset:0
    ds_read_b64_tr_b16 v[98:99], v20 offset:1024
    ds_read_b128 v[128:131], v16 offset:0
    ds_read_b64_tr_b16 v[100:101], v21 offset:0
    ds_read_b64_tr_b16 v[102:103], v21 offset:1024
    ds_read_b128 v[132:135], v16 offset:2048
    ds_read_b64_tr_b16 v[104:105], v22 offset:0
    ds_read_b64_tr_b16 v[106:107], v22 offset:1024
    ds_read_b128 v[136:139], v16 offset:4096
    ds_read_b64_tr_b16 v[108:109], v23 offset:0
    ds_read_b64_tr_b16 v[110:111], v23 offset:1024
    ds_read_b128 v[140:143], v16 offset:6144
    ds_read_b64_tr_b16 v[112:113], v20 offset:8192
    ds_read_b64_tr_b16 v[114:115], v20 offset:9216
    ds_read_b128 v[144:147], v17 offset:0
    ds_read_b64_tr_b16 v[116:117], v21 offset:8192
    ds_read_b64_tr_b16 v[118:119], v21 offset:9216
    ds_read_b128 v[148:151], v17 offset:2048
    ds_read_b64_tr_b16 v[120:121], v22 offset:8192
    ds_read_b64_tr_b16 v[122:123], v22 offset:9216
    ds_read_b128 v[152:155], v17 offset:4096
    ds_read_b64_tr_b16 v[124:125], v23 offset:8192
    ds_read_b64_tr_b16 v[126:127], v23 offset:9216
    ds_read_b128 v[156:159], v17 offset:6144
    s_add_u32 m0, s59, 81920
    s_add_u32 s53, s55, 1048576
    buffer_load_dwordx4 v8, s[16:19], s53 offen offset:0 lds
    buffer_load_dwordx4 v9, s[16:19], s53 offen offset:1024 lds
    buffer_load_dwordx4 v10, s[16:19], s53 offen offset:2048 lds
    buffer_load_dwordx4 v11, s[16:19], s53 offen offset:3072 lds
    s_add_u32 m0, s59, 65536
    s_add_u32 s51, s54, 256
    buffer_load_dwordx4 v4, s[4:7], s51 offen offset:0 lds
    buffer_load_dwordx4 v5, s[4:7], s51 offen offset:1024 lds
    buffer_load_dwordx4 v6, s[4:7], s51 offen offset:2048 lds
    buffer_load_dwordx4 v7, s[4:7], s51 offen offset:3072 lds
    s_waitcnt vmcnt(8) lgkmcnt(0)
    s_barrier
    v_mfma_f32_16x16x32_bf16 v[32:35], v[96:99], v[128:131], 0
    s_add_u32 m0, s59, 114688
    s_add_u32 s53, s55, 1572864
    ds_read_b64_tr_b16 v[160:161], v20 offset:32768
    v_mfma_f32_16x16x32_bf16 v[36:39], v[100:103], v[128:131], 0
    ds_read_b64_tr_b16 v[162:163], v20 offset:33792
    v_mfma_f32_16x16x32_bf16 v[40:43], v[104:107], v[128:131], 0
    buffer_load_dwordx4 v8, s[16:19], s53 offen offset:0 lds
    ds_read_b128 v[192:195], v16 offset:32768
    v_mfma_f32_16x16x32_bf16 v[44:47], v[108:111], v[128:131], 0
    ds_read_b64_tr_b16 v[164:165], v21 offset:32768
    v_mfma_f32_16x16x32_bf16 v[48:51], v[96:99], v[132:135], 0
    ds_read_b64_tr_b16 v[166:167], v21 offset:33792
    v_mfma_f32_16x16x32_bf16 v[52:55], v[100:103], v[132:135], 0
    ds_read_b128 v[196:199], v16 offset:34816
    v_mfma_f32_16x16x32_bf16 v[56:59], v[104:107], v[132:135], 0
    buffer_load_dwordx4 v9, s[16:19], s53 offen offset:1024 lds
    ds_read_b64_tr_b16 v[168:169], v22 offset:32768
    v_mfma_f32_16x16x32_bf16 v[60:63], v[108:111], v[132:135], 0
    ds_read_b64_tr_b16 v[170:171], v22 offset:33792
    v_mfma_f32_16x16x32_bf16 v[64:67], v[96:99], v[136:139], 0
    ds_read_b128 v[200:203], v16 offset:36864
    v_mfma_f32_16x16x32_bf16 v[68:71], v[100:103], v[136:139], 0
    ds_read_b64_tr_b16 v[172:173], v23 offset:32768
    v_mfma_f32_16x16x32_bf16 v[72:75], v[104:107], v[136:139], 0
    buffer_load_dwordx4 v10, s[16:19], s53 offen offset:2048 lds
    ds_read_b64_tr_b16 v[174:175], v23 offset:33792
    v_mfma_f32_16x16x32_bf16 v[76:79], v[108:111], v[136:139], 0
    ds_read_b128 v[204:207], v16 offset:38912
    v_mfma_f32_16x16x32_bf16 v[80:83], v[96:99], v[140:143], 0
    ds_read_b64_tr_b16 v[176:177], v20 offset:40960
    v_mfma_f32_16x16x32_bf16 v[84:87], v[100:103], v[140:143], 0
    ds_read_b64_tr_b16 v[178:179], v20 offset:41984
    v_mfma_f32_16x16x32_bf16 v[88:91], v[104:107], v[140:143], 0
    buffer_load_dwordx4 v11, s[16:19], s53 offen offset:3072 lds
    ds_read_b128 v[208:211], v17 offset:32768
    v_mfma_f32_16x16x32_bf16 v[92:95], v[108:111], v[140:143], 0
    ds_read_b64_tr_b16 v[180:181], v21 offset:40960
    v_mfma_f32_16x16x32_bf16 v[32:35], v[112:115], v[144:147], v[32:35]
    s_add_u32 m0, s59, 98304
    s_add_u32 s51, s54, 384
    ds_read_b64_tr_b16 v[182:183], v21 offset:41984
    v_mfma_f32_16x16x32_bf16 v[36:39], v[116:119], v[144:147], v[36:39]
    ds_read_b128 v[212:215], v17 offset:34816
    v_mfma_f32_16x16x32_bf16 v[40:43], v[120:123], v[144:147], v[40:43]
    buffer_load_dwordx4 v4, s[4:7], s51 offen offset:0 lds
    ds_read_b64_tr_b16 v[184:185], v22 offset:40960
    v_mfma_f32_16x16x32_bf16 v[44:47], v[124:127], v[144:147], v[44:47]
    ds_read_b64_tr_b16 v[186:187], v22 offset:41984
    v_mfma_f32_16x16x32_bf16 v[48:51], v[112:115], v[148:151], v[48:51]
    ds_read_b128 v[216:219], v17 offset:36864
    v_mfma_f32_16x16x32_bf16 v[52:55], v[116:119], v[148:151], v[52:55]
    ds_read_b64_tr_b16 v[188:189], v23 offset:40960
    v_mfma_f32_16x16x32_bf16 v[56:59], v[120:123], v[148:151], v[56:59]
    buffer_load_dwordx4 v5, s[4:7], s51 offen offset:1024 lds
    ds_read_b64_tr_b16 v[190:191], v23 offset:41984
    v_mfma_f32_16x16x32_bf16 v[60:63], v[124:127], v[148:151], v[60:63]
    ds_read_b128 v[220:223], v17 offset:38912
    v_mfma_f32_16x16x32_bf16 v[64:67], v[112:115], v[152:155], v[64:67]
    v_mfma_f32_16x16x32_bf16 v[68:71], v[116:119], v[152:155], v[68:71]
    v_mfma_f32_16x16x32_bf16 v[72:75], v[120:123], v[152:155], v[72:75]
    buffer_load_dwordx4 v6, s[4:7], s51 offen offset:2048 lds
    v_mfma_f32_16x16x32_bf16 v[76:79], v[124:127], v[152:155], v[76:79]
    v_mfma_f32_16x16x32_bf16 v[80:83], v[112:115], v[156:159], v[80:83]
    v_mfma_f32_16x16x32_bf16 v[84:87], v[116:119], v[156:159], v[84:87]
    v_mfma_f32_16x16x32_bf16 v[88:91], v[120:123], v[156:159], v[88:91]
    buffer_load_dwordx4 v7, s[4:7], s51 offen offset:3072 lds
    v_mfma_f32_16x16x32_bf16 v[92:95], v[124:127], v[156:159], v[92:95]
    s_waitcnt vmcnt(8) lgkmcnt(0)
    s_barrier
    v_mfma_f32_16x16x32_bf16 v[32:35], v[160:163], v[192:195], v[32:35]
    s_add_u32 m0, s59, 16384
    s_add_u32 s53, s55, 2097152
    ds_read_b64_tr_b16 v[96:97], v24 offset:0
    v_mfma_f32_16x16x32_bf16 v[36:39], v[164:167], v[192:195], v[36:39]
    ds_read_b64_tr_b16 v[98:99], v24 offset:1024
    v_mfma_f32_16x16x32_bf16 v[40:43], v[168:171], v[192:195], v[40:43]
    buffer_load_dwordx4 v8, s[16:19], s53 offen offset:0 lds
    ds_read_b128 v[128:131], v18 offset:0
    v_mfma_f32_16x16x32_bf16 v[44:47], v[172:175], v[192:195], v[44:47]
    ds_read_b64_tr_b16 v[100:101], v25 offset:0
    v_mfma_f32_16x16x32_bf16 v[48:51], v[160:163], v[196:199], v[48:51]
    ds_read_b64_tr_b16 v[102:103], v25 offset:1024
    v_mfma_f32_16x16x32_bf16 v[52:55], v[164:167], v[196:199], v[52:55]
    ds_read_b128 v[132:135], v18 offset:2048
    v_mfma_f32_16x16x32_bf16 v[56:59], v[168:171], v[196:199], v[56:59]
    buffer_load_dwordx4 v9, s[16:19], s53 offen offset:1024 lds
    ds_read_b64_tr_b16 v[104:105], v26 offset:0
    v_mfma_f32_16x16x32_bf16 v[60:63], v[172:175], v[196:199], v[60:63]
    ds_read_b64_tr_b16 v[106:107], v26 offset:1024
    v_mfma_f32_16x16x32_bf16 v[64:67], v[160:163], v[200:203], v[64:67]
    ds_read_b128 v[136:139], v18 offset:4096
    v_mfma_f32_16x16x32_bf16 v[68:71], v[164:167], v[200:203], v[68:71]
    ds_read_b64_tr_b16 v[108:109], v27 offset:0
    v_mfma_f32_16x16x32_bf16 v[72:75], v[168:171], v[200:203], v[72:75]
    buffer_load_dwordx4 v10, s[16:19], s53 offen offset:2048 lds
    ds_read_b64_tr_b16 v[110:111], v27 offset:1024
    v_mfma_f32_16x16x32_bf16 v[76:79], v[172:175], v[200:203], v[76:79]
    ds_read_b128 v[140:143], v18 offset:6144
    v_mfma_f32_16x16x32_bf16 v[80:83], v[160:163], v[204:207], v[80:83]
    ds_read_b64_tr_b16 v[112:113], v24 offset:8192
    v_mfma_f32_16x16x32_bf16 v[84:87], v[164:167], v[204:207], v[84:87]
    ds_read_b64_tr_b16 v[114:115], v24 offset:9216
    v_mfma_f32_16x16x32_bf16 v[88:91], v[168:171], v[204:207], v[88:91]
    buffer_load_dwordx4 v11, s[16:19], s53 offen offset:3072 lds
    ds_read_b128 v[144:147], v19 offset:0
    v_mfma_f32_16x16x32_bf16 v[92:95], v[172:175], v[204:207], v[92:95]
    ds_read_b64_tr_b16 v[116:117], v25 offset:8192
    v_mfma_f32_16x16x32_bf16 v[32:35], v[176:179], v[208:211], v[32:35]
    s_add_u32 m0, s59, 0
    s_add_u32 s51, s54, 512
    ds_read_b64_tr_b16 v[118:119], v25 offset:9216
    v_mfma_f32_16x16x32_bf16 v[36:39], v[180:183], v[208:211], v[36:39]
    ds_read_b128 v[148:151], v19 offset:2048
    v_mfma_f32_16x16x32_bf16 v[40:43], v[184:187], v[208:211], v[40:43]
    buffer_load_dwordx4 v4, s[4:7], s51 offen offset:0 lds
    ds_read_b64_tr_b16 v[120:121], v26 offset:8192
    v_mfma_f32_16x16x32_bf16 v[44:47], v[188:191], v[208:211], v[44:47]
    ds_read_b64_tr_b16 v[122:123], v26 offset:9216
    v_mfma_f32_16x16x32_bf16 v[48:51], v[176:179], v[212:215], v[48:51]
    ds_read_b128 v[152:155], v19 offset:4096
    v_mfma_f32_16x16x32_bf16 v[52:55], v[180:183], v[212:215], v[52:55]
    ds_read_b64_tr_b16 v[124:125], v27 offset:8192
    v_mfma_f32_16x16x32_bf16 v[56:59], v[184:187], v[212:215], v[56:59]
    buffer_load_dwordx4 v5, s[4:7], s51 offen offset:1024 lds
    ds_read_b64_tr_b16 v[126:127], v27 offset:9216
    v_mfma_f32_16x16x32_bf16 v[60:63], v[188:191], v[212:215], v[60:63]
    ds_read_b128 v[156:159], v19 offset:6144
    v_mfma_f32_16x16x32_bf16 v[64:67], v[176:179], v[216:219], v[64:67]
    v_mfma_f32_16x16x32_bf16 v[68:71], v[180:183], v[216:219], v[68:71]
    v_mfma_f32_16x16x32_bf16 v[72:75], v[184:187], v[216:219], v[72:75]
    buffer_load_dwordx4 v6, s[4:7], s51 offen offset:2048 lds
    v_mfma_f32_16x16x32_bf16 v[76:79], v[188:191], v[216:219], v[76:79]
    v_mfma_f32_16x16x32_bf16 v[80:83], v[176:179], v[220:223], v[80:83]
    v_mfma_f32_16x16x32_bf16 v[84:87], v[180:183], v[220:223], v[84:87]
    v_mfma_f32_16x16x32_bf16 v[88:91], v[184:187], v[220:223], v[88:91]
    buffer_load_dwordx4 v7, s[4:7], s51 offen offset:3072 lds
    v_mfma_f32_16x16x32_bf16 v[92:95], v[188:191], v[220:223], v[92:95]
    s_waitcnt vmcnt(8) lgkmcnt(0)
    s_barrier
    v_mfma_f32_16x16x32_bf16 v[32:35], v[96:99], v[128:131], v[32:35]
    s_add_u32 m0, s59, 49152
    s_add_u32 s53, s55, 2621440
    ds_read_b64_tr_b16 v[160:161], v24 offset:32768
    v_mfma_f32_16x16x32_bf16 v[36:39], v[100:103], v[128:131], v[36:39]
    ds_read_b64_tr_b16 v[162:163], v24 offset:33792
    v_mfma_f32_16x16x32_bf16 v[40:43], v[104:107], v[128:131], v[40:43]
    buffer_load_dwordx4 v8, s[16:19], s53 offen offset:0 lds
    ds_read_b128 v[192:195], v18 offset:32768
    v_mfma_f32_16x16x32_bf16 v[44:47], v[108:111], v[128:131], v[44:47]
    ds_read_b64_tr_b16 v[164:165], v25 offset:32768
    v_mfma_f32_16x16x32_bf16 v[48:51], v[96:99], v[132:135], v[48:51]
    ds_read_b64_tr_b16 v[166:167], v25 offset:33792
    v_mfma_f32_16x16x32_bf16 v[52:55], v[100:103], v[132:135], v[52:55]
    ds_read_b128 v[196:199], v18 offset:34816
    v_mfma_f32_16x16x32_bf16 v[56:59], v[104:107], v[132:135], v[56:59]
    buffer_load_dwordx4 v9, s[16:19], s53 offen offset:1024 lds
    ds_read_b64_tr_b16 v[168:169], v26 offset:32768
    v_mfma_f32_16x16x32_bf16 v[60:63], v[108:111], v[132:135], v[60:63]
    ds_read_b64_tr_b16 v[170:171], v26 offset:33792
    v_mfma_f32_16x16x32_bf16 v[64:67], v[96:99], v[136:139], v[64:67]
    ds_read_b128 v[200:203], v18 offset:36864
    v_mfma_f32_16x16x32_bf16 v[68:71], v[100:103], v[136:139], v[68:71]
    ds_read_b64_tr_b16 v[172:173], v27 offset:32768
    v_mfma_f32_16x16x32_bf16 v[72:75], v[104:107], v[136:139], v[72:75]
    buffer_load_dwordx4 v10, s[16:19], s53 offen offset:2048 lds
    ds_read_b64_tr_b16 v[174:175], v27 offset:33792
    v_mfma_f32_16x16x32_bf16 v[76:79], v[108:111], v[136:139], v[76:79]
    ds_read_b128 v[204:207], v18 offset:38912
    v_mfma_f32_16x16x32_bf16 v[80:83], v[96:99], v[140:143], v[80:83]
    ds_read_b64_tr_b16 v[176:177], v24 offset:40960
    v_mfma_f32_16x16x32_bf16 v[84:87], v[100:103], v[140:143], v[84:87]
    ds_read_b64_tr_b16 v[178:179], v24 offset:41984
    v_mfma_f32_16x16x32_bf16 v[88:91], v[104:107], v[140:143], v[88:91]
    buffer_load_dwordx4 v11, s[16:19], s53 offen offset:3072 lds
    ds_read_b128 v[208:211], v19 offset:32768
    v_mfma_f32_16x16x32_bf16 v[92:95], v[108:111], v[140:143], v[92:95]
    ds_read_b64_tr_b16 v[180:181], v25 offset:40960
    v_mfma_f32_16x16x32_bf16 v[32:35], v[112:115], v[144:147], v[32:35]
    s_add_u32 m0, s59, 32768
    s_add_u32 s51, s54, 640
    ds_read_b64_tr_b16 v[182:183], v25 offset:41984
    v_mfma_f32_16x16x32_bf16 v[36:39], v[116:119], v[144:147], v[36:39]
    ds_read_b128 v[212:215], v19 offset:34816
    v_mfma_f32_16x16x32_bf16 v[40:43], v[120:123], v[144:147], v[40:43]
    buffer_load_dwordx4 v4, s[4:7], s51 offen offset:0 lds
    ds_read_b64_tr_b16 v[184:185], v26 offset:40960
    v_mfma_f32_16x16x32_bf16 v[44:47], v[124:127], v[144:147], v[44:47]
    ds_read_b64_tr_b16 v[186:187], v26 offset:41984
    v_mfma_f32_16x16x32_bf16 v[48:51], v[112:115], v[148:151], v[48:51]
    ds_read_b128 v[216:219], v19 offset:36864
    v_mfma_f32_16x16x32_bf16 v[52:55], v[116:119], v[148:151], v[52:55]
    ds_read_b64_tr_b16 v[188:189], v27 offset:40960
    v_mfma_f32_16x16x32_bf16 v[56:59], v[120:123], v[148:151], v[56:59]
    buffer_load_dwordx4 v5, s[4:7], s51 offen offset:1024 lds
    ds_read_b64_tr_b16 v[190:191], v27 offset:41984
    v_mfma_f32_16x16x32_bf16 v[60:63], v[124:127], v[148:151], v[60:63]
    ds_read_b128 v[220:223], v19 offset:38912
    v_mfma_f32_16x16x32_bf16 v[64:67], v[112:115], v[152:155], v[64:67]
    v_mfma_f32_16x16x32_bf16 v[68:71], v[116:119], v[152:155], v[68:71]
    v_mfma_f32_16x16x32_bf16 v[72:75], v[120:123], v[152:155], v[72:75]
    buffer_load_dwordx4 v6, s[4:7], s51 offen offset:2048 lds
    v_mfma_f32_16x16x32_bf16 v[76:79], v[124:127], v[152:155], v[76:79]
    v_mfma_f32_16x16x32_bf16 v[80:83], v[112:115], v[156:159], v[80:83]
    v_mfma_f32_16x16x32_bf16 v[84:87], v[116:119], v[156:159], v[84:87]
    v_mfma_f32_16x16x32_bf16 v[88:91], v[120:123], v[156:159], v[88:91]
    buffer_load_dwordx4 v7, s[4:7], s51 offen offset:3072 lds
    v_mfma_f32_16x16x32_bf16 v[92:95], v[124:127], v[156:159], v[92:95]
    s_waitcnt vmcnt(8) lgkmcnt(0)
    s_barrier
    v_mfma_f32_16x16x32_bf16 v[32:35], v[160:163], v[192:195], v[32:35]
    s_add_u32 m0, s59, 81920
    s_add_u32 s53, s55, 3145728
    ds_read_b64_tr_b16 v[96:97], v20 offset:0
    v_mfma_f32_16x16x32_bf16 v[36:39], v[164:167], v[192:195], v[36:39]
    ds_read_b64_tr_b16 v[98:99], v20 offset:1024
    v_mfma_f32_16x16x32_bf16 v[40:43], v[168:171], v[192:195], v[40:43]
    buffer_load_dwordx4 v8, s[16:19], s53 offen offset:0 lds
    ds_read_b128 v[128:131], v16 offset:0
    v_mfma_f32_16x16x32_bf16 v[44:47], v[172:175], v[192:195], v[44:47]
    ds_read_b64_tr_b16 v[100:101], v21 offset:0
    v_mfma_f32_16x16x32_bf16 v[48:51], v[160:163], v[196:199], v[48:51]
    ds_read_b64_tr_b16 v[102:103], v21 offset:1024
    v_mfma_f32_16x16x32_bf16 v[52:55], v[164:167], v[196:199], v[52:55]
    ds_read_b128 v[132:135], v16 offset:2048
    v_mfma_f32_16x16x32_bf16 v[56:59], v[168:171], v[196:199], v[56:59]
    buffer_load_dwordx4 v9, s[16:19], s53 offen offset:1024 lds
    ds_read_b64_tr_b16 v[104:105], v22 offset:0
    v_mfma_f32_16x16x32_bf16 v[60:63], v[172:175], v[196:199], v[60:63]
    ds_read_b64_tr_b16 v[106:107], v22 offset:1024
    v_mfma_f32_16x16x32_bf16 v[64:67], v[160:163], v[200:203], v[64:67]
    ds_read_b128 v[136:139], v16 offset:4096
    v_mfma_f32_16x16x32_bf16 v[68:71], v[164:167], v[200:203], v[68:71]
    ds_read_b64_tr_b16 v[108:109], v23 offset:0
    v_mfma_f32_16x16x32_bf16 v[72:75], v[168:171], v[200:203], v[72:75]
    buffer_load_dwordx4 v10, s[16:19], s53 offen offset:2048 lds
    ds_read_b64_tr_b16 v[110:111], v23 offset:1024
    v_mfma_f32_16x16x32_bf16 v[76:79], v[172:175], v[200:203], v[76:79]
    ds_read_b128 v[140:143], v16 offset:6144
    v_mfma_f32_16x16x32_bf16 v[80:83], v[160:163], v[204:207], v[80:83]
    ds_read_b64_tr_b16 v[112:113], v20 offset:8192
    v_mfma_f32_16x16x32_bf16 v[84:87], v[164:167], v[204:207], v[84:87]
    ds_read_b64_tr_b16 v[114:115], v20 offset:9216
    v_mfma_f32_16x16x32_bf16 v[88:91], v[168:171], v[204:207], v[88:91]
    buffer_load_dwordx4 v11, s[16:19], s53 offen offset:3072 lds
    ds_read_b128 v[144:147], v17 offset:0
    v_mfma_f32_16x16x32_bf16 v[92:95], v[172:175], v[204:207], v[92:95]
    ds_read_b64_tr_b16 v[116:117], v21 offset:8192
    v_mfma_f32_16x16x32_bf16 v[32:35], v[176:179], v[208:211], v[32:35]
    s_add_u32 m0, s59, 65536
    s_add_u32 s51, s54, 768
    ds_read_b64_tr_b16 v[118:119], v21 offset:9216
    v_mfma_f32_16x16x32_bf16 v[36:39], v[180:183], v[208:211], v[36:39]
    ds_read_b128 v[148:151], v17 offset:2048
    v_mfma_f32_16x16x32_bf16 v[40:43], v[184:187], v[208:211], v[40:43]
    buffer_load_dwordx4 v4, s[4:7], s51 offen offset:0 lds
    ds_read_b64_tr_b16 v[120:121], v22 offset:8192
    v_mfma_f32_16x16x32_bf16 v[44:47], v[188:191], v[208:211], v[44:47]
    ds_read_b64_tr_b16 v[122:123], v22 offset:9216
    v_mfma_f32_16x16x32_bf16 v[48:51], v[176:179], v[212:215], v[48:51]
    ds_read_b128 v[152:155], v17 offset:4096
    v_mfma_f32_16x16x32_bf16 v[52:55], v[180:183], v[212:215], v[52:55]
    ds_read_b64_tr_b16 v[124:125], v23 offset:8192
    v_mfma_f32_16x16x32_bf16 v[56:59], v[184:187], v[212:215], v[56:59]
    buffer_load_dwordx4 v5, s[4:7], s51 offen offset:1024 lds
    ds_read_b64_tr_b16 v[126:127], v23 offset:9216
    v_mfma_f32_16x16x32_bf16 v[60:63], v[188:191], v[212:215], v[60:63]
    ds_read_b128 v[156:159], v17 offset:6144
    v_mfma_f32_16x16x32_bf16 v[64:67], v[176:179], v[216:219], v[64:67]
    v_mfma_f32_16x16x32_bf16 v[68:71], v[180:183], v[216:219], v[68:71]
    v_mfma_f32_16x16x32_bf16 v[72:75], v[184:187], v[216:219], v[72:75]
    buffer_load_dwordx4 v6, s[4:7], s51 offen offset:2048 lds
    v_mfma_f32_16x16x32_bf16 v[76:79], v[188:191], v[216:219], v[76:79]
    v_mfma_f32_16x16x32_bf16 v[80:83], v[176:179], v[220:223], v[80:83]
    v_mfma_f32_16x16x32_bf16 v[84:87], v[180:183], v[220:223], v[84:87]
    v_mfma_f32_16x16x32_bf16 v[88:91], v[184:187], v[220:223], v[88:91]
    buffer_load_dwordx4 v7, s[4:7], s51 offen offset:3072 lds
    v_mfma_f32_16x16x32_bf16 v[92:95], v[188:191], v[220:223], v[92:95]
    s_waitcnt vmcnt(8) lgkmcnt(0)
    s_barrier
    s_load_dwordx2 s[40:41], s[32:33], 0
    v_mfma_f32_16x16x32_bf16 v[32:35], v[96:99], v[128:131], v[32:35]
    s_add_u32 m0, s59, 114688
    s_add_u32 s53, s55, 3670016
    ds_read_b64_tr_b16 v[160:161], v20 offset:32768
    v_mfma_f32_16x16x32_bf16 v[36:39], v[100:103], v[128:131], v[36:39]
    ds_read_b64_tr_b16 v[162:163], v20 offset:33792
    v_mfma_f32_16x16x32_bf16 v[40:43], v[104:107], v[128:131], v[40:43]
    buffer_load_dwordx4 v8, s[16:19], s53 offen offset:0 lds
    ds_read_b128 v[192:195], v16 offset:32768
    v_mfma_f32_16x16x32_bf16 v[44:47], v[108:111], v[128:131], v[44:47]
    ds_read_b64_tr_b16 v[164:165], v21 offset:32768
    v_mfma_f32_16x16x32_bf16 v[48:51], v[96:99], v[132:135], v[48:51]
    ds_read_b64_tr_b16 v[166:167], v21 offset:33792
    v_mfma_f32_16x16x32_bf16 v[52:55], v[100:103], v[132:135], v[52:55]
    ds_read_b128 v[196:199], v16 offset:34816
    v_mfma_f32_16x16x32_bf16 v[56:59], v[104:107], v[132:135], v[56:59]
    buffer_load_dwordx4 v9, s[16:19], s53 offen offset:1024 lds
    ds_read_b64_tr_b16 v[168:169], v22 offset:32768
    v_mfma_f32_16x16x32_bf16 v[60:63], v[108:111], v[132:135], v[60:63]
    ds_read_b64_tr_b16 v[170:171], v22 offset:33792
    v_mfma_f32_16x16x32_bf16 v[64:67], v[96:99], v[136:139], v[64:67]
    ds_read_b128 v[200:203], v16 offset:36864
    v_mfma_f32_16x16x32_bf16 v[68:71], v[100:103], v[136:139], v[68:71]
    ds_read_b64_tr_b16 v[172:173], v23 offset:32768
    v_mfma_f32_16x16x32_bf16 v[72:75], v[104:107], v[136:139], v[72:75]
    buffer_load_dwordx4 v10, s[16:19], s53 offen offset:2048 lds
    ds_read_b64_tr_b16 v[174:175], v23 offset:33792
    v_mfma_f32_16x16x32_bf16 v[76:79], v[108:111], v[136:139], v[76:79]
    ds_read_b128 v[204:207], v16 offset:38912
    v_mfma_f32_16x16x32_bf16 v[80:83], v[96:99], v[140:143], v[80:83]
    ds_read_b64_tr_b16 v[176:177], v20 offset:40960
    v_mfma_f32_16x16x32_bf16 v[84:87], v[100:103], v[140:143], v[84:87]
    ds_read_b64_tr_b16 v[178:179], v20 offset:41984
    v_mfma_f32_16x16x32_bf16 v[88:91], v[104:107], v[140:143], v[88:91]
    buffer_load_dwordx4 v11, s[16:19], s53 offen offset:3072 lds
    ds_read_b128 v[208:211], v17 offset:32768
    v_mfma_f32_16x16x32_bf16 v[92:95], v[108:111], v[140:143], v[92:95]
    ds_read_b64_tr_b16 v[180:181], v21 offset:40960
    v_mfma_f32_16x16x32_bf16 v[32:35], v[112:115], v[144:147], v[32:35]
    s_add_u32 m0, s59, 98304
    s_add_u32 s51, s54, 896
    ds_read_b64_tr_b16 v[182:183], v21 offset:41984
    v_mfma_f32_16x16x32_bf16 v[36:39], v[116:119], v[144:147], v[36:39]
    ds_read_b128 v[212:215], v17 offset:34816
    v_mfma_f32_16x16x32_bf16 v[40:43], v[120:123], v[144:147], v[40:43]
    buffer_load_dwordx4 v4, s[4:7], s51 offen offset:0 lds
    ds_read_b64_tr_b16 v[184:185], v22 offset:40960
    v_mfma_f32_16x16x32_bf16 v[44:47], v[124:127], v[144:147], v[44:47]
    ds_read_b64_tr_b16 v[186:187], v22 offset:41984
    v_mfma_f32_16x16x32_bf16 v[48:51], v[112:115], v[148:151], v[48:51]
    ds_read_b128 v[216:219], v17 offset:36864
    v_mfma_f32_16x16x32_bf16 v[52:55], v[116:119], v[148:151], v[52:55]
    ds_read_b64_tr_b16 v[188:189], v23 offset:40960
    v_mfma_f32_16x16x32_bf16 v[56:59], v[120:123], v[148:151], v[56:59]
    buffer_load_dwordx4 v5, s[4:7], s51 offen offset:1024 lds
    ds_read_b64_tr_b16 v[190:191], v23 offset:41984
    v_mfma_f32_16x16x32_bf16 v[60:63], v[124:127], v[148:151], v[60:63]
    ds_read_b128 v[220:223], v17 offset:38912
    v_mfma_f32_16x16x32_bf16 v[64:67], v[112:115], v[152:155], v[64:67]
    v_mfma_f32_16x16x32_bf16 v[68:71], v[116:119], v[152:155], v[68:71]
    v_mfma_f32_16x16x32_bf16 v[72:75], v[120:123], v[152:155], v[72:75]
    buffer_load_dwordx4 v6, s[4:7], s51 offen offset:2048 lds
    v_mfma_f32_16x16x32_bf16 v[76:79], v[124:127], v[152:155], v[76:79]
    v_mfma_f32_16x16x32_bf16 v[80:83], v[112:115], v[156:159], v[80:83]
    v_mfma_f32_16x16x32_bf16 v[84:87], v[116:119], v[156:159], v[84:87]
    v_mfma_f32_16x16x32_bf16 v[88:91], v[120:123], v[156:159], v[88:91]
    buffer_load_dwordx4 v7, s[4:7], s51 offen offset:3072 lds
    v_mfma_f32_16x16x32_bf16 v[92:95], v[124:127], v[156:159], v[92:95]
    s_waitcnt vmcnt(8) lgkmcnt(0)
    s_barrier
    v_mfma_f32_16x16x32_bf16 v[32:35], v[160:163], v[192:195], v[32:35]
    s_add_u32 m0, s59, 16384
    s_add_u32 s53, s55, 4194304
    ds_read_b64_tr_b16 v[96:97], v24 offset:0
    v_mfma_f32_16x16x32_bf16 v[36:39], v[164:167], v[192:195], v[36:39]
    ds_read_b64_tr_b16 v[98:99], v24 offset:1024
    v_mfma_f32_16x16x32_bf16 v[40:43], v[168:171], v[192:195], v[40:43]
    buffer_load_dwordx4 v8, s[16:19], s53 offen offset:0 lds
    ds_read_b128 v[128:131], v18 offset:0
    v_mfma_f32_16x16x32_bf16 v[44:47], v[172:175], v[192:195], v[44:47]
    ds_read_b64_tr_b16 v[100:101], v25 offset:0
    v_mfma_f32_16x16x32_bf16 v[48:51], v[160:163], v[196:199], v[48:51]
    ds_read_b64_tr_b16 v[102:103], v25 offset:1024
    v_mfma_f32_16x16x32_bf16 v[52:55], v[164:167], v[196:199], v[52:55]
    ds_read_b128 v[132:135], v18 offset:2048
    v_mfma_f32_16x16x32_bf16 v[56:59], v[168:171], v[196:199], v[56:59]
    buffer_load_dwordx4 v9, s[16:19], s53 offen offset:1024 lds
    ds_read_b64_tr_b16 v[104:105], v26 offset:0
    v_mfma_f32_16x16x32_bf16 v[60:63], v[172:175], v[196:199], v[60:63]
    ds_read_b64_tr_b16 v[106:107], v26 offset:1024
    v_mfma_f32_16x16x32_bf16 v[64:67], v[160:163], v[200:203], v[64:67]
    ds_read_b128 v[136:139], v18 offset:4096
    v_mfma_f32_16x16x32_bf16 v[68:71], v[164:167], v[200:203], v[68:71]
    ds_read_b64_tr_b16 v[108:109], v27 offset:0
    v_mfma_f32_16x16x32_bf16 v[72:75], v[168:171], v[200:203], v[72:75]
    buffer_load_dwordx4 v10, s[16:19], s53 offen offset:2048 lds
    ds_read_b64_tr_b16 v[110:111], v27 offset:1024
    v_mfma_f32_16x16x32_bf16 v[76:79], v[172:175], v[200:203], v[76:79]
    ds_read_b128 v[140:143], v18 offset:6144
    v_mfma_f32_16x16x32_bf16 v[80:83], v[160:163], v[204:207], v[80:83]
    ds_read_b64_tr_b16 v[112:113], v24 offset:8192
    v_mfma_f32_16x16x32_bf16 v[84:87], v[164:167], v[204:207], v[84:87]
    ds_read_b64_tr_b16 v[114:115], v24 offset:9216
    v_mfma_f32_16x16x32_bf16 v[88:91], v[168:171], v[204:207], v[88:91]
    buffer_load_dwordx4 v11, s[16:19], s53 offen offset:3072 lds
    ds_read_b128 v[144:147], v19 offset:0
    v_mfma_f32_16x16x32_bf16 v[92:95], v[172:175], v[204:207], v[92:95]
    ds_read_b64_tr_b16 v[116:117], v25 offset:8192
    v_mfma_f32_16x16x32_bf16 v[32:35], v[176:179], v[208:211], v[32:35]
    s_add_u32 m0, s59, 0
    s_add_u32 s51, s54, 1024
    ds_read_b64_tr_b16 v[118:119], v25 offset:9216
    v_mfma_f32_16x16x32_bf16 v[36:39], v[180:183], v[208:211], v[36:39]
    ds_read_b128 v[148:151], v19 offset:2048
    v_mfma_f32_16x16x32_bf16 v[40:43], v[184:187], v[208:211], v[40:43]
    buffer_load_dwordx4 v4, s[4:7], s51 offen offset:0 lds
    ds_read_b64_tr_b16 v[120:121], v26 offset:8192
    v_mfma_f32_16x16x32_bf16 v[44:47], v[188:191], v[208:211], v[44:47]
    ds_read_b64_tr_b16 v[122:123], v26 offset:9216
    v_mfma_f32_16x16x32_bf16 v[48:51], v[176:179], v[212:215], v[48:51]
    ds_read_b128 v[152:155], v19 offset:4096
    v_mfma_f32_16x16x32_bf16 v[52:55], v[180:183], v[212:215], v[52:55]
    ds_read_b64_tr_b16 v[124:125], v27 offset:8192
    v_mfma_f32_16x16x32_bf16 v[56:59], v[184:187], v[212:215], v[56:59]
    buffer_load_dwordx4 v5, s[4:7], s51 offen offset:1024 lds
    ds_read_b64_tr_b16 v[126:127], v27 offset:9216
    v_mfma_f32_16x16x32_bf16 v[60:63], v[188:191], v[212:215], v[60:63]
    ds_read_b128 v[156:159], v19 offset:6144
    v_mfma_f32_16x16x32_bf16 v[64:67], v[176:179], v[216:219], v[64:67]
    v_mfma_f32_16x16x32_bf16 v[68:71], v[180:183], v[216:219], v[68:71]
    v_mfma_f32_16x16x32_bf16 v[72:75], v[184:187], v[216:219], v[72:75]
    buffer_load_dwordx4 v6, s[4:7], s51 offen offset:2048 lds
    v_mfma_f32_16x16x32_bf16 v[76:79], v[188:191], v[216:219], v[76:79]
    v_mfma_f32_16x16x32_bf16 v[80:83], v[176:179], v[220:223], v[80:83]
    v_mfma_f32_16x16x32_bf16 v[84:87], v[180:183], v[220:223], v[84:87]
    v_mfma_f32_16x16x32_bf16 v[88:91], v[184:187], v[220:223], v[88:91]
    buffer_load_dwordx4 v7, s[4:7], s51 offen offset:3072 lds
    v_mfma_f32_16x16x32_bf16 v[92:95], v[188:191], v[220:223], v[92:95]
    s_waitcnt vmcnt(8) lgkmcnt(0)
    s_barrier
    s_waitcnt lgkmcnt(0)
    s_and_b32 s63, s40, 1
    s_lshr_b32 s64, s41, 31
    s_and_b32 s63, s63, s64
    s_cbranch_scc1 Lp_ngx
    v_mov_b32 v30, 0
    s_mov_b32 s62, 0
Lp_ng:
    global_load_dwordx2 v[28:29], v30, s[32:33] sc1
    s_add_u32 s62, s62, 1
    s_waitcnt vmcnt(0)
    v_readfirstlane_b32 s40, v28
    v_readfirstlane_b32 s41, v29
    s_cmp_ge_u32 s62, 2097152
    s_cbranch_scc1 Lp_ngx
    s_and_b32 s63, s40, 1
    s_lshr_b32 s64, s41, 31
    s_and_b32 s63, s63, s64
    s_cbranch_scc0 Lp_ng
Lp_ngx:
    s_getreg_b32 s3, hwreg(HW_REG_XCC_ID, 0, 4)
    s_xor_b32 s3, s3, s41
    s_lshl_b32 s62, s35, 5
    s_add_u32 s62, s62, s36
    s_lshl_b32 s62, s62, 3
    s_add_u32 s62, s62, 23101440
    v_mov_b32 v28, s40
    v_mov_b32 v29, s3
    s_mov_b64 exec, 1
    buffer_store_dwordx2 v[28:29], off, s[28:31], s62
    s_mov_b64 exec, -1
    v_mfma_f32_16x16x32_bf16 v[32:35], v[96:99], v[128:131], v[32:35]
    s_add_u32 m0, s59, 49152
    s_add_u32 s53, s55, 4718592
    ds_read_b64_tr_b16 v[160:161], v24 offset:32768
    v_mfma_f32_16x16x32_bf16 v[36:39], v[100:103], v[128:131], v[36:39]
    ds_read_b64_tr_b16 v[162:163], v24 offset:33792
    v_mfma_f32_16x16x32_bf16 v[40:43], v[104:107], v[128:131], v[40:43]
    buffer_load_dwordx4 v8, s[16:19], s53 offen offset:0 lds
    ds_read_b128 v[192:195], v18 offset:32768
    v_mfma_f32_16x16x32_bf16 v[44:47], v[108:111], v[128:131], v[44:47]
    ds_read_b64_tr_b16 v[164:165], v25 offset:32768
    v_mfma_f32_16x16x32_bf16 v[48:51], v[96:99], v[132:135], v[48:51]
    ds_read_b64_tr_b16 v[166:167], v25 offset:33792
    v_mfma_f32_16x16x32_bf16 v[52:55], v[100:103], v[132:135], v[52:55]
    ds_read_b128 v[196:199], v18 offset:34816
    v_mfma_f32_16x16x32_bf16 v[56:59], v[104:107], v[132:135], v[56:59]
    buffer_load_dwordx4 v9, s[16:19], s53 offen offset:1024 lds
    ds_read_b64_tr_b16 v[168:169], v26 offset:32768
    v_mfma_f32_16x16x32_bf16 v[60:63], v[108:111], v[132:135], v[60:63]
    ds_read_b64_tr_b16 v[170:171], v26 offset:33792
    v_mfma_f32_16x16x32_bf16 v[64:67], v[96:99], v[136:139], v[64:67]
    ds_read_b128 v[200:203], v18 offset:36864
    v_mfma_f32_16x16x32_bf16 v[68:71], v[100:103], v[136:139], v[68:71]
    ds_read_b64_tr_b16 v[172:173], v27 offset:32768
    v_mfma_f32_16x16x32_bf16 v[72:75], v[104:107], v[136:139], v[72:75]
    buffer_load_dwordx4 v10, s[16:19], s53 offen offset:2048 lds
    ds_read_b64_tr_b16 v[174:175], v27 offset:33792
    v_mfma_f32_16x16x32_bf16 v[76:79], v[108:111], v[136:139], v[76:79]
    ds_read_b128 v[204:207], v18 offset:38912
    v_mfma_f32_16x16x32_bf16 v[80:83], v[96:99], v[140:143], v[80:83]
    ds_read_b64_tr_b16 v[176:177], v24 offset:40960
    v_mfma_f32_16x16x32_bf16 v[84:87], v[100:103], v[140:143], v[84:87]
    ds_read_b64_tr_b16 v[178:179], v24 offset:41984
    v_mfma_f32_16x16x32_bf16 v[88:91], v[104:107], v[140:143], v[88:91]
    buffer_load_dwordx4 v11, s[16:19], s53 offen offset:3072 lds
    ds_read_b128 v[208:211], v19 offset:32768
    v_mfma_f32_16x16x32_bf16 v[92:95], v[108:111], v[140:143], v[92:95]
    ds_read_b64_tr_b16 v[180:181], v25 offset:40960
    v_mfma_f32_16x16x32_bf16 v[32:35], v[112:115], v[144:147], v[32:35]
    s_add_u32 m0, s59, 32768
    s_add_u32 s51, s54, 1152
    ds_read_b64_tr_b16 v[182:183], v25 offset:41984
    v_mfma_f32_16x16x32_bf16 v[36:39], v[116:119], v[144:147], v[36:39]
    ds_read_b128 v[212:215], v19 offset:34816
    v_mfma_f32_16x16x32_bf16 v[40:43], v[120:123], v[144:147], v[40:43]
    buffer_load_dwordx4 v4, s[4:7], s51 offen offset:0 lds
    ds_read_b64_tr_b16 v[184:185], v26 offset:40960
    v_mfma_f32_16x16x32_bf16 v[44:47], v[124:127], v[144:147], v[44:47]
    ds_read_b64_tr_b16 v[186:187], v26 offset:41984
    v_mfma_f32_16x16x32_bf16 v[48:51], v[112:115], v[148:151], v[48:51]
    ds_read_b128 v[216:219], v19 offset:36864
    v_mfma_f32_16x16x32_bf16 v[52:55], v[116:119], v[148:151], v[52:55]
    ds_read_b64_tr_b16 v[188:189], v27 offset:40960
    v_mfma_f32_16x16x32_bf16 v[56:59], v[120:123], v[148:151], v[56:59]
    buffer_load_dwordx4 v5, s[4:7], s51 offen offset:1024 lds
    ds_read_b64_tr_b16 v[190:191], v27 offset:41984
    v_mfma_f32_16x16x32_bf16 v[60:63], v[124:127], v[148:151], v[60:63]
    ds_read_b128 v[220:223], v19 offset:38912
    v_mfma_f32_16x16x32_bf16 v[64:67], v[112:115], v[152:155], v[64:67]
    v_mfma_f32_16x16x32_bf16 v[68:71], v[116:119], v[152:155], v[68:71]
    v_mfma_f32_16x16x32_bf16 v[72:75], v[120:123], v[152:155], v[72:75]
    buffer_load_dwordx4 v6, s[4:7], s51 offen offset:2048 lds
    v_mfma_f32_16x16x32_bf16 v[76:79], v[124:127], v[152:155], v[76:79]
    v_mfma_f32_16x16x32_bf16 v[80:83], v[112:115], v[156:159], v[80:83]
    v_mfma_f32_16x16x32_bf16 v[84:87], v[116:119], v[156:159], v[84:87]
    v_mfma_f32_16x16x32_bf16 v[88:91], v[120:123], v[156:159], v[88:91]
    buffer_load_dwordx4 v7, s[4:7], s51 offen offset:3072 lds
    v_mfma_f32_16x16x32_bf16 v[92:95], v[124:127], v[156:159], v[92:95]
    s_waitcnt vmcnt(9) lgkmcnt(0)
    s_barrier
    v_mfma_f32_16x16x32_bf16 v[32:35], v[160:163], v[192:195], v[32:35]
    s_add_u32 m0, s59, 81920
    s_add_u32 s53, s55, 5242880
    ds_read_b64_tr_b16 v[96:97], v20 offset:0
    v_mfma_f32_16x16x32_bf16 v[36:39], v[164:167], v[192:195], v[36:39]
    ds_read_b64_tr_b16 v[98:99], v20 offset:1024
    v_mfma_f32_16x16x32_bf16 v[40:43], v[168:171], v[192:195], v[40:43]
    buffer_load_dwordx4 v8, s[16:19], s53 offen offset:0 lds
    ds_read_b128 v[128:131], v16 offset:0
    v_mfma_f32_16x16x32_bf16 v[44:47], v[172:175], v[192:195], v[44:47]
    ds_read_b64_tr_b16 v[100:101], v21 offset:0
    v_mfma_f32_16x16x32_bf16 v[48:51], v[160:163], v[196:199], v[48:51]
    ds_read_b64_tr_b16 v[102:103], v21 offset:1024
    v_mfma_f32_16x16x32_bf16 v[52:55], v[164:167], v[196:199], v[52:55]
    ds_read_b128 v[132:135], v16 offset:2048
    v_mfma_f32_16x16x32_bf16 v[56:59], v[168:171], v[196:199], v[56:59]
    buffer_load_dwordx4 v9, s[16:19], s53 offen offset:1024 lds
    ds_read_b64_tr_b16 v[104:105], v22 offset:0
    v_mfma_f32_16x16x32_bf16 v[60:63], v[172:175], v[196:199], v[60:63]
    ds_read_b64_tr_b16 v[106:107], v22 offset:1024
    v_mfma_f32_16x16x32_bf16 v[64:67], v[160:163], v[200:203], v[64:67]
    ds_read_b128 v[136:139], v16 offset:4096
    v_mfma_f32_16x16x32_bf16 v[68:71], v[164:167], v[200:203], v[68:71]
    ds_read_b64_tr_b16 v[108:109], v23 offset:0
    v_mfma_f32_16x16x32_bf16 v[72:75], v[168:171], v[200:203], v[72:75]
    buffer_load_dwordx4 v10, s[16:19], s53 offen offset:2048 lds
    ds_read_b64_tr_b16 v[110:111], v23 offset:1024
    v_mfma_f32_16x16x32_bf16 v[76:79], v[172:175], v[200:203], v[76:79]
    ds_read_b128 v[140:143], v16 offset:6144
    v_mfma_f32_16x16x32_bf16 v[80:83], v[160:163], v[204:207], v[80:83]
    ds_read_b64_tr_b16 v[112:113], v20 offset:8192
    v_mfma_f32_16x16x32_bf16 v[84:87], v[164:167], v[204:207], v[84:87]
    ds_read_b64_tr_b16 v[114:115], v20 offset:9216
    v_mfma_f32_16x16x32_bf16 v[88:91], v[168:171], v[204:207], v[88:91]
    buffer_load_dwordx4 v11, s[16:19], s53 offen offset:3072 lds
    ds_read_b128 v[144:147], v17 offset:0
    v_mfma_f32_16x16x32_bf16 v[92:95], v[172:175], v[204:207], v[92:95]
    ds_read_b64_tr_b16 v[116:117], v21 offset:8192
    v_mfma_f32_16x16x32_bf16 v[32:35], v[176:179], v[208:211], v[32:35]
    s_add_u32 m0, s59, 65536
    s_add_u32 s51, s54, 1280
    ds_read_b64_tr_b16 v[118:119], v21 offset:9216
    v_mfma_f32_16x16x32_bf16 v[36:39], v[180:183], v[208:211], v[36:39]
    ds_read_b128 v[148:151], v17 offset:2048
    v_mfma_f32_16x16x32_bf16 v[40:43], v[184:187], v[208:211], v[40:43]
    buffer_load_dwordx4 v4, s[4:7], s51 offen offset:0 lds
    ds_read_b64_tr_b16 v[120:121], v22 offset:8192
    v_mfma_f32_16x16x32_bf16 v[44:47], v[188:191], v[208:211], v[44:47]
    ds_read_b64_tr_b16 v[122:123], v22 offset:9216
    v_mfma_f32_16x16x32_bf16 v[48:51], v[176:179], v[212:215], v[48:51]
    ds_read_b128 v[152:155], v17 offset:4096
    v_mfma_f32_16x16x32_bf16 v[52:55], v[180:183], v[212:215], v[52:55]
    ds_read_b64_tr_b16 v[124:125], v23 offset:8192
    v_mfma_f32_16x16x32_bf16 v[56:59], v[184:187], v[212:215], v[56:59]
    buffer_load_dwordx4 v5, s[4:7], s51 offen offset:1024 lds
    ds_read_b64_tr_b16 v[126:127], v23 offset:9216
    v_mfma_f32_16x16x32_bf16 v[60:63], v[188:191], v[212:215], v[60:63]
    ds_read_b128 v[156:159], v17 offset:6144
    v_mfma_f32_16x16x32_bf16 v[64:67], v[176:179], v[216:219], v[64:67]
    v_mfma_f32_16x16x32_bf16 v[68:71], v[180:183], v[216:219], v[68:71]
    v_mfma_f32_16x16x32_bf16 v[72:75], v[184:187], v[216:219], v[72:75]
    buffer_load_dwordx4 v6, s[4:7], s51 offen offset:2048 lds
    v_mfma_f32_16x16x32_bf16 v[76:79], v[188:191], v[216:219], v[76:79]
    v_mfma_f32_16x16x32_bf16 v[80:83], v[176:179], v[220:223], v[80:83]
    v_mfma_f32_16x16x32_bf16 v[84:87], v[180:183], v[220:223], v[84:87]
    v_mfma_f32_16x16x32_bf16 v[88:91], v[184:187], v[220:223], v[88:91]
    buffer_load_dwordx4 v7, s[4:7], s51 offen offset:3072 lds
    v_mfma_f32_16x16x32_bf16 v[92:95], v[188:191], v[220:223], v[92:95]
    s_waitcnt vmcnt(8) lgkmcnt(0)
    s_barrier
    v_mfma_f32_16x16x32_bf16 v[32:35], v[96:99], v[128:131], v[32:35]
    s_add_u32 m0, s59, 114688
    s_add_u32 s53, s55, 5767168
    ds_read_b64_tr_b16 v[160:161], v20 offset:32768
    v_mfma_f32_16x16x32_bf16 v[36:39], v[100:103], v[128:131], v[36:39]
    ds_read_b64_tr_b16 v[162:163], v20 offset:33792
    v_mfma_f32_16x16x32_bf16 v[40:43], v[104:107], v[128:131], v[40:43]
    buffer_load_dwordx4 v8, s[16:19], s53 offen offset:0 lds
    ds_read_b128 v[192:195], v16 offset:32768
    v_mfma_f32_16x16x32_bf16 v[44:47], v[108:111], v[128:131], v[44:47]
    ds_read_b64_tr_b16 v[164:165], v21 offset:32768
    v_mfma_f32_16x16x32_bf16 v[48:51], v[96:99], v[132:135], v[48:51]
    ds_read_b64_tr_b16 v[166:167], v21 offset:33792
    v_mfma_f32_16x16x32_bf16 v[52:55], v[100:103], v[132:135], v[52:55]
    ds_read_b128 v[196:199], v16 offset:34816
    v_mfma_f32_16x16x32_bf16 v[56:59], v[104:107], v[132:135], v[56:59]
    buffer_load_dwordx4 v9, s[16:19], s53 offen offset:1024 lds
    ds_read_b64_tr_b16 v[168:169], v22 offset:32768
    v_mfma_f32_16x16x32_bf16 v[60:63], v[108:111], v[132:135], v[60:63]
    ds_read_b64_tr_b16 v[170:171], v22 offset:33792
    v_mfma_f32_16x16x32_bf16 v[64:67], v[96:99], v[136:139], v[64:67]
    ds_read_b128 v[200:203], v16 offset:36864
    v_mfma_f32_16x16x32_bf16 v[68:71], v[100:103], v[136:139], v[68:71]
    ds_read_b64_tr_b16 v[172:173], v23 offset:32768
    v_mfma_f32_16x16x32_bf16 v[72:75], v[104:107], v[136:139], v[72:75]
    buffer_load_dwordx4 v10, s[16:19], s53 offen offset:2048 lds
    ds_read_b64_tr_b16 v[174:175], v23 offset:33792
    v_mfma_f32_16x16x32_bf16 v[76:79], v[108:111], v[136:139], v[76:79]
    ds_read_b128 v[204:207], v16 offset:38912
    v_mfma_f32_16x16x32_bf16 v[80:83], v[96:99], v[140:143], v[80:83]
    ds_read_b64_tr_b16 v[176:177], v20 offset:40960
    v_mfma_f32_16x16x32_bf16 v[84:87], v[100:103], v[140:143], v[84:87]
    ds_read_b64_tr_b16 v[178:179], v20 offset:41984
    v_mfma_f32_16x16x32_bf16 v[88:91], v[104:107], v[140:143], v[88:91]
    buffer_load_dwordx4 v11, s[16:19], s53 offen offset:3072 lds
    ds_read_b128 v[208:211], v17 offset:32768
    v_mfma_f32_16x16x32_bf16 v[92:95], v[108:111], v[140:143], v[92:95]
    ds_read_b64_tr_b16 v[180:181], v21 offset:40960
    v_mfma_f32_16x16x32_bf16 v[32:35], v[112:115], v[144:147], v[32:35]
    s_add_u32 m0, s59, 98304
    s_add_u32 s51, s54, 1408
    ds_read_b64_tr_b16 v[182:183], v21 offset:41984
    v_mfma_f32_16x16x32_bf16 v[36:39], v[116:119], v[144:147], v[36:39]
    ds_read_b128 v[212:215], v17 offset:34816
    v_mfma_f32_16x16x32_bf16 v[40:43], v[120:123], v[144:147], v[40:43]
    buffer_load_dwordx4 v4, s[4:7], s51 offen offset:0 lds
    ds_read_b64_tr_b16 v[184:185], v22 offset:40960
    v_mfma_f32_16x16x32_bf16 v[44:47], v[124:127], v[144:147], v[44:47]
    ds_read_b64_tr_b16 v[186:187], v22 offset:41984
    v_mfma_f32_16x16x32_bf16 v[48:51], v[112:115], v[148:151], v[48:51]
    ds_read_b128 v[216:219], v17 offset:36864
    v_mfma_f32_16x16x32_bf16 v[52:55], v[116:119], v[148:151], v[52:55]
    ds_read_b64_tr_b16 v[188:189], v23 offset:40960
    v_mfma_f32_16x16x32_bf16 v[56:59], v[120:123], v[148:151], v[56:59]
    buffer_load_dwordx4 v5, s[4:7], s51 offen offset:1024 lds
    ds_read_b64_tr_b16 v[190:191], v23 offset:41984
    v_mfma_f32_16x16x32_bf16 v[60:63], v[124:127], v[148:151], v[60:63]
    ds_read_b128 v[220:223], v17 offset:38912
    v_mfma_f32_16x16x32_bf16 v[64:67], v[112:115], v[152:155], v[64:67]
    v_mfma_f32_16x16x32_bf16 v[68:71], v[116:119], v[152:155], v[68:71]
    v_mfma_f32_16x16x32_bf16 v[72:75], v[120:123], v[152:155], v[72:75]
    buffer_load_dwordx4 v6, s[4:7], s51 offen offset:2048 lds
    v_mfma_f32_16x16x32_bf16 v[76:79], v[124:127], v[152:155], v[76:79]
    v_mfma_f32_16x16x32_bf16 v[80:83], v[112:115], v[156:159], v[80:83]
    v_mfma_f32_16x16x32_bf16 v[84:87], v[116:119], v[156:159], v[84:87]
    v_mfma_f32_16x16x32_bf16 v[88:91], v[120:123], v[156:159], v[88:91]
    buffer_load_dwordx4 v7, s[4:7], s51 offen offset:3072 lds
    v_mfma_f32_16x16x32_bf16 v[92:95], v[124:127], v[156:159], v[92:95]
    s_waitcnt vmcnt(8) lgkmcnt(0)
    s_barrier
    v_mfma_f32_16x16x32_bf16 v[32:35], v[160:163], v[192:195], v[32:35]
    s_add_u32 m0, s59, 16384
    s_add_u32 s53, s55, 6291456
    ds_read_b64_tr_b16 v[96:97], v24 offset:0
    v_mfma_f32_16x16x32_bf16 v[36:39], v[164:167], v[192:195], v[36:39]
    ds_read_b64_tr_b16 v[98:99], v24 offset:1024
    v_mfma_f32_16x16x32_bf16 v[40:43], v[168:171], v[192:195], v[40:43]
    buffer_load_dwordx4 v8, s[16:19], s53 offen offset:0 lds
    ds_read_b128 v[128:131], v18 offset:0
    v_mfma_f32_16x16x32_bf16 v[44:47], v[172:175], v[192:195], v[44:47]
    ds_read_b64_tr_b16 v[100:101], v25 offset:0
    v_mfma_f32_16x16x32_bf16 v[48:51], v[160:163], v[196:199], v[48:51]
    ds_read_b64_tr_b16 v[102:103], v25 offset:1024
    v_mfma_f32_16x16x32_bf16 v[52:55], v[164:167], v[196:199], v[52:55]
    ds_read_b128 v[132:135], v18 offset:2048
    v_mfma_f32_16x16x32_bf16 v[56:59], v[168:171], v[196:199], v[56:59]
    buffer_load_dwordx4 v9, s[16:19], s53 offen offset:1024 lds
    ds_read_b64_tr_b16 v[104:105], v26 offset:0
    v_mfma_f32_16x16x32_bf16 v[60:63], v[172:175], v[196:199], v[60:63]
    ds_read_b64_tr_b16 v[106:107], v26 offset:1024
    v_mfma_f32_16x16x32_bf16 v[64:67], v[160:163], v[200:203], v[64:67]
    ds_read_b128 v[136:139], v18 offset:4096
    v_mfma_f32_16x16x32_bf16 v[68:71], v[164:167], v[200:203], v[68:71]
    ds_read_b64_tr_b16 v[108:109], v27 offset:0
    v_mfma_f32_16x16x32_bf16 v[72:75], v[168:171], v[200:203], v[72:75]
    buffer_load_dwordx4 v10, s[16:19], s53 offen offset:2048 lds
    ds_read_b64_tr_b16 v[110:111], v27 offset:1024
    v_mfma_f32_16x16x32_bf16 v[76:79], v[172:175], v[200:203], v[76:79]
    ds_read_b128 v[140:143], v18 offset:6144
    v_mfma_f32_16x16x32_bf16 v[80:83], v[160:163], v[204:207], v[80:83]
    ds_read_b64_tr_b16 v[112:113], v24 offset:8192
    v_mfma_f32_16x16x32_bf16 v[84:87], v[164:167], v[204:207], v[84:87]
    ds_read_b64_tr_b16 v[114:115], v24 offset:9216
    v_mfma_f32_16x16x32_bf16 v[88:91], v[168:171], v[204:207], v[88:91]
    buffer_load_dwordx4 v11, s[16:19], s53 offen offset:3072 lds
    ds_read_b128 v[144:147], v19 offset:0
    v_mfma_f32_16x16x32_bf16 v[92:95], v[172:175], v[204:207], v[92:95]
    ds_read_b64_tr_b16 v[116:117], v25 offset:8192
    v_mfma_f32_16x16x32_bf16 v[32:35], v[176:179], v[208:211], v[32:35]
    s_add_u32 m0, s59, 0
    s_add_u32 s51, s54, 1536
    ds_read_b64_tr_b16 v[118:119], v25 offset:9216
    v_mfma_f32_16x16x32_bf16 v[36:39], v[180:183], v[208:211], v[36:39]
    ds_read_b128 v[148:151], v19 offset:2048
    v_mfma_f32_16x16x32_bf16 v[40:43], v[184:187], v[208:211], v[40:43]
    buffer_load_dwordx4 v4, s[4:7], s51 offen offset:0 lds
    ds_read_b64_tr_b16 v[120:121], v26 offset:8192
    v_mfma_f32_16x16x32_bf16 v[44:47], v[188:191], v[208:211], v[44:47]
    ds_read_b64_tr_b16 v[122:123], v26 offset:9216
    v_mfma_f32_16x16x32_bf16 v[48:51], v[176:179], v[212:215], v[48:51]
    ds_read_b128 v[152:155], v19 offset:4096
    v_mfma_f32_16x16x32_bf16 v[52:55], v[180:183], v[212:215], v[52:55]
    ds_read_b64_tr_b16 v[124:125], v27 offset:8192
    v_mfma_f32_16x16x32_bf16 v[56:59], v[184:187], v[212:215], v[56:59]
    buffer_load_dwordx4 v5, s[4:7], s51 offen offset:1024 lds
    ds_read_b64_tr_b16 v[126:127], v27 offset:9216
    v_mfma_f32_16x16x32_bf16 v[60:63], v[188:191], v[212:215], v[60:63]
    ds_read_b128 v[156:159], v19 offset:6144
    v_mfma_f32_16x16x32_bf16 v[64:67], v[176:179], v[216:219], v[64:67]
    v_mfma_f32_16x16x32_bf16 v[68:71], v[180:183], v[216:219], v[68:71]
    v_mfma_f32_16x16x32_bf16 v[72:75], v[184:187], v[216:219], v[72:75]
    buffer_load_dwordx4 v6, s[4:7], s51 offen offset:2048 lds
    v_mfma_f32_16x16x32_bf16 v[76:79], v[188:191], v[216:219], v[76:79]
    v_mfma_f32_16x16x32_bf16 v[80:83], v[176:179], v[220:223], v[80:83]
    v_mfma_f32_16x16x32_bf16 v[84:87], v[180:183], v[220:223], v[84:87]
    v_mfma_f32_16x16x32_bf16 v[88:91], v[184:187], v[220:223], v[88:91]
    buffer_load_dwordx4 v7, s[4:7], s51 offen offset:3072 lds
    v_mfma_f32_16x16x32_bf16 v[92:95], v[188:191], v[220:223], v[92:95]
    s_waitcnt vmcnt(8) lgkmcnt(0)
    s_barrier
    v_mfma_f32_16x16x32_bf16 v[32:35], v[96:99], v[128:131], v[32:35]
    s_add_u32 m0, s59, 49152
    s_add_u32 s53, s55, 6815744
    ds_read_b64_tr_b16 v[160:161], v24 offset:32768
    v_mfma_f32_16x16x32_bf16 v[36:39], v[100:103], v[128:131], v[36:39]
    ds_read_b64_tr_b16 v[162:163], v24 offset:33792
    v_mfma_f32_16x16x32_bf16 v[40:43], v[104:107], v[128:131], v[40:43]
    buffer_load_dwordx4 v8, s[16:19], s53 offen offset:0 lds
    ds_read_b128 v[192:195], v18 offset:32768
    v_mfma_f32_16x16x32_bf16 v[44:47], v[108:111], v[128:131], v[44:47]
    ds_read_b64_tr_b16 v[164:165], v25 offset:32768
    v_mfma_f32_16x16x32_bf16 v[48:51], v[96:99], v[132:135], v[48:51]
    ds_read_b64_tr_b16 v[166:167], v25 offset:33792
    v_mfma_f32_16x16x32_bf16 v[52:55], v[100:103], v[132:135], v[52:55]
    ds_read_b128 v[196:199], v18 offset:34816
    v_mfma_f32_16x16x32_bf16 v[56:59], v[104:107], v[132:135], v[56:59]
    buffer_load_dwordx4 v9, s[16:19], s53 offen offset:1024 lds
    ds_read_b64_tr_b16 v[168:169], v26 offset:32768
    v_mfma_f32_16x16x32_bf16 v[60:63], v[108:111], v[132:135], v[60:63]
    ds_read_b64_tr_b16 v[170:171], v26 offset:33792
    v_mfma_f32_16x16x32_bf16 v[64:67], v[96:99], v[136:139], v[64:67]
    ds_read_b128 v[200:203], v18 offset:36864
    v_mfma_f32_16x16x32_bf16 v[68:71], v[100:103], v[136:139], v[68:71]
    ds_read_b64_tr_b16 v[172:173], v27 offset:32768
    v_mfma_f32_16x16x32_bf16 v[72:75], v[104:107], v[136:139], v[72:75]
    buffer_load_dwordx4 v10, s[16:19], s53 offen offset:2048 lds
    ds_read_b64_tr_b16 v[174:175], v27 offset:33792
    v_mfma_f32_16x16x32_bf16 v[76:79], v[108:111], v[136:139], v[76:79]
    ds_read_b128 v[204:207], v18 offset:38912
    v_mfma_f32_16x16x32_bf16 v[80:83], v[96:99], v[140:143], v[80:83]
    ds_read_b64_tr_b16 v[176:177], v24 offset:40960
    v_mfma_f32_16x16x32_bf16 v[84:87], v[100:103], v[140:143], v[84:87]
    ds_read_b64_tr_b16 v[178:179], v24 offset:41984
    v_mfma_f32_16x16x32_bf16 v[88:91], v[104:107], v[140:143], v[88:91]
    buffer_load_dwordx4 v11, s[16:19], s53 offen offset:3072 lds
    ds_read_b128 v[208:211], v19 offset:32768
    v_mfma_f32_16x16x32_bf16 v[92:95], v[108:111], v[140:143], v[92:95]
    ds_read_b64_tr_b16 v[180:181], v25 offset:40960
    v_mfma_f32_16x16x32_bf16 v[32:35], v[112:115], v[144:147], v[32:35]
    s_add_u32 m0, s59, 32768
    s_add_u32 s51, s54, 1664
    ds_read_b64_tr_b16 v[182:183], v25 offset:41984
    v_mfma_f32_16x16x32_bf16 v[36:39], v[116:119], v[144:147], v[36:39]
    ds_read_b128 v[212:215], v19 offset:34816
    v_mfma_f32_16x16x32_bf16 v[40:43], v[120:123], v[144:147], v[40:43]
    buffer_load_dwordx4 v4, s[4:7], s51 offen offset:0 lds
    ds_read_b64_tr_b16 v[184:185], v26 offset:40960
    v_mfma_f32_16x16x32_bf16 v[44:47], v[124:127], v[144:147], v[44:47]
    ds_read_b64_tr_b16 v[186:187], v26 offset:41984
    v_mfma_f32_16x16x32_bf16 v[48:51], v[112:115], v[148:151], v[48:51]
    ds_read_b128 v[216:219], v19 offset:36864
    v_mfma_f32_16x16x32_bf16 v[52:55], v[116:119], v[148:151], v[52:55]
    ds_read_b64_tr_b16 v[188:189], v27 offset:40960
    v_mfma_f32_16x16x32_bf16 v[56:59], v[120:123], v[148:151], v[56:59]
    buffer_load_dwordx4 v5, s[4:7], s51 offen offset:1024 lds
    ds_read_b64_tr_b16 v[190:191], v27 offset:41984
    v_mfma_f32_16x16x32_bf16 v[60:63], v[124:127], v[148:151], v[60:63]
    ds_read_b128 v[220:223], v19 offset:38912
    v_mfma_f32_16x16x32_bf16 v[64:67], v[112:115], v[152:155], v[64:67]
    v_mfma_f32_16x16x32_bf16 v[68:71], v[116:119], v[152:155], v[68:71]
    v_mfma_f32_16x16x32_bf16 v[72:75], v[120:123], v[152:155], v[72:75]
    buffer_load_dwordx4 v6, s[4:7], s51 offen offset:2048 lds
    v_mfma_f32_16x16x32_bf16 v[76:79], v[124:127], v[152:155], v[76:79]
    v_mfma_f32_16x16x32_bf16 v[80:83], v[112:115], v[156:159], v[80:83]
    v_mfma_f32_16x16x32_bf16 v[84:87], v[116:119], v[156:159], v[84:87]
    v_mfma_f32_16x16x32_bf16 v[88:91], v[120:123], v[156:159], v[88:91]
    buffer_load_dwordx4 v7, s[4:7], s51 offen offset:3072 lds
    v_mfma_f32_16x16x32_bf16 v[92:95], v[124:127], v[156:159], v[92:95]
    s_waitcnt vmcnt(8) lgkmcnt(0)
    s_barrier
    v_mfma_f32_16x16x32_bf16 v[32:35], v[160:163], v[192:195], v[32:35]
    s_add_u32 m0, s59, 81920
    s_add_u32 s53, s55, 7340032
    ds_read_b64_tr_b16 v[96:97], v20 offset:0
    v_mfma_f32_16x16x32_bf16 v[36:39], v[164:167], v[192:195], v[36:39]
    ds_read_b64_tr_b16 v[98:99], v20 offset:1024
    v_mfma_f32_16x16x32_bf16 v[40:43], v[168:171], v[192:195], v[40:43]
    buffer_load_dwordx4 v8, s[16:19], s53 offen offset:0 lds
    ds_read_b128 v[128:131], v16 offset:0
    v_mfma_f32_16x16x32_bf16 v[44:47], v[172:175], v[192:195], v[44:47]
    ds_read_b64_tr_b16 v[100:101], v21 offset:0
    v_mfma_f32_16x16x32_bf16 v[48:51], v[160:163], v[196:199], v[48:51]
    ds_read_b64_tr_b16 v[102:103], v21 offset:1024
    v_mfma_f32_16x16x32_bf16 v[52:55], v[164:167], v[196:199], v[52:55]
    ds_read_b128 v[132:135], v16 offset:2048
    v_mfma_f32_16x16x32_bf16 v[56:59], v[168:171], v[196:199], v[56:59]
    buffer_load_dwordx4 v9, s[16:19], s53 offen offset:1024 lds
    ds_read_b64_tr_b16 v[104:105], v22 offset:0
    v_mfma_f32_16x16x32_bf16 v[60:63], v[172:175], v[196:199], v[60:63]
    ds_read_b64_tr_b16 v[106:107], v22 offset:1024
    v_mfma_f32_16x16x32_bf16 v[64:67], v[160:163], v[200:203], v[64:67]
    ds_read_b128 v[136:139], v16 offset:4096
    v_mfma_f32_16x16x32_bf16 v[68:71], v[164:167], v[200:203], v[68:71]
    ds_read_b64_tr_b16 v[108:109], v23 offset:0
    v_mfma_f32_16x16x32_bf16 v[72:75], v[168:171], v[200:203], v[72:75]
    buffer_load_dwordx4 v10, s[16:19], s53 offen offset:2048 lds
    ds_read_b64_tr_b16 v[110:111], v23 offset:1024
    v_mfma_f32_16x16x32_bf16 v[76:79], v[172:175], v[200:203], v[76:79]
    ds_read_b128 v[140:143], v16 offset:6144
    v_mfma_f32_16x16x32_bf16 v[80:83], v[160:163], v[204:207], v[80:83]
    ds_read_b64_tr_b16 v[112:113], v20 offset:8192
    v_mfma_f32_16x16x32_bf16 v[84:87], v[164:167], v[204:207], v[84:87]
    ds_read_b64_tr_b16 v[114:115], v20 offset:9216
    v_mfma_f32_16x16x32_bf16 v[88:91], v[168:171], v[204:207], v[88:91]
    buffer_load_dwordx4 v11, s[16:19], s53 offen offset:3072 lds
    ds_read_b128 v[144:147], v17 offset:0
    v_mfma_f32_16x16x32_bf16 v[92:95], v[172:175], v[204:207], v[92:95]
    ds_read_b64_tr_b16 v[116:117], v21 offset:8192
    v_mfma_f32_16x16x32_bf16 v[32:35], v[176:179], v[208:211], v[32:35]
    s_add_u32 m0, s59, 65536
    s_add_u32 s51, s54, 1792
    ds_read_b64_tr_b16 v[118:119], v21 offset:9216
    v_mfma_f32_16x16x32_bf16 v[36:39], v[180:183], v[208:211], v[36:39]
    ds_read_b128 v[148:151], v17 offset:2048
    v_mfma_f32_16x16x32_bf16 v[40:43], v[184:187], v[208:211], v[40:43]
    buffer_load_dwordx4 v4, s[4:7], s51 offen offset:0 lds
    ds_read_b64_tr_b16 v[120:121], v22 offset:8192
    v_mfma_f32_16x16x32_bf16 v[44:47], v[188:191], v[208:211], v[44:47]
    ds_read_b64_tr_b16 v[122:123], v22 offset:9216
    v_mfma_f32_16x16x32_bf16 v[48:51], v[176:179], v[212:215], v[48:51]
    ds_read_b128 v[152:155], v17 offset:4096
    v_mfma_f32_16x16x32_bf16 v[52:55], v[180:183], v[212:215], v[52:55]
    ds_read_b64_tr_b16 v[124:125], v23 offset:8192
    v_mfma_f32_16x16x32_bf16 v[56:59], v[184:187], v[212:215], v[56:59]
    buffer_load_dwordx4 v5, s[4:7], s51 offen offset:1024 lds
    ds_read_b64_tr_b16 v[126:127], v23 offset:9216
    v_mfma_f32_16x16x32_bf16 v[60:63], v[188:191], v[212:215], v[60:63]
    ds_read_b128 v[156:159], v17 offset:6144
    v_mfma_f32_16x16x32_bf16 v[64:67], v[176:179], v[216:219], v[64:67]
    v_mfma_f32_16x16x32_bf16 v[68:71], v[180:183], v[216:219], v[68:71]
    v_mfma_f32_16x16x32_bf16 v[72:75], v[184:187], v[216:219], v[72:75]
    buffer_load_dwordx4 v6, s[4:7], s51 offen offset:2048 lds
    v_mfma_f32_16x16x32_bf16 v[76:79], v[188:191], v[216:219], v[76:79]
    v_mfma_f32_16x16x32_bf16 v[80:83], v[176:179], v[220:223], v[80:83]
    v_mfma_f32_16x16x32_bf16 v[84:87], v[180:183], v[220:223], v[84:87]
    v_mfma_f32_16x16x32_bf16 v[88:91], v[184:187], v[220:223], v[88:91]
    buffer_load_dwordx4 v7, s[4:7], s51 offen offset:3072 lds
    v_mfma_f32_16x16x32_bf16 v[92:95], v[188:191], v[220:223], v[92:95]
    s_waitcnt vmcnt(8) lgkmcnt(0)
    s_barrier
    v_mfma_f32_16x16x32_bf16 v[32:35], v[96:99], v[128:131], v[32:35]
    s_add_u32 m0, s59, 114688
    s_add_u32 s53, s55, 7864320
    ds_read_b64_tr_b16 v[160:161], v20 offset:32768
    v_mfma_f32_16x16x32_bf16 v[36:39], v[100:103], v[128:131], v[36:39]
    ds_read_b64_tr_b16 v[162:163], v20 offset:33792
    v_mfma_f32_16x16x32_bf16 v[40:43], v[104:107], v[128:131], v[40:43]
    buffer_load_dwordx4 v8, s[16:19], s53 offen offset:0 lds
    ds_read_b128 v[192:195], v16 offset:32768
    v_mfma_f32_16x16x32_bf16 v[44:47], v[108:111], v[128:131], v[44:47]
    ds_read_b64_tr_b16 v[164:165], v21 offset:32768
    v_mfma_f32_16x16x32_bf16 v[48:51], v[96:99], v[132:135], v[48:51]
    ds_read_b64_tr_b16 v[166:167], v21 offset:33792
    v_mfma_f32_16x16x32_bf16 v[52:55], v[100:103], v[132:135], v[52:55]
    ds_read_b128 v[196:199], v16 offset:34816
    v_mfma_f32_16x16x32_bf16 v[56:59], v[104:107], v[132:135], v[56:59]
    buffer_load_dwordx4 v9, s[16:19], s53 offen offset:1024 lds
    ds_read_b64_tr_b16 v[168:169], v22 offset:32768
    v_mfma_f32_16x16x32_bf16 v[60:63], v[108:111], v[132:135], v[60:63]
    ds_read_b64_tr_b16 v[170:171], v22 offset:33792
    v_mfma_f32_16x16x32_bf16 v[64:67], v[96:99], v[136:139], v[64:67]
    ds_read_b128 v[200:203], v16 offset:36864
    v_mfma_f32_16x16x32_bf16 v[68:71], v[100:103], v[136:139], v[68:71]
    ds_read_b64_tr_b16 v[172:173], v23 offset:32768
    v_mfma_f32_16x16x32_bf16 v[72:75], v[104:107], v[136:139], v[72:75]
    buffer_load_dwordx4 v10, s[16:19], s53 offen offset:2048 lds
    ds_read_b64_tr_b16 v[174:175], v23 offset:33792
    v_mfma_f32_16x16x32_bf16 v[76:79], v[108:111], v[136:139], v[76:79]
    ds_read_b128 v[204:207], v16 offset:38912
    v_mfma_f32_16x16x32_bf16 v[80:83], v[96:99], v[140:143], v[80:83]
    ds_read_b64_tr_b16 v[176:177], v20 offset:40960
    v_mfma_f32_16x16x32_bf16 v[84:87], v[100:103], v[140:143], v[84:87]
    ds_read_b64_tr_b16 v[178:179], v20 offset:41984
    v_mfma_f32_16x16x32_bf16 v[88:91], v[104:107], v[140:143], v[88:91]
    buffer_load_dwordx4 v11, s[16:19], s53 offen offset:3072 lds
    ds_read_b128 v[208:211], v17 offset:32768
    v_mfma_f32_16x16x32_bf16 v[92:95], v[108:111], v[140:143], v[92:95]
    ds_read_b64_tr_b16 v[180:181], v21 offset:40960
    v_mfma_f32_16x16x32_bf16 v[32:35], v[112:115], v[144:147], v[32:35]
    s_add_u32 m0, s59, 98304
    s_add_u32 s51, s54, 1920
    ds_read_b64_tr_b16 v[182:183], v21 offset:41984
    v_mfma_f32_16x16x32_bf16 v[36:39], v[116:119], v[144:147], v[36:39]
    ds_read_b128 v[212:215], v17 offset:34816
    v_mfma_f32_16x16x32_bf16 v[40:43], v[120:123], v[144:147], v[40:43]
    buffer_load_dwordx4 v4, s[4:7], s51 offen offset:0 lds
    ds_read_b64_tr_b16 v[184:185], v22 offset:40960
    v_mfma_f32_16x16x32_bf16 v[44:47], v[124:127], v[144:147], v[44:47]
    ds_read_b64_tr_b16 v[186:187], v22 offset:41984
    v_mfma_f32_16x16x32_bf16 v[48:51], v[112:115], v[148:151], v[48:51]
    ds_read_b128 v[216:219], v17 offset:36864
    v_mfma_f32_16x16x32_bf16 v[52:55], v[116:119], v[148:151], v[52:55]
    ds_read_b64_tr_b16 v[188:189], v23 offset:40960
    v_mfma_f32_16x16x32_bf16 v[56:59], v[120:123], v[148:151], v[56:59]
    buffer_load_dwordx4 v5, s[4:7], s51 offen offset:1024 lds
    ds_read_b64_tr_b16 v[190:191], v23 offset:41984
    v_mfma_f32_16x16x32_bf16 v[60:63], v[124:127], v[148:151], v[60:63]
    ds_read_b128 v[220:223], v17 offset:38912
    v_mfma_f32_16x16x32_bf16 v[64:67], v[112:115], v[152:155], v[64:67]
    v_mfma_f32_16x16x32_bf16 v[68:71], v[116:119], v[152:155], v[68:71]
    v_mfma_f32_16x16x32_bf16 v[72:75], v[120:123], v[152:155], v[72:75]
    buffer_load_dwordx4 v6, s[4:7], s51 offen offset:2048 lds
    v_mfma_f32_16x16x32_bf16 v[76:79], v[124:127], v[152:155], v[76:79]
    v_mfma_f32_16x16x32_bf16 v[80:83], v[112:115], v[156:159], v[80:83]
    v_mfma_f32_16x16x32_bf16 v[84:87], v[116:119], v[156:159], v[84:87]
    v_mfma_f32_16x16x32_bf16 v[88:91], v[120:123], v[156:159], v[88:91]
    buffer_load_dwordx4 v7, s[4:7], s51 offen offset:3072 lds
    v_mfma_f32_16x16x32_bf16 v[92:95], v[124:127], v[156:159], v[92:95]
    s_waitcnt vmcnt(8) lgkmcnt(0)
    s_barrier
    v_and_b32 v30, 31, v1
    v_lshlrev_b32 v30, 3, v30
    s_lshl_b32 s62, s35, 8
    s_add_u32 s62, s62, 23101440
    buffer_load_dwordx2 v[28:29], v30, s[28:31], s62 offen sc1
    v_mfma_f32_16x16x32_bf16 v[32:35], v[160:163], v[192:195], v[32:35]
    ds_read_b64_tr_b16 v[96:97], v24 offset:0
    s_lshr_b32 s45, s35, 1
    v_mfma_f32_16x16x32_bf16 v[36:39], v[164:167], v[192:195], v[36:39]
    ds_read_b64_tr_b16 v[98:99], v24 offset:1024
    s_and_b32 s44, s35, 1
    v_mfma_f32_16x16x32_bf16 v[40:43], v[168:171], v[192:195], v[40:43]
    ds_read_b128 v[128:131], v18 offset:0
    s_lshl_b32 s44, s44, 4
    v_mfma_f32_16x16x32_bf16 v[44:47], v[172:175], v[192:195], v[44:47]
    ds_read_b64_tr_b16 v[100:101], v25 offset:0
    s_add_u32 s44, s44, s38
    v_mfma_f32_16x16x32_bf16 v[48:51], v[160:163], v[196:199], v[48:51]
    ds_read_b64_tr_b16 v[102:103], v25 offset:1024
    v_mfma_f32_16x16x32_bf16 v[52:55], v[164:167], v[196:199], v[52:55]
    ds_read_b128 v[132:135], v18 offset:2048
    s_lshl_b32 s62, s44, 2
    v_mfma_f32_16x16x32_bf16 v[56:59], v[168:171], v[196:199], v[56:59]
    ds_read_b64_tr_b16 v[104:105], v26 offset:0
    s_add_u32 s62, s62, s45
    v_mfma_f32_16x16x32_bf16 v[60:63], v[172:175], v[196:199], v[60:63]
    ds_read_b64_tr_b16 v[106:107], v26 offset:1024
    s_lshl_b32 s62, s62, 19
    v_mfma_f32_16x16x32_bf16 v[64:67], v[160:163], v[200:203], v[64:67]
    ds_read_b128 v[136:139], v18 offset:4096
    s_mul_i32 s63, s37, 270336
    v_mfma_f32_16x16x32_bf16 v[68:71], v[164:167], v[200:203], v[68:71]
    ds_read_b64_tr_b16 v[108:109], v27 offset:0
    v_mfma_f32_16x16x32_bf16 v[72:75], v[168:171], v[200:203], v[72:75]
    ds_read_b64_tr_b16 v[110:111], v27 offset:1024
    s_add_u32 s62, s62, s63
    v_mfma_f32_16x16x32_bf16 v[76:79], v[172:175], v[200:203], v[76:79]
    ds_read_b128 v[140:143], v18 offset:6144
    s_mov_b32 s63, 270336
    v_mfma_f32_16x16x32_bf16 v[80:83], v[160:163], v[204:207], v[80:83]
    ds_read_b64_tr_b16 v[112:113], v24 offset:8192
    s_cmp_eq_u32 s37, 0
    v_mfma_f32_16x16x32_bf16 v[84:87], v[164:167], v[204:207], v[84:87]
    ds_read_b64_tr_b16 v[114:115], v24 offset:9216
    v_mfma_f32_16x16x32_bf16 v[88:91], v[168:171], v[204:207], v[88:91]
    ds_read_b128 v[144:147], v19 offset:0
    s_cselect_b32 s63, s63, 253952
    v_mfma_f32_16x16x32_bf16 v[92:95], v[172:175], v[204:207], v[92:95]
    ds_read_b64_tr_b16 v[116:117], v25 offset:8192
    s_add_u32 s8, s8, s62
    v_mfma_f32_16x16x32_bf16 v[32:35], v[176:179], v[208:211], v[32:35]
    ds_read_b64_tr_b16 v[118:119], v25 offset:9216
    s_addc_u32 s9, s9, 0
    v_mfma_f32_16x16x32_bf16 v[36:39], v[180:183], v[208:211], v[36:39]
    ds_read_b128 v[148:151], v19 offset:2048
    s_mov_b32 s10, s63
    v_mfma_f32_16x16x32_bf16 v[40:43], v[184:187], v[208:211], v[40:43]
    ds_read_b64_tr_b16 v[120:121], v26 offset:8192
    v_mfma_f32_16x16x32_bf16 v[44:47], v[188:191], v[208:211], v[44:47]
    ds_read_b64_tr_b16 v[122:123], v26 offset:9216
    s_add_u32 s12, s12, s62
    v_mfma_f32_16x16x32_bf16 v[48:51], v[176:179], v[212:215], v[48:51]
    ds_read_b128 v[152:155], v19 offset:4096
    s_addc_u32 s13, s13, 0
    v_mfma_f32_16x16x32_bf16 v[52:55], v[180:183], v[212:215], v[52:55]
    ds_read_b64_tr_b16 v[124:125], v27 offset:8192
    s_mov_b32 s14, s63
    v_mfma_f32_16x16x32_bf16 v[56:59], v[184:187], v[212:215], v[56:59]
    ds_read_b64_tr_b16 v[126:127], v27 offset:9216
    v_mfma_f32_16x16x32_bf16 v[60:63], v[188:191], v[212:215], v[60:63]
    ds_read_b128 v[156:159], v19 offset:6144
    s_mul_i32 s52, s34, 2112
    v_mfma_f32_16x16x32_bf16 v[64:67], v[176:179], v[216:219], v[64:67]
    v_lshrrev_b32 v12, 4, v1
    v_mfma_f32_16x16x32_bf16 v[68:71], v[180:183], v[216:219], v[68:71]
    v_and_b32 v13, 15, v1
    v_mfma_f32_16x16x32_bf16 v[72:75], v[184:187], v[216:219], v[72:75]
    v_lshlrev_b32 v13, 4, v13
    v_mfma_f32_16x16x32_bf16 v[76:79], v[188:191], v[216:219], v[76:79]
    v_mfma_f32_16x16x32_bf16 v[80:83], v[176:179], v[220:223], v[80:83]
    v_lshl_add_u32 v13, v12, 11, v13
    v_mfma_f32_16x16x32_bf16 v[84:87], v[180:183], v[220:223], v[84:87]
    s_lshl_b32 s62, s34, 9
    v_mfma_f32_16x16x32_bf16 v[88:91], v[184:187], v[220:223], v[88:91]
    v_add_u32 v6, s62, v13
    v_mfma_f32_16x16x32_bf16 v[92:95], v[188:191], v[220:223], v[92:95]
    s_waitcnt vmcnt(1) lgkmcnt(0)
    s_barrier
    v_mfma_f32_16x16x32_bf16 v[32:35], v[96:99], v[128:131], v[32:35]
    ds_read_b64_tr_b16 v[160:161], v24 offset:32768
    s_mov_b32 s46, 0
    s_add_u32 m0, s52, 0
    v_mfma_f32_16x16x32_bf16 v[36:39], v[100:103], v[128:131], v[36:39]
    ds_read_b64_tr_b16 v[162:163], v24 offset:33792
    s_nop 0
    v_mfma_f32_16x16x32_bf16 v[40:43], v[104:107], v[128:131], v[40:43]
    ds_read_b128 v[192:195], v18 offset:32768
    buffer_load_dwordx4 v6, s[8:11], s46 offen offset:0 nt lds
    v_mfma_f32_16x16x32_bf16 v[44:47], v[108:111], v[128:131], v[44:47]
    ds_read_b64_tr_b16 v[164:165], v25 offset:32768
    s_add_u32 m0, s52, 800
    s_nop 0
    v_mfma_f32_16x16x32_bf16 v[48:51], v[96:99], v[132:135], v[48:51]
    ds_read_b64_tr_b16 v[166:167], v25 offset:33792
    buffer_load_dwordx4 v6, s[8:11], s46 offen offset:256 nt lds
    v_mfma_f32_16x16x32_bf16 v[52:55], v[100:103], v[132:135], v[52:55]
    ds_read_b128 v[196:199], v18 offset:34816
    s_mov_b32 s46, 8192
    v_mfma_f32_16x16x32_bf16 v[56:59], v[104:107], v[132:135], v[56:59]
    ds_read_b64_tr_b16 v[168:169], v26 offset:32768
    s_add_u32 m0, s52, 8448
    s_nop 0
    v_mfma_f32_16x16x32_bf16 v[60:63], v[108:111], v[132:135], v[60:63]
    ds_read_b64_tr_b16 v[170:171], v26 offset:33792
    buffer_load_dwordx4 v6, s[8:11], s46 offen offset:0 nt lds
    v_mfma_f32_16x16x32_bf16 v[64:67], v[96:99], v[136:139], v[64:67]
    ds_read_b128 v[200:203], v18 offset:36864
    s_add_u32 m0, s52, 9248
    v_mfma_f32_16x16x32_bf16 v[68:71], v[100:103], v[136:139], v[68:71]
    ds_read_b64_tr_b16 v[172:173], v27 offset:32768
    s_nop 0
    buffer_load_dwordx4 v6, s[8:11], s46 offen offset:256 nt lds
    v_mfma_f32_16x16x32_bf16 v[72:75], v[104:107], v[136:139], v[72:75]
    ds_read_b64_tr_b16 v[174:175], v27 offset:33792
    s_mov_b32 s46, 16384
    v_mfma_f32_16x16x32_bf16 v[76:79], v[108:111], v[136:139], v[76:79]
    ds_read_b128 v[204:207], v18 offset:38912
    s_add_u32 m0, s52, 16896
    v_mfma_f32_16x16x32_bf16 v[80:83], v[96:99], v[140:143], v[80:83]
    ds_read_b64_tr_b16 v[176:177], v24 offset:40960
    s_nop 0
    buffer_load_dwordx4 v6, s[8:11], s46 offen offset:0 nt lds
    v_mfma_f32_16x16x32_bf16 v[84:87], v[100:103], v[140:143], v[84:87]
    ds_read_b64_tr_b16 v[178:179], v24 offset:41984
    s_add_u32 m0, s52, 17696
    v_mfma_f32_16x16x32_bf16 v[88:91], v[104:107], v[140:143], v[88:91]
    ds_read_b128 v[208:211], v19 offset:32768
    s_nop 0
    v_mfma_f32_16x16x32_bf16 v[92:95], v[108:111], v[140:143], v[92:95]
    ds_read_b64_tr_b16 v[180:181], v25 offset:40960
    buffer_load_dwordx4 v6, s[8:11], s46 offen offset:256 nt lds
    v_mfma_f32_16x16x32_bf16 v[32:35], v[112:115], v[144:147], v[32:35]
    ds_read_b64_tr_b16 v[182:183], v25 offset:41984
    s_mov_b32 s46, 0
    s_add_u32 m0, s52, 25344
    v_mfma_f32_16x16x32_bf16 v[36:39], v[116:119], v[144:147], v[36:39]
    ds_read_b128 v[212:215], v19 offset:34816
    s_nop 0
    v_mfma_f32_16x16x32_bf16 v[40:43], v[120:123], v[144:147], v[40:43]
    ds_read_b64_tr_b16 v[184:185], v26 offset:40960
    buffer_load_dwordx4 v6, s[12:15], s46 offen offset:0 nt lds
    v_mfma_f32_16x16x32_bf16 v[44:47], v[124:127], v[144:147], v[44:47]
    ds_read_b64_tr_b16 v[186:187], v26 offset:41984
    s_add_u32 m0, s52, 26144
    s_nop 0
    v_mfma_f32_16x16x32_bf16 v[48:51], v[112:115], v[148:151], v[48:51]
    ds_read_b128 v[216:219], v19 offset:36864
    buffer_load_dwordx4 v6, s[12:15], s46 offen offset:256 nt lds
    v_mfma_f32_16x16x32_bf16 v[52:55], v[116:119], v[148:151], v[52:55]
    ds_read_b64_tr_b16 v[188:189], v27 offset:40960
    s_mov_b32 s46, 24576
    v_mfma_f32_16x16x32_bf16 v[56:59], v[120:123], v[148:151], v[56:59]
    ds_read_b64_tr_b16 v[190:191], v27 offset:41984
    s_add_u32 m0, s52, 33792
    s_nop 0
    v_mfma_f32_16x16x32_bf16 v[60:63], v[124:127], v[148:151], v[60:63]
    ds_read_b128 v[220:223], v19 offset:38912
    buffer_load_dwordx4 v6, s[8:11], s46 offen offset:0 nt lds
    v_mfma_f32_16x16x32_bf16 v[64:67], v[112:115], v[152:155], v[64:67]
    s_add_u32 m0, s52, 34592
    v_mfma_f32_16x16x32_bf16 v[68:71], v[116:119], v[152:155], v[68:71]
    s_nop 0
    buffer_load_dwordx4 v6, s[8:11], s46 offen offset:256 nt lds
    v_mfma_f32_16x16x32_bf16 v[72:75], v[120:123], v[152:155], v[72:75]
    s_mov_b32 s46, 8192
    v_mfma_f32_16x16x32_bf16 v[76:79], v[124:127], v[152:155], v[76:79]
    s_add_u32 m0, s52, 42240
    v_mfma_f32_16x16x32_bf16 v[80:83], v[112:115], v[156:159], v[80:83]
    s_nop 0
    buffer_load_dwordx4 v6, s[12:15], s46 offen offset:0 nt lds
    v_mfma_f32_16x16x32_bf16 v[84:87], v[116:119], v[156:159], v[84:87]
    s_add_u32 m0, s52, 43040
    v_mfma_f32_16x16x32_bf16 v[88:91], v[120:123], v[156:159], v[88:91]
    s_nop 0
    v_mfma_f32_16x16x32_bf16 v[92:95], v[124:127], v[156:159], v[92:95]
    buffer_load_dwordx4 v6, s[12:15], s46 offen offset:256 nt lds
    s_waitcnt lgkmcnt(0)
    s_waitcnt vmcnt(12)
    v_cmp_ne_u32 vcc, s40, v28
    v_cmp_ne_u32 s[62:63], s3, v29
    s_nop 0
    s_or_b64 s[62:63], s[62:63], vcc
    s_cselect_b32 s39, 0, 1
    s_cmp_eq_u32 s39, 0
    s_cbranch_scc1 Lqe_far
    v_mfma_f32_16x16x32_bf16 v[32:35], v[160:163], v[192:195], v[32:35]
    v_and_b32 v2, 15, v1
    v_lshlrev_b32 v2, 4, v2
    v_lshrrev_b32 v3, 5, v1
    v_mfma_f32_16x16x32_bf16 v[36:39], v[164:167], v[192:195], v[36:39]
    v_lshl_add_u32 v2, v3, 8, v2
    v_bfe_u32 v3, v1, 4, 1
    v_mfma_f32_16x16x32_bf16 v[40:43], v[168:171], v[192:195], v[40:43]
    v_lshl_add_u32 v2, v3, 3, v2
    s_lshl_b32 s66, s47, 1
    v_mfma_f32_16x16x32_bf16 v[44:47], v[172:175], v[192:195], v[44:47]
    s_add_u32 s66, s66, s43
    s_lshl_b32 s66, s66, 19
    v_mfma_f32_16x16x32_bf16 v[32:35], v[176:179], v[208:211], v[32:35]
    s_lshl_b32 s67, s49, 12
    s_add_u32 s66, s66, s67
    v_mfma_f32_16x16x32_bf16 v[36:39], v[180:183], v[208:211], v[36:39]
    s_lshl_b32 s67, s42, 11
    s_add_u32 s66, s66, s67
    v_mfma_f32_16x16x32_bf16 v[40:43], v[184:187], v[208:211], v[40:43]
    s_add_u32 s66, s66, 0
    s_mov_b32 s68, 0x3e0293ee
    v_mfma_f32_16x16x32_bf16 v[44:47], v[188:191], v[208:211], v[44:47]
    s_lshl_b32 s65, s47, 1
    s_add_u32 s65, s65, s43
    v_mfma_f32_16x16x32_bf16 v[48:51], v[160:163], v[196:199], v[48:51]
    s_lshl_b32 s65, s65, 5
    s_add_u32 s65, s65, s49
    v_mfma_f32_16x16x32_bf16 v[52:55], v[164:167], v[196:199], v[52:55]
    s_lshl_b32 s65, s65, 1
    s_add_u32 s65, s65, s42
    v_mfma_f32_16x16x32_bf16 v[56:59], v[168:171], v[196:199], v[56:59]
    s_lshl_b32 s65, s65, 3
    s_add_u32 s65, s65, 23068672
    v_mfma_f32_16x16x32_bf16 v[60:63], v[172:175], v[196:199], v[60:63]
    v_mfma_f32_16x16x32_bf16 v[48:51], v[176:179], v[212:215], v[48:51]
    v_mul_f32 v32, s68, v32
    v_mul_f32 v33, s68, v33
    v_mul_f32 v34, s68, v34
    v_mfma_f32_16x16x32_bf16 v[52:55], v[180:183], v[212:215], v[52:55]
    v_mul_f32 v35, s68, v35
    v_cvt_pk_bf16_f32 v96, v32, v33
    v_cvt_pk_bf16_f32 v97, v34, v35
    v_mfma_f32_16x16x32_bf16 v[56:59], v[184:187], v[212:215], v[56:59]
    buffer_store_dwordx2 v[96:97], v2, s[28:31], s66 offen offset:0
    v_mul_f32 v36, s68, v36
    v_mul_f32 v37, s68, v37
    v_mfma_f32_16x16x32_bf16 v[60:63], v[188:191], v[212:215], v[60:63]
    v_mul_f32 v38, s68, v38
    v_mul_f32 v39, s68, v39
    v_cvt_pk_bf16_f32 v98, v36, v37
    v_mfma_f32_16x16x32_bf16 v[64:67], v[160:163], v[200:203], v[64:67]
    v_cvt_pk_bf16_f32 v99, v38, v39
    buffer_store_dwordx2 v[98:99], v2, s[28:31], s66 offen offset:512
    v_mfma_f32_16x16x32_bf16 v[68:71], v[164:167], v[200:203], v[68:71]
    v_mul_f32 v40, s68, v40
    v_mul_f32 v41, s68, v41
    v_mul_f32 v42, s68, v42
    v_mfma_f32_16x16x32_bf16 v[72:75], v[168:171], v[200:203], v[72:75]
    v_mul_f32 v43, s68, v43
    v_cvt_pk_bf16_f32 v100, v40, v41
    v_cvt_pk_bf16_f32 v101, v42, v43
    v_mfma_f32_16x16x32_bf16 v[76:79], v[172:175], v[200:203], v[76:79]
    buffer_store_dwordx2 v[100:101], v2, s[28:31], s66 offen offset:1024
    v_mul_f32 v44, s68, v44
    v_mul_f32 v45, s68, v45
    v_mfma_f32_16x16x32_bf16 v[64:67], v[176:179], v[216:219], v[64:67]
    v_mul_f32 v46, s68, v46
    v_mul_f32 v47, s68, v47
    v_cvt_pk_bf16_f32 v102, v44, v45
    v_mfma_f32_16x16x32_bf16 v[68:71], v[180:183], v[216:219], v[68:71]
    v_cvt_pk_bf16_f32 v103, v46, v47
    buffer_store_dwordx2 v[102:103], v2, s[28:31], s66 offen offset:1536
    v_mfma_f32_16x16x32_bf16 v[72:75], v[184:187], v[216:219], v[72:75]
    s_add_u32 s66, s66, 0x20000
    v_mul_f32 v48, s68, v48
    v_mul_f32 v49, s68, v49
    v_mfma_f32_16x16x32_bf16 v[76:79], v[188:191], v[216:219], v[76:79]
    v_mul_f32 v50, s68, v50
    v_mul_f32 v51, s68, v51
    v_cvt_pk_bf16_f32 v104, v48, v49
    v_mfma_f32_16x16x32_bf16 v[80:83], v[160:163], v[204:207], v[80:83]
    v_cvt_pk_bf16_f32 v105, v50, v51
    buffer_store_dwordx2 v[104:105], v2, s[28:31], s66 offen offset:0
    v_mul_f32 v52, s68, v52
    v_mfma_f32_16x16x32_bf16 v[84:87], v[164:167], v[204:207], v[84:87]
    v_mul_f32 v53, s68, v53
    v_mul_f32 v54, s68, v54
    v_mul_f32 v55, s68, v55
    v_mfma_f32_16x16x32_bf16 v[88:91], v[168:171], v[204:207], v[88:91]
    v_cvt_pk_bf16_f32 v106, v52, v53
    v_cvt_pk_bf16_f32 v107, v54, v55
    buffer_store_dwordx2 v[106:107], v2, s[28:31], s66 offen offset:512
    v_mfma_f32_16x16x32_bf16 v[92:95], v[172:175], v[204:207], v[92:95]
    v_mul_f32 v56, s68, v56
    v_mul_f32 v57, s68, v57
    v_mul_f32 v58, s68, v58
    v_mfma_f32_16x16x32_bf16 v[80:83], v[176:179], v[220:223], v[80:83]
    v_mul_f32 v59, s68, v59
    v_cvt_pk_bf16_f32 v108, v56, v57
    v_cvt_pk_bf16_f32 v109, v58, v59
    v_mfma_f32_16x16x32_bf16 v[84:87], v[180:183], v[220:223], v[84:87]
    buffer_store_dwordx2 v[108:109], v2, s[28:31], s66 offen offset:1024
    v_mul_f32 v60, s68, v60
    v_mul_f32 v61, s68, v61
    v_mfma_f32_16x16x32_bf16 v[88:91], v[184:187], v[220:223], v[88:91]
    v_mul_f32 v62, s68, v62
    v_mul_f32 v63, s68, v63
    v_cvt_pk_bf16_f32 v110, v60, v61
    v_mfma_f32_16x16x32_bf16 v[92:95], v[188:191], v[220:223], v[92:95]
    v_cvt_pk_bf16_f32 v111, v62, v63
    buffer_store_dwordx2 v[110:111], v2, s[28:31], s66 offen offset:1536
    s_add_u32 s66, s66, 0x20000
    v_mul_f32 v64, s68, v64
    v_mul_f32 v65, s68, v65
    v_mul_f32 v66, s68, v66
    v_mul_f32 v67, s68, v67
    v_cvt_pk_bf16_f32 v112, v64, v65
    v_cvt_pk_bf16_f32 v113, v66, v67
    buffer_store_dwordx2 v[112:113], v2, s[28:31], s66 offen offset:0
    v_mul_f32 v68, s68, v68
    v_mul_f32 v69, s68, v69
    v_mul_f32 v70, s68, v70
    v_mul_f32 v71, s68, v71
    v_cvt_pk_bf16_f32 v114, v68, v69
    v_cvt_pk_bf16_f32 v115, v70, v71
    buffer_store_dwordx2 v[114:115], v2, s[28:31], s66 offen offset:512
    v_mul_f32 v72, s68, v72
    v_mul_f32 v73, s68, v73
    v_mul_f32 v74, s68, v74
    v_mul_f32 v75, s68, v75
    v_cvt_pk_bf16_f32 v116, v72, v73
    v_cvt_pk_bf16_f32 v117, v74, v75
    buffer_store_dwordx2 v[116:117], v2, s[28:31], s66 offen offset:1024
    v_mul_f32 v76, s68, v76
    v_mul_f32 v77, s68, v77
    v_mul_f32 v78, s68, v78
    v_mul_f32 v79, s68, v79
    v_cvt_pk_bf16_f32 v118, v76, v77
    v_cvt_pk_bf16_f32 v119, v78, v79
    buffer_store_dwordx2 v[118:119], v2, s[28:31], s66 offen offset:1536
    s_add_u32 s66, s66, 0x20000
    v_mul_f32 v80, s68, v80
    v_mul_f32 v81, s68, v81
    v_mul_f32 v82, s68, v82
    v_mul_f32 v83, s68, v83
    v_cvt_pk_bf16_f32 v120, v80, v81
    v_cvt_pk_bf16_f32 v121, v82, v83
    buffer_store_dwordx2 v[120:121], v2, s[28:31], s66 offen offset:0
    v_mul_f32 v84, s68, v84
    v_mul_f32 v85, s68, v85
    v_mul_f32 v86, s68, v86
    v_mul_f32 v87, s68, v87
    v_cvt_pk_bf16_f32 v122, v84, v85
    v_cvt_pk_bf16_f32 v123, v86, v87
    buffer_store_dwordx2 v[122:123], v2, s[28:31], s66 offen offset:512
    v_mul_f32 v88, s68, v88
    v_mul_f32 v89, s68, v89
    v_mul_f32 v90, s68, v90
    v_mul_f32 v91, s68, v91
    v_cvt_pk_bf16_f32 v124, v88, v89
    v_cvt_pk_bf16_f32 v125, v90, v91
    buffer_store_dwordx2 v[124:125], v2, s[28:31], s66 offen offset:1024
    v_mul_f32 v92, s68, v92
    v_mul_f32 v93, s68, v93
    v_mul_f32 v94, s68, v94
    v_mul_f32 v95, s68, v95
    v_cvt_pk_bf16_f32 v126, v92, v93
    v_cvt_pk_bf16_f32 v127, v94, v95
    buffer_store_dwordx2 v[126:127], v2, s[28:31], s66 offen offset:1536
    v_mov_b32 v28, s40
    v_mov_b32 v29, s41
    v_mov_b32 v30, 0
    s_waitcnt vmcnt(0)
    s_mov_b64 exec, 1
    buffer_store_dwordx2 v[28:29], v30, s[28:31], s65 offen
    s_mov_b64 exec, -1
    s_branch Lqe_j
Lqe_far:
    v_mfma_f32_16x16x32_bf16 v[32:35], v[160:163], v[192:195], v[32:35]
    v_and_b32 v2, 15, v1
    v_lshlrev_b32 v2, 4, v2
    v_lshrrev_b32 v3, 5, v1
    v_mfma_f32_16x16x32_bf16 v[36:39], v[164:167], v[192:195], v[36:39]
    v_lshl_add_u32 v2, v3, 8, v2
    v_bfe_u32 v3, v1, 4, 1
    v_mfma_f32_16x16x32_bf16 v[40:43], v[168:171], v[192:195], v[40:43]
    v_lshl_add_u32 v2, v3, 3, v2
    s_lshl_b32 s66, s47, 1
    v_mfma_f32_16x16x32_bf16 v[44:47], v[172:175], v[192:195], v[44:47]
    s_add_u32 s66, s66, s43
    s_lshl_b32 s66, s66, 19
    v_mfma_f32_16x16x32_bf16 v[32:35], v[176:179], v[208:211], v[32:35]
    s_lshl_b32 s67, s49, 12
    s_add_u32 s66, s66, s67
    v_mfma_f32_16x16x32_bf16 v[36:39], v[180:183], v[208:211], v[36:39]
    s_lshl_b32 s67, s42, 11
    s_add_u32 s66, s66, s67
    v_mfma_f32_16x16x32_bf16 v[40:43], v[184:187], v[208:211], v[40:43]
    s_add_u32 s66, s66, 0
    s_mov_b32 s68, 0x3e0293ee
    v_mfma_f32_16x16x32_bf16 v[44:47], v[188:191], v[208:211], v[44:47]
    s_lshl_b32 s65, s47, 1
    s_add_u32 s65, s65, s43
    v_mfma_f32_16x16x32_bf16 v[48:51], v[160:163], v[196:199], v[48:51]
    s_lshl_b32 s65, s65, 5
    s_add_u32 s65, s65, s49
    v_mfma_f32_16x16x32_bf16 v[52:55], v[164:167], v[196:199], v[52:55]
    s_lshl_b32 s65, s65, 1
    s_add_u32 s65, s65, s42
    v_mfma_f32_16x16x32_bf16 v[56:59], v[168:171], v[196:199], v[56:59]
    s_lshl_b32 s65, s65, 3
    s_add_u32 s65, s65, 23068672
    v_mfma_f32_16x16x32_bf16 v[60:63], v[172:175], v[196:199], v[60:63]
    v_mfma_f32_16x16x32_bf16 v[48:51], v[176:179], v[212:215], v[48:51]
    v_mul_f32 v32, s68, v32
    v_mul_f32 v33, s68, v33
    v_mul_f32 v34, s68, v34
    v_mfma_f32_16x16x32_bf16 v[52:55], v[180:183], v[212:215], v[52:55]
    v_mul_f32 v35, s68, v35
    v_cvt_pk_bf16_f32 v96, v32, v33
    v_cvt_pk_bf16_f32 v97, v34, v35
    v_mfma_f32_16x16x32_bf16 v[56:59], v[184:187], v[212:215], v[56:59]
    buffer_store_dwordx2 v[96:97], v2, s[28:31], s66 offen offset:0 sc1
    v_mul_f32 v36, s68, v36
    v_mul_f32 v37, s68, v37
    v_mfma_f32_16x16x32_bf16 v[60:63], v[188:191], v[212:215], v[60:63]
    v_mul_f32 v38, s68, v38
    v_mul_f32 v39, s68, v39
    v_cvt_pk_bf16_f32 v98, v36, v37
    v_mfma_f32_16x16x32_bf16 v[64:67], v[160:163], v[200:203], v[64:67]
    v_cvt_pk_bf16_f32 v99, v38, v39
    buffer_store_dwordx2 v[98:99], v2, s[28:31], s66 offen offset:512 sc1
    v_mfma_f32_16x16x32_bf16 v[68:71], v[164:167], v[200:203], v[68:71]
    v_mul_f32 v40, s68, v40
    v_mul_f32 v41, s68, v41
    v_mul_f32 v42, s68, v42
    v_mfma_f32_16x16x32_bf16 v[72:75], v[168:171], v[200:203], v[72:75]
    v_mul_f32 v43, s68, v43
    v_cvt_pk_bf16_f32 v100, v40, v41
    v_cvt_pk_bf16_f32 v101, v42, v43
    v_mfma_f32_16x16x32_bf16 v[76:79], v[172:175], v[200:203], v[76:79]
    buffer_store_dwordx2 v[100:101], v2, s[28:31], s66 offen offset:1024 sc1
    v_mul_f32 v44, s68, v44
    v_mul_f32 v45, s68, v45
    v_mfma_f32_16x16x32_bf16 v[64:67], v[176:179], v[216:219], v[64:67]
    v_mul_f32 v46, s68, v46
    v_mul_f32 v47, s68, v47
    v_cvt_pk_bf16_f32 v102, v44, v45
    v_mfma_f32_16x16x32_bf16 v[68:71], v[180:183], v[216:219], v[68:71]
    v_cvt_pk_bf16_f32 v103, v46, v47
    buffer_store_dwordx2 v[102:103], v2, s[28:31], s66 offen offset:1536 sc1
    v_mfma_f32_16x16x32_bf16 v[72:75], v[184:187], v[216:219], v[72:75]
    s_add_u32 s66, s66, 0x20000
    v_mul_f32 v48, s68, v48
    v_mul_f32 v49, s68, v49
    v_mfma_f32_16x16x32_bf16 v[76:79], v[188:191], v[216:219], v[76:79]
    v_mul_f32 v50, s68, v50
    v_mul_f32 v51, s68, v51
    v_cvt_pk_bf16_f32 v104, v48, v49
    v_mfma_f32_16x16x32_bf16 v[80:83], v[160:163], v[204:207], v[80:83]
    v_cvt_pk_bf16_f32 v105, v50, v51
    buffer_store_dwordx2 v[104:105], v2, s[28:31], s66 offen offset:0 sc1
    v_mul_f32 v52, s68, v52
    v_mfma_f32_16x16x32_bf16 v[84:87], v[164:167], v[204:207], v[84:87]
    v_mul_f32 v53, s68, v53
    v_mul_f32 v54, s68, v54
    v_mul_f32 v55, s68, v55
    v_mfma_f32_16x16x32_bf16 v[88:91], v[168:171], v[204:207], v[88:91]
    v_cvt_pk_bf16_f32 v106, v52, v53
    v_cvt_pk_bf16_f32 v107, v54, v55
    buffer_store_dwordx2 v[106:107], v2, s[28:31], s66 offen offset:512 sc1
    v_mfma_f32_16x16x32_bf16 v[92:95], v[172:175], v[204:207], v[92:95]
    v_mul_f32 v56, s68, v56
    v_mul_f32 v57, s68, v57
    v_mul_f32 v58, s68, v58
    v_mfma_f32_16x16x32_bf16 v[80:83], v[176:179], v[220:223], v[80:83]
    v_mul_f32 v59, s68, v59
    v_cvt_pk_bf16_f32 v108, v56, v57
    v_cvt_pk_bf16_f32 v109, v58, v59
    v_mfma_f32_16x16x32_bf16 v[84:87], v[180:183], v[220:223], v[84:87]
    buffer_store_dwordx2 v[108:109], v2, s[28:31], s66 offen offset:1024 sc1
    v_mul_f32 v60, s68, v60
    v_mul_f32 v61, s68, v61
    v_mfma_f32_16x16x32_bf16 v[88:91], v[184:187], v[220:223], v[88:91]
    v_mul_f32 v62, s68, v62
    v_mul_f32 v63, s68, v63
    v_cvt_pk_bf16_f32 v110, v60, v61
    v_mfma_f32_16x16x32_bf16 v[92:95], v[188:191], v[220:223], v[92:95]
    v_cvt_pk_bf16_f32 v111, v62, v63
    buffer_store_dwordx2 v[110:111], v2, s[28:31], s66 offen offset:1536 sc1
    s_add_u32 s66, s66, 0x20000
    v_mul_f32 v64, s68, v64
    v_mul_f32 v65, s68, v65
    v_mul_f32 v66, s68, v66
    v_mul_f32 v67, s68, v67
    v_cvt_pk_bf16_f32 v112, v64, v65
    v_cvt_pk_bf16_f32 v113, v66, v67
    buffer_store_dwordx2 v[112:113], v2, s[28:31], s66 offen offset:0 sc1
    v_mul_f32 v68, s68, v68
    v_mul_f32 v69, s68, v69
    v_mul_f32 v70, s68, v70
    v_mul_f32 v71, s68, v71
    v_cvt_pk_bf16_f32 v114, v68, v69
    v_cvt_pk_bf16_f32 v115, v70, v71
    buffer_store_dwordx2 v[114:115], v2, s[28:31], s66 offen offset:512 sc1
    v_mul_f32 v72, s68, v72
    v_mul_f32 v73, s68, v73
    v_mul_f32 v74, s68, v74
    v_mul_f32 v75, s68, v75
    v_cvt_pk_bf16_f32 v116, v72, v73
    v_cvt_pk_bf16_f32 v117, v74, v75
    buffer_store_dwordx2 v[116:117], v2, s[28:31], s66 offen offset:1024 sc1
    v_mul_f32 v76, s68, v76
    v_mul_f32 v77, s68, v77
    v_mul_f32 v78, s68, v78
    v_mul_f32 v79, s68, v79
    v_cvt_pk_bf16_f32 v118, v76, v77
    v_cvt_pk_bf16_f32 v119, v78, v79
    buffer_store_dwordx2 v[118:119], v2, s[28:31], s66 offen offset:1536 sc1
    s_add_u32 s66, s66, 0x20000
    v_mul_f32 v80, s68, v80
    v_mul_f32 v81, s68, v81
    v_mul_f32 v82, s68, v82
    v_mul_f32 v83, s68, v83
    v_cvt_pk_bf16_f32 v120, v80, v81
    v_cvt_pk_bf16_f32 v121, v82, v83
    buffer_store_dwordx2 v[120:121], v2, s[28:31], s66 offen offset:0 sc1
    v_mul_f32 v84, s68, v84
    v_mul_f32 v85, s68, v85
    v_mul_f32 v86, s68, v86
    v_mul_f32 v87, s68, v87
    v_cvt_pk_bf16_f32 v122, v84, v85
    v_cvt_pk_bf16_f32 v123, v86, v87
    buffer_store_dwordx2 v[122:123], v2, s[28:31], s66 offen offset:512 sc1
    v_mul_f32 v88, s68, v88
    v_mul_f32 v89, s68, v89
    v_mul_f32 v90, s68, v90
    v_mul_f32 v91, s68, v91
    v_cvt_pk_bf16_f32 v124, v88, v89
    v_cvt_pk_bf16_f32 v125, v90, v91
    buffer_store_dwordx2 v[124:125], v2, s[28:31], s66 offen offset:1024 sc1
    v_mul_f32 v92, s68, v92
    v_mul_f32 v93, s68, v93
    v_mul_f32 v94, s68, v94
    v_mul_f32 v95, s68, v95
    v_cvt_pk_bf16_f32 v126, v92, v93
    v_cvt_pk_bf16_f32 v127, v94, v95
    buffer_store_dwordx2 v[126:127], v2, s[28:31], s66 offen offset:1536 sc1
    v_mov_b32 v28, s40
    v_mov_b32 v29, s41
    v_mov_b32 v30, 0
    s_waitcnt vmcnt(0)
    s_mov_b64 exec, 1
    buffer_store_dwordx2 v[28:29], v30, s[28:31], s65 offen sc1
    s_mov_b64 exec, -1
Lqe_j:
    s_barrier
    v_lshlrev_b32 v15, 4, v1
    s_lshl_b32 s62, s44, 2
    s_add_u32 s62, s62, s45
    s_lshl_b32 s62, s62, 2
    s_add_u32 s62, s62, s34
    s_lshl_b32 s63, s62, 13
    s_add_u32 s47, s63, 4194304
    s_add_u32 s48, s47, 4096
    s_add_u32 s43, s63, 4194304
    s_add_u32 s66, s43, 4096
    s_lshl_b32 s51, s62, 10
    s_add_u32 s51, s51, 12582912
    s_lshl_b32 s42, s45, 5
    s_add_u32 s42, s42, s44
    s_lshl_b32 s42, s42, 2
    s_add_u32 s42, s42, s34
    s_lshl_b32 s42, s42, 3
    s_add_u32 s42, s42, 23076864
    s_lshl_b32 s67, s45, 2
    s_add_u32 s67, s67, s34
    s_lshl_b32 s67, s67, 5
    s_add_u32 s67, s67, s44
    s_lshl_b32 s67, s67, 3
    s_add_u32 s67, s67, 23085056
    s_lshr_b32 s65, s44, 2
    s_lshl_b32 s65, s65, 5
    s_lshl_b32 s64, s45, 3
    s_add_u32 s65, s65, s64
    s_lshl_b32 s64, s34, 1
    s_add_u32 s65, s65, s64
    s_lshl_b32 s65, s65, 4
    s_add_u32 s65, s65, 23068672
    v_and_b32 v30, 3, v1
    v_lshlrev_b32 v30, 3, v30
    s_mov_b32 s62, 0
Lwp_w:
    buffer_load_dwordx2 v[28:29], v30, s[28:31], s65 offen sc1
    s_add_u32 s62, s62, 1
    s_cmp_ge_u32 s62, 2097152
    s_cbranch_scc1 Lwp_wx
    s_waitcnt vmcnt(0)
    v_cmp_ne_u64 vcc, s[40:41], v[28:29]
    s_cbranch_vccnz Lwp_w
Lwp_wx:
    s_waitcnt vmcnt(0)
    s_sub_u32 s62, s43, 4194304
    s_add_u32 s63, s62, 4096
    buffer_load_dwordx4 v[96:99], v15, s[28:31], s62 offen offset:0 sc1
    buffer_load_dwordx4 v[100:103], v15, s[28:31], s62 offen offset:1024 sc1
    buffer_load_dwordx4 v[104:107], v15, s[28:31], s62 offen offset:2048 sc1
    buffer_load_dwordx4 v[108:111], v15, s[28:31], s62 offen offset:3072 sc1
    buffer_load_dwordx4 v[112:115], v15, s[28:31], s63 offen offset:0 sc1
    buffer_load_dwordx4 v[116:119], v15, s[28:31], s63 offen offset:1024 sc1
    buffer_load_dwordx4 v[120:123], v15, s[28:31], s63 offen offset:2048 sc1
    buffer_load_dwordx4 v[124:127], v15, s[28:31], s63 offen offset:3072 sc1
    s_mov_b32 s46, 32768
    s_add_u32 m0, s52, 50688
    s_nop 0
    buffer_load_dwordx4 v6, s[8:11], s46 offen offset:0 nt lds
    s_add_u32 m0, s52, 51488
    s_nop 0
    buffer_load_dwordx4 v6, s[8:11], s46 offen offset:256 nt lds
    s_mov_b32 s46, 16384
    s_add_u32 m0, s52, 59136
    s_nop 0
    buffer_load_dwordx4 v6, s[12:15], s46 offen offset:0 nt lds
    s_add_u32 m0, s52, 59936
    s_nop 0
    buffer_load_dwordx4 v6, s[12:15], s46 offen offset:256 nt lds
    s_lshr_b32 s57, s35, 1
    s_and_b32 s56, s35, 1
    s_lshl_b32 s56, s56, 2
    s_and_b32 s62, s38, 3
    s_add_u32 s56, s56, s62
    s_lshr_b32 s55, s38, 2
    s_lshl_b32 s55, s55, 1
    s_add_u32 s55, s55, s37
    s_xor_b32 s55, s55, 1
    s_lshl_b32 s58, s56, 3
    s_add_u32 s58, s58, s55
    s_lshl_b32 s55, s55, 7
    s_lshl_b32 s54, s57, 21
    s_lshl_b32 s62, s34, 15
    s_add_u32 s54, s54, s62
    s_lshl_b32 s62, s55, 1
    s_add_u32 s54, s54, s62
    s_add_u32 s62, s38, 0
    s_and_b32 s62, s62, 3
    s_lshl_b32 s62, s62, 19
    s_add_u32 s4, s54, s62
    s_add_u32 s62, s38, 1
    s_and_b32 s62, s62, 3
    s_lshl_b32 s62, s62, 19
    s_add_u32 s5, s54, s62
    s_add_u32 s62, s38, 2
    s_and_b32 s62, s62, 3
    s_lshl_b32 s62, s62, 19
    s_add_u32 s6, s54, s62
    s_add_u32 s62, s38, 3
    s_and_b32 s62, s62, 3
    s_lshl_b32 s62, s62, 19
    s_add_u32 s7, s54, s62
    s_lshl_b32 s59, s34, 12
    v_lshrrev_b32 v28, 4, v1
    v_and_b32 v29, 15, v1
    v_lshlrev_b32 v30, 2, v28
    v_xor_b32 v30, v29, v30
    v_lshlrev_b32 v30, 4, v30
    v_lshl_add_u32 v10, v28, 11, v30
    v_add_u32 v11, 7168, v10
    v_add_u32 v12, 14336, v10
    v_add_u32 v13, 21504, v10
    v_lshrrev_b32 v28, 4, v1
    v_and_b32 v30, 7, v1
    v_mul_u32_u24 v30, 1056, v30
    v_bfe_u32 v31, v1, 3, 1
    v_lshl_add_u32 v30, v31, 8, v30
    v_lshl_add_u32 v2, v28, 4, v30
    v_bfe_u32 v30, v1, 2, 3
    v_mul_u32_u24 v30, 1056, v30
    v_lshrrev_b32 v31, 5, v1
    v_lshl_add_u32 v30, v31, 8, v30
    v_and_b32 v31, 3, v1
    v_lshl_add_u32 v30, v31, 3, v30
    v_add_u32 v16, 8448, v30
    v_lshrrev_b32 v30, 2, v1
    v_lshlrev_b32 v30, 8, v30
    v_lshl_add_u32 v30, v31, 4, v30
    v_bfe_u32 v31, v1, 2, 2
    v_xor_b32 v31, s34, v31
    v_lshl_add_u32 v14, v31, 6, v30
    v_add_u32 v3, 50688, v2
    v_add_u32 v17, 50688, v16
    v_add_u32 v19, 50688, v14
    v_add_u32 v4, 101376, v2
    v_add_u32 v18, 101376, v16
    v_add_u32 v5, 101376, v14
    v_mov_b32 v8, v254
    v_mov_b32 v160, 0
    v_mov_b32 v161, 0
    v_mov_b32 v162, 0
    v_mov_b32 v163, 0
    v_mov_b32 v164, 0
    v_mov_b32 v165, 0
    v_mov_b32 v166, 0
    v_mov_b32 v167, 0
    v_mov_b32 v168, 0
    v_mov_b32 v169, 0
    v_mov_b32 v170, 0
    v_mov_b32 v171, 0
    v_mov_b32 v20, 0
    v_mov_b32 v21, 0
    v_mov_b32 v22, 0
    v_mov_b32 v23, 0
    v_mov_b32 v24, 0
    v_mov_b32 v25, 0
    v_mov_b32 v26, 0
    v_mov_b32 v27, 0
    s_mov_b32 s49, 0xbf800000
    s_mov_b32 s50, 0xff800000
    s_add_u32 s63, s34, s38
    s_and_b32 s63, s63, 3
    s_lshl_b32 s100, s57, 2
    s_add_u32 s100, s100, s63
    s_lshl_b32 s64, s100, 13
    s_add_u32 s64, s64, 4194304
    s_lshl_b32 s62, s56, 19
    s_add_u32 s64, s64, s62
    s_lshl_b32 s100, s100, 5
    s_lshl_b32 s62, s56, 2
    s_add_u32 s100, s100, s62
    s_lshl_b32 s100, s100, 3
    s_add_u32 s100, s100, 23085056
    s_lshl_b32 s101, s34, 13
    s_add_u32 s62, s57, 1
    s_and_b32 s62, s62, 3
    s_lshl_b32 s62, s62, 17
    s_add_u32 s16, s64, s62
    s_add_u32 s62, s57, 2
    s_and_b32 s62, s62, 3
    s_lshl_b32 s62, s62, 17
    s_add_u32 s17, s64, s62
    s_add_u32 s62, s57, 3
    s_and_b32 s62, s62, 3
    s_lshl_b32 s62, s62, 17
    s_add_u32 s18, s64, s62
    s_add_u32 s62, s57, 4
    s_and_b32 s62, s62, 3
    s_lshl_b32 s62, s62, 17
    s_add_u32 s19, s64, s62
    s_mov_b32 s46, 40960
    s_add_u32 m0, s52, 67584
    s_nop 0
    buffer_load_dwordx4 v6, s[8:11], s46 offen offset:0 nt lds
    s_add_u32 m0, s52, 68384
    s_nop 0
    buffer_load_dwordx4 v6, s[8:11], s46 offen offset:256 nt lds
    s_mov_b32 s46, 24576
    s_add_u32 m0, s52, 76032
    s_nop 0
    buffer_load_dwordx4 v6, s[12:15], s46 offen offset:0 nt lds
    s_add_u32 m0, s52, 76832
    s_nop 0
    buffer_load_dwordx4 v6, s[12:15], s46 offen offset:256 nt lds
    s_waitcnt vmcnt(8)
    s_barrier
    ds_read_b128 v[192:195], v2 offset:0
    ds_read_b128 v[196:199], v2 offset:512
    ds_read_b128 v[200:203], v2 offset:64
    ds_read_b128 v[204:207], v2 offset:576
    ds_read_b128 v[208:211], v2 offset:128
    ds_read_b128 v[212:215], v2 offset:640
    ds_read_b128 v[216:219], v2 offset:192
    ds_read_b128 v[220:223], v2 offset:704
    s_waitcnt lgkmcnt(7)
    v_mfma_f32_16x16x32_bf16 v[128:131], v[192:195], v[96:99], v[160:163]
    v_mfma_f32_16x16x32_bf16 v[136:139], v[192:195], v[112:115], v[164:167]
    ds_read_b128 v[192:195], v2 offset:8448
    s_waitcnt lgkmcnt(7)
    v_mfma_f32_16x16x32_bf16 v[132:135], v[196:199], v[96:99], v[160:163]
    v_mfma_f32_16x16x32_bf16 v[140:143], v[196:199], v[112:115], v[164:167]
    ds_read_b128 v[196:199], v2 offset:8960
    s_waitcnt lgkmcnt(7)
    v_mfma_f32_16x16x32_bf16 v[128:131], v[200:203], v[100:103], v[128:131]
    v_mfma_f32_16x16x32_bf16 v[136:139], v[200:203], v[116:119], v[136:139]
    ds_read_b128 v[200:203], v2 offset:8512
    s_waitcnt lgkmcnt(7)
    v_mfma_f32_16x16x32_bf16 v[132:135], v[204:207], v[100:103], v[132:135]
    v_mfma_f32_16x16x32_bf16 v[140:143], v[204:207], v[116:119], v[140:143]
    ds_read_b128 v[204:207], v2 offset:9024
    s_waitcnt lgkmcnt(7)
    v_mfma_f32_16x16x32_bf16 v[128:131], v[208:211], v[104:107], v[128:131]
    v_mfma_f32_16x16x32_bf16 v[136:139], v[208:211], v[120:123], v[136:139]
    ds_read_b128 v[208:211], v2 offset:8576
    s_waitcnt lgkmcnt(7)
    v_mfma_f32_16x16x32_bf16 v[132:135], v[212:215], v[104:107], v[132:135]
    v_mfma_f32_16x16x32_bf16 v[140:143], v[212:215], v[120:123], v[140:143]
    ds_read_b128 v[212:215], v2 offset:9088
    s_waitcnt lgkmcnt(7)
    v_mfma_f32_16x16x32_bf16 v[128:131], v[216:219], v[108:111], v[128:131]
    v_mfma_f32_16x16x32_bf16 v[136:139], v[216:219], v[124:127], v[136:139]
    ds_read_b128 v[216:219], v2 offset:8640
    s_waitcnt lgkmcnt(7)
    v_mfma_f32_16x16x32_bf16 v[132:135], v[220:223], v[108:111], v[132:135]
    v_mfma_f32_16x16x32_bf16 v[140:143], v[220:223], v[124:127], v[140:143]
    ds_read_b128 v[220:223], v2 offset:9152
    s_nop 5
    s_waitcnt vmcnt(20) lgkmcnt(0)
    s_barrier
    v_mfma_f32_16x16x32_bf16 v[144:147], v[192:195], v[96:99], v[160:163]
    s_mov_b32 s46, 49152
    s_add_u32 m0, s52, 84480
    v_mfma_f32_16x16x32_bf16 v[152:155], v[192:195], v[112:115], v[164:167]
    buffer_load_dwordx4 v6, s[8:11], s46 offen offset:0 nt lds
    v_mfma_f32_16x16x32_bf16 v[148:151], v[196:199], v[96:99], v[160:163]
    s_add_u32 m0, s52, 85280
    v_mfma_f32_16x16x32_bf16 v[156:159], v[196:199], v[112:115], v[164:167]
    buffer_load_dwordx4 v6, s[8:11], s46 offen offset:256 nt lds
    v_mfma_f32_16x16x32_bf16 v[144:147], v[200:203], v[100:103], v[144:147]
    s_mov_b32 s46, 32768
    s_add_u32 m0, s52, 92928
    v_mfma_f32_16x16x32_bf16 v[152:155], v[200:203], v[116:119], v[152:155]
    buffer_load_dwordx4 v6, s[12:15], s46 offen offset:0 nt lds
    v_mfma_f32_16x16x32_bf16 v[148:151], v[204:207], v[100:103], v[148:151]
    s_add_u32 m0, s52, 93728
    v_mfma_f32_16x16x32_bf16 v[156:159], v[204:207], v[116:119], v[156:159]
    buffer_load_dwordx4 v6, s[12:15], s46 offen offset:256 nt lds
    v_mfma_f32_16x16x32_bf16 v[144:147], v[208:211], v[104:107], v[144:147]
    ds_read_b64_tr_b16 v[224:225], v16 offset:16896
    ds_read_b64_tr_b16 v[226:227], v16 offset:17408
    ds_read_b64_tr_b16 v[228:229], v16 offset:16928
    ds_read_b64_tr_b16 v[230:231], v16 offset:17440
    v_mfma_f32_16x16x32_bf16 v[152:155], v[208:211], v[120:123], v[152:155]
    ds_read_b64_tr_b16 v[232:233], v16 offset:16960
    ds_read_b64_tr_b16 v[234:235], v16 offset:17472
    ds_read_b64_tr_b16 v[236:237], v16 offset:16992
    ds_read_b64_tr_b16 v[238:239], v16 offset:17504
    v_mfma_f32_16x16x32_bf16 v[148:151], v[212:215], v[104:107], v[148:151]
    ds_read_b64_tr_b16 v[240:241], v16 offset:17024
    ds_read_b64_tr_b16 v[242:243], v16 offset:17536
    ds_read_b64_tr_b16 v[244:245], v16 offset:17056
    ds_read_b64_tr_b16 v[246:247], v16 offset:17568
    v_exp_f32 v21, v137
    v_add_f32 v168, v168, v27
    v_cvt_pk_bf16_f32 v179, v26, v27
    v_exp_f32 v22, v138
    v_add_f32 v169, v171, v20
    v_exp_f32 v23, v139
    v_add_f32 v169, v169, v21
    v_mfma_f32_16x16x32_bf16 v[156:159], v[212:215], v[120:123], v[156:159]
    ds_read_b64_tr_b16 v[248:249], v16 offset:17088
    ds_read_b64_tr_b16 v[250:251], v16 offset:17600
    ds_read_b64_tr_b16 v[252:253], v16 offset:17120
    ds_read_b64_tr_b16 v[254:255], v16 offset:17632
    v_cvt_pk_bf16_f32 v180, v20, v21
    v_exp_f32 v24, v140
    v_add_f32 v169, v169, v22
    v_exp_f32 v25, v141
    v_add_f32 v169, v169, v23
    v_cvt_pk_bf16_f32 v181, v22, v23
    v_exp_f32 v26, v142
    v_mfma_f32_16x16x32_bf16 v[144:147], v[216:219], v[108:111], v[144:147]
    v_add_f32 v169, v169, v24
    v_exp_f32 v27, v143
    v_add_f32 v169, v169, v25
    v_cvt_pk_bf16_f32 v182, v24, v25
    v_add_f32 v169, v169, v26
    v_add_f32 v169, v169, v27
    v_cvt_pk_bf16_f32 v183, v26, v27
    v_mfma_f32_16x16x32_bf16 v[152:155], v[216:219], v[124:127], v[152:155]
    v_max_f32 v30, v168, v169
    v_cmp_lt_f32 vcc, s49, v30
    v_mfma_f32_16x16x32_bf16 v[148:151], v[220:223], v[108:111], v[148:151]
    s_cbranch_vccnz LP_r0
LP_b0:
    v_mfma_f32_16x16x32_bf16 v[156:159], v[220:223], v[124:127], v[156:159]
    s_waitcnt lgkmcnt(0)
    v_mfma_f32_16x16x32_bf16 v[32:35], v[224:227], v[176:179], 0
    ds_read_b128 v[192:195], v2 offset:16896
    ds_read_b128 v[196:199], v2 offset:17408
    v_mfma_f32_16x16x32_bf16 v[64:67], v[224:227], v[180:183], 0
    ds_read_b128 v[200:203], v2 offset:16960
    ds_read_b128 v[204:207], v2 offset:17472
    v_mfma_f32_16x16x32_bf16 v[36:39], v[228:231], v[176:179], 0
    ds_read_b128 v[208:211], v2 offset:17024
    ds_read_b128 v[212:215], v2 offset:17536
    v_mfma_f32_16x16x32_bf16 v[68:71], v[228:231], v[180:183], 0
    ds_read_b128 v[216:219], v2 offset:17088
    ds_read_b128 v[220:223], v2 offset:17600
    v_mfma_f32_16x16x32_bf16 v[40:43], v[232:235], v[176:179], 0
    v_mfma_f32_16x16x32_bf16 v[72:75], v[232:235], v[180:183], 0
    v_mfma_f32_16x16x32_bf16 v[44:47], v[236:239], v[176:179], 0
    v_mfma_f32_16x16x32_bf16 v[76:79], v[236:239], v[180:183], 0
    v_mfma_f32_16x16x32_bf16 v[48:51], v[240:243], v[176:179], 0
    v_mfma_f32_16x16x32_bf16 v[80:83], v[240:243], v[180:183], 0
    v_mfma_f32_16x16x32_bf16 v[52:55], v[244:247], v[176:179], 0
    v_mfma_f32_16x16x32_bf16 v[84:87], v[244:247], v[180:183], 0
    v_mfma_f32_16x16x32_bf16 v[56:59], v[248:251], v[176:179], 0
    v_mfma_f32_16x16x32_bf16 v[88:91], v[248:251], v[180:183], 0
    v_mfma_f32_16x16x32_bf16 v[60:63], v[252:255], v[176:179], 0
    v_exp_f32 v20, v144
    v_exp_f32 v21, v145
    v_exp_f32 v22, v146
    v_add_f32 v170, v168, v20
    v_exp_f32 v23, v147
    v_add_f32 v170, v170, v21
    v_cvt_pk_bf16_f32 v184, v20, v21
    v_exp_f32 v24, v148
    v_add_f32 v170, v170, v22
    v_exp_f32 v25, v149
    v_mfma_f32_16x16x32_bf16 v[92:95], v[252:255], v[180:183], 0
    v_add_f32 v170, v170, v23
    v_cvt_pk_bf16_f32 v185, v22, v23
    v_exp_f32 v26, v150
    v_add_f32 v170, v170, v24
    v_exp_f32 v27, v151
    v_add_f32 v170, v170, v25
    v_cvt_pk_bf16_f32 v186, v24, v25
    v_exp_f32 v20, v152
    v_add_f32 v170, v170, v26
    s_waitcnt vmcnt(20) lgkmcnt(0)
    s_barrier
    v_mfma_f32_16x16x32_bf16 v[128:131], v[192:195], v[96:99], v[160:163]
    s_mov_b32 s46, 57344
    s_add_u32 m0, s52, 101376
    v_mfma_f32_16x16x32_bf16 v[136:139], v[192:195], v[112:115], v[164:167]
    buffer_load_dwordx4 v6, s[8:11], s46 offen offset:0 nt lds
    v_mfma_f32_16x16x32_bf16 v[132:135], v[196:199], v[96:99], v[160:163]
    s_add_u32 m0, s52, 102176
    v_mfma_f32_16x16x32_bf16 v[140:143], v[196:199], v[112:115], v[164:167]
    buffer_load_dwordx4 v6, s[8:11], s46 offen offset:256 nt lds
    v_mfma_f32_16x16x32_bf16 v[128:131], v[200:203], v[100:103], v[128:131]
    s_mov_b32 s46, 40960
    s_add_u32 m0, s52, 109824
    v_mfma_f32_16x16x32_bf16 v[136:139], v[200:203], v[116:119], v[136:139]
    buffer_load_dwordx4 v6, s[12:15], s46 offen offset:0 nt lds
    v_mfma_f32_16x16x32_bf16 v[132:135], v[204:207], v[100:103], v[132:135]
    s_add_u32 m0, s52, 110624
    v_mfma_f32_16x16x32_bf16 v[140:143], v[204:207], v[116:119], v[140:143]
    buffer_load_dwordx4 v6, s[12:15], s46 offen offset:256 nt lds
    v_mfma_f32_16x16x32_bf16 v[128:131], v[208:211], v[104:107], v[128:131]
    ds_read_b64_tr_b16 v[224:225], v16 offset:33792
    ds_read_b64_tr_b16 v[226:227], v16 offset:34304
    ds_read_b64_tr_b16 v[228:229], v16 offset:33824
    ds_read_b64_tr_b16 v[230:231], v16 offset:34336
    v_mfma_f32_16x16x32_bf16 v[136:139], v[208:211], v[120:123], v[136:139]
    ds_read_b64_tr_b16 v[232:233], v16 offset:33856
    ds_read_b64_tr_b16 v[234:235], v16 offset:34368
    ds_read_b64_tr_b16 v[236:237], v16 offset:33888
    ds_read_b64_tr_b16 v[238:239], v16 offset:34400
    v_mfma_f32_16x16x32_bf16 v[132:135], v[212:215], v[104:107], v[132:135]
    ds_read_b64_tr_b16 v[240:241], v16 offset:33920
    ds_read_b64_tr_b16 v[242:243], v16 offset:34432
    ds_read_b64_tr_b16 v[244:245], v16 offset:33952
    ds_read_b64_tr_b16 v[246:247], v16 offset:34464
    v_exp_f32 v21, v153
    v_add_f32 v170, v170, v27
    v_cvt_pk_bf16_f32 v187, v26, v27
    v_exp_f32 v22, v154
    v_add_f32 v171, v169, v20
    v_exp_f32 v23, v155
    v_add_f32 v171, v171, v21
    v_mfma_f32_16x16x32_bf16 v[140:143], v[212:215], v[120:123], v[140:143]
    ds_read_b64_tr_b16 v[248:249], v16 offset:33984
    ds_read_b64_tr_b16 v[250:251], v16 offset:34496
    ds_read_b64_tr_b16 v[252:253], v16 offset:34016
    ds_read_b64_tr_b16 v[254:255], v16 offset:34528
    v_cvt_pk_bf16_f32 v188, v20, v21
    v_exp_f32 v24, v156
    v_add_f32 v171, v171, v22
    v_exp_f32 v25, v157
    v_add_f32 v171, v171, v23
    v_cvt_pk_bf16_f32 v189, v22, v23
    v_exp_f32 v26, v158
    v_mfma_f32_16x16x32_bf16 v[128:131], v[216:219], v[108:111], v[128:131]
    v_add_f32 v171, v171, v24
    v_exp_f32 v27, v159
    v_add_f32 v171, v171, v25
    v_cvt_pk_bf16_f32 v190, v24, v25
    v_add_f32 v171, v171, v26
    v_add_f32 v171, v171, v27
    v_cvt_pk_bf16_f32 v191, v26, v27
    v_mfma_f32_16x16x32_bf16 v[136:139], v[216:219], v[124:127], v[136:139]
    v_max_f32 v30, v170, v171
    v_cmp_lt_f32 vcc, s49, v30
    v_mfma_f32_16x16x32_bf16 v[132:135], v[220:223], v[108:111], v[132:135]
    s_cbranch_vccnz LP_r1
LP_b1:
    v_mfma_f32_16x16x32_bf16 v[140:143], v[220:223], v[124:127], v[140:143]
    s_waitcnt lgkmcnt(0)
    v_mfma_f32_16x16x32_bf16 v[32:35], v[224:227], v[184:187], v[32:35]
    ds_read_b128 v[192:195], v2 offset:33792
    ds_read_b128 v[196:199], v2 offset:34304
    v_mfma_f32_16x16x32_bf16 v[64:67], v[224:227], v[188:191], v[64:67]
    ds_read_b128 v[200:203], v2 offset:33856
    ds_read_b128 v[204:207], v2 offset:34368
    v_mfma_f32_16x16x32_bf16 v[36:39], v[228:231], v[184:187], v[36:39]
    ds_read_b128 v[208:211], v2 offset:33920
    ds_read_b128 v[212:215], v2 offset:34432
    v_mfma_f32_16x16x32_bf16 v[68:71], v[228:231], v[188:191], v[68:71]
    ds_read_b128 v[216:219], v2 offset:33984
    ds_read_b128 v[220:223], v2 offset:34496
    v_mfma_f32_16x16x32_bf16 v[40:43], v[232:235], v[184:187], v[40:43]
    v_mfma_f32_16x16x32_bf16 v[72:75], v[232:235], v[188:191], v[72:75]
    v_mfma_f32_16x16x32_bf16 v[44:47], v[236:239], v[184:187], v[44:47]
    v_mfma_f32_16x16x32_bf16 v[76:79], v[236:239], v[188:191], v[76:79]
    v_mfma_f32_16x16x32_bf16 v[48:51], v[240:243], v[184:187], v[48:51]
    v_mfma_f32_16x16x32_bf16 v[80:83], v[240:243], v[188:191], v[80:83]
    v_mfma_f32_16x16x32_bf16 v[52:55], v[244:247], v[184:187], v[52:55]
    v_mfma_f32_16x16x32_bf16 v[84:87], v[244:247], v[188:191], v[84:87]
    v_mfma_f32_16x16x32_bf16 v[56:59], v[248:251], v[184:187], v[56:59]
    v_mfma_f32_16x16x32_bf16 v[88:91], v[248:251], v[188:191], v[88:91]
    v_mfma_f32_16x16x32_bf16 v[60:63], v[252:255], v[184:187], v[60:63]
    v_exp_f32 v20, v128
    v_exp_f32 v21, v129
    v_exp_f32 v22, v130
    v_add_f32 v168, v170, v20
    v_exp_f32 v23, v131
    v_add_f32 v168, v168, v21
    v_cvt_pk_bf16_f32 v176, v20, v21
    v_exp_f32 v24, v132
    v_add_f32 v168, v168, v22
    v_exp_f32 v25, v133
    v_mfma_f32_16x16x32_bf16 v[92:95], v[252:255], v[188:191], v[92:95]
    global_load_dword v9, v8, s[0:1]
    v_add_f32 v168, v168, v23
    v_cvt_pk_bf16_f32 v177, v22, v23
    v_exp_f32 v26, v134
    v_add_f32 v168, v168, v24
    v_exp_f32 v27, v135
    v_add_f32 v168, v168, v25
    v_cvt_pk_bf16_f32 v178, v24, v25
    v_exp_f32 v20, v136
    v_add_f32 v168, v168, v26
    s_waitcnt vmcnt(13) lgkmcnt(0)
    s_barrier
    v_mfma_f32_16x16x32_bf16 v[144:147], v[192:195], v[96:99], v[160:163]
    s_mov_b32 s46, 65536
    s_add_u32 m0, s52, 118272
    v_mfma_f32_16x16x32_bf16 v[152:155], v[192:195], v[112:115], v[164:167]
    buffer_load_dwordx4 v6, s[8:11], s46 offen offset:0 nt lds
    v_mfma_f32_16x16x32_bf16 v[148:151], v[196:199], v[96:99], v[160:163]
    s_add_u32 m0, s52, 119072
    v_mfma_f32_16x16x32_bf16 v[156:159], v[196:199], v[112:115], v[164:167]
    buffer_load_dwordx4 v6, s[8:11], s46 offen offset:256 nt lds
    v_mfma_f32_16x16x32_bf16 v[144:147], v[200:203], v[100:103], v[144:147]
    s_mov_b32 s46, 49152
    s_add_u32 m0, s52, 126720
    v_mfma_f32_16x16x32_bf16 v[152:155], v[200:203], v[116:119], v[152:155]
    buffer_load_dwordx4 v6, s[12:15], s46 offen offset:0 nt lds
    v_mfma_f32_16x16x32_bf16 v[148:151], v[204:207], v[100:103], v[148:151]
    s_add_u32 m0, s52, 127520
    v_mfma_f32_16x16x32_bf16 v[156:159], v[204:207], v[116:119], v[156:159]
    buffer_load_dwordx4 v6, s[12:15], s46 offen offset:256 nt lds
    v_mfma_f32_16x16x32_bf16 v[144:147], v[208:211], v[104:107], v[144:147]
    s_add_u32 s46, s4, 0
    s_add_u32 m0, s59, 135168
    ds_read_b64_tr_b16 v[224:225], v17 offset:0
    ds_read_b64_tr_b16 v[226:227], v17 offset:512
    ds_read_b64_tr_b16 v[228:229], v17 offset:32
    ds_read_b64_tr_b16 v[230:231], v17 offset:544
    v_mfma_f32_16x16x32_bf16 v[152:155], v[208:211], v[120:123], v[152:155]
    buffer_load_dwordx4 v10, s[20:23], s46 offen offset:0  lds
    ds_read_b64_tr_b16 v[232:233], v17 offset:64
    ds_read_b64_tr_b16 v[234:235], v17 offset:576
    ds_read_b64_tr_b16 v[236:237], v17 offset:96
    ds_read_b64_tr_b16 v[238:239], v17 offset:608
    v_mfma_f32_16x16x32_bf16 v[148:151], v[212:215], v[104:107], v[148:151]
    ds_read_b64_tr_b16 v[240:241], v17 offset:128
    ds_read_b64_tr_b16 v[242:243], v17 offset:640
    ds_read_b64_tr_b16 v[244:245], v17 offset:160
    ds_read_b64_tr_b16 v[246:247], v17 offset:672
    v_exp_f32 v21, v137
    v_add_f32 v168, v168, v27
    v_cvt_pk_bf16_f32 v179, v26, v27
    v_exp_f32 v22, v138
    v_add_f32 v169, v171, v20
    v_exp_f32 v23, v139
    v_add_f32 v169, v169, v21
    v_mfma_f32_16x16x32_bf16 v[156:159], v[212:215], v[120:123], v[156:159]
    buffer_load_dwordx4 v11, s[20:23], s46 offen offset:1024  lds
    ds_read_b64_tr_b16 v[248:249], v17 offset:192
    ds_read_b64_tr_b16 v[250:251], v17 offset:704
    ds_read_b64_tr_b16 v[252:253], v17 offset:224
    ds_read_b64_tr_b16 v[254:255], v17 offset:736
    v_cvt_pk_bf16_f32 v180, v20, v21
    v_exp_f32 v24, v140
    v_add_f32 v169, v169, v22
    v_exp_f32 v25, v141
    v_add_f32 v169, v169, v23
    v_cvt_pk_bf16_f32 v181, v22, v23
    v_exp_f32 v26, v142
    v_mfma_f32_16x16x32_bf16 v[144:147], v[216:219], v[108:111], v[144:147]
    v_add_f32 v169, v169, v24
    v_exp_f32 v27, v143
    v_add_f32 v169, v169, v25
    v_cvt_pk_bf16_f32 v182, v24, v25
    v_add_f32 v169, v169, v26
    v_add_f32 v169, v169, v27
    v_cvt_pk_bf16_f32 v183, v26, v27
    v_mfma_f32_16x16x32_bf16 v[152:155], v[216:219], v[124:127], v[152:155]
    buffer_load_dwordx4 v12, s[20:23], s46 offen offset:2048  lds
    v_max_f32 v30, v168, v169
    v_cmp_lt_f32 vcc, s49, v30
    v_mfma_f32_16x16x32_bf16 v[148:151], v[220:223], v[108:111], v[148:151]
    s_cbranch_vccnz LP_r2
LP_b2:
    v_mfma_f32_16x16x32_bf16 v[156:159], v[220:223], v[124:127], v[156:159]
    buffer_load_dwordx4 v13, s[20:23], s46 offen offset:3072  lds
    s_waitcnt lgkmcnt(0)
    v_mfma_f32_16x16x32_bf16 v[32:35], v[224:227], v[176:179], v[32:35]
    s_add_u32 s46, s4, 131072
    s_add_u32 m0, s59, 0
    ds_read_b128 v[192:195], v3 offset:0
    ds_read_b128 v[196:199], v3 offset:512
    v_mfma_f32_16x16x32_bf16 v[64:67], v[224:227], v[180:183], v[64:67]
    buffer_load_dwordx4 v10, s[20:23], s46 offen offset:0  lds
    ds_read_b128 v[200:203], v3 offset:64
    ds_read_b128 v[204:207], v3 offset:576
    v_mfma_f32_16x16x32_bf16 v[36:39], v[228:231], v[176:179], v[36:39]
    ds_read_b128 v[208:211], v3 offset:128
    ds_read_b128 v[212:215], v3 offset:640
    v_mfma_f32_16x16x32_bf16 v[68:71], v[228:231], v[180:183], v[68:71]
    buffer_load_dwordx4 v11, s[20:23], s46 offen offset:1024  lds
    ds_read_b128 v[216:219], v3 offset:192
    ds_read_b128 v[220:223], v3 offset:704
    v_mfma_f32_16x16x32_bf16 v[40:43], v[232:235], v[176:179], v[40:43]
    v_mfma_f32_16x16x32_bf16 v[72:75], v[232:235], v[180:183], v[72:75]
    buffer_load_dwordx4 v12, s[20:23], s46 offen offset:2048  lds
    v_mfma_f32_16x16x32_bf16 v[44:47], v[236:239], v[176:179], v[44:47]
    v_mfma_f32_16x16x32_bf16 v[76:79], v[236:239], v[180:183], v[76:79]
    buffer_load_dwordx4 v13, s[20:23], s46 offen offset:3072  lds
    v_mfma_f32_16x16x32_bf16 v[48:51], v[240:243], v[176:179], v[48:51]
    v_mfma_f32_16x16x32_bf16 v[80:83], v[240:243], v[180:183], v[80:83]
    v_mfma_f32_16x16x32_bf16 v[52:55], v[244:247], v[176:179], v[52:55]
    v_mfma_f32_16x16x32_bf16 v[84:87], v[244:247], v[180:183], v[84:87]
    v_mfma_f32_16x16x32_bf16 v[56:59], v[248:251], v[176:179], v[56:59]
    v_mfma_f32_16x16x32_bf16 v[88:91], v[248:251], v[180:183], v[88:91]
    v_mfma_f32_16x16x32_bf16 v[60:63], v[252:255], v[176:179], v[60:63]
    v_exp_f32 v20, v144
    v_exp_f32 v21, v145
    v_exp_f32 v22, v146
    v_add_f32 v170, v168, v20
    v_exp_f32 v23, v147
    v_add_f32 v170, v170, v21
    v_cvt_pk_bf16_f32 v184, v20, v21
    v_exp_f32 v24, v148
    v_add_f32 v170, v170, v22
    v_exp_f32 v25, v149
    v_mfma_f32_16x16x32_bf16 v[92:95], v[252:255], v[180:183], v[92:95]
    v_add_f32 v170, v170, v23
    v_cvt_pk_bf16_f32 v185, v22, v23
    v_exp_f32 v26, v150
    v_add_f32 v170, v170, v24
    v_exp_f32 v27, v151
    v_add_f32 v170, v170, v25
    v_cvt_pk_bf16_f32 v186, v24, v25
    v_exp_f32 v20, v152
    v_add_f32 v170, v170, v26
    s_waitcnt vmcnt(21) lgkmcnt(0)
    s_barrier
    v_mfma_f32_16x16x32_bf16 v[128:131], v[192:195], v[96:99], v[160:163]
    s_mov_b32 s46, 73728
    s_add_u32 m0, s52, 16896
    v_mfma_f32_16x16x32_bf16 v[136:139], v[192:195], v[112:115], v[164:167]
    buffer_load_dwordx4 v6, s[8:11], s46 offen offset:0 nt lds
    v_mfma_f32_16x16x32_bf16 v[132:135], v[196:199], v[96:99], v[160:163]
    s_add_u32 m0, s52, 17696
    v_mfma_f32_16x16x32_bf16 v[140:143], v[196:199], v[112:115], v[164:167]
    buffer_load_dwordx4 v6, s[8:11], s46 offen offset:256 nt lds
    v_mfma_f32_16x16x32_bf16 v[128:131], v[200:203], v[100:103], v[128:131]
    s_mov_b32 s46, 57344
    s_add_u32 m0, s52, 25344
    v_mfma_f32_16x16x32_bf16 v[136:139], v[200:203], v[116:119], v[136:139]
    buffer_load_dwordx4 v6, s[12:15], s46 offen offset:0 nt lds
    v_mfma_f32_16x16x32_bf16 v[132:135], v[204:207], v[100:103], v[132:135]
    s_add_u32 m0, s52, 26144
    v_mfma_f32_16x16x32_bf16 v[140:143], v[204:207], v[116:119], v[140:143]
    buffer_load_dwordx4 v6, s[12:15], s46 offen offset:256 nt lds
    v_mfma_f32_16x16x32_bf16 v[128:131], v[208:211], v[104:107], v[128:131]
    s_add_u32 s46, s4, 262144
    s_add_u32 m0, s59, 33792
    ds_read_b64_tr_b16 v[224:225], v17 offset:16896
    ds_read_b64_tr_b16 v[226:227], v17 offset:17408
    ds_read_b64_tr_b16 v[228:229], v17 offset:16928
    ds_read_b64_tr_b16 v[230:231], v17 offset:17440
    v_mfma_f32_16x16x32_bf16 v[136:139], v[208:211], v[120:123], v[136:139]
    buffer_load_dwordx4 v10, s[20:23], s46 offen offset:0  lds
    ds_read_b64_tr_b16 v[232:233], v17 offset:16960
    ds_read_b64_tr_b16 v[234:235], v17 offset:17472
    ds_read_b64_tr_b16 v[236:237], v17 offset:16992
    ds_read_b64_tr_b16 v[238:239], v17 offset:17504
    v_mfma_f32_16x16x32_bf16 v[132:135], v[212:215], v[104:107], v[132:135]
    ds_read_b64_tr_b16 v[240:241], v17 offset:17024
    ds_read_b64_tr_b16 v[242:243], v17 offset:17536
    ds_read_b64_tr_b16 v[244:245], v17 offset:17056
    ds_read_b64_tr_b16 v[246:247], v17 offset:17568
    v_exp_f32 v21, v153
    v_add_f32 v170, v170, v27
    v_cvt_pk_bf16_f32 v187, v26, v27
    v_exp_f32 v22, v154
    v_add_f32 v171, v169, v20
    v_exp_f32 v23, v155
    v_add_f32 v171, v171, v21
    v_mfma_f32_16x16x32_bf16 v[140:143], v[212:215], v[120:123], v[140:143]
    buffer_load_dwordx4 v11, s[20:23], s46 offen offset:1024  lds
    ds_read_b64_tr_b16 v[248:249], v17 offset:17088
    ds_read_b64_tr_b16 v[250:251], v17 offset:17600
    ds_read_b64_tr_b16 v[252:253], v17 offset:17120
    ds_read_b64_tr_b16 v[254:255], v17 offset:17632
    v_cvt_pk_bf16_f32 v188, v20, v21
    v_exp_f32 v24, v156
    v_add_f32 v171, v171, v22
    v_exp_f32 v25, v157
    v_add_f32 v171, v171, v23
    v_cvt_pk_bf16_f32 v189, v22, v23
    v_exp_f32 v26, v158
    v_mfma_f32_16x16x32_bf16 v[128:131], v[216:219], v[108:111], v[128:131]
    v_add_f32 v171, v171, v24
    v_exp_f32 v27, v159
    v_add_f32 v171, v171, v25
    v_cvt_pk_bf16_f32 v190, v24, v25
    v_add_f32 v171, v171, v26
    v_add_f32 v171, v171, v27
    v_cvt_pk_bf16_f32 v191, v26, v27
    v_mfma_f32_16x16x32_bf16 v[136:139], v[216:219], v[124:127], v[136:139]
    buffer_load_dwordx4 v12, s[20:23], s46 offen offset:2048  lds
    v_max_f32 v30, v170, v171
    v_cmp_lt_f32 vcc, s49, v30
    v_mfma_f32_16x16x32_bf16 v[132:135], v[220:223], v[108:111], v[132:135]
    s_cbranch_vccnz LP_r3
LP_b3:
    v_mfma_f32_16x16x32_bf16 v[140:143], v[220:223], v[124:127], v[140:143]
    buffer_load_dwordx4 v13, s[20:23], s46 offen offset:3072  lds
    s_waitcnt lgkmcnt(0)
    v_mfma_f32_16x16x32_bf16 v[32:35], v[224:227], v[184:187], v[32:35]
    s_add_u32 s46, s4, 393216
    s_add_u32 m0, s59, 50688
    ds_read_b128 v[192:195], v3 offset:16896
    ds_read_b128 v[196:199], v3 offset:17408
    v_mfma_f32_16x16x32_bf16 v[64:67], v[224:227], v[188:191], v[64:67]
    buffer_load_dwordx4 v10, s[20:23], s46 offen offset:0  lds
    ds_read_b128 v[200:203], v3 offset:16960
    ds_read_b128 v[204:207], v3 offset:17472
    v_mfma_f32_16x16x32_bf16 v[36:39], v[228:231], v[184:187], v[36:39]
    ds_read_b128 v[208:211], v3 offset:17024
    ds_read_b128 v[212:215], v3 offset:17536
    v_mfma_f32_16x16x32_bf16 v[68:71], v[228:231], v[188:191], v[68:71]
    buffer_load_dwordx4 v11, s[20:23], s46 offen offset:1024  lds
    ds_read_b128 v[216:219], v3 offset:17088
    ds_read_b128 v[220:223], v3 offset:17600
    v_mfma_f32_16x16x32_bf16 v[40:43], v[232:235], v[184:187], v[40:43]
    v_mfma_f32_16x16x32_bf16 v[72:75], v[232:235], v[188:191], v[72:75]
    buffer_load_dwordx4 v12, s[20:23], s46 offen offset:2048  lds
    v_mfma_f32_16x16x32_bf16 v[44:47], v[236:239], v[184:187], v[44:47]
    v_mfma_f32_16x16x32_bf16 v[76:79], v[236:239], v[188:191], v[76:79]
    buffer_load_dwordx4 v13, s[20:23], s46 offen offset:3072  lds
    v_mfma_f32_16x16x32_bf16 v[48:51], v[240:243], v[184:187], v[48:51]
    v_mfma_f32_16x16x32_bf16 v[80:83], v[240:243], v[188:191], v[80:83]
    v_mfma_f32_16x16x32_bf16 v[52:55], v[244:247], v[184:187], v[52:55]
    v_mfma_f32_16x16x32_bf16 v[84:87], v[244:247], v[188:191], v[84:87]
    v_mfma_f32_16x16x32_bf16 v[56:59], v[248:251], v[184:187], v[56:59]
    v_mfma_f32_16x16x32_bf16 v[88:91], v[248:251], v[188:191], v[88:91]
    v_mfma_f32_16x16x32_bf16 v[60:63], v[252:255], v[184:187], v[60:63]
    v_exp_f32 v20, v128
    v_exp_f32 v21, v129
    v_exp_f32 v22, v130
    v_add_f32 v168, v170, v20
    v_exp_f32 v23, v131
    v_add_f32 v168, v168, v21
    v_cvt_pk_bf16_f32 v176, v20, v21
    v_exp_f32 v24, v132
    v_add_f32 v168, v168, v22
    v_exp_f32 v25, v133
    v_mfma_f32_16x16x32_bf16 v[92:95], v[252:255], v[188:191], v[92:95]
    v_add_f32 v168, v168, v23
    v_cvt_pk_bf16_f32 v177, v22, v23
    v_exp_f32 v26, v134
    v_add_f32 v168, v168, v24
    v_exp_f32 v27, v135
    v_add_f32 v168, v168, v25
    v_cvt_pk_bf16_f32 v178, v24, v25
    v_exp_f32 v20, v136
    v_add_f32 v168, v168, v26
    s_waitcnt vmcnt(12) lgkmcnt(0)
    s_barrier
    v_mfma_f32_16x16x32_bf16 v[144:147], v[192:195], v[96:99], v[160:163]
    s_mov_b32 s46, 81920
    s_add_u32 m0, s52, 67584
    v_mfma_f32_16x16x32_bf16 v[152:155], v[192:195], v[112:115], v[164:167]
    buffer_load_dwordx4 v6, s[8:11], s46 offen offset:0 nt lds
    v_mfma_f32_16x16x32_bf16 v[148:151], v[196:199], v[96:99], v[160:163]
    s_add_u32 m0, s52, 68384
    v_mfma_f32_16x16x32_bf16 v[156:159], v[196:199], v[112:115], v[164:167]
    buffer_load_dwordx4 v6, s[8:11], s46 offen offset:256 nt lds
    v_mfma_f32_16x16x32_bf16 v[144:147], v[200:203], v[100:103], v[144:147]
    s_mov_b32 s46, 65536
    s_add_u32 m0, s52, 76032
    v_mfma_f32_16x16x32_bf16 v[152:155], v[200:203], v[116:119], v[152:155]
    buffer_load_dwordx4 v6, s[12:15], s46 offen offset:0 nt lds
    v_mfma_f32_16x16x32_bf16 v[148:151], v[204:207], v[100:103], v[148:151]
    s_add_u32 m0, s52, 76832
    v_mfma_f32_16x16x32_bf16 v[156:159], v[204:207], v[116:119], v[156:159]
    buffer_load_dwordx4 v6, s[12:15], s46 offen offset:256 nt lds
    v_mfma_f32_16x16x32_bf16 v[144:147], v[208:211], v[104:107], v[144:147]
    ds_read_b64_tr_b16 v[224:225], v17 offset:33792
    ds_read_b64_tr_b16 v[226:227], v17 offset:34304
    ds_read_b64_tr_b16 v[228:229], v17 offset:33824
    ds_read_b64_tr_b16 v[230:231], v17 offset:34336
    v_mfma_f32_16x16x32_bf16 v[152:155], v[208:211], v[120:123], v[152:155]
    ds_read_b64_tr_b16 v[232:233], v17 offset:33856
    ds_read_b64_tr_b16 v[234:235], v17 offset:34368
    ds_read_b64_tr_b16 v[236:237], v17 offset:33888
    ds_read_b64_tr_b16 v[238:239], v17 offset:34400
    v_mfma_f32_16x16x32_bf16 v[148:151], v[212:215], v[104:107], v[148:151]
    ds_read_b64_tr_b16 v[240:241], v17 offset:33920
    ds_read_b64_tr_b16 v[242:243], v17 offset:34432
    ds_read_b64_tr_b16 v[244:245], v17 offset:33952
    ds_read_b64_tr_b16 v[246:247], v17 offset:34464
    v_exp_f32 v21, v137
    v_add_f32 v168, v168, v27
    v_cvt_pk_bf16_f32 v179, v26, v27
    v_exp_f32 v22, v138
    v_add_f32 v169, v171, v20
    v_exp_f32 v23, v139
    v_add_f32 v169, v169, v21
    v_mfma_f32_16x16x32_bf16 v[156:159], v[212:215], v[120:123], v[156:159]
    ds_read_b64_tr_b16 v[248:249], v17 offset:33984
    ds_read_b64_tr_b16 v[250:251], v17 offset:34496
    ds_read_b64_tr_b16 v[252:253], v17 offset:34016
    ds_read_b64_tr_b16 v[254:255], v17 offset:34528
    v_cvt_pk_bf16_f32 v180, v20, v21
    v_exp_f32 v24, v140
    v_add_f32 v169, v169, v22
    v_exp_f32 v25, v141
    v_add_f32 v169, v169, v23
    v_cvt_pk_bf16_f32 v181, v22, v23
    v_exp_f32 v26, v142
    v_mfma_f32_16x16x32_bf16 v[144:147], v[216:219], v[108:111], v[144:147]
    v_add_f32 v169, v169, v24
    v_exp_f32 v27, v143
    v_add_f32 v169, v169, v25
    v_cvt_pk_bf16_f32 v182, v24, v25
    v_add_f32 v169, v169, v26
    v_add_f32 v169, v169, v27
    v_cvt_pk_bf16_f32 v183, v26, v27
    v_mfma_f32_16x16x32_bf16 v[152:155], v[216:219], v[124:127], v[152:155]
    v_max_f32 v30, v168, v169
    v_cmp_lt_f32 vcc, s49, v30
    v_mfma_f32_16x16x32_bf16 v[148:151], v[220:223], v[108:111], v[148:151]
    s_cbranch_vccnz LP_r4
LP_b4:
    v_mfma_f32_16x16x32_bf16 v[156:159], v[220:223], v[124:127], v[156:159]
    s_waitcnt lgkmcnt(0)
    v_mfma_f32_16x16x32_bf16 v[32:35], v[224:227], v[176:179], v[32:35]
    ds_read_b128 v[192:195], v3 offset:33792
    ds_read_b128 v[196:199], v3 offset:34304
    v_mfma_f32_16x16x32_bf16 v[64:67], v[224:227], v[180:183], v[64:67]
    ds_read_b128 v[200:203], v3 offset:33856
    ds_read_b128 v[204:207], v3 offset:34368
    v_mfma_f32_16x16x32_bf16 v[36:39], v[228:231], v[176:179], v[36:39]
    ds_read_b128 v[208:211], v3 offset:33920
    ds_read_b128 v[212:215], v3 offset:34432
    v_mfma_f32_16x16x32_bf16 v[68:71], v[228:231], v[180:183], v[68:71]
    ds_read_b128 v[216:219], v3 offset:33984
    ds_read_b128 v[220:223], v3 offset:34496
    v_mfma_f32_16x16x32_bf16 v[40:43], v[232:235], v[176:179], v[40:43]
    ds_read_b64_tr_b16 a[0:1], v5 offset:33792
    ds_read_b64_tr_b16 a[2:3], v5 offset:37888
    v_mfma_f32_16x16x32_bf16 v[72:75], v[232:235], v[180:183], v[72:75]
    ds_read_b64_tr_b16 a[4:5], v5 offset:33800
    ds_read_b64_tr_b16 a[6:7], v5 offset:37896
    v_mfma_f32_16x16x32_bf16 v[44:47], v[236:239], v[176:179], v[44:47]
    ds_read_b64_tr_b16 a[8:9], v5 offset:41984
    v_mfma_f32_16x16x32_bf16 v[76:79], v[236:239], v[180:183], v[76:79]
    ds_read_b64_tr_b16 a[10:11], v5 offset:46080
    ds_read_b64_tr_b16 a[12:13], v5 offset:41992
    v_mfma_f32_16x16x32_bf16 v[48:51], v[240:243], v[176:179], v[48:51]
    ds_read_b64_tr_b16 a[14:15], v5 offset:46088
    v_mfma_f32_16x16x32_bf16 v[80:83], v[240:243], v[180:183], v[80:83]
    ds_read_b64_tr_b16 a[16:17], v14 offset:0
    ds_read_b64_tr_b16 a[18:19], v14 offset:4096
    v_mfma_f32_16x16x32_bf16 v[52:55], v[244:247], v[176:179], v[52:55]
    ds_read_b64_tr_b16 a[20:21], v14 offset:8
    ds_read_b64_tr_b16 a[22:23], v14 offset:4104
    v_mfma_f32_16x16x32_bf16 v[84:87], v[244:247], v[180:183], v[84:87]
    ds_read_b64_tr_b16 a[24:25], v14 offset:8192
    v_mfma_f32_16x16x32_bf16 v[56:59], v[248:251], v[176:179], v[56:59]
    ds_read_b64_tr_b16 a[26:27], v14 offset:12288
    ds_read_b64_tr_b16 a[28:29], v14 offset:8200
    v_mfma_f32_16x16x32_bf16 v[88:91], v[248:251], v[180:183], v[88:91]
    ds_read_b64_tr_b16 a[30:31], v14 offset:12296
    v_mfma_f32_16x16x32_bf16 v[60:63], v[252:255], v[176:179], v[60:63]
    v_exp_f32 v20, v144
    v_exp_f32 v21, v145
    v_exp_f32 v22, v146
    v_add_f32 v170, v168, v20
    v_exp_f32 v23, v147
    v_add_f32 v170, v170, v21
    v_cvt_pk_bf16_f32 v184, v20, v21
    v_exp_f32 v24, v148
    v_add_f32 v170, v170, v22
    v_exp_f32 v25, v149
    v_mfma_f32_16x16x32_bf16 v[92:95], v[252:255], v[180:183], v[92:95]
    v_add_f32 v170, v170, v23
    v_cvt_pk_bf16_f32 v185, v22, v23
    v_exp_f32 v26, v150
    v_add_f32 v170, v170, v24
    v_exp_f32 v27, v151
    v_add_f32 v170, v170, v25
    v_cvt_pk_bf16_f32 v186, v24, v25
    v_exp_f32 v20, v152
    v_add_f32 v170, v170, v26
    s_waitcnt vmcnt(4) lgkmcnt(0)
    s_barrier
    v_mfma_f32_16x16x32_bf16 v[128:131], v[192:195], v[96:99], v[160:163]
    s_add_u32 s46, s5, 0
    s_add_u32 m0, s59, 84480
    v_mfma_f32_16x16x32_bf16 v[136:139], v[192:195], v[112:115], v[164:167]
    buffer_load_dwordx4 v10, s[20:23], s46 offen offset:0  lds
    v_mfma_f32_16x16x32_bf16 v[132:135], v[196:199], v[96:99], v[160:163]
    v_mfma_f32_16x16x32_bf16 v[140:143], v[196:199], v[112:115], v[164:167]
    buffer_load_dwordx4 v11, s[20:23], s46 offen offset:1024  lds
    v_mfma_f32_16x16x32_bf16 v[128:131], v[200:203], v[100:103], v[128:131]
    v_mfma_f32_16x16x32_bf16 v[136:139], v[200:203], v[116:119], v[136:139]
    buffer_load_dwordx4 v12, s[20:23], s46 offen offset:2048  lds
    v_mfma_f32_16x16x32_bf16 v[132:135], v[204:207], v[100:103], v[132:135]
    v_mfma_f32_16x16x32_bf16 v[140:143], v[204:207], v[116:119], v[140:143]
    buffer_load_dwordx4 v13, s[20:23], s46 offen offset:3072  lds
    v_mfma_f32_16x16x32_bf16 v[128:131], v[208:211], v[104:107], v[128:131]
    s_add_u32 s46, s5, 131072
    s_add_u32 m0, s59, 135168
    ds_read_b64_tr_b16 v[224:225], v18 offset:0
    ds_read_b64_tr_b16 v[226:227], v18 offset:512
    ds_read_b64_tr_b16 v[228:229], v18 offset:32
    ds_read_b64_tr_b16 v[230:231], v18 offset:544
    v_mfma_f32_16x16x32_bf16 v[136:139], v[208:211], v[120:123], v[136:139]
    buffer_load_dwordx4 v10, s[20:23], s46 offen offset:0  lds
    ds_read_b64_tr_b16 v[232:233], v18 offset:64
    ds_read_b64_tr_b16 v[234:235], v18 offset:576
    ds_read_b64_tr_b16 v[236:237], v18 offset:96
    ds_read_b64_tr_b16 v[238:239], v18 offset:608
    v_mfma_f32_16x16x32_bf16 v[132:135], v[212:215], v[104:107], v[132:135]
    ds_read_b64_tr_b16 v[240:241], v18 offset:128
    ds_read_b64_tr_b16 v[242:243], v18 offset:640
    ds_read_b64_tr_b16 v[244:245], v18 offset:160
    ds_read_b64_tr_b16 v[246:247], v18 offset:672
    v_exp_f32 v21, v153
    v_add_f32 v170, v170, v27
    v_cvt_pk_bf16_f32 v187, v26, v27
    v_exp_f32 v22, v154
    v_add_f32 v171, v169, v20
    v_exp_f32 v23, v155
    v_add_f32 v171, v171, v21
    v_mfma_f32_16x16x32_bf16 v[140:143], v[212:215], v[120:123], v[140:143]
    buffer_load_dwordx4 v11, s[20:23], s46 offen offset:1024  lds
    ds_read_b64_tr_b16 v[248:249], v18 offset:192
    ds_read_b64_tr_b16 v[250:251], v18 offset:704
    ds_read_b64_tr_b16 v[252:253], v18 offset:224
    ds_read_b64_tr_b16 v[254:255], v18 offset:736
    v_cvt_pk_bf16_f32 v188, v20, v21
    v_exp_f32 v24, v156
    v_add_f32 v171, v171, v22
    v_exp_f32 v25, v157
    v_add_f32 v171, v171, v23
    v_cvt_pk_bf16_f32 v189, v22, v23
    v_exp_f32 v26, v158
    v_mfma_f32_16x16x32_bf16 v[128:131], v[216:219], v[108:111], v[128:131]
    v_add_f32 v171, v171, v24
    v_exp_f32 v27, v159
    v_add_f32 v171, v171, v25
    v_cvt_pk_bf16_f32 v190, v24, v25
    v_add_f32 v171, v171, v26
    v_add_f32 v171, v171, v27
    v_cvt_pk_bf16_f32 v191, v26, v27
    v_mfma_f32_16x16x32_bf16 v[136:139], v[216:219], v[124:127], v[136:139]
    buffer_load_dwordx4 v12, s[20:23], s46 offen offset:2048  lds
    v_max_f32 v30, v170, v171
    v_cmp_lt_f32 vcc, s49, v30
    v_mfma_f32_16x16x32_bf16 v[132:135], v[220:223], v[108:111], v[132:135]
    s_cbranch_vccnz LP_r5
LP_b5:
    v_mfma_f32_16x16x32_bf16 v[140:143], v[220:223], v[124:127], v[140:143]
    buffer_load_dwordx4 v13, s[20:23], s46 offen offset:3072  lds
    s_waitcnt lgkmcnt(0)
    v_mfma_f32_16x16x32_bf16 v[32:35], v[224:227], v[184:187], v[32:35]
    s_mov_b32 s46, 90112
    s_add_u32 m0, s52, 0
    ds_read_b128 v[192:195], v4 offset:0
    ds_read_b128 v[196:199], v4 offset:512
    v_mfma_f32_16x16x32_bf16 v[64:67], v[224:227], v[188:191], v[64:67]
    buffer_load_dwordx4 v6, s[8:11], s46 offen offset:0 nt lds
    ds_read_b128 v[200:203], v4 offset:64
    ds_read_b128 v[204:207], v4 offset:576
    v_mfma_f32_16x16x32_bf16 v[36:39], v[228:231], v[184:187], v[36:39]
    s_add_u32 m0, s52, 800
    ds_read_b128 v[208:211], v4 offset:128
    ds_read_b128 v[212:215], v4 offset:640
    v_mfma_f32_16x16x32_bf16 v[68:71], v[228:231], v[188:191], v[68:71]
    buffer_load_dwordx4 v6, s[8:11], s46 offen offset:256 nt lds
    ds_read_b128 v[216:219], v4 offset:192
    ds_read_b128 v[220:223], v4 offset:704
    v_mfma_f32_16x16x32_bf16 v[40:43], v[232:235], v[184:187], v[40:43]
    s_mov_b32 s46, 73728
    s_add_u32 m0, s52, 8448
    ds_read_b64_tr_b16 a[32:33], v14 offset:33792
    ds_read_b64_tr_b16 a[34:35], v14 offset:37888
    v_mfma_f32_16x16x32_bf16 v[72:75], v[232:235], v[188:191], v[72:75]
    buffer_load_dwordx4 v6, s[12:15], s46 offen offset:0 nt lds
    ds_read_b64_tr_b16 a[36:37], v14 offset:33800
    ds_read_b64_tr_b16 a[38:39], v14 offset:37896
    v_mfma_f32_16x16x32_bf16 v[44:47], v[236:239], v[184:187], v[44:47]
    s_add_u32 m0, s52, 9248
    ds_read_b64_tr_b16 a[40:41], v14 offset:41984
    v_mfma_f32_16x16x32_bf16 v[76:79], v[236:239], v[188:191], v[76:79]
    buffer_load_dwordx4 v6, s[12:15], s46 offen offset:256 nt lds
    ds_read_b64_tr_b16 a[42:43], v14 offset:46080
    ds_read_b64_tr_b16 a[44:45], v14 offset:41992
    v_mfma_f32_16x16x32_bf16 v[48:51], v[240:243], v[184:187], v[48:51]
    ds_read_b64_tr_b16 a[46:47], v14 offset:46088
    v_mfma_f32_16x16x32_bf16 v[80:83], v[240:243], v[188:191], v[80:83]
    ds_read_b64_tr_b16 a[48:49], v19 offset:0
    ds_read_b64_tr_b16 a[50:51], v19 offset:4096
    v_mfma_f32_16x16x32_bf16 v[52:55], v[244:247], v[184:187], v[52:55]
    ds_read_b64_tr_b16 a[52:53], v19 offset:8
    ds_read_b64_tr_b16 a[54:55], v19 offset:4104
    v_mfma_f32_16x16x32_bf16 v[84:87], v[244:247], v[188:191], v[84:87]
    ds_read_b64_tr_b16 a[56:57], v19 offset:8192
    v_mfma_f32_16x16x32_bf16 v[56:59], v[248:251], v[184:187], v[56:59]
    ds_read_b64_tr_b16 a[58:59], v19 offset:12288
    ds_read_b64_tr_b16 a[60:61], v19 offset:8200
    v_mfma_f32_16x16x32_bf16 v[88:91], v[248:251], v[188:191], v[88:91]
    ds_read_b64_tr_b16 a[62:63], v19 offset:12296
    v_mfma_f32_16x16x32_bf16 v[60:63], v[252:255], v[184:187], v[60:63]
    v_exp_f32 v20, v128
    v_exp_f32 v21, v129
    v_exp_f32 v22, v130
    v_add_f32 v168, v170, v20
    v_exp_f32 v23, v131
    v_add_f32 v168, v168, v21
    v_cvt_pk_bf16_f32 v176, v20, v21
    v_exp_f32 v24, v132
    v_add_f32 v168, v168, v22
    v_exp_f32 v25, v133
    v_mfma_f32_16x16x32_bf16 v[92:95], v[252:255], v[188:191], v[92:95]
    v_add_f32 v168, v168, v23
    v_cvt_pk_bf16_f32 v177, v22, v23
    v_exp_f32 v26, v134
    v_add_f32 v168, v168, v24
    v_exp_f32 v27, v135
    v_add_f32 v168, v168, v25
    v_cvt_pk_bf16_f32 v178, v24, v25
    v_exp_f32 v20, v136
    v_add_f32 v168, v168, v26
    s_waitcnt vmcnt(36) lgkmcnt(0)
    s_barrier
    v_mfma_f32_16x16x32_bf16 v[144:147], v[192:195], v[96:99], v[160:163]
    s_add_u32 s46, s5, 262144
    s_add_u32 m0, s59, 101376
    v_mfma_f32_16x16x32_bf16 v[152:155], v[192:195], v[112:115], v[164:167]
    buffer_load_dwordx4 v10, s[20:23], s46 offen offset:0  lds
    v_mfma_f32_16x16x32_bf16 v[148:151], v[196:199], v[96:99], v[160:163]
    v_mfma_f32_16x16x32_bf16 v[156:159], v[196:199], v[112:115], v[164:167]
    buffer_load_dwordx4 v11, s[20:23], s46 offen offset:1024  lds
    v_mfma_f32_16x16x32_bf16 v[144:147], v[200:203], v[100:103], v[144:147]
    v_mfma_f32_16x16x32_bf16 v[152:155], v[200:203], v[116:119], v[152:155]
    buffer_load_dwordx4 v12, s[20:23], s46 offen offset:2048  lds
    v_mfma_f32_16x16x32_bf16 v[148:151], v[204:207], v[100:103], v[148:151]
    v_mfma_f32_16x16x32_bf16 v[156:159], v[204:207], v[116:119], v[156:159]
    buffer_load_dwordx4 v13, s[20:23], s46 offen offset:3072  lds
    v_mfma_f32_16x16x32_bf16 v[144:147], v[208:211], v[104:107], v[144:147]
    s_add_u32 s46, s5, 393216
    s_add_u32 m0, s59, 33792
    ds_read_b64_tr_b16 v[224:225], v18 offset:16896
    ds_read_b64_tr_b16 v[226:227], v18 offset:17408
    ds_read_b64_tr_b16 v[228:229], v18 offset:16928
    ds_read_b64_tr_b16 v[230:231], v18 offset:17440
    v_mfma_f32_16x16x32_bf16 v[152:155], v[208:211], v[120:123], v[152:155]
    buffer_load_dwordx4 v10, s[20:23], s46 offen offset:0  lds
    ds_read_b64_tr_b16 v[232:233], v18 offset:16960
    ds_read_b64_tr_b16 v[234:235], v18 offset:17472
    ds_read_b64_tr_b16 v[236:237], v18 offset:16992
    ds_read_b64_tr_b16 v[238:239], v18 offset:17504
    v_mfma_f32_16x16x32_bf16 v[148:151], v[212:215], v[104:107], v[148:151]
    ds_read_b64_tr_b16 v[240:241], v18 offset:17024
    ds_read_b64_tr_b16 v[242:243], v18 offset:17536
    ds_read_b64_tr_b16 v[244:245], v18 offset:17056
    ds_read_b64_tr_b16 v[246:247], v18 offset:17568
    v_exp_f32 v21, v137
    v_add_f32 v168, v168, v27
    v_cvt_pk_bf16_f32 v179, v26, v27
    v_exp_f32 v22, v138
    v_add_f32 v169, v171, v20
    v_exp_f32 v23, v139
    v_add_f32 v169, v169, v21
    v_mfma_f32_16x16x32_bf16 v[156:159], v[212:215], v[120:123], v[156:159]
    buffer_load_dwordx4 v11, s[20:23], s46 offen offset:1024  lds
    ds_read_b64_tr_b16 v[248:249], v18 offset:17088
    ds_read_b64_tr_b16 v[250:251], v18 offset:17600
    ds_read_b64_tr_b16 v[252:253], v18 offset:17120
    ds_read_b64_tr_b16 v[254:255], v18 offset:17632
    v_cvt_pk_bf16_f32 v180, v20, v21
    v_exp_f32 v24, v140
    v_add_f32 v169, v169, v22
    v_exp_f32 v25, v141
    v_add_f32 v169, v169, v23
    v_cvt_pk_bf16_f32 v181, v22, v23
    v_exp_f32 v26, v142
    v_mfma_f32_16x16x32_bf16 v[144:147], v[216:219], v[108:111], v[144:147]
    v_add_f32 v169, v169, v24
    v_exp_f32 v27, v143
    v_add_f32 v169, v169, v25
    v_cvt_pk_bf16_f32 v182, v24, v25
    v_add_f32 v169, v169, v26
    v_add_f32 v169, v169, v27
    v_cvt_pk_bf16_f32 v183, v26, v27
    v_mfma_f32_16x16x32_bf16 v[152:155], v[216:219], v[124:127], v[152:155]
    buffer_load_dwordx4 v12, s[20:23], s46 offen offset:2048  lds
    v_max_f32 v30, v168, v169
    v_cmp_lt_f32 vcc, s49, v30
    v_mfma_f32_16x16x32_bf16 v[148:151], v[220:223], v[108:111], v[148:151]
    s_cbranch_vccnz LP_r6
LP_b6:
    v_mfma_f32_16x16x32_bf16 v[156:159], v[220:223], v[124:127], v[156:159]
    buffer_load_dwordx4 v13, s[20:23], s46 offen offset:3072  lds
    s_waitcnt lgkmcnt(0)
    v_mfma_f32_16x16x32_bf16 v[32:35], v[224:227], v[176:179], v[32:35]
    s_mov_b32 s46, 98304
    s_add_u32 m0, s52, 50688
    ds_read_b128 v[192:195], v4 offset:16896
    ds_read_b128 v[196:199], v4 offset:17408
    v_mfma_f32_16x16x32_bf16 v[64:67], v[224:227], v[180:183], v[64:67]
    buffer_load_dwordx4 v6, s[8:11], s46 offen offset:0 nt lds
    ds_read_b128 v[200:203], v4 offset:16960
    ds_read_b128 v[204:207], v4 offset:17472
    v_mfma_f32_16x16x32_bf16 v[36:39], v[228:231], v[176:179], v[36:39]
    s_add_u32 m0, s52, 51488
    ds_read_b128 v[208:211], v4 offset:17024
    ds_read_b128 v[212:215], v4 offset:17536
    v_mfma_f32_16x16x32_bf16 v[68:71], v[228:231], v[180:183], v[68:71]
    buffer_load_dwordx4 v6, s[8:11], s46 offen offset:256 nt lds
    ds_read_b128 v[216:219], v4 offset:17088
    ds_read_b128 v[220:223], v4 offset:17600
    v_mfma_f32_16x16x32_bf16 v[40:43], v[232:235], v[176:179], v[40:43]
    s_mov_b32 s46, 81920
    s_add_u32 m0, s52, 59136
    v_mfma_f32_16x16x32_bf16 v[72:75], v[232:235], v[180:183], v[72:75]
    buffer_load_dwordx4 v6, s[12:15], s46 offen offset:0 nt lds
    v_mfma_f32_16x16x32_bf16 v[44:47], v[236:239], v[176:179], v[44:47]
    s_add_u32 m0, s52, 59936
    v_mfma_f32_16x16x32_bf16 v[76:79], v[236:239], v[180:183], v[76:79]
    buffer_load_dwordx4 v6, s[12:15], s46 offen offset:256 nt lds
    v_mfma_f32_16x16x32_bf16 v[48:51], v[240:243], v[176:179], v[48:51]
    v_mfma_f32_16x16x32_bf16 v[80:83], v[240:243], v[180:183], v[80:83]
    v_mfma_f32_16x16x32_bf16 v[52:55], v[244:247], v[176:179], v[52:55]
    v_mfma_f32_16x16x32_bf16 v[84:87], v[244:247], v[180:183], v[84:87]
    v_mfma_f32_16x16x32_bf16 v[56:59], v[248:251], v[176:179], v[56:59]
    v_mfma_f32_16x16x32_bf16 v[88:91], v[248:251], v[180:183], v[88:91]
    v_mfma_f32_16x16x32_bf16 v[60:63], v[252:255], v[176:179], v[60:63]
    v_exp_f32 v20, v144
    v_exp_f32 v21, v145
    v_exp_f32 v22, v146
    v_add_f32 v170, v168, v20
    v_exp_f32 v23, v147
    v_add_f32 v170, v170, v21
    v_cvt_pk_bf16_f32 v184, v20, v21
    v_exp_f32 v24, v148
    v_add_f32 v170, v170, v22
    v_exp_f32 v25, v149
    v_mfma_f32_16x16x32_bf16 v[92:95], v[252:255], v[180:183], v[92:95]
    v_add_f32 v170, v170, v23
    v_cvt_pk_bf16_f32 v185, v22, v23
    v_exp_f32 v26, v150
    v_add_f32 v170, v170, v24
    v_exp_f32 v27, v151
    v_add_f32 v170, v170, v25
    v_cvt_pk_bf16_f32 v186, v24, v25
    v_exp_f32 v20, v152
    v_add_f32 v170, v170, v26
    s_waitcnt vmcnt(16) lgkmcnt(0)
    s_barrier
    v_mfma_f32_16x16x32_bf16 v[128:131], v[192:195], v[96:99], v[160:163]
    s_add_u32 s46, s6, 0
    s_add_u32 m0, s59, 118272
    v_mfma_f32_16x16x32_bf16 v[136:139], v[192:195], v[112:115], v[164:167]
    buffer_load_dwordx4 v10, s[20:23], s46 offen offset:0  lds
    v_mfma_f32_16x16x32_bf16 v[132:135], v[196:199], v[96:99], v[160:163]
    v_mfma_f32_16x16x32_bf16 v[140:143], v[196:199], v[112:115], v[164:167]
    buffer_load_dwordx4 v11, s[20:23], s46 offen offset:1024  lds
    v_mfma_f32_16x16x32_bf16 v[128:131], v[200:203], v[100:103], v[128:131]
    v_mfma_f32_16x16x32_bf16 v[136:139], v[200:203], v[116:119], v[136:139]
    buffer_load_dwordx4 v12, s[20:23], s46 offen offset:2048  lds
    v_mfma_f32_16x16x32_bf16 v[132:135], v[204:207], v[100:103], v[132:135]
    v_mfma_f32_16x16x32_bf16 v[140:143], v[204:207], v[116:119], v[140:143]
    buffer_load_dwordx4 v13, s[20:23], s46 offen offset:3072  lds
    v_mfma_f32_16x16x32_bf16 v[128:131], v[208:211], v[104:107], v[128:131]
    ds_read_b64_tr_b16 v[224:225], v16 offset:16896
    ds_read_b64_tr_b16 v[226:227], v16 offset:17408
    ds_read_b64_tr_b16 v[228:229], v16 offset:16928
    ds_read_b64_tr_b16 v[230:231], v16 offset:17440
    v_mfma_f32_16x16x32_bf16 v[136:139], v[208:211], v[120:123], v[136:139]
    ds_read_b64_tr_b16 v[232:233], v16 offset:16960
    ds_read_b64_tr_b16 v[234:235], v16 offset:17472
    ds_read_b64_tr_b16 v[236:237], v16 offset:16992
    ds_read_b64_tr_b16 v[238:239], v16 offset:17504
    v_mfma_f32_16x16x32_bf16 v[132:135], v[212:215], v[104:107], v[132:135]
    ds_read_b64_tr_b16 v[240:241], v16 offset:17024
    ds_read_b64_tr_b16 v[242:243], v16 offset:17536
    ds_read_b64_tr_b16 v[244:245], v16 offset:17056
    ds_read_b64_tr_b16 v[246:247], v16 offset:17568
    v_exp_f32 v21, v153
    v_add_f32 v170, v170, v27
    v_cvt_pk_bf16_f32 v187, v26, v27
    v_exp_f32 v22, v154
    v_add_f32 v171, v169, v20
    v_exp_f32 v23, v155
    v_add_f32 v171, v171, v21
    v_mfma_f32_16x16x32_bf16 v[140:143], v[212:215], v[120:123], v[140:143]
    ds_read_b64_tr_b16 v[248:249], v16 offset:17088
    ds_read_b64_tr_b16 v[250:251], v16 offset:17600
    ds_read_b64_tr_b16 v[252:253], v16 offset:17120
    ds_read_b64_tr_b16 v[254:255], v16 offset:17632
    v_cvt_pk_bf16_f32 v188, v20, v21
    v_exp_f32 v24, v156
    v_add_f32 v171, v171, v22
    v_exp_f32 v25, v157
    v_add_f32 v171, v171, v23
    v_cvt_pk_bf16_f32 v189, v22, v23
    v_exp_f32 v26, v158
    v_mfma_f32_16x16x32_bf16 v[128:131], v[216:219], v[108:111], v[128:131]
    v_add_f32 v171, v171, v24
    v_exp_f32 v27, v159
    v_add_f32 v171, v171, v25
    v_cvt_pk_bf16_f32 v190, v24, v25
    v_add_f32 v171, v171, v26
    v_add_f32 v171, v171, v27
    v_cvt_pk_bf16_f32 v191, v26, v27
    v_mfma_f32_16x16x32_bf16 v[136:139], v[216:219], v[124:127], v[136:139]
    v_max_f32 v30, v170, v171
    v_cmp_lt_f32 vcc, s49, v30
    v_mfma_f32_16x16x32_bf16 v[132:135], v[220:223], v[108:111], v[132:135]
    s_cbranch_vccnz LP_r7
LP_b7:
    v_mfma_f32_16x16x32_bf16 v[140:143], v[220:223], v[124:127], v[140:143]
    s_waitcnt lgkmcnt(0)
    v_mfma_f32_16x16x32_bf16 v[32:35], v[224:227], v[184:187], v[32:35]
    ds_read_b128 v[192:195], v2 offset:16896
    ds_read_b128 v[196:199], v2 offset:17408
    v_mfma_f32_16x16x32_bf16 v[64:67], v[224:227], v[188:191], v[64:67]
    ds_read_b128 v[200:203], v2 offset:16960
    ds_read_b128 v[204:207], v2 offset:17472
    v_mfma_f32_16x16x32_bf16 v[36:39], v[228:231], v[184:187], v[36:39]
    ds_read_b128 v[208:211], v2 offset:17024
    ds_read_b128 v[212:215], v2 offset:17536
    v_mfma_f32_16x16x32_bf16 v[68:71], v[228:231], v[188:191], v[68:71]
    ds_read_b128 v[216:219], v2 offset:17088
    ds_read_b128 v[220:223], v2 offset:17600
    v_mfma_f32_16x16x32_bf16 v[40:43], v[232:235], v[184:187], v[40:43]
    ds_read_b64_tr_b16 a[64:65], v19 offset:33792
    ds_read_b64_tr_b16 a[66:67], v19 offset:37888
    v_mfma_f32_16x16x32_bf16 v[72:75], v[232:235], v[188:191], v[72:75]
    ds_read_b64_tr_b16 a[68:69], v19 offset:33800
    ds_read_b64_tr_b16 a[70:71], v19 offset:37896
    v_mfma_f32_16x16x32_bf16 v[44:47], v[236:239], v[184:187], v[44:47]
    ds_read_b64_tr_b16 a[72:73], v19 offset:41984
    v_mfma_f32_16x16x32_bf16 v[76:79], v[236:239], v[188:191], v[76:79]
    ds_read_b64_tr_b16 a[74:75], v19 offset:46080
    ds_read_b64_tr_b16 a[76:77], v19 offset:41992
    v_mfma_f32_16x16x32_bf16 v[48:51], v[240:243], v[184:187], v[48:51]
    ds_read_b64_tr_b16 a[78:79], v19 offset:46088
    v_mfma_f32_16x16x32_bf16 v[80:83], v[240:243], v[188:191], v[80:83]
    ds_read_b64_tr_b16 a[80:81], v5 offset:33792
    ds_read_b64_tr_b16 a[82:83], v5 offset:37888
    v_mfma_f32_16x16x32_bf16 v[52:55], v[244:247], v[184:187], v[52:55]
    ds_read_b64_tr_b16 a[84:85], v5 offset:33800
    ds_read_b64_tr_b16 a[86:87], v5 offset:37896
    v_mfma_f32_16x16x32_bf16 v[84:87], v[244:247], v[188:191], v[84:87]
    ds_read_b64_tr_b16 a[88:89], v5 offset:41984
    v_mfma_f32_16x16x32_bf16 v[56:59], v[248:251], v[184:187], v[56:59]
    ds_read_b64_tr_b16 a[90:91], v5 offset:46080
    ds_read_b64_tr_b16 a[92:93], v5 offset:41992
    v_mfma_f32_16x16x32_bf16 v[88:91], v[248:251], v[188:191], v[88:91]
    ds_read_b64_tr_b16 a[94:95], v5 offset:46088
    v_mfma_f32_16x16x32_bf16 v[60:63], v[252:255], v[184:187], v[60:63]
    v_exp_f32 v20, v128
    v_exp_f32 v21, v129
    v_exp_f32 v22, v130
    v_add_f32 v168, v170, v20
    v_exp_f32 v23, v131
    v_add_f32 v168, v168, v21
    v_cvt_pk_bf16_f32 v176, v20, v21
    v_exp_f32 v24, v132
    v_add_f32 v168, v168, v22
    v_exp_f32 v25, v133
    v_mfma_f32_16x16x32_bf16 v[92:95], v[252:255], v[188:191], v[92:95]
    v_add_f32 v168, v168, v23
    v_cvt_pk_bf16_f32 v177, v22, v23
    v_exp_f32 v26, v134
    v_add_f32 v168, v168, v24
    v_exp_f32 v27, v135
    v_add_f32 v168, v168, v25
    v_cvt_pk_bf16_f32 v178, v24, v25
    v_exp_f32 v20, v136
    v_add_f32 v168, v168, v26
    s_waitcnt vmcnt(8) lgkmcnt(0)
    s_barrier
    v_mfma_f32_16x16x32_bf16 v[144:147], v[192:195], v[96:99], v[160:163]
    s_add_u32 s46, s6, 131072
    s_add_u32 m0, s59, 16896
    v_mfma_f32_16x16x32_bf16 v[152:155], v[192:195], v[112:115], v[164:167]
    buffer_load_dwordx4 v10, s[20:23], s46 offen offset:0  lds
    v_mfma_f32_16x16x32_bf16 v[148:151], v[196:199], v[96:99], v[160:163]
    v_mfma_f32_16x16x32_bf16 v[156:159], v[196:199], v[112:115], v[164:167]
    buffer_load_dwordx4 v11, s[20:23], s46 offen offset:1024  lds
    v_mfma_f32_16x16x32_bf16 v[144:147], v[200:203], v[100:103], v[144:147]
    v_mfma_f32_16x16x32_bf16 v[152:155], v[200:203], v[116:119], v[152:155]
    buffer_load_dwordx4 v12, s[20:23], s46 offen offset:2048  lds
    v_mfma_f32_16x16x32_bf16 v[148:151], v[204:207], v[100:103], v[148:151]
    v_mfma_f32_16x16x32_bf16 v[156:159], v[204:207], v[116:119], v[156:159]
    buffer_load_dwordx4 v13, s[20:23], s46 offen offset:3072  lds
    v_mfma_f32_16x16x32_bf16 v[144:147], v[208:211], v[104:107], v[144:147]
    s_mov_b32 s46, 106496
    s_add_u32 m0, s52, 84480
    ds_read_b64_tr_b16 v[224:225], v17 offset:16896
    ds_read_b64_tr_b16 v[226:227], v17 offset:17408
    ds_read_b64_tr_b16 v[228:229], v17 offset:16928
    ds_read_b64_tr_b16 v[230:231], v17 offset:17440
    v_mfma_f32_16x16x32_bf16 v[152:155], v[208:211], v[120:123], v[152:155]
    buffer_load_dwordx4 v6, s[8:11], s46 offen offset:0 nt lds
    ds_read_b64_tr_b16 v[232:233], v17 offset:16960
    ds_read_b64_tr_b16 v[234:235], v17 offset:17472
    ds_read_b64_tr_b16 v[236:237], v17 offset:16992
    ds_read_b64_tr_b16 v[238:239], v17 offset:17504
    v_mfma_f32_16x16x32_bf16 v[148:151], v[212:215], v[104:107], v[148:151]
    s_add_u32 m0, s52, 85280
    ds_read_b64_tr_b16 v[240:241], v17 offset:17024
    ds_read_b64_tr_b16 v[242:243], v17 offset:17536
    ds_read_b64_tr_b16 v[244:245], v17 offset:17056
    ds_read_b64_tr_b16 v[246:247], v17 offset:17568
    v_exp_f32 v21, v137
    v_add_f32 v168, v168, v27
    v_cvt_pk_bf16_f32 v179, v26, v27
    v_exp_f32 v22, v138
    v_add_f32 v169, v171, v20
    v_exp_f32 v23, v139
    v_add_f32 v169, v169, v21
    v_mfma_f32_16x16x32_bf16 v[156:159], v[212:215], v[120:123], v[156:159]
    buffer_load_dwordx4 v6, s[8:11], s46 offen offset:256 nt lds
    ds_read_b64_tr_b16 v[248:249], v17 offset:17088
    ds_read_b64_tr_b16 v[250:251], v17 offset:17600
    ds_read_b64_tr_b16 v[252:253], v17 offset:17120
    ds_read_b64_tr_b16 v[254:255], v17 offset:17632
    v_cvt_pk_bf16_f32 v180, v20, v21
    v_exp_f32 v24, v140
    v_add_f32 v169, v169, v22
    v_exp_f32 v25, v141
    v_add_f32 v169, v169, v23
    v_cvt_pk_bf16_f32 v181, v22, v23
    v_exp_f32 v26, v142
    v_mfma_f32_16x16x32_bf16 v[144:147], v[216:219], v[108:111], v[144:147]
    s_mov_b32 s46, 90112
    s_add_u32 m0, s52, 92928
    v_add_f32 v169, v169, v24
    v_exp_f32 v27, v143
    v_add_f32 v169, v169, v25
    v_cvt_pk_bf16_f32 v182, v24, v25
    v_add_f32 v169, v169, v26
    v_add_f32 v169, v169, v27
    v_cvt_pk_bf16_f32 v183, v26, v27
    v_mfma_f32_16x16x32_bf16 v[152:155], v[216:219], v[124:127], v[152:155]
    buffer_load_dwordx4 v6, s[12:15], s46 offen offset:0 nt lds
    v_max_f32 v30, v168, v169
    v_cmp_lt_f32 vcc, s49, v30
    v_mfma_f32_16x16x32_bf16 v[148:151], v[220:223], v[108:111], v[148:151]
    s_add_u32 m0, s52, 93728
    s_cbranch_vccnz LP_r8
LP_b8:
    v_mfma_f32_16x16x32_bf16 v[156:159], v[220:223], v[124:127], v[156:159]
    buffer_load_dwordx4 v6, s[12:15], s46 offen offset:256 nt lds
    s_waitcnt lgkmcnt(0)
    v_mfma_f32_16x16x32_bf16 v[32:35], v[224:227], v[176:179], v[32:35]
    s_add_u32 s46, s6, 262144
    s_add_u32 m0, s59, 135168
    ds_read_b128 v[192:195], v3 offset:16896
    ds_read_b128 v[196:199], v3 offset:17408
    v_mfma_f32_16x16x32_bf16 v[64:67], v[224:227], v[180:183], v[64:67]
    buffer_load_dwordx4 v10, s[20:23], s46 offen offset:0  lds
    ds_read_b128 v[200:203], v3 offset:16960
    ds_read_b128 v[204:207], v3 offset:17472
    v_mfma_f32_16x16x32_bf16 v[36:39], v[228:231], v[176:179], v[36:39]
    ds_read_b128 v[208:211], v3 offset:17024
    ds_read_b128 v[212:215], v3 offset:17536
    v_mfma_f32_16x16x32_bf16 v[68:71], v[228:231], v[180:183], v[68:71]
    buffer_load_dwordx4 v11, s[20:23], s46 offen offset:1024  lds
    ds_read_b128 v[216:219], v3 offset:17088
    ds_read_b128 v[220:223], v3 offset:17600
    v_mfma_f32_16x16x32_bf16 v[40:43], v[232:235], v[176:179], v[40:43]
    ds_read_b64_tr_b16 a[96:97], v5 offset:0
    ds_read_b64_tr_b16 a[98:99], v5 offset:4096
    v_mfma_f32_16x16x32_bf16 v[72:75], v[232:235], v[180:183], v[72:75]
    buffer_load_dwordx4 v12, s[20:23], s46 offen offset:2048  lds
    ds_read_b64_tr_b16 a[100:101], v5 offset:8
    ds_read_b64_tr_b16 a[102:103], v5 offset:4104
    v_mfma_f32_16x16x32_bf16 v[44:47], v[236:239], v[176:179], v[44:47]
    ds_read_b64_tr_b16 a[104:105], v5 offset:8192
    v_mfma_f32_16x16x32_bf16 v[76:79], v[236:239], v[180:183], v[76:79]
    buffer_load_dwordx4 v13, s[20:23], s46 offen offset:3072  lds
    ds_read_b64_tr_b16 a[106:107], v5 offset:12288
    ds_read_b64_tr_b16 a[108:109], v5 offset:8200
    v_mfma_f32_16x16x32_bf16 v[48:51], v[240:243], v[176:179], v[48:51]
    ds_read_b64_tr_b16 a[110:111], v5 offset:12296
    v_mfma_f32_16x16x32_bf16 v[80:83], v[240:243], v[180:183], v[80:83]
    ds_read_b64_tr_b16 a[112:113], v14 offset:33792
    ds_read_b64_tr_b16 a[114:115], v14 offset:37888
    v_mfma_f32_16x16x32_bf16 v[52:55], v[244:247], v[176:179], v[52:55]
    ds_read_b64_tr_b16 a[116:117], v14 offset:33800
    ds_read_b64_tr_b16 a[118:119], v14 offset:37896
    v_mfma_f32_16x16x32_bf16 v[84:87], v[244:247], v[180:183], v[84:87]
    ds_read_b64_tr_b16 a[120:121], v14 offset:41984
    v_mfma_f32_16x16x32_bf16 v[56:59], v[248:251], v[176:179], v[56:59]
    ds_read_b64_tr_b16 a[122:123], v14 offset:46080
    ds_read_b64_tr_b16 a[124:125], v14 offset:41992
    v_mfma_f32_16x16x32_bf16 v[88:91], v[248:251], v[180:183], v[88:91]
    ds_read_b64_tr_b16 a[126:127], v14 offset:46088
    v_mfma_f32_16x16x32_bf16 v[60:63], v[252:255], v[176:179], v[60:63]
    v_exp_f32 v20, v144
    v_exp_f32 v21, v145
    v_exp_f32 v22, v146
    v_add_f32 v170, v168, v20
    v_exp_f32 v23, v147
    v_add_f32 v170, v170, v21
    v_cvt_pk_bf16_f32 v184, v20, v21
    v_exp_f32 v24, v148
    v_add_f32 v170, v170, v22
    v_exp_f32 v25, v149
    v_mfma_f32_16x16x32_bf16 v[92:95], v[252:255], v[180:183], v[92:95]
    global_load_dword v9, v8, s[0:1]
    v_add_f32 v170, v170, v23
    v_cvt_pk_bf16_f32 v185, v22, v23
    v_exp_f32 v26, v150
    v_add_f32 v170, v170, v24
    v_exp_f32 v27, v151
    v_add_f32 v170, v170, v25
    v_cvt_pk_bf16_f32 v186, v24, v25
    v_exp_f32 v20, v152
    v_add_f32 v170, v170, v26
    s_waitcnt vmcnt(13) lgkmcnt(0)
    s_barrier
    v_mfma_f32_16x16x32_bf16 v[128:131], v[192:195], v[96:99], v[160:163]
    s_add_u32 s46, s6, 393216
    s_add_u32 m0, s59, 67584
    v_mfma_f32_16x16x32_bf16 v[136:139], v[192:195], v[112:115], v[164:167]
    buffer_load_dwordx4 v10, s[20:23], s46 offen offset:0  lds
    v_mfma_f32_16x16x32_bf16 v[132:135], v[196:199], v[96:99], v[160:163]
    v_mfma_f32_16x16x32_bf16 v[140:143], v[196:199], v[112:115], v[164:167]
    buffer_load_dwordx4 v11, s[20:23], s46 offen offset:1024  lds
    v_mfma_f32_16x16x32_bf16 v[128:131], v[200:203], v[100:103], v[128:131]
    v_mfma_f32_16x16x32_bf16 v[136:139], v[200:203], v[116:119], v[136:139]
    buffer_load_dwordx4 v12, s[20:23], s46 offen offset:2048  lds
    v_mfma_f32_16x16x32_bf16 v[132:135], v[204:207], v[100:103], v[132:135]
    v_mfma_f32_16x16x32_bf16 v[140:143], v[204:207], v[116:119], v[140:143]
    buffer_load_dwordx4 v13, s[20:23], s46 offen offset:3072  lds
    v_mfma_f32_16x16x32_bf16 v[128:131], v[208:211], v[104:107], v[128:131]
    s_mov_b32 s46, 114688
    s_add_u32 m0, s52, 101376
    ds_read_b64_tr_b16 v[224:225], v16 offset:0
    ds_read_b64_tr_b16 v[226:227], v16 offset:512
    ds_read_b64_tr_b16 v[228:229], v16 offset:32
    ds_read_b64_tr_b16 v[230:231], v16 offset:544
    v_mfma_f32_16x16x32_bf16 v[136:139], v[208:211], v[120:123], v[136:139]
    buffer_load_dwordx4 v6, s[8:11], s46 offen offset:0 nt lds
    ds_read_b64_tr_b16 v[232:233], v16 offset:64
    ds_read_b64_tr_b16 v[234:235], v16 offset:576
    ds_read_b64_tr_b16 v[236:237], v16 offset:96
    ds_read_b64_tr_b16 v[238:239], v16 offset:608
    v_mfma_f32_16x16x32_bf16 v[132:135], v[212:215], v[104:107], v[132:135]
    s_add_u32 m0, s52, 102176
    ds_read_b64_tr_b16 v[240:241], v16 offset:128
    ds_read_b64_tr_b16 v[242:243], v16 offset:640
    ds_read_b64_tr_b16 v[244:245], v16 offset:160
    ds_read_b64_tr_b16 v[246:247], v16 offset:672
    v_exp_f32 v21, v153
    v_add_f32 v170, v170, v27
    v_cvt_pk_bf16_f32 v187, v26, v27
    v_exp_f32 v22, v154
    v_add_f32 v171, v169, v20
    v_exp_f32 v23, v155
    v_add_f32 v171, v171, v21
    v_mfma_f32_16x16x32_bf16 v[140:143], v[212:215], v[120:123], v[140:143]
    buffer_load_dwordx4 v6, s[8:11], s46 offen offset:256 nt lds
    ds_read_b64_tr_b16 v[248:249], v16 offset:192
    ds_read_b64_tr_b16 v[250:251], v16 offset:704
    ds_read_b64_tr_b16 v[252:253], v16 offset:224
    ds_read_b64_tr_b16 v[254:255], v16 offset:736
    v_cvt_pk_bf16_f32 v188, v20, v21
    v_exp_f32 v24, v156
    v_add_f32 v171, v171, v22
    v_exp_f32 v25, v157
    v_add_f32 v171, v171, v23
    v_cvt_pk_bf16_f32 v189, v22, v23
    v_exp_f32 v26, v158
    v_mfma_f32_16x16x32_bf16 v[128:131], v[216:219], v[108:111], v[128:131]
    s_mov_b32 s46, 98304
    s_add_u32 m0, s52, 109824
    v_add_f32 v171, v171, v24
    v_exp_f32 v27, v159
    v_add_f32 v171, v171, v25
    v_cvt_pk_bf16_f32 v190, v24, v25
    v_add_f32 v171, v171, v26
    v_add_f32 v171, v171, v27
    v_cvt_pk_bf16_f32 v191, v26, v27
    v_mfma_f32_16x16x32_bf16 v[136:139], v[216:219], v[124:127], v[136:139]
    buffer_load_dwordx4 v6, s[12:15], s46 offen offset:0 nt lds
    v_max_f32 v30, v170, v171
    v_cmp_lt_f32 vcc, s49, v30
    v_mfma_f32_16x16x32_bf16 v[132:135], v[220:223], v[108:111], v[132:135]
    s_add_u32 m0, s52, 110624
    s_cbranch_vccnz LP_r9
LP_b9:
    v_mfma_f32_16x16x32_bf16 v[140:143], v[220:223], v[124:127], v[140:143]
    buffer_load_dwordx4 v6, s[12:15], s46 offen offset:256 nt lds
    s_waitcnt lgkmcnt(0)
    v_mfma_f32_16x16x32_bf16 v[32:35], v[224:227], v[184:187], v[32:35]
    s_add_u32 s46, s7, 0
    s_add_u32 m0, s59, 33792
    ds_read_b128 v[192:195], v2 offset:0
    ds_read_b128 v[196:199], v2 offset:512
    v_mfma_f32_16x16x32_bf16 v[64:67], v[224:227], v[188:191], v[64:67]
    buffer_load_dwordx4 v10, s[20:23], s46 offen offset:0  lds
    ds_read_b128 v[200:203], v2 offset:64
    ds_read_b128 v[204:207], v2 offset:576
    v_mfma_f32_16x16x32_bf16 v[36:39], v[228:231], v[184:187], v[36:39]
    ds_read_b128 v[208:211], v2 offset:128
    ds_read_b128 v[212:215], v2 offset:640
    v_mfma_f32_16x16x32_bf16 v[68:71], v[228:231], v[188:191], v[68:71]
    buffer_load_dwordx4 v11, s[20:23], s46 offen offset:1024  lds
    ds_read_b128 v[216:219], v2 offset:192
    ds_read_b128 v[220:223], v2 offset:704
    v_mfma_f32_16x16x32_bf16 v[40:43], v[232:235], v[184:187], v[40:43]
    ds_read_b64_tr_b16 a[128:129], v5 offset:16896
    v_mfma_f32_16x16x32_bf16 v[72:75], v[232:235], v[188:191], v[72:75]
    buffer_load_dwordx4 v12, s[20:23], s46 offen offset:2048  lds
    ds_read_b64_tr_b16 a[130:131], v5 offset:20992
    v_mfma_f32_16x16x32_bf16 v[44:47], v[236:239], v[184:187], v[44:47]
    ds_read_b64_tr_b16 a[132:133], v5 offset:16904
    v_mfma_f32_16x16x32_bf16 v[76:79], v[236:239], v[188:191], v[76:79]
    buffer_load_dwordx4 v13, s[20:23], s46 offen offset:3072  lds
    ds_read_b64_tr_b16 a[134:135], v5 offset:21000
    v_mfma_f32_16x16x32_bf16 v[48:51], v[240:243], v[184:187], v[48:51]
    v_mfma_f32_16x16x32_bf16 v[80:83], v[240:243], v[188:191], v[80:83]
    ds_read_b64_tr_b16 a[136:137], v5 offset:25088
    v_mfma_f32_16x16x32_bf16 v[52:55], v[244:247], v[184:187], v[52:55]
    ds_read_b64_tr_b16 a[138:139], v5 offset:29184
    v_mfma_f32_16x16x32_bf16 v[84:87], v[244:247], v[188:191], v[84:87]
    ds_read_b64_tr_b16 a[140:141], v5 offset:25096
    v_mfma_f32_16x16x32_bf16 v[56:59], v[248:251], v[184:187], v[56:59]
    ds_read_b64_tr_b16 a[142:143], v5 offset:29192
    v_mfma_f32_16x16x32_bf16 v[88:91], v[248:251], v[188:191], v[88:91]
    v_mfma_f32_16x16x32_bf16 v[60:63], v[252:255], v[184:187], v[60:63]
    v_exp_f32 v20, v128
    v_exp_f32 v21, v129
    v_exp_f32 v22, v130
    v_add_f32 v168, v170, v20
    v_exp_f32 v23, v131
    v_add_f32 v168, v168, v21
    v_cvt_pk_bf16_f32 v176, v20, v21
    v_exp_f32 v24, v132
    v_add_f32 v168, v168, v22
    v_exp_f32 v25, v133
    v_mfma_f32_16x16x32_bf16 v[92:95], v[252:255], v[188:191], v[92:95]
    v_add_f32 v168, v168, v23
    v_cvt_pk_bf16_f32 v177, v22, v23
    v_exp_f32 v26, v134
    v_add_f32 v168, v168, v24
    v_exp_f32 v27, v135
    v_add_f32 v168, v168, v25
    v_cvt_pk_bf16_f32 v178, v24, v25
    v_exp_f32 v20, v136
    v_add_f32 v168, v168, v26
    s_waitcnt vmcnt(13) lgkmcnt(0)
    s_barrier
    v_mfma_f32_16x16x32_bf16 v[144:147], v[192:195], v[96:99], v[160:163]
    s_add_u32 s46, s7, 131072
    s_add_u32 m0, s59, 0
    v_mfma_f32_16x16x32_bf16 v[152:155], v[192:195], v[112:115], v[164:167]
    buffer_load_dwordx4 v10, s[20:23], s46 offen offset:0  lds
    v_mfma_f32_16x16x32_bf16 v[148:151], v[196:199], v[96:99], v[160:163]
    v_mfma_f32_16x16x32_bf16 v[156:159], v[196:199], v[112:115], v[164:167]
    buffer_load_dwordx4 v11, s[20:23], s46 offen offset:1024  lds
    v_mfma_f32_16x16x32_bf16 v[144:147], v[200:203], v[100:103], v[144:147]
    v_mfma_f32_16x16x32_bf16 v[152:155], v[200:203], v[116:119], v[152:155]
    buffer_load_dwordx4 v12, s[20:23], s46 offen offset:2048  lds
    v_mfma_f32_16x16x32_bf16 v[148:151], v[204:207], v[100:103], v[148:151]
    v_mfma_f32_16x16x32_bf16 v[156:159], v[204:207], v[116:119], v[156:159]
    buffer_load_dwordx4 v13, s[20:23], s46 offen offset:3072  lds
    v_mfma_f32_16x16x32_bf16 v[144:147], v[208:211], v[104:107], v[144:147]
    s_mov_b32 s46, 122880
    s_add_u32 m0, s52, 118272
    ds_read_b64_tr_b16 v[224:225], v17 offset:0
    ds_read_b64_tr_b16 v[226:227], v17 offset:512
    ds_read_b64_tr_b16 v[228:229], v17 offset:32
    ds_read_b64_tr_b16 v[230:231], v17 offset:544
    v_mfma_f32_16x16x32_bf16 v[152:155], v[208:211], v[120:123], v[152:155]
    buffer_load_dwordx4 v6, s[8:11], s46 offen offset:0 nt lds
    ds_read_b64_tr_b16 v[232:233], v17 offset:64
    ds_read_b64_tr_b16 v[234:235], v17 offset:576
    ds_read_b64_tr_b16 v[236:237], v17 offset:96
    ds_read_b64_tr_b16 v[238:239], v17 offset:608
    v_mfma_f32_16x16x32_bf16 v[148:151], v[212:215], v[104:107], v[148:151]
    s_add_u32 m0, s52, 119072
    ds_read_b64_tr_b16 v[240:241], v17 offset:128
    ds_read_b64_tr_b16 v[242:243], v17 offset:640
    ds_read_b64_tr_b16 v[244:245], v17 offset:160
    ds_read_b64_tr_b16 v[246:247], v17 offset:672
    v_exp_f32 v21, v137
    v_add_f32 v168, v168, v27
    v_cvt_pk_bf16_f32 v179, v26, v27
    v_exp_f32 v22, v138
    v_add_f32 v169, v171, v20
    v_exp_f32 v23, v139
    v_add_f32 v169, v169, v21
    v_mfma_f32_16x16x32_bf16 v[156:159], v[212:215], v[120:123], v[156:159]
    buffer_load_dwordx4 v6, s[8:11], s46 offen offset:256 nt lds
    ds_read_b64_tr_b16 v[248:249], v17 offset:192
    ds_read_b64_tr_b16 v[250:251], v17 offset:704
    ds_read_b64_tr_b16 v[252:253], v17 offset:224
    ds_read_b64_tr_b16 v[254:255], v17 offset:736
    v_cvt_pk_bf16_f32 v180, v20, v21
    v_exp_f32 v24, v140
    v_add_f32 v169, v169, v22
    v_exp_f32 v25, v141
    v_add_f32 v169, v169, v23
    v_cvt_pk_bf16_f32 v181, v22, v23
    v_exp_f32 v26, v142
    v_mfma_f32_16x16x32_bf16 v[144:147], v[216:219], v[108:111], v[144:147]
    s_mov_b32 s46, 106496
    s_add_u32 m0, s52, 126720
    v_add_f32 v169, v169, v24
    v_exp_f32 v27, v143
    v_add_f32 v169, v169, v25
    v_cvt_pk_bf16_f32 v182, v24, v25
    v_add_f32 v169, v169, v26
    v_add_f32 v169, v169, v27
    v_cvt_pk_bf16_f32 v183, v26, v27
    v_mfma_f32_16x16x32_bf16 v[152:155], v[216:219], v[124:127], v[152:155]
    buffer_load_dwordx4 v6, s[12:15], s46 offen offset:0 nt lds
    v_max_f32 v30, v168, v169
    v_cmp_lt_f32 vcc, s49, v30
    v_mfma_f32_16x16x32_bf16 v[148:151], v[220:223], v[108:111], v[148:151]
    s_add_u32 m0, s52, 127520
    s_cbranch_vccnz LP_r10
LP_b10:
    v_mfma_f32_16x16x32_bf16 v[156:159], v[220:223], v[124:127], v[156:159]
    buffer_load_dwordx4 v6, s[12:15], s46 offen offset:256 nt lds
    s_waitcnt lgkmcnt(0)
    v_mfma_f32_16x16x32_bf16 v[32:35], v[224:227], v[176:179], v[32:35]
    ds_read_b128 v[192:195], v3 offset:0
    ds_read_b128 v[196:199], v3 offset:512
    v_mfma_f32_16x16x32_bf16 v[64:67], v[224:227], v[180:183], v[64:67]
    ds_read_b128 v[200:203], v3 offset:64
    ds_read_b128 v[204:207], v3 offset:576
    v_mfma_f32_16x16x32_bf16 v[36:39], v[228:231], v[176:179], v[36:39]
    ds_read_b128 v[208:211], v3 offset:128
    ds_read_b128 v[212:215], v3 offset:640
    v_mfma_f32_16x16x32_bf16 v[68:71], v[228:231], v[180:183], v[68:71]
    ds_read_b128 v[216:219], v3 offset:192
    ds_read_b128 v[220:223], v3 offset:704
    v_mfma_f32_16x16x32_bf16 v[40:43], v[232:235], v[176:179], v[40:43]
    ds_read_b64_tr_b16 a[144:145], v14 offset:16896
    ds_read_b64_tr_b16 a[146:147], v14 offset:20992
    v_mfma_f32_16x16x32_bf16 v[72:75], v[232:235], v[180:183], v[72:75]
    ds_read_b64_tr_b16 a[148:149], v14 offset:16904
    ds_read_b64_tr_b16 a[150:151], v14 offset:21000
    v_mfma_f32_16x16x32_bf16 v[44:47], v[236:239], v[176:179], v[44:47]
    ds_read_b64_tr_b16 a[152:153], v14 offset:25088
    v_mfma_f32_16x16x32_bf16 v[76:79], v[236:239], v[180:183], v[76:79]
    ds_read_b64_tr_b16 a[154:155], v14 offset:29184
    ds_read_b64_tr_b16 a[156:157], v14 offset:25096
    v_mfma_f32_16x16x32_bf16 v[48:51], v[240:243], v[176:179], v[48:51]
    ds_read_b64_tr_b16 a[158:159], v14 offset:29192
    v_mfma_f32_16x16x32_bf16 v[80:83], v[240:243], v[180:183], v[80:83]
    ds_read_b64_tr_b16 a[160:161], v5 offset:33792
    ds_read_b64_tr_b16 a[162:163], v5 offset:37888
    v_mfma_f32_16x16x32_bf16 v[52:55], v[244:247], v[176:179], v[52:55]
    ds_read_b64_tr_b16 a[164:165], v5 offset:33800
    ds_read_b64_tr_b16 a[166:167], v5 offset:37896
    v_mfma_f32_16x16x32_bf16 v[84:87], v[244:247], v[180:183], v[84:87]
    ds_read_b64_tr_b16 a[168:169], v5 offset:41984
    v_mfma_f32_16x16x32_bf16 v[56:59], v[248:251], v[176:179], v[56:59]
    ds_read_b64_tr_b16 a[170:171], v5 offset:46080
    ds_read_b64_tr_b16 a[172:173], v5 offset:41992
    v_mfma_f32_16x16x32_bf16 v[88:91], v[248:251], v[180:183], v[88:91]
    ds_read_b64_tr_b16 a[174:175], v5 offset:46088
    v_mfma_f32_16x16x32_bf16 v[60:63], v[252:255], v[176:179], v[60:63]
    v_exp_f32 v20, v144
    v_exp_f32 v21, v145
    v_exp_f32 v22, v146
    v_add_f32 v170, v168, v20
    v_exp_f32 v23, v147
    v_add_f32 v170, v170, v21
    v_cvt_pk_bf16_f32 v184, v20, v21
    v_exp_f32 v24, v148
    v_add_f32 v170, v170, v22
    v_exp_f32 v25, v149
    v_mfma_f32_16x16x32_bf16 v[92:95], v[252:255], v[180:183], v[92:95]
    v_add_f32 v170, v170, v23
    v_cvt_pk_bf16_f32 v185, v22, v23
    v_exp_f32 v26, v150
    v_add_f32 v170, v170, v24
    v_exp_f32 v27, v151
    v_add_f32 v170, v170, v25
    v_cvt_pk_bf16_f32 v186, v24, v25
    v_exp_f32 v20, v152
    v_add_f32 v170, v170, v26
    s_waitcnt vmcnt(8) lgkmcnt(0)
    s_barrier
    v_mfma_f32_16x16x32_bf16 v[128:131], v[192:195], v[96:99], v[160:163]
    s_add_u32 s46, s7, 262144
    s_add_u32 m0, s59, 50688
    v_mfma_f32_16x16x32_bf16 v[136:139], v[192:195], v[112:115], v[164:167]
    buffer_load_dwordx4 v10, s[20:23], s46 offen offset:0  lds
    v_mfma_f32_16x16x32_bf16 v[132:135], v[196:199], v[96:99], v[160:163]
    v_mfma_f32_16x16x32_bf16 v[140:143], v[196:199], v[112:115], v[164:167]
    buffer_load_dwordx4 v11, s[20:23], s46 offen offset:1024  lds
    v_mfma_f32_16x16x32_bf16 v[128:131], v[200:203], v[100:103], v[128:131]
    v_mfma_f32_16x16x32_bf16 v[136:139], v[200:203], v[116:119], v[136:139]
    buffer_load_dwordx4 v12, s[20:23], s46 offen offset:2048  lds
    v_mfma_f32_16x16x32_bf16 v[132:135], v[204:207], v[100:103], v[132:135]
    v_mfma_f32_16x16x32_bf16 v[140:143], v[204:207], v[116:119], v[140:143]
    buffer_load_dwordx4 v13, s[20:23], s46 offen offset:3072  lds
    v_mfma_f32_16x16x32_bf16 v[128:131], v[208:211], v[104:107], v[128:131]
    s_add_u32 s46, s7, 393216
    s_add_u32 m0, s59, 16896
    ds_read_b64_tr_b16 v[224:225], v17 offset:33792
    ds_read_b64_tr_b16 v[226:227], v17 offset:34304
    ds_read_b64_tr_b16 v[228:229], v17 offset:33824
    ds_read_b64_tr_b16 v[230:231], v17 offset:34336
    v_mfma_f32_16x16x32_bf16 v[136:139], v[208:211], v[120:123], v[136:139]
    buffer_load_dwordx4 v10, s[20:23], s46 offen offset:0  lds
    ds_read_b64_tr_b16 v[232:233], v17 offset:33856
    ds_read_b64_tr_b16 v[234:235], v17 offset:34368
    ds_read_b64_tr_b16 v[236:237], v17 offset:33888
    ds_read_b64_tr_b16 v[238:239], v17 offset:34400
    v_mfma_f32_16x16x32_bf16 v[132:135], v[212:215], v[104:107], v[132:135]
    ds_read_b64_tr_b16 v[240:241], v17 offset:33920
    ds_read_b64_tr_b16 v[242:243], v17 offset:34432
    ds_read_b64_tr_b16 v[244:245], v17 offset:33952
    ds_read_b64_tr_b16 v[246:247], v17 offset:34464
    v_exp_f32 v21, v153
    v_add_f32 v170, v170, v27
    v_cvt_pk_bf16_f32 v187, v26, v27
    v_exp_f32 v22, v154
    v_add_f32 v171, v169, v20
    v_exp_f32 v23, v155
    v_add_f32 v171, v171, v21
    v_mfma_f32_16x16x32_bf16 v[140:143], v[212:215], v[120:123], v[140:143]
    buffer_load_dwordx4 v11, s[20:23], s46 offen offset:1024  lds
    ds_read_b64_tr_b16 v[248:249], v17 offset:33984
    ds_read_b64_tr_b16 v[250:251], v17 offset:34496
    ds_read_b64_tr_b16 v[252:253], v17 offset:34016
    ds_read_b64_tr_b16 v[254:255], v17 offset:34528
    v_cvt_pk_bf16_f32 v188, v20, v21
    v_exp_f32 v24, v156
    v_add_f32 v171, v171, v22
    v_exp_f32 v25, v157
    v_add_f32 v171, v171, v23
    v_cvt_pk_bf16_f32 v189, v22, v23
    v_exp_f32 v26, v158
    v_mfma_f32_16x16x32_bf16 v[128:131], v[216:219], v[108:111], v[128:131]
    v_add_f32 v171, v171, v24
    v_exp_f32 v27, v159
    v_add_f32 v171, v171, v25
    v_cvt_pk_bf16_f32 v190, v24, v25
    v_add_f32 v171, v171, v26
    v_add_f32 v171, v171, v27
    v_cvt_pk_bf16_f32 v191, v26, v27
    v_mfma_f32_16x16x32_bf16 v[136:139], v[216:219], v[124:127], v[136:139]
    buffer_load_dwordx4 v12, s[20:23], s46 offen offset:2048  lds
    v_max_f32 v30, v170, v171
    v_cmp_lt_f32 vcc, s49, v30
    v_mfma_f32_16x16x32_bf16 v[132:135], v[220:223], v[108:111], v[132:135]
    s_cbranch_vccnz LP_r11
LP_b11:
    v_mfma_f32_16x16x32_bf16 v[140:143], v[220:223], v[124:127], v[140:143]
    buffer_load_dwordx4 v13, s[20:23], s46 offen offset:3072  lds
    s_waitcnt lgkmcnt(0)
    v_mfma_f32_16x16x32_bf16 v[32:35], v[224:227], v[184:187], v[32:35]
    s_mov_b32 s46, 131072
    s_add_u32 m0, s52, 135168
    ds_read_b128 v[192:195], v3 offset:33792
    ds_read_b128 v[196:199], v3 offset:34304
    v_mfma_f32_16x16x32_bf16 v[64:67], v[224:227], v[188:191], v[64:67]
    buffer_load_dwordx4 v6, s[8:11], s46 offen offset:0 nt lds
    ds_read_b128 v[200:203], v3 offset:33856
    ds_read_b128 v[204:207], v3 offset:34368
    v_mfma_f32_16x16x32_bf16 v[36:39], v[228:231], v[184:187], v[36:39]
    s_add_u32 m0, s52, 135968
    ds_read_b128 v[208:211], v3 offset:33920
    ds_read_b128 v[212:215], v3 offset:34432
    v_mfma_f32_16x16x32_bf16 v[68:71], v[228:231], v[188:191], v[68:71]
    buffer_load_dwordx4 v6, s[8:11], s46 offen offset:256 nt lds
    ds_read_b128 v[216:219], v3 offset:33984
    ds_read_b128 v[220:223], v3 offset:34496
    v_mfma_f32_16x16x32_bf16 v[40:43], v[232:235], v[184:187], v[40:43]
    s_mov_b32 s46, 114688
    s_add_u32 m0, s52, 143616
    ds_read_b64_tr_b16 a[176:177], v19 offset:16896
    ds_read_b64_tr_b16 a[178:179], v19 offset:20992
    v_mfma_f32_16x16x32_bf16 v[72:75], v[232:235], v[188:191], v[72:75]
    buffer_load_dwordx4 v6, s[12:15], s46 offen offset:0 nt lds
    ds_read_b64_tr_b16 a[180:181], v19 offset:16904
    ds_read_b64_tr_b16 a[182:183], v19 offset:21000
    v_mfma_f32_16x16x32_bf16 v[44:47], v[236:239], v[184:187], v[44:47]
    s_add_u32 m0, s52, 144416
    ds_read_b64_tr_b16 a[184:185], v19 offset:25088
    v_mfma_f32_16x16x32_bf16 v[76:79], v[236:239], v[188:191], v[76:79]
    buffer_load_dwordx4 v6, s[12:15], s46 offen offset:256 nt lds
    ds_read_b64_tr_b16 a[186:187], v19 offset:29184
    ds_read_b64_tr_b16 a[188:189], v19 offset:25096
    v_mfma_f32_16x16x32_bf16 v[48:51], v[240:243], v[184:187], v[48:51]
    ds_read_b64_tr_b16 a[190:191], v19 offset:29192
    v_mfma_f32_16x16x32_bf16 v[80:83], v[240:243], v[188:191], v[80:83]
    ds_read_b64_tr_b16 a[192:193], v14 offset:33792
    ds_read_b64_tr_b16 a[194:195], v14 offset:37888
    v_mfma_f32_16x16x32_bf16 v[52:55], v[244:247], v[184:187], v[52:55]
    ds_read_b64_tr_b16 a[196:197], v14 offset:33800
    ds_read_b64_tr_b16 a[198:199], v14 offset:37896
    v_mfma_f32_16x16x32_bf16 v[84:87], v[244:247], v[188:191], v[84:87]
    ds_read_b64_tr_b16 a[200:201], v14 offset:41984
    v_mfma_f32_16x16x32_bf16 v[56:59], v[248:251], v[184:187], v[56:59]
    ds_read_b64_tr_b16 a[202:203], v14 offset:46080
    ds_read_b64_tr_b16 a[204:205], v14 offset:41992
    v_mfma_f32_16x16x32_bf16 v[88:91], v[248:251], v[188:191], v[88:91]
    ds_read_b64_tr_b16 a[206:207], v14 offset:46088
    v_mfma_f32_16x16x32_bf16 v[60:63], v[252:255], v[184:187], v[60:63]
    v_exp_f32 v20, v128
    v_exp_f32 v21, v129
    v_exp_f32 v22, v130
    v_add_f32 v168, v170, v20
    v_exp_f32 v23, v131
    v_add_f32 v168, v168, v21
    v_cvt_pk_bf16_f32 v176, v20, v21
    v_exp_f32 v24, v132
    v_add_f32 v168, v168, v22
    v_exp_f32 v25, v133
    v_mfma_f32_16x16x32_bf16 v[92:95], v[252:255], v[188:191], v[92:95]
    v_add_f32 v168, v168, v23
    v_cvt_pk_bf16_f32 v177, v22, v23
    v_exp_f32 v26, v134
    v_add_f32 v168, v168, v24
    v_exp_f32 v27, v135
    v_add_f32 v168, v168, v25
    v_cvt_pk_bf16_f32 v178, v24, v25
    v_exp_f32 v20, v136
    v_add_f32 v168, v168, v26
    s_waitcnt vmcnt(16) lgkmcnt(0)
    s_barrier
    v_mfma_f32_16x16x32_bf16 v[144:147], v[192:195], v[96:99], v[160:163]
    s_mov_b32 s46, 139264
    s_add_u32 m0, s52, 84480
    v_mfma_f32_16x16x32_bf16 v[152:155], v[192:195], v[112:115], v[164:167]
    buffer_load_dwordx4 v6, s[8:11], s46 offen offset:0 nt lds
    v_mfma_f32_16x16x32_bf16 v[148:151], v[196:199], v[96:99], v[160:163]
    s_add_u32 m0, s52, 85280
    v_mfma_f32_16x16x32_bf16 v[156:159], v[196:199], v[112:115], v[164:167]
    buffer_load_dwordx4 v6, s[8:11], s46 offen offset:256 nt lds
    v_mfma_f32_16x16x32_bf16 v[144:147], v[200:203], v[100:103], v[144:147]
    s_mov_b32 s46, 122880
    s_add_u32 m0, s52, 92928
    v_mfma_f32_16x16x32_bf16 v[152:155], v[200:203], v[116:119], v[152:155]
    buffer_load_dwordx4 v6, s[12:15], s46 offen offset:0 nt lds
    v_mfma_f32_16x16x32_bf16 v[148:151], v[204:207], v[100:103], v[148:151]
    s_add_u32 m0, s52, 93728
    v_mfma_f32_16x16x32_bf16 v[156:159], v[204:207], v[116:119], v[156:159]
    buffer_load_dwordx4 v6, s[12:15], s46 offen offset:256 nt lds
    v_mfma_f32_16x16x32_bf16 v[144:147], v[208:211], v[104:107], v[144:147]
    s_mov_b32 s46, 147456
    s_add_u32 m0, s52, 67584
    ds_read_b64_tr_b16 v[224:225], v18 offset:0
    ds_read_b64_tr_b16 v[226:227], v18 offset:512
    ds_read_b64_tr_b16 v[228:229], v18 offset:32
    ds_read_b64_tr_b16 v[230:231], v18 offset:544
    v_mfma_f32_16x16x32_bf16 v[152:155], v[208:211], v[120:123], v[152:155]
    buffer_load_dwordx4 v6, s[8:11], s46 offen offset:0 nt lds
    ds_read_b64_tr_b16 v[232:233], v18 offset:64
    ds_read_b64_tr_b16 v[234:235], v18 offset:576
    ds_read_b64_tr_b16 v[236:237], v18 offset:96
    ds_read_b64_tr_b16 v[238:239], v18 offset:608
    v_mfma_f32_16x16x32_bf16 v[148:151], v[212:215], v[104:107], v[148:151]
    s_add_u32 m0, s52, 68384
    ds_read_b64_tr_b16 v[240:241], v18 offset:128
    ds_read_b64_tr_b16 v[242:243], v18 offset:640
    ds_read_b64_tr_b16 v[244:245], v18 offset:160
    ds_read_b64_tr_b16 v[246:247], v18 offset:672
    v_exp_f32 v21, v137
    v_add_f32 v168, v168, v27
    v_cvt_pk_bf16_f32 v179, v26, v27
    v_exp_f32 v22, v138
    v_add_f32 v169, v171, v20
    v_exp_f32 v23, v139
    v_add_f32 v169, v169, v21
    v_mfma_f32_16x16x32_bf16 v[156:159], v[212:215], v[120:123], v[156:159]
    buffer_load_dwordx4 v6, s[8:11], s46 offen offset:256 nt lds
    ds_read_b64_tr_b16 v[248:249], v18 offset:192
    ds_read_b64_tr_b16 v[250:251], v18 offset:704
    ds_read_b64_tr_b16 v[252:253], v18 offset:224
    ds_read_b64_tr_b16 v[254:255], v18 offset:736
    v_cvt_pk_bf16_f32 v180, v20, v21
    v_exp_f32 v24, v140
    v_add_f32 v169, v169, v22
    v_exp_f32 v25, v141
    v_add_f32 v169, v169, v23
    v_cvt_pk_bf16_f32 v181, v22, v23
    v_exp_f32 v26, v142
    v_mfma_f32_16x16x32_bf16 v[144:147], v[216:219], v[108:111], v[144:147]
    s_mov_b32 s46, 131072
    s_add_u32 m0, s52, 76032
    v_add_f32 v169, v169, v24
    v_exp_f32 v27, v143
    v_add_f32 v169, v169, v25
    v_cvt_pk_bf16_f32 v182, v24, v25
    v_add_f32 v169, v169, v26
    v_add_f32 v169, v169, v27
    v_cvt_pk_bf16_f32 v183, v26, v27
    v_mfma_f32_16x16x32_bf16 v[152:155], v[216:219], v[124:127], v[152:155]
    buffer_load_dwordx4 v6, s[12:15], s46 offen offset:0 nt lds
    v_max_f32 v30, v168, v169
    v_cmp_lt_f32 vcc, s49, v30
    v_mfma_f32_16x16x32_bf16 v[148:151], v[220:223], v[108:111], v[148:151]
    s_add_u32 m0, s52, 76832
    s_cbranch_vccnz LP_r12
LP_b12:
    v_mfma_f32_16x16x32_bf16 v[156:159], v[220:223], v[124:127], v[156:159]
    buffer_load_dwordx4 v6, s[12:15], s46 offen offset:256 nt lds
    s_waitcnt lgkmcnt(0)
    v_mfma_f32_16x16x32_bf16 v[32:35], v[224:227], v[176:179], v[32:35]
    ds_read_b128 v[192:195], v4 offset:0
    ds_read_b128 v[196:199], v4 offset:512
    v_mfma_f32_16x16x32_bf16 v[64:67], v[224:227], v[180:183], v[64:67]
    ds_read_b128 v[200:203], v4 offset:64
    ds_read_b128 v[204:207], v4 offset:576
    v_mfma_f32_16x16x32_bf16 v[36:39], v[228:231], v[176:179], v[36:39]
    ds_read_b128 v[208:211], v4 offset:128
    ds_read_b128 v[212:215], v4 offset:640
    v_mfma_f32_16x16x32_bf16 v[68:71], v[228:231], v[180:183], v[68:71]
    ds_read_b128 v[216:219], v4 offset:192
    ds_read_b128 v[220:223], v4 offset:704
    v_mfma_f32_16x16x32_bf16 v[40:43], v[232:235], v[176:179], v[40:43]
    ds_read_b64_tr_b16 a[208:209], v14 offset:0
    v_mfma_f32_16x16x32_bf16 v[72:75], v[232:235], v[180:183], v[72:75]
    ds_read_b64_tr_b16 a[210:211], v14 offset:4096
    v_mfma_f32_16x16x32_bf16 v[44:47], v[236:239], v[176:179], v[44:47]
    ds_read_b64_tr_b16 a[212:213], v14 offset:8
    v_mfma_f32_16x16x32_bf16 v[76:79], v[236:239], v[180:183], v[76:79]
    ds_read_b64_tr_b16 a[214:215], v14 offset:4104
    v_mfma_f32_16x16x32_bf16 v[48:51], v[240:243], v[176:179], v[48:51]
    v_mfma_f32_16x16x32_bf16 v[80:83], v[240:243], v[180:183], v[80:83]
    ds_read_b64_tr_b16 a[216:217], v14 offset:8192
    v_mfma_f32_16x16x32_bf16 v[52:55], v[244:247], v[176:179], v[52:55]
    ds_read_b64_tr_b16 a[218:219], v14 offset:12288
    v_mfma_f32_16x16x32_bf16 v[84:87], v[244:247], v[180:183], v[84:87]
    ds_read_b64_tr_b16 a[220:221], v14 offset:8200
    v_mfma_f32_16x16x32_bf16 v[56:59], v[248:251], v[176:179], v[56:59]
    ds_read_b64_tr_b16 a[222:223], v14 offset:12296
    v_mfma_f32_16x16x32_bf16 v[88:91], v[248:251], v[180:183], v[88:91]
    v_mfma_f32_16x16x32_bf16 v[60:63], v[252:255], v[176:179], v[60:63]
    v_exp_f32 v20, v144
    v_exp_f32 v21, v145
    v_exp_f32 v22, v146
    v_add_f32 v170, v168, v20
    v_exp_f32 v23, v147
    v_add_f32 v170, v170, v21
    v_cvt_pk_bf16_f32 v184, v20, v21
    v_exp_f32 v24, v148
    v_add_f32 v170, v170, v22
    v_exp_f32 v25, v149
    v_mfma_f32_16x16x32_bf16 v[92:95], v[252:255], v[180:183], v[92:95]
    v_add_f32 v170, v170, v23
    v_cvt_pk_bf16_f32 v185, v22, v23
    v_exp_f32 v26, v150
    v_add_f32 v170, v170, v24
    v_exp_f32 v27, v151
    v_add_f32 v170, v170, v25
    v_cvt_pk_bf16_f32 v186, v24, v25
    v_exp_f32 v20, v152
    v_add_f32 v170, v170, v26
    s_waitcnt vmcnt(12) lgkmcnt(0)
    s_barrier
    v_mfma_f32_16x16x32_bf16 v[128:131], v[192:195], v[96:99], v[160:163]
    s_mov_b32 s46, 155648
    s_add_u32 m0, s52, 33792
    v_mfma_f32_16x16x32_bf16 v[136:139], v[192:195], v[112:115], v[164:167]
    buffer_load_dwordx4 v6, s[8:11], s46 offen offset:0 nt lds
    v_mfma_f32_16x16x32_bf16 v[132:135], v[196:199], v[96:99], v[160:163]
    s_add_u32 m0, s52, 34592
    v_mfma_f32_16x16x32_bf16 v[140:143], v[196:199], v[112:115], v[164:167]
    buffer_load_dwordx4 v6, s[8:11], s46 offen offset:256 nt lds
    v_mfma_f32_16x16x32_bf16 v[128:131], v[200:203], v[100:103], v[128:131]
    s_mov_b32 s46, 139264
    s_add_u32 m0, s52, 42240
    v_mfma_f32_16x16x32_bf16 v[136:139], v[200:203], v[116:119], v[136:139]
    buffer_load_dwordx4 v6, s[12:15], s46 offen offset:0 nt lds
    v_mfma_f32_16x16x32_bf16 v[132:135], v[204:207], v[100:103], v[132:135]
    s_add_u32 m0, s52, 43040
    v_mfma_f32_16x16x32_bf16 v[140:143], v[204:207], v[116:119], v[140:143]
    buffer_load_dwordx4 v6, s[12:15], s46 offen offset:256 nt lds
    v_mfma_f32_16x16x32_bf16 v[128:131], v[208:211], v[104:107], v[128:131]
    ds_read_b64_tr_b16 v[224:225], v18 offset:16896
    ds_read_b64_tr_b16 v[226:227], v18 offset:17408
    ds_read_b64_tr_b16 v[228:229], v18 offset:16928
    ds_read_b64_tr_b16 v[230:231], v18 offset:17440
    v_mfma_f32_16x16x32_bf16 v[136:139], v[208:211], v[120:123], v[136:139]
    ds_read_b64_tr_b16 v[232:233], v18 offset:16960
    ds_read_b64_tr_b16 v[234:235], v18 offset:17472
    ds_read_b64_tr_b16 v[236:237], v18 offset:16992
    ds_read_b64_tr_b16 v[238:239], v18 offset:17504
    v_mfma_f32_16x16x32_bf16 v[132:135], v[212:215], v[104:107], v[132:135]
    ds_read_b64_tr_b16 v[240:241], v18 offset:17024
    ds_read_b64_tr_b16 v[242:243], v18 offset:17536
    ds_read_b64_tr_b16 v[244:245], v18 offset:17056
    ds_read_b64_tr_b16 v[246:247], v18 offset:17568
    v_exp_f32 v21, v153
    v_add_f32 v170, v170, v27
    v_cvt_pk_bf16_f32 v187, v26, v27
    v_exp_f32 v22, v154
    v_add_f32 v171, v169, v20
    v_exp_f32 v23, v155
    v_add_f32 v171, v171, v21
    v_mfma_f32_16x16x32_bf16 v[140:143], v[212:215], v[120:123], v[140:143]
    ds_read_b64_tr_b16 v[248:249], v18 offset:17088
    ds_read_b64_tr_b16 v[250:251], v18 offset:17600
    ds_read_b64_tr_b16 v[252:253], v18 offset:17120
    ds_read_b64_tr_b16 v[254:255], v18 offset:17632
    v_cvt_pk_bf16_f32 v188, v20, v21
    v_exp_f32 v24, v156
    v_add_f32 v171, v171, v22
    v_exp_f32 v25, v157
    v_add_f32 v171, v171, v23
    v_cvt_pk_bf16_f32 v189, v22, v23
    v_exp_f32 v26, v158
    v_mfma_f32_16x16x32_bf16 v[128:131], v[216:219], v[108:111], v[128:131]
    v_add_f32 v171, v171, v24
    v_exp_f32 v27, v159
    v_add_f32 v171, v171, v25
    v_cvt_pk_bf16_f32 v190, v24, v25
    v_add_f32 v171, v171, v26
    v_add_f32 v171, v171, v27
    v_cvt_pk_bf16_f32 v191, v26, v27
    v_mfma_f32_16x16x32_bf16 v[136:139], v[216:219], v[124:127], v[136:139]
    v_max_f32 v30, v170, v171
    v_cmp_lt_f32 vcc, s49, v30
    v_mfma_f32_16x16x32_bf16 v[132:135], v[220:223], v[108:111], v[132:135]
    s_cbranch_vccnz LP_r13
LP_b13:
    v_mfma_f32_16x16x32_bf16 v[140:143], v[220:223], v[124:127], v[140:143]
    s_waitcnt lgkmcnt(0)
    v_mfma_f32_16x16x32_bf16 v[32:35], v[224:227], v[184:187], v[32:35]
    ds_read_b128 v[192:195], v4 offset:16896
    ds_read_b128 v[196:199], v4 offset:17408
    v_mfma_f32_16x16x32_bf16 v[64:67], v[224:227], v[188:191], v[64:67]
    ds_read_b128 v[200:203], v4 offset:16960
    ds_read_b128 v[204:207], v4 offset:17472
    v_mfma_f32_16x16x32_bf16 v[36:39], v[228:231], v[184:187], v[36:39]
    ds_read_b128 v[208:211], v4 offset:17024
    ds_read_b128 v[212:215], v4 offset:17536
    v_mfma_f32_16x16x32_bf16 v[68:71], v[228:231], v[188:191], v[68:71]
    ds_read_b128 v[216:219], v4 offset:17088
    ds_read_b128 v[220:223], v4 offset:17600
    v_mfma_f32_16x16x32_bf16 v[40:43], v[232:235], v[184:187], v[40:43]
    ds_read_b64_tr_b16 a[224:225], v19 offset:0
    ds_read_b64_tr_b16 a[226:227], v19 offset:4096
    v_mfma_f32_16x16x32_bf16 v[72:75], v[232:235], v[188:191], v[72:75]
    ds_read_b64_tr_b16 a[228:229], v19 offset:8
    ds_read_b64_tr_b16 a[230:231], v19 offset:4104
    v_mfma_f32_16x16x32_bf16 v[44:47], v[236:239], v[184:187], v[44:47]
    ds_read_b64_tr_b16 a[232:233], v19 offset:8192
    v_mfma_f32_16x16x32_bf16 v[76:79], v[236:239], v[188:191], v[76:79]
    ds_read_b64_tr_b16 a[234:235], v19 offset:12288
    ds_read_b64_tr_b16 a[236:237], v19 offset:8200
    v_mfma_f32_16x16x32_bf16 v[48:51], v[240:243], v[184:187], v[48:51]
    ds_read_b64_tr_b16 a[238:239], v19 offset:12296
    v_mfma_f32_16x16x32_bf16 v[80:83], v[240:243], v[188:191], v[80:83]
    ds_read_b64_tr_b16 a[240:241], v14 offset:16896
    ds_read_b64_tr_b16 a[242:243], v14 offset:20992
    v_mfma_f32_16x16x32_bf16 v[52:55], v[244:247], v[184:187], v[52:55]
    ds_read_b64_tr_b16 a[244:245], v14 offset:16904
    ds_read_b64_tr_b16 a[246:247], v14 offset:21000
    v_mfma_f32_16x16x32_bf16 v[84:87], v[244:247], v[188:191], v[84:87]
    ds_read_b64_tr_b16 a[248:249], v14 offset:25088
    v_mfma_f32_16x16x32_bf16 v[56:59], v[248:251], v[184:187], v[56:59]
    ds_read_b64_tr_b16 a[250:251], v14 offset:29184
    ds_read_b64_tr_b16 a[252:253], v14 offset:25096
    v_mfma_f32_16x16x32_bf16 v[88:91], v[248:251], v[188:191], v[88:91]
    ds_read_b64_tr_b16 a[254:255], v14 offset:29192
    v_mfma_f32_16x16x32_bf16 v[60:63], v[252:255], v[184:187], v[60:63]
    v_exp_f32 v20, v128
    v_exp_f32 v21, v129
    v_exp_f32 v22, v130
    v_add_f32 v168, v170, v20
    v_exp_f32 v23, v131
    v_add_f32 v168, v168, v21
    v_cvt_pk_bf16_f32 v176, v20, v21
    v_exp_f32 v24, v132
    v_add_f32 v168, v168, v22
    v_exp_f32 v25, v133
    v_mfma_f32_16x16x32_bf16 v[92:95], v[252:255], v[188:191], v[92:95]
    v_add_f32 v168, v168, v23
    v_cvt_pk_bf16_f32 v177, v22, v23
    v_exp_f32 v26, v134
    v_add_f32 v168, v168, v24
    v_exp_f32 v27, v135
    v_add_f32 v168, v168, v25
    v_cvt_pk_bf16_f32 v178, v24, v25
    v_exp_f32 v20, v136
    v_add_f32 v168, v168, v26
    s_waitcnt vmcnt(12) lgkmcnt(0)
    s_barrier
    v_mfma_f32_16x16x32_bf16 v[144:147], v[192:195], v[96:99], v[160:163]
    s_mov_b32 s46, 163840
    s_add_u32 m0, s52, 101376
    v_mfma_f32_16x16x32_bf16 v[152:155], v[192:195], v[112:115], v[164:167]
    buffer_load_dwordx4 v6, s[8:11], s46 offen offset:0 nt lds
    v_mfma_f32_16x16x32_bf16 v[148:151], v[196:199], v[96:99], v[160:163]
    s_add_u32 m0, s52, 102176
    v_mfma_f32_16x16x32_bf16 v[156:159], v[196:199], v[112:115], v[164:167]
    buffer_load_dwordx4 v6, s[8:11], s46 offen offset:256 nt lds
    v_mfma_f32_16x16x32_bf16 v[144:147], v[200:203], v[100:103], v[144:147]
    s_mov_b32 s46, 147456
    s_add_u32 m0, s52, 109824
    v_mfma_f32_16x16x32_bf16 v[152:155], v[200:203], v[116:119], v[152:155]
    buffer_load_dwordx4 v6, s[12:15], s46 offen offset:0 nt lds
    v_mfma_f32_16x16x32_bf16 v[148:151], v[204:207], v[100:103], v[148:151]
    s_add_u32 m0, s52, 110624
    v_mfma_f32_16x16x32_bf16 v[156:159], v[204:207], v[116:119], v[156:159]
    buffer_load_dwordx4 v6, s[12:15], s46 offen offset:256 nt lds
    v_mfma_f32_16x16x32_bf16 v[144:147], v[208:211], v[104:107], v[144:147]
    ds_read_b64_tr_b16 v[224:225], v18 offset:33792
    ds_read_b64_tr_b16 v[226:227], v18 offset:34304
    ds_read_b64_tr_b16 v[228:229], v18 offset:33824
    ds_read_b64_tr_b16 v[230:231], v18 offset:34336
    v_mfma_f32_16x16x32_bf16 v[152:155], v[208:211], v[120:123], v[152:155]
    ds_read_b64_tr_b16 v[232:233], v18 offset:33856
    ds_read_b64_tr_b16 v[234:235], v18 offset:34368
    ds_read_b64_tr_b16 v[236:237], v18 offset:33888
    ds_read_b64_tr_b16 v[238:239], v18 offset:34400
    v_mfma_f32_16x16x32_bf16 v[148:151], v[212:215], v[104:107], v[148:151]
    ds_read_b64_tr_b16 v[240:241], v18 offset:33920
    ds_read_b64_tr_b16 v[242:243], v18 offset:34432
    ds_read_b64_tr_b16 v[244:245], v18 offset:33952
    ds_read_b64_tr_b16 v[246:247], v18 offset:34464
    v_exp_f32 v21, v137
    v_add_f32 v168, v168, v27
    v_cvt_pk_bf16_f32 v179, v26, v27
    v_exp_f32 v22, v138
    v_add_f32 v169, v171, v20
    v_exp_f32 v23, v139
    v_add_f32 v169, v169, v21
    v_mfma_f32_16x16x32_bf16 v[156:159], v[212:215], v[120:123], v[156:159]
    ds_read_b64_tr_b16 v[248:249], v18 offset:33984
    ds_read_b64_tr_b16 v[250:251], v18 offset:34496
    ds_read_b64_tr_b16 v[252:253], v18 offset:34016
    ds_read_b64_tr_b16 v[254:255], v18 offset:34528
    v_cvt_pk_bf16_f32 v180, v20, v21
    v_exp_f32 v24, v140
    v_add_f32 v169, v169, v22
    v_exp_f32 v25, v141
    v_add_f32 v169, v169, v23
    v_cvt_pk_bf16_f32 v181, v22, v23
    v_exp_f32 v26, v142
    v_mfma_f32_16x16x32_bf16 v[144:147], v[216:219], v[108:111], v[144:147]
    v_add_f32 v169, v169, v24
    v_exp_f32 v27, v143
    v_add_f32 v169, v169, v25
    v_cvt_pk_bf16_f32 v182, v24, v25
    v_add_f32 v169, v169, v26
    v_add_f32 v169, v169, v27
    v_cvt_pk_bf16_f32 v183, v26, v27
    v_mfma_f32_16x16x32_bf16 v[152:155], v[216:219], v[124:127], v[152:155]
    v_max_f32 v30, v168, v169
    v_cmp_lt_f32 vcc, s49, v30
    v_mfma_f32_16x16x32_bf16 v[148:151], v[220:223], v[108:111], v[148:151]
    s_cbranch_vccnz LP_r14
LP_b14:
    v_mfma_f32_16x16x32_bf16 v[156:159], v[220:223], v[124:127], v[156:159]
    s_waitcnt lgkmcnt(0)
    v_mfma_f32_16x16x32_bf16 v[32:35], v[224:227], v[176:179], v[32:35]
    ds_read_b128 v[192:195], v4 offset:33792
    ds_read_b128 v[196:199], v4 offset:34304
    v_mfma_f32_16x16x32_bf16 v[64:67], v[224:227], v[180:183], v[64:67]
    ds_read_b128 v[200:203], v4 offset:33856
    ds_read_b128 v[204:207], v4 offset:34368
    v_mfma_f32_16x16x32_bf16 v[36:39], v[228:231], v[176:179], v[36:39]
    ds_read_b128 v[208:211], v4 offset:33920
    ds_read_b128 v[212:215], v4 offset:34432
    v_mfma_f32_16x16x32_bf16 v[68:71], v[228:231], v[180:183], v[68:71]
    ds_read_b128 v[216:219], v4 offset:33984
    ds_read_b128 v[220:223], v4 offset:34496
    v_mfma_f32_16x16x32_bf16 v[40:43], v[232:235], v[176:179], v[40:43]
    v_mfma_f32_16x16x32_bf16 v[72:75], v[232:235], v[180:183], v[72:75]
    v_mfma_f32_16x16x32_bf16 v[44:47], v[236:239], v[176:179], v[44:47]
    v_mfma_f32_16x16x32_bf16 v[76:79], v[236:239], v[180:183], v[76:79]
    v_mfma_f32_16x16x32_bf16 v[48:51], v[240:243], v[176:179], v[48:51]
    v_mfma_f32_16x16x32_bf16 v[80:83], v[240:243], v[180:183], v[80:83]
    v_mfma_f32_16x16x32_bf16 v[52:55], v[244:247], v[176:179], v[52:55]
    v_mfma_f32_16x16x32_bf16 v[84:87], v[244:247], v[180:183], v[84:87]
    v_mfma_f32_16x16x32_bf16 v[56:59], v[248:251], v[176:179], v[56:59]
    v_mfma_f32_16x16x32_bf16 v[88:91], v[248:251], v[180:183], v[88:91]
    v_mfma_f32_16x16x32_bf16 v[60:63], v[252:255], v[176:179], v[60:63]
    v_exp_f32 v20, v144
    v_exp_f32 v21, v145
    v_exp_f32 v22, v146
    v_add_f32 v170, v168, v20
    v_exp_f32 v23, v147
    v_add_f32 v170, v170, v21
    v_cvt_pk_bf16_f32 v184, v20, v21
    v_exp_f32 v24, v148
    v_add_f32 v170, v170, v22
    v_exp_f32 v25, v149
    v_mfma_f32_16x16x32_bf16 v[92:95], v[252:255], v[180:183], v[92:95]
    v_add_f32 v170, v170, v23
    v_cvt_pk_bf16_f32 v185, v22, v23
    v_exp_f32 v26, v150
    v_add_f32 v170, v170, v24
    v_exp_f32 v27, v151
    v_add_f32 v170, v170, v25
    v_cvt_pk_bf16_f32 v186, v24, v25
    v_exp_f32 v20, v152
    v_add_f32 v170, v170, v26
    s_waitcnt vmcnt(12) lgkmcnt(0)
    s_barrier
    v_mfma_f32_16x16x32_bf16 v[128:131], v[192:195], v[96:99], v[160:163]
    s_mov_b32 s46, 172032
    s_add_u32 m0, s52, 0
    v_mfma_f32_16x16x32_bf16 v[136:139], v[192:195], v[112:115], v[164:167]
    buffer_load_dwordx4 v6, s[8:11], s46 offen offset:0 nt lds
    v_mfma_f32_16x16x32_bf16 v[132:135], v[196:199], v[96:99], v[160:163]
    s_add_u32 m0, s52, 800
    v_mfma_f32_16x16x32_bf16 v[140:143], v[196:199], v[112:115], v[164:167]
    buffer_load_dwordx4 v6, s[8:11], s46 offen offset:256 nt lds
    v_mfma_f32_16x16x32_bf16 v[128:131], v[200:203], v[100:103], v[128:131]
    s_mov_b32 s46, 155648
    s_add_u32 m0, s52, 8448
    v_mfma_f32_16x16x32_bf16 v[136:139], v[200:203], v[116:119], v[136:139]
    buffer_load_dwordx4 v6, s[12:15], s46 offen offset:0 nt lds
    v_mfma_f32_16x16x32_bf16 v[132:135], v[204:207], v[100:103], v[132:135]
    s_add_u32 m0, s52, 9248
    v_mfma_f32_16x16x32_bf16 v[140:143], v[204:207], v[116:119], v[140:143]
    buffer_load_dwordx4 v6, s[12:15], s46 offen offset:256 nt lds
    v_mfma_f32_16x16x32_bf16 v[128:131], v[208:211], v[104:107], v[128:131]
    ds_read_b64_tr_b16 v[224:225], v17 offset:33792
    ds_read_b64_tr_b16 v[226:227], v17 offset:34304
    ds_read_b64_tr_b16 v[228:229], v17 offset:33824
    ds_read_b64_tr_b16 v[230:231], v17 offset:34336
    v_mfma_f32_16x16x32_bf16 v[136:139], v[208:211], v[120:123], v[136:139]
    ds_read_b64_tr_b16 v[232:233], v17 offset:33856
    ds_read_b64_tr_b16 v[234:235], v17 offset:34368
    ds_read_b64_tr_b16 v[236:237], v17 offset:33888
    ds_read_b64_tr_b16 v[238:239], v17 offset:34400
    v_mfma_f32_16x16x32_bf16 v[132:135], v[212:215], v[104:107], v[132:135]
    ds_read_b64_tr_b16 v[240:241], v17 offset:33920
    ds_read_b64_tr_b16 v[242:243], v17 offset:34432
    ds_read_b64_tr_b16 v[244:245], v17 offset:33952
    ds_read_b64_tr_b16 v[246:247], v17 offset:34464
    v_exp_f32 v21, v153
    v_add_f32 v170, v170, v27
    v_cvt_pk_bf16_f32 v187, v26, v27
    v_exp_f32 v22, v154
    v_add_f32 v171, v169, v20
    v_exp_f32 v23, v155
    v_add_f32 v171, v171, v21
    v_mfma_f32_16x16x32_bf16 v[140:143], v[212:215], v[120:123], v[140:143]
    ds_read_b64_tr_b16 v[248:249], v17 offset:33984
    ds_read_b64_tr_b16 v[250:251], v17 offset:34496
    ds_read_b64_tr_b16 v[252:253], v17 offset:34016
    ds_read_b64_tr_b16 v[254:255], v17 offset:34528
    v_cvt_pk_bf16_f32 v188, v20, v21
    v_exp_f32 v24, v156
    v_add_f32 v171, v171, v22
    v_exp_f32 v25, v157
    v_add_f32 v171, v171, v23
    v_cvt_pk_bf16_f32 v189, v22, v23
    v_exp_f32 v26, v158
    v_mfma_f32_16x16x32_bf16 v[128:131], v[216:219], v[108:111], v[128:131]
    v_add_f32 v171, v171, v24
    v_exp_f32 v27, v159
    v_add_f32 v171, v171, v25
    v_cvt_pk_bf16_f32 v190, v24, v25
    v_add_f32 v171, v171, v26
    v_add_f32 v171, v171, v27
    v_cvt_pk_bf16_f32 v191, v26, v27
    v_mfma_f32_16x16x32_bf16 v[136:139], v[216:219], v[124:127], v[136:139]
    v_max_f32 v30, v170, v171
    v_cmp_lt_f32 vcc, s49, v30
    v_mfma_f32_16x16x32_bf16 v[132:135], v[220:223], v[108:111], v[132:135]
    s_cbranch_vccnz LP_r15
LP_b15:
    v_mfma_f32_16x16x32_bf16 v[140:143], v[220:223], v[124:127], v[140:143]
    s_waitcnt lgkmcnt(0)
    v_mfma_f32_16x16x32_bf16 v[32:35], v[224:227], v[184:187], v[32:35]
    ds_read_b128 v[192:195], v3 offset:33792
    ds_read_b128 v[196:199], v3 offset:34304
    v_mfma_f32_16x16x32_bf16 v[64:67], v[224:227], v[188:191], v[64:67]
    ds_read_b128 v[200:203], v3 offset:33856
    ds_read_b128 v[204:207], v3 offset:34368
    v_mfma_f32_16x16x32_bf16 v[36:39], v[228:231], v[184:187], v[36:39]
    ds_read_b128 v[208:211], v3 offset:33920
    ds_read_b128 v[212:215], v3 offset:34432
    v_mfma_f32_16x16x32_bf16 v[68:71], v[228:231], v[188:191], v[68:71]
    ds_read_b128 v[216:219], v3 offset:33984
    ds_read_b128 v[220:223], v3 offset:34496
    v_mfma_f32_16x16x32_bf16 v[40:43], v[232:235], v[184:187], v[40:43]
    v_mfma_f32_16x16x32_bf16 v[72:75], v[232:235], v[188:191], v[72:75]
    v_mfma_f32_16x16x32_bf16 v[44:47], v[236:239], v[184:187], v[44:47]
    v_mfma_f32_16x16x32_bf16 v[76:79], v[236:239], v[188:191], v[76:79]
    v_mfma_f32_16x16x32_bf16 v[48:51], v[240:243], v[184:187], v[48:51]
    v_mfma_f32_16x16x32_bf16 v[80:83], v[240:243], v[188:191], v[80:83]
    v_mfma_f32_16x16x32_bf16 v[52:55], v[244:247], v[184:187], v[52:55]
    v_mfma_f32_16x16x32_bf16 v[84:87], v[244:247], v[188:191], v[84:87]
    v_mfma_f32_16x16x32_bf16 v[56:59], v[248:251], v[184:187], v[56:59]
    v_mfma_f32_16x16x32_bf16 v[88:91], v[248:251], v[188:191], v[88:91]
    v_mfma_f32_16x16x32_bf16 v[60:63], v[252:255], v[184:187], v[60:63]
    v_exp_f32 v20, v128
    v_exp_f32 v21, v129
    v_exp_f32 v22, v130
    v_add_f32 v168, v170, v20
    v_exp_f32 v23, v131
    v_add_f32 v168, v168, v21
    v_cvt_pk_bf16_f32 v176, v20, v21
    v_exp_f32 v24, v132
    v_add_f32 v168, v168, v22
    v_exp_f32 v25, v133
    v_mfma_f32_16x16x32_bf16 v[92:95], v[252:255], v[188:191], v[92:95]
    global_load_dword v9, v8, s[0:1]
    v_add_f32 v168, v168, v23
    v_cvt_pk_bf16_f32 v177, v22, v23
    v_exp_f32 v26, v134
    v_add_f32 v168, v168, v24
    v_exp_f32 v27, v135
    v_add_f32 v168, v168, v25
    v_cvt_pk_bf16_f32 v178, v24, v25
    v_exp_f32 v20, v136
    v_add_f32 v168, v168, v26
    s_waitcnt vmcnt(13) lgkmcnt(0)
    s_barrier
    v_mfma_f32_16x16x32_bf16 v[144:147], v[192:195], v[96:99], v[160:163]
    s_mov_b32 s46, 180224
    s_add_u32 m0, s52, 118272
    v_mfma_f32_16x16x32_bf16 v[152:155], v[192:195], v[112:115], v[164:167]
    buffer_load_dwordx4 v6, s[8:11], s46 offen offset:0 nt lds
    v_mfma_f32_16x16x32_bf16 v[148:151], v[196:199], v[96:99], v[160:163]
    s_add_u32 m0, s52, 119072
    v_mfma_f32_16x16x32_bf16 v[156:159], v[196:199], v[112:115], v[164:167]
    buffer_load_dwordx4 v6, s[8:11], s46 offen offset:256 nt lds
    v_mfma_f32_16x16x32_bf16 v[144:147], v[200:203], v[100:103], v[144:147]
    s_mov_b32 s46, 163840
    s_add_u32 m0, s52, 126720
    v_mfma_f32_16x16x32_bf16 v[152:155], v[200:203], v[116:119], v[152:155]
    buffer_load_dwordx4 v6, s[12:15], s46 offen offset:0 nt lds
    v_mfma_f32_16x16x32_bf16 v[148:151], v[204:207], v[100:103], v[148:151]
    s_add_u32 m0, s52, 127520
    v_mfma_f32_16x16x32_bf16 v[156:159], v[204:207], v[116:119], v[156:159]
    buffer_load_dwordx4 v6, s[12:15], s46 offen offset:256 nt lds
    v_mfma_f32_16x16x32_bf16 v[144:147], v[208:211], v[104:107], v[144:147]
    ds_read_b64_tr_b16 v[224:225], v17 offset:16896
    ds_read_b64_tr_b16 v[226:227], v17 offset:17408
    ds_read_b64_tr_b16 v[228:229], v17 offset:16928
    ds_read_b64_tr_b16 v[230:231], v17 offset:17440
    v_mfma_f32_16x16x32_bf16 v[152:155], v[208:211], v[120:123], v[152:155]
    ds_read_b64_tr_b16 v[232:233], v17 offset:16960
    ds_read_b64_tr_b16 v[234:235], v17 offset:17472
    ds_read_b64_tr_b16 v[236:237], v17 offset:16992
    ds_read_b64_tr_b16 v[238:239], v17 offset:17504
    v_mfma_f32_16x16x32_bf16 v[148:151], v[212:215], v[104:107], v[148:151]
    ds_read_b64_tr_b16 v[240:241], v17 offset:17024
    ds_read_b64_tr_b16 v[242:243], v17 offset:17536
    ds_read_b64_tr_b16 v[244:245], v17 offset:17056
    ds_read_b64_tr_b16 v[246:247], v17 offset:17568
    v_exp_f32 v21, v137
    v_add_f32 v168, v168, v27
    v_cvt_pk_bf16_f32 v179, v26, v27
    v_exp_f32 v22, v138
    v_add_f32 v169, v171, v20
    v_exp_f32 v23, v139
    v_add_f32 v169, v169, v21
    v_mfma_f32_16x16x32_bf16 v[156:159], v[212:215], v[120:123], v[156:159]
    ds_read_b64_tr_b16 v[248:249], v17 offset:17088
    ds_read_b64_tr_b16 v[250:251], v17 offset:17600
    ds_read_b64_tr_b16 v[252:253], v17 offset:17120
    ds_read_b64_tr_b16 v[254:255], v17 offset:17632
    v_cvt_pk_bf16_f32 v180, v20, v21
    v_exp_f32 v24, v140
    v_add_f32 v169, v169, v22
    v_exp_f32 v25, v141
    v_add_f32 v169, v169, v23
    v_cvt_pk_bf16_f32 v181, v22, v23
    v_exp_f32 v26, v142
    v_mfma_f32_16x16x32_bf16 v[144:147], v[216:219], v[108:111], v[144:147]
    v_add_f32 v169, v169, v24
    v_exp_f32 v27, v143
    v_add_f32 v169, v169, v25
    v_cvt_pk_bf16_f32 v182, v24, v25
    v_add_f32 v169, v169, v26
    v_add_f32 v169, v169, v27
    v_cvt_pk_bf16_f32 v183, v26, v27
    v_mfma_f32_16x16x32_bf16 v[152:155], v[216:219], v[124:127], v[152:155]
    v_max_f32 v30, v168, v169
    v_cmp_lt_f32 vcc, s49, v30
    v_mfma_f32_16x16x32_bf16 v[148:151], v[220:223], v[108:111], v[148:151]
    s_cbranch_vccnz LP_r16
LP_b16:
    v_mfma_f32_16x16x32_bf16 v[156:159], v[220:223], v[124:127], v[156:159]
    s_waitcnt lgkmcnt(0)
    v_mfma_f32_16x16x32_bf16 v[32:35], v[224:227], v[176:179], v[32:35]
    ds_read_b128 v[192:195], v3 offset:16896
    ds_read_b128 v[196:199], v3 offset:17408
    v_mfma_f32_16x16x32_bf16 v[64:67], v[224:227], v[180:183], v[64:67]
    ds_read_b128 v[200:203], v3 offset:16960
    ds_read_b128 v[204:207], v3 offset:17472
    v_mfma_f32_16x16x32_bf16 v[36:39], v[228:231], v[176:179], v[36:39]
    ds_read_b128 v[208:211], v3 offset:17024
    ds_read_b128 v[212:215], v3 offset:17536
    v_mfma_f32_16x16x32_bf16 v[68:71], v[228:231], v[180:183], v[68:71]
    ds_read_b128 v[216:219], v3 offset:17088
    ds_read_b128 v[220:223], v3 offset:17600
    v_mfma_f32_16x16x32_bf16 v[40:43], v[232:235], v[176:179], v[40:43]
    v_mfma_f32_16x16x32_bf16 v[72:75], v[232:235], v[180:183], v[72:75]
    v_mfma_f32_16x16x32_bf16 v[44:47], v[236:239], v[176:179], v[44:47]
    v_mfma_f32_16x16x32_bf16 v[76:79], v[236:239], v[180:183], v[76:79]
    v_mfma_f32_16x16x32_bf16 v[48:51], v[240:243], v[176:179], v[48:51]
    v_mfma_f32_16x16x32_bf16 v[80:83], v[240:243], v[180:183], v[80:83]
    v_mfma_f32_16x16x32_bf16 v[52:55], v[244:247], v[176:179], v[52:55]
    v_mfma_f32_16x16x32_bf16 v[84:87], v[244:247], v[180:183], v[84:87]
    v_mfma_f32_16x16x32_bf16 v[56:59], v[248:251], v[176:179], v[56:59]
    v_mfma_f32_16x16x32_bf16 v[88:91], v[248:251], v[180:183], v[88:91]
    v_mfma_f32_16x16x32_bf16 v[60:63], v[252:255], v[176:179], v[60:63]
    v_exp_f32 v20, v144
    v_exp_f32 v21, v145
    v_exp_f32 v22, v146
    v_add_f32 v170, v168, v20
    v_exp_f32 v23, v147
    v_add_f32 v170, v170, v21
    v_cvt_pk_bf16_f32 v184, v20, v21
    v_exp_f32 v24, v148
    v_add_f32 v170, v170, v22
    v_exp_f32 v25, v149
    v_mfma_f32_16x16x32_bf16 v[92:95], v[252:255], v[180:183], v[92:95]
    v_add_f32 v170, v170, v23
    v_cvt_pk_bf16_f32 v185, v22, v23
    v_exp_f32 v26, v150
    v_add_f32 v170, v170, v24
    v_exp_f32 v27, v151
    v_add_f32 v170, v170, v25
    v_cvt_pk_bf16_f32 v186, v24, v25
    v_exp_f32 v20, v152
    v_add_f32 v170, v170, v26
    s_waitcnt vmcnt(13) lgkmcnt(0)
    s_barrier
    v_mfma_f32_16x16x32_bf16 v[128:131], v[192:195], v[96:99], v[160:163]
    s_mov_b32 s46, 188416
    s_add_u32 m0, s52, 50688
    v_mfma_f32_16x16x32_bf16 v[136:139], v[192:195], v[112:115], v[164:167]
    buffer_load_dwordx4 v6, s[8:11], s46 offen offset:0 nt lds
    v_mfma_f32_16x16x32_bf16 v[132:135], v[196:199], v[96:99], v[160:163]
    s_add_u32 m0, s52, 51488
    v_mfma_f32_16x16x32_bf16 v[140:143], v[196:199], v[112:115], v[164:167]
    buffer_load_dwordx4 v6, s[8:11], s46 offen offset:256 nt lds
    v_mfma_f32_16x16x32_bf16 v[128:131], v[200:203], v[100:103], v[128:131]
    s_mov_b32 s46, 172032
    s_add_u32 m0, s52, 59136
    v_mfma_f32_16x16x32_bf16 v[136:139], v[200:203], v[116:119], v[136:139]
    buffer_load_dwordx4 v6, s[12:15], s46 offen offset:0 nt lds
    v_mfma_f32_16x16x32_bf16 v[132:135], v[204:207], v[100:103], v[132:135]
    s_add_u32 m0, s52, 59936
    v_mfma_f32_16x16x32_bf16 v[140:143], v[204:207], v[116:119], v[140:143]
    buffer_load_dwordx4 v6, s[12:15], s46 offen offset:256 nt lds
    v_mfma_f32_16x16x32_bf16 v[128:131], v[208:211], v[104:107], v[128:131]
    ds_read_b64_tr_b16 v[224:225], v16 offset:33792
    ds_read_b64_tr_b16 v[226:227], v16 offset:34304
    ds_read_b64_tr_b16 v[228:229], v16 offset:33824
    ds_read_b64_tr_b16 v[230:231], v16 offset:34336
    v_mfma_f32_16x16x32_bf16 v[136:139], v[208:211], v[120:123], v[136:139]
    ds_read_b64_tr_b16 v[232:233], v16 offset:33856
    ds_read_b64_tr_b16 v[234:235], v16 offset:34368
    ds_read_b64_tr_b16 v[236:237], v16 offset:33888
    ds_read_b64_tr_b16 v[238:239], v16 offset:34400
    v_mfma_f32_16x16x32_bf16 v[132:135], v[212:215], v[104:107], v[132:135]
    ds_read_b64_tr_b16 v[240:241], v16 offset:33920
    ds_read_b64_tr_b16 v[242:243], v16 offset:34432
    ds_read_b64_tr_b16 v[244:245], v16 offset:33952
    ds_read_b64_tr_b16 v[246:247], v16 offset:34464
    v_exp_f32 v21, v153
    v_add_f32 v170, v170, v27
    v_cvt_pk_bf16_f32 v187, v26, v27
    v_exp_f32 v22, v154
    v_add_f32 v171, v169, v20
    v_exp_f32 v23, v155
    v_add_f32 v171, v171, v21
    v_mfma_f32_16x16x32_bf16 v[140:143], v[212:215], v[120:123], v[140:143]
    ds_read_b64_tr_b16 v[248:249], v16 offset:33984
    ds_read_b64_tr_b16 v[250:251], v16 offset:34496
    ds_read_b64_tr_b16 v[252:253], v16 offset:34016
    ds_read_b64_tr_b16 v[254:255], v16 offset:34528
    v_cvt_pk_bf16_f32 v188, v20, v21
    v_exp_f32 v24, v156
    v_add_f32 v171, v171, v22
    v_exp_f32 v25, v157
    v_add_f32 v171, v171, v23
    v_cvt_pk_bf16_f32 v189, v22, v23
    v_exp_f32 v26, v158
    v_mfma_f32_16x16x32_bf16 v[128:131], v[216:219], v[108:111], v[128:131]
    v_add_f32 v171, v171, v24
    v_exp_f32 v27, v159
    v_add_f32 v171, v171, v25
    v_cvt_pk_bf16_f32 v190, v24, v25
    v_add_f32 v171, v171, v26
    v_add_f32 v171, v171, v27
    v_cvt_pk_bf16_f32 v191, v26, v27
    v_mfma_f32_16x16x32_bf16 v[136:139], v[216:219], v[124:127], v[136:139]
    v_max_f32 v30, v170, v171
    v_cmp_lt_f32 vcc, s49, v30
    v_mfma_f32_16x16x32_bf16 v[132:135], v[220:223], v[108:111], v[132:135]
    s_cbranch_vccnz LP_r17
LP_b17:
    v_mfma_f32_16x16x32_bf16 v[140:143], v[220:223], v[124:127], v[140:143]
    s_waitcnt lgkmcnt(0)
    v_mfma_f32_16x16x32_bf16 v[32:35], v[224:227], v[184:187], v[32:35]
    ds_read_b128 v[192:195], v2 offset:33792
    ds_read_b128 v[196:199], v2 offset:34304
    v_mfma_f32_16x16x32_bf16 v[64:67], v[224:227], v[188:191], v[64:67]
    ds_read_b128 v[200:203], v2 offset:33856
    ds_read_b128 v[204:207], v2 offset:34368
    v_mfma_f32_16x16x32_bf16 v[36:39], v[228:231], v[184:187], v[36:39]
    ds_read_b128 v[208:211], v2 offset:33920
    ds_read_b128 v[212:215], v2 offset:34432
    v_mfma_f32_16x16x32_bf16 v[68:71], v[228:231], v[188:191], v[68:71]
    ds_read_b128 v[216:219], v2 offset:33984
    ds_read_b128 v[220:223], v2 offset:34496
    v_mfma_f32_16x16x32_bf16 v[40:43], v[232:235], v[184:187], v[40:43]
    v_mfma_f32_16x16x32_bf16 v[72:75], v[232:235], v[188:191], v[72:75]
    v_mfma_f32_16x16x32_bf16 v[44:47], v[236:239], v[184:187], v[44:47]
    v_mfma_f32_16x16x32_bf16 v[76:79], v[236:239], v[188:191], v[76:79]
    v_mfma_f32_16x16x32_bf16 v[48:51], v[240:243], v[184:187], v[48:51]
    v_mfma_f32_16x16x32_bf16 v[80:83], v[240:243], v[188:191], v[80:83]
    v_mfma_f32_16x16x32_bf16 v[52:55], v[244:247], v[184:187], v[52:55]
    v_mfma_f32_16x16x32_bf16 v[84:87], v[244:247], v[188:191], v[84:87]
    v_mfma_f32_16x16x32_bf16 v[56:59], v[248:251], v[184:187], v[56:59]
    v_mfma_f32_16x16x32_bf16 v[88:91], v[248:251], v[188:191], v[88:91]
    v_mfma_f32_16x16x32_bf16 v[60:63], v[252:255], v[184:187], v[60:63]
    v_exp_f32 v20, v128
    v_exp_f32 v21, v129
    v_exp_f32 v22, v130
    v_add_f32 v168, v170, v20
    v_exp_f32 v23, v131
    v_add_f32 v168, v168, v21
    v_cvt_pk_bf16_f32 v176, v20, v21
    v_exp_f32 v24, v132
    v_add_f32 v168, v168, v22
    v_exp_f32 v25, v133
    v_mfma_f32_16x16x32_bf16 v[92:95], v[252:255], v[188:191], v[92:95]
    v_add_f32 v168, v168, v23
    v_cvt_pk_bf16_f32 v177, v22, v23
    v_exp_f32 v26, v134
    v_add_f32 v168, v168, v24
    v_exp_f32 v27, v135
    v_add_f32 v168, v168, v25
    v_cvt_pk_bf16_f32 v178, v24, v25
    v_exp_f32 v20, v136
    v_add_f32 v168, v168, v26
    s_waitcnt vmcnt(13) lgkmcnt(0)
    s_barrier
    v_mfma_f32_16x16x32_bf16 v[144:147], v[192:195], v[96:99], v[160:163]
    s_mov_b32 s46, 196608
    s_add_u32 m0, s52, 16896
    v_mfma_f32_16x16x32_bf16 v[152:155], v[192:195], v[112:115], v[164:167]
    buffer_load_dwordx4 v6, s[8:11], s46 offen offset:0 nt lds
    v_mfma_f32_16x16x32_bf16 v[148:151], v[196:199], v[96:99], v[160:163]
    s_add_u32 m0, s52, 17696
    v_mfma_f32_16x16x32_bf16 v[156:159], v[196:199], v[112:115], v[164:167]
    buffer_load_dwordx4 v6, s[8:11], s46 offen offset:256 nt lds
    v_mfma_f32_16x16x32_bf16 v[144:147], v[200:203], v[100:103], v[144:147]
    s_mov_b32 s46, 180224
    s_add_u32 m0, s52, 25344
    v_mfma_f32_16x16x32_bf16 v[152:155], v[200:203], v[116:119], v[152:155]
    buffer_load_dwordx4 v6, s[12:15], s46 offen offset:0 nt lds
    v_mfma_f32_16x16x32_bf16 v[148:151], v[204:207], v[100:103], v[148:151]
    s_add_u32 m0, s52, 26144
    v_mfma_f32_16x16x32_bf16 v[156:159], v[204:207], v[116:119], v[156:159]
    buffer_load_dwordx4 v6, s[12:15], s46 offen offset:256 nt lds
    v_mfma_f32_16x16x32_bf16 v[144:147], v[208:211], v[104:107], v[144:147]
    ds_read_b64_tr_b16 v[224:225], v18 offset:0
    ds_read_b64_tr_b16 v[226:227], v18 offset:512
    ds_read_b64_tr_b16 v[228:229], v18 offset:32
    ds_read_b64_tr_b16 v[230:231], v18 offset:544
    v_mfma_f32_16x16x32_bf16 v[152:155], v[208:211], v[120:123], v[152:155]
    ds_read_b64_tr_b16 v[232:233], v18 offset:64
    ds_read_b64_tr_b16 v[234:235], v18 offset:576
    ds_read_b64_tr_b16 v[236:237], v18 offset:96
    ds_read_b64_tr_b16 v[238:239], v18 offset:608
    v_mfma_f32_16x16x32_bf16 v[148:151], v[212:215], v[104:107], v[148:151]
    ds_read_b64_tr_b16 v[240:241], v18 offset:128
    ds_read_b64_tr_b16 v[242:243], v18 offset:640
    ds_read_b64_tr_b16 v[244:245], v18 offset:160
    ds_read_b64_tr_b16 v[246:247], v18 offset:672
    v_exp_f32 v21, v137
    v_add_f32 v168, v168, v27
    v_cvt_pk_bf16_f32 v179, v26, v27
    v_exp_f32 v22, v138
    v_add_f32 v169, v171, v20
    v_exp_f32 v23, v139
    v_add_f32 v169, v169, v21
    v_mfma_f32_16x16x32_bf16 v[156:159], v[212:215], v[120:123], v[156:159]
    ds_read_b64_tr_b16 v[248:249], v18 offset:192
    ds_read_b64_tr_b16 v[250:251], v18 offset:704
    ds_read_b64_tr_b16 v[252:253], v18 offset:224
    ds_read_b64_tr_b16 v[254:255], v18 offset:736
    v_cvt_pk_bf16_f32 v180, v20, v21
    v_exp_f32 v24, v140
    v_add_f32 v169, v169, v22
    v_exp_f32 v25, v141
    v_add_f32 v169, v169, v23
    v_cvt_pk_bf16_f32 v181, v22, v23
    v_exp_f32 v26, v142
    v_mfma_f32_16x16x32_bf16 v[144:147], v[216:219], v[108:111], v[144:147]
    v_add_f32 v169, v169, v24
    v_exp_f32 v27, v143
    v_add_f32 v169, v169, v25
    v_cvt_pk_bf16_f32 v182, v24, v25
    v_add_f32 v169, v169, v26
    v_add_f32 v169, v169, v27
    v_cvt_pk_bf16_f32 v183, v26, v27
    v_mfma_f32_16x16x32_bf16 v[152:155], v[216:219], v[124:127], v[152:155]
    v_max_f32 v30, v168, v169
    v_cmp_lt_f32 vcc, s49, v30
    v_mfma_f32_16x16x32_bf16 v[148:151], v[220:223], v[108:111], v[148:151]
    s_cbranch_vccnz LP_r18
LP_b18:
    v_mfma_f32_16x16x32_bf16 v[156:159], v[220:223], v[124:127], v[156:159]
    s_waitcnt lgkmcnt(0)
    v_mfma_f32_16x16x32_bf16 v[32:35], v[224:227], v[176:179], v[32:35]
    ds_read_b128 v[192:195], v4 offset:0
    ds_read_b128 v[196:199], v4 offset:512
    v_mfma_f32_16x16x32_bf16 v[64:67], v[224:227], v[180:183], v[64:67]
    ds_read_b128 v[200:203], v4 offset:64
    ds_read_b128 v[204:207], v4 offset:576
    v_mfma_f32_16x16x32_bf16 v[36:39], v[228:231], v[176:179], v[36:39]
    ds_read_b128 v[208:211], v4 offset:128
    ds_read_b128 v[212:215], v4 offset:640
    v_mfma_f32_16x16x32_bf16 v[68:71], v[228:231], v[180:183], v[68:71]
    ds_read_b128 v[216:219], v4 offset:192
    ds_read_b128 v[220:223], v4 offset:704
    v_mfma_f32_16x16x32_bf16 v[40:43], v[232:235], v[176:179], v[40:43]
    v_mfma_f32_16x16x32_bf16 v[72:75], v[232:235], v[180:183], v[72:75]
    v_mfma_f32_16x16x32_bf16 v[44:47], v[236:239], v[176:179], v[44:47]
    v_mfma_f32_16x16x32_bf16 v[76:79], v[236:239], v[180:183], v[76:79]
    v_mfma_f32_16x16x32_bf16 v[48:51], v[240:243], v[176:179], v[48:51]
    v_mfma_f32_16x16x32_bf16 v[80:83], v[240:243], v[180:183], v[80:83]
    v_mfma_f32_16x16x32_bf16 v[52:55], v[244:247], v[176:179], v[52:55]
    v_mfma_f32_16x16x32_bf16 v[84:87], v[244:247], v[180:183], v[84:87]
    v_mfma_f32_16x16x32_bf16 v[56:59], v[248:251], v[176:179], v[56:59]
    v_mfma_f32_16x16x32_bf16 v[88:91], v[248:251], v[180:183], v[88:91]
    v_mfma_f32_16x16x32_bf16 v[60:63], v[252:255], v[176:179], v[60:63]
    v_exp_f32 v20, v144
    v_exp_f32 v21, v145
    v_exp_f32 v22, v146
    v_add_f32 v170, v168, v20
    v_exp_f32 v23, v147
    v_add_f32 v170, v170, v21
    v_cvt_pk_bf16_f32 v184, v20, v21
    v_exp_f32 v24, v148
    v_add_f32 v170, v170, v22
    v_exp_f32 v25, v149
    v_mfma_f32_16x16x32_bf16 v[92:95], v[252:255], v[180:183], v[92:95]
    v_add_f32 v170, v170, v23
    v_cvt_pk_bf16_f32 v185, v22, v23
    v_exp_f32 v26, v150
    v_add_f32 v170, v170, v24
    v_exp_f32 v27, v151
    v_add_f32 v170, v170, v25
    v_cvt_pk_bf16_f32 v186, v24, v25
    v_exp_f32 v20, v152
    v_add_f32 v170, v170, v26
    s_waitcnt vmcnt(13) lgkmcnt(0)
    s_barrier
    v_mfma_f32_16x16x32_bf16 v[128:131], v[192:195], v[96:99], v[160:163]
    s_mov_b32 s46, 204800
    s_add_u32 m0, s52, 135168
    v_mfma_f32_16x16x32_bf16 v[136:139], v[192:195], v[112:115], v[164:167]
    buffer_load_dwordx4 v6, s[8:11], s46 offen offset:0 nt lds
    v_mfma_f32_16x16x32_bf16 v[132:135], v[196:199], v[96:99], v[160:163]
    s_add_u32 m0, s52, 135968
    v_mfma_f32_16x16x32_bf16 v[140:143], v[196:199], v[112:115], v[164:167]
    buffer_load_dwordx4 v6, s[8:11], s46 offen offset:256 nt lds
    v_mfma_f32_16x16x32_bf16 v[128:131], v[200:203], v[100:103], v[128:131]
    s_mov_b32 s46, 188416
    s_add_u32 m0, s52, 143616
    v_mfma_f32_16x16x32_bf16 v[136:139], v[200:203], v[116:119], v[136:139]
    buffer_load_dwordx4 v6, s[12:15], s46 offen offset:0 nt lds
    v_mfma_f32_16x16x32_bf16 v[132:135], v[204:207], v[100:103], v[132:135]
    s_add_u32 m0, s52, 144416
    v_mfma_f32_16x16x32_bf16 v[140:143], v[204:207], v[116:119], v[140:143]
    buffer_load_dwordx4 v6, s[12:15], s46 offen offset:256 nt lds
    v_mfma_f32_16x16x32_bf16 v[128:131], v[208:211], v[104:107], v[128:131]
    ds_read_b64_tr_b16 v[224:225], v16 offset:0
    ds_read_b64_tr_b16 v[226:227], v16 offset:512
    ds_read_b64_tr_b16 v[228:229], v16 offset:32
    ds_read_b64_tr_b16 v[230:231], v16 offset:544
    v_mfma_f32_16x16x32_bf16 v[136:139], v[208:211], v[120:123], v[136:139]
    ds_read_b64_tr_b16 v[232:233], v16 offset:64
    ds_read_b64_tr_b16 v[234:235], v16 offset:576
    ds_read_b64_tr_b16 v[236:237], v16 offset:96
    ds_read_b64_tr_b16 v[238:239], v16 offset:608
    v_mfma_f32_16x16x32_bf16 v[132:135], v[212:215], v[104:107], v[132:135]
    ds_read_b64_tr_b16 v[240:241], v16 offset:128
    ds_read_b64_tr_b16 v[242:243], v16 offset:640
    ds_read_b64_tr_b16 v[244:245], v16 offset:160
    ds_read_b64_tr_b16 v[246:247], v16 offset:672
    v_exp_f32 v21, v153
    v_add_f32 v170, v170, v27
    v_cvt_pk_bf16_f32 v187, v26, v27
    v_exp_f32 v22, v154
    v_add_f32 v171, v169, v20
    v_exp_f32 v23, v155
    v_add_f32 v171, v171, v21
    v_mfma_f32_16x16x32_bf16 v[140:143], v[212:215], v[120:123], v[140:143]
    ds_read_b64_tr_b16 v[248:249], v16 offset:192
    ds_read_b64_tr_b16 v[250:251], v16 offset:704
    ds_read_b64_tr_b16 v[252:253], v16 offset:224
    ds_read_b64_tr_b16 v[254:255], v16 offset:736
    v_cvt_pk_bf16_f32 v188, v20, v21
    v_exp_f32 v24, v156
    v_add_f32 v171, v171, v22
    v_exp_f32 v25, v157
    v_add_f32 v171, v171, v23
    v_cvt_pk_bf16_f32 v189, v22, v23
    v_exp_f32 v26, v158
    v_mfma_f32_16x16x32_bf16 v[128:131], v[216:219], v[108:111], v[128:131]
    v_add_f32 v171, v171, v24
    v_exp_f32 v27, v159
    v_add_f32 v171, v171, v25
    v_cvt_pk_bf16_f32 v190, v24, v25
    v_add_f32 v171, v171, v26
    v_add_f32 v171, v171, v27
    v_cvt_pk_bf16_f32 v191, v26, v27
    v_mfma_f32_16x16x32_bf16 v[136:139], v[216:219], v[124:127], v[136:139]
    v_max_f32 v30, v170, v171
    v_cmp_lt_f32 vcc, s49, v30
    v_mfma_f32_16x16x32_bf16 v[132:135], v[220:223], v[108:111], v[132:135]
    s_cbranch_vccnz LP_r19
LP_b19:
    v_mfma_f32_16x16x32_bf16 v[140:143], v[220:223], v[124:127], v[140:143]
    s_waitcnt lgkmcnt(0)
    v_mfma_f32_16x16x32_bf16 v[32:35], v[224:227], v[184:187], v[32:35]
    ds_read_b128 v[192:195], v2 offset:0
    ds_read_b128 v[196:199], v2 offset:512
    v_mfma_f32_16x16x32_bf16 v[64:67], v[224:227], v[188:191], v[64:67]
    ds_read_b128 v[200:203], v2 offset:64
    ds_read_b128 v[204:207], v2 offset:576
    v_mfma_f32_16x16x32_bf16 v[36:39], v[228:231], v[184:187], v[36:39]
    ds_read_b128 v[208:211], v2 offset:128
    ds_read_b128 v[212:215], v2 offset:640
    v_mfma_f32_16x16x32_bf16 v[68:71], v[228:231], v[188:191], v[68:71]
    ds_read_b128 v[216:219], v2 offset:192
    ds_read_b128 v[220:223], v2 offset:704
    v_mfma_f32_16x16x32_bf16 v[40:43], v[232:235], v[184:187], v[40:43]
    v_mfma_f32_16x16x32_bf16 v[72:75], v[232:235], v[188:191], v[72:75]
    v_mfma_f32_16x16x32_bf16 v[44:47], v[236:239], v[184:187], v[44:47]
    v_mfma_f32_16x16x32_bf16 v[76:79], v[236:239], v[188:191], v[76:79]
    v_mfma_f32_16x16x32_bf16 v[48:51], v[240:243], v[184:187], v[48:51]
    v_mfma_f32_16x16x32_bf16 v[80:83], v[240:243], v[188:191], v[80:83]
    v_mfma_f32_16x16x32_bf16 v[52:55], v[244:247], v[184:187], v[52:55]
    v_mfma_f32_16x16x32_bf16 v[84:87], v[244:247], v[188:191], v[84:87]
    v_mfma_f32_16x16x32_bf16 v[56:59], v[248:251], v[184:187], v[56:59]
    v_mfma_f32_16x16x32_bf16 v[88:91], v[248:251], v[188:191], v[88:91]
    v_mfma_f32_16x16x32_bf16 v[60:63], v[252:255], v[184:187], v[60:63]
    v_exp_f32 v20, v128
    v_exp_f32 v21, v129
    v_exp_f32 v22, v130
    v_add_f32 v168, v170, v20
    v_exp_f32 v23, v131
    v_add_f32 v168, v168, v21
    v_cvt_pk_bf16_f32 v176, v20, v21
    v_exp_f32 v24, v132
    v_add_f32 v168, v168, v22
    v_exp_f32 v25, v133
    v_mfma_f32_16x16x32_bf16 v[92:95], v[252:255], v[188:191], v[92:95]
    v_add_f32 v168, v168, v23
    v_cvt_pk_bf16_f32 v177, v22, v23
    v_exp_f32 v26, v134
    v_add_f32 v168, v168, v24
    v_exp_f32 v27, v135
    v_add_f32 v168, v168, v25
    v_cvt_pk_bf16_f32 v178, v24, v25
    v_exp_f32 v20, v136
    v_add_f32 v168, v168, v26
    s_waitcnt vmcnt(12) lgkmcnt(0)
    s_barrier
    v_mfma_f32_16x16x32_bf16 v[144:147], v[192:195], v[96:99], v[160:163]
    s_mov_b32 s46, 212992
    s_add_u32 m0, s52, 84480
    v_mfma_f32_16x16x32_bf16 v[152:155], v[192:195], v[112:115], v[164:167]
    buffer_load_dwordx4 v6, s[8:11], s46 offen offset:0 nt lds
    v_mfma_f32_16x16x32_bf16 v[148:151], v[196:199], v[96:99], v[160:163]
    s_add_u32 m0, s52, 85280
    v_mfma_f32_16x16x32_bf16 v[156:159], v[196:199], v[112:115], v[164:167]
    buffer_load_dwordx4 v6, s[8:11], s46 offen offset:256 nt lds
    v_mfma_f32_16x16x32_bf16 v[144:147], v[200:203], v[100:103], v[144:147]
    s_mov_b32 s46, 196608
    s_add_u32 m0, s52, 92928
    v_mfma_f32_16x16x32_bf16 v[152:155], v[200:203], v[116:119], v[152:155]
    buffer_load_dwordx4 v6, s[12:15], s46 offen offset:0 nt lds
    v_mfma_f32_16x16x32_bf16 v[148:151], v[204:207], v[100:103], v[148:151]
    s_add_u32 m0, s52, 93728
    v_mfma_f32_16x16x32_bf16 v[156:159], v[204:207], v[116:119], v[156:159]
    buffer_load_dwordx4 v6, s[12:15], s46 offen offset:256 nt lds
    v_mfma_f32_16x16x32_bf16 v[144:147], v[208:211], v[104:107], v[144:147]
    ds_read_b64_tr_b16 v[224:225], v18 offset:16896
    ds_read_b64_tr_b16 v[226:227], v18 offset:17408
    ds_read_b64_tr_b16 v[228:229], v18 offset:16928
    ds_read_b64_tr_b16 v[230:231], v18 offset:17440
    v_mfma_f32_16x16x32_bf16 v[152:155], v[208:211], v[120:123], v[152:155]
    ds_read_b64_tr_b16 v[232:233], v18 offset:16960
    ds_read_b64_tr_b16 v[234:235], v18 offset:17472
    ds_read_b64_tr_b16 v[236:237], v18 offset:16992
    ds_read_b64_tr_b16 v[238:239], v18 offset:17504
    v_mfma_f32_16x16x32_bf16 v[148:151], v[212:215], v[104:107], v[148:151]
    ds_read_b64_tr_b16 v[240:241], v18 offset:17024
    ds_read_b64_tr_b16 v[242:243], v18 offset:17536
    ds_read_b64_tr_b16 v[244:245], v18 offset:17056
    ds_read_b64_tr_b16 v[246:247], v18 offset:17568
    v_exp_f32 v21, v137
    v_add_f32 v168, v168, v27
    v_cvt_pk_bf16_f32 v179, v26, v27
    v_exp_f32 v22, v138
    v_add_f32 v169, v171, v20
    v_exp_f32 v23, v139
    v_add_f32 v169, v169, v21
    v_mfma_f32_16x16x32_bf16 v[156:159], v[212:215], v[120:123], v[156:159]
    ds_read_b64_tr_b16 v[248:249], v18 offset:17088
    ds_read_b64_tr_b16 v[250:251], v18 offset:17600
    ds_read_b64_tr_b16 v[252:253], v18 offset:17120
    ds_read_b64_tr_b16 v[254:255], v18 offset:17632
    v_cvt_pk_bf16_f32 v180, v20, v21
    v_exp_f32 v24, v140
    v_add_f32 v169, v169, v22
    v_exp_f32 v25, v141
    v_add_f32 v169, v169, v23
    v_cvt_pk_bf16_f32 v181, v22, v23
    v_exp_f32 v26, v142
    v_mfma_f32_16x16x32_bf16 v[144:147], v[216:219], v[108:111], v[144:147]
    v_add_f32 v169, v169, v24
    v_exp_f32 v27, v143
    v_add_f32 v169, v169, v25
    v_cvt_pk_bf16_f32 v182, v24, v25
    v_add_f32 v169, v169, v26
    v_add_f32 v169, v169, v27
    v_cvt_pk_bf16_f32 v183, v26, v27
    v_mfma_f32_16x16x32_bf16 v[152:155], v[216:219], v[124:127], v[152:155]
    v_max_f32 v30, v168, v169
    v_cmp_lt_f32 vcc, s49, v30
    v_mfma_f32_16x16x32_bf16 v[148:151], v[220:223], v[108:111], v[148:151]
    s_cbranch_vccnz LP_r20
LP_b20:
    v_mfma_f32_16x16x32_bf16 v[156:159], v[220:223], v[124:127], v[156:159]
    s_waitcnt lgkmcnt(0)
    v_mfma_f32_16x16x32_bf16 v[32:35], v[224:227], v[176:179], v[32:35]
    ds_read_b128 v[192:195], v4 offset:16896
    ds_read_b128 v[196:199], v4 offset:17408
    v_mfma_f32_16x16x32_bf16 v[64:67], v[224:227], v[180:183], v[64:67]
    ds_read_b128 v[200:203], v4 offset:16960
    ds_read_b128 v[204:207], v4 offset:17472
    v_mfma_f32_16x16x32_bf16 v[36:39], v[228:231], v[176:179], v[36:39]
    ds_read_b128 v[208:211], v4 offset:17024
    ds_read_b128 v[212:215], v4 offset:17536
    v_mfma_f32_16x16x32_bf16 v[68:71], v[228:231], v[180:183], v[68:71]
    ds_read_b128 v[216:219], v4 offset:17088
    ds_read_b128 v[220:223], v4 offset:17600
    v_mfma_f32_16x16x32_bf16 v[40:43], v[232:235], v[176:179], v[40:43]
    v_mfma_f32_16x16x32_bf16 v[72:75], v[232:235], v[180:183], v[72:75]
    v_mfma_f32_16x16x32_bf16 v[44:47], v[236:239], v[176:179], v[44:47]
    v_mfma_f32_16x16x32_bf16 v[76:79], v[236:239], v[180:183], v[76:79]
    v_mfma_f32_16x16x32_bf16 v[48:51], v[240:243], v[176:179], v[48:51]
    v_mfma_f32_16x16x32_bf16 v[80:83], v[240:243], v[180:183], v[80:83]
    v_mfma_f32_16x16x32_bf16 v[52:55], v[244:247], v[176:179], v[52:55]
    v_mfma_f32_16x16x32_bf16 v[84:87], v[244:247], v[180:183], v[84:87]
    v_mfma_f32_16x16x32_bf16 v[56:59], v[248:251], v[176:179], v[56:59]
    v_mfma_f32_16x16x32_bf16 v[88:91], v[248:251], v[180:183], v[88:91]
    v_mfma_f32_16x16x32_bf16 v[60:63], v[252:255], v[176:179], v[60:63]
    v_exp_f32 v20, v144
    v_exp_f32 v21, v145
    v_exp_f32 v22, v146
    v_add_f32 v170, v168, v20
    v_exp_f32 v23, v147
    v_add_f32 v170, v170, v21
    v_cvt_pk_bf16_f32 v184, v20, v21
    v_exp_f32 v24, v148
    v_add_f32 v170, v170, v22
    v_exp_f32 v25, v149
    v_mfma_f32_16x16x32_bf16 v[92:95], v[252:255], v[180:183], v[92:95]
    v_add_f32 v170, v170, v23
    v_cvt_pk_bf16_f32 v185, v22, v23
    v_exp_f32 v26, v150
    v_add_f32 v170, v170, v24
    v_exp_f32 v27, v151
    v_add_f32 v170, v170, v25
    v_cvt_pk_bf16_f32 v186, v24, v25
    v_exp_f32 v20, v152
    v_add_f32 v170, v170, v26
    s_waitcnt vmcnt(12) lgkmcnt(0)
    s_barrier
    v_mfma_f32_16x16x32_bf16 v[128:131], v[192:195], v[96:99], v[160:163]
    s_mov_b32 s46, 221184
    s_add_u32 m0, s52, 67584
    v_mfma_f32_16x16x32_bf16 v[136:139], v[192:195], v[112:115], v[164:167]
    buffer_load_dwordx4 v6, s[8:11], s46 offen offset:0 nt lds
    v_mfma_f32_16x16x32_bf16 v[132:135], v[196:199], v[96:99], v[160:163]
    s_add_u32 m0, s52, 68384
    v_mfma_f32_16x16x32_bf16 v[140:143], v[196:199], v[112:115], v[164:167]
    buffer_load_dwordx4 v6, s[8:11], s46 offen offset:256 nt lds
    v_mfma_f32_16x16x32_bf16 v[128:131], v[200:203], v[100:103], v[128:131]
    s_mov_b32 s46, 204800
    s_add_u32 m0, s52, 76032
    v_mfma_f32_16x16x32_bf16 v[136:139], v[200:203], v[116:119], v[136:139]
    buffer_load_dwordx4 v6, s[12:15], s46 offen offset:0 nt lds
    v_mfma_f32_16x16x32_bf16 v[132:135], v[204:207], v[100:103], v[132:135]
    s_add_u32 m0, s52, 76832
    v_mfma_f32_16x16x32_bf16 v[140:143], v[204:207], v[116:119], v[140:143]
    buffer_load_dwordx4 v6, s[12:15], s46 offen offset:256 nt lds
    v_mfma_f32_16x16x32_bf16 v[128:131], v[208:211], v[104:107], v[128:131]
    ds_read_b64_tr_b16 v[224:225], v17 offset:0
    ds_read_b64_tr_b16 v[226:227], v17 offset:512
    ds_read_b64_tr_b16 v[228:229], v17 offset:32
    ds_read_b64_tr_b16 v[230:231], v17 offset:544
    v_mfma_f32_16x16x32_bf16 v[136:139], v[208:211], v[120:123], v[136:139]
    ds_read_b64_tr_b16 v[232:233], v17 offset:64
    ds_read_b64_tr_b16 v[234:235], v17 offset:576
    ds_read_b64_tr_b16 v[236:237], v17 offset:96
    ds_read_b64_tr_b16 v[238:239], v17 offset:608
    v_mfma_f32_16x16x32_bf16 v[132:135], v[212:215], v[104:107], v[132:135]
    ds_read_b64_tr_b16 v[240:241], v17 offset:128
    ds_read_b64_tr_b16 v[242:243], v17 offset:640
    ds_read_b64_tr_b16 v[244:245], v17 offset:160
    ds_read_b64_tr_b16 v[246:247], v17 offset:672
    v_exp_f32 v21, v153
    v_add_f32 v170, v170, v27
    v_cvt_pk_bf16_f32 v187, v26, v27
    v_exp_f32 v22, v154
    v_add_f32 v171, v169, v20
    v_exp_f32 v23, v155
    v_add_f32 v171, v171, v21
    v_mfma_f32_16x16x32_bf16 v[140:143], v[212:215], v[120:123], v[140:143]
    ds_read_b64_tr_b16 v[248:249], v17 offset:192
    ds_read_b64_tr_b16 v[250:251], v17 offset:704
    ds_read_b64_tr_b16 v[252:253], v17 offset:224
    ds_read_b64_tr_b16 v[254:255], v17 offset:736
    v_cvt_pk_bf16_f32 v188, v20, v21
    v_exp_f32 v24, v156
    v_add_f32 v171, v171, v22
    v_exp_f32 v25, v157
    v_add_f32 v171, v171, v23
    v_cvt_pk_bf16_f32 v189, v22, v23
    v_exp_f32 v26, v158
    v_mfma_f32_16x16x32_bf16 v[128:131], v[216:219], v[108:111], v[128:131]
    v_add_f32 v171, v171, v24
    v_exp_f32 v27, v159
    v_add_f32 v171, v171, v25
    v_cvt_pk_bf16_f32 v190, v24, v25
    v_add_f32 v171, v171, v26
    v_add_f32 v171, v171, v27
    v_cvt_pk_bf16_f32 v191, v26, v27
    v_mfma_f32_16x16x32_bf16 v[136:139], v[216:219], v[124:127], v[136:139]
    v_max_f32 v30, v170, v171
    v_cmp_lt_f32 vcc, s49, v30
    v_mfma_f32_16x16x32_bf16 v[132:135], v[220:223], v[108:111], v[132:135]
    s_cbranch_vccnz LP_r21
LP_b21:
    v_mfma_f32_16x16x32_bf16 v[140:143], v[220:223], v[124:127], v[140:143]
    s_waitcnt lgkmcnt(0)
    v_mfma_f32_16x16x32_bf16 v[32:35], v[224:227], v[184:187], v[32:35]
    ds_read_b128 v[192:195], v3 offset:0
    ds_read_b128 v[196:199], v3 offset:512
    v_mfma_f32_16x16x32_bf16 v[64:67], v[224:227], v[188:191], v[64:67]
    ds_read_b128 v[200:203], v3 offset:64
    ds_read_b128 v[204:207], v3 offset:576
    v_mfma_f32_16x16x32_bf16 v[36:39], v[228:231], v[184:187], v[36:39]
    ds_read_b128 v[208:211], v3 offset:128
    ds_read_b128 v[212:215], v3 offset:640
    v_mfma_f32_16x16x32_bf16 v[68:71], v[228:231], v[188:191], v[68:71]
    ds_read_b128 v[216:219], v3 offset:192
    ds_read_b128 v[220:223], v3 offset:704
    v_mfma_f32_16x16x32_bf16 v[40:43], v[232:235], v[184:187], v[40:43]
    v_mfma_f32_16x16x32_bf16 v[72:75], v[232:235], v[188:191], v[72:75]
    v_mfma_f32_16x16x32_bf16 v[44:47], v[236:239], v[184:187], v[44:47]
    v_mfma_f32_16x16x32_bf16 v[76:79], v[236:239], v[188:191], v[76:79]
    v_mfma_f32_16x16x32_bf16 v[48:51], v[240:243], v[184:187], v[48:51]
    v_mfma_f32_16x16x32_bf16 v[80:83], v[240:243], v[188:191], v[80:83]
    v_mfma_f32_16x16x32_bf16 v[52:55], v[244:247], v[184:187], v[52:55]
    v_mfma_f32_16x16x32_bf16 v[84:87], v[244:247], v[188:191], v[84:87]
    v_mfma_f32_16x16x32_bf16 v[56:59], v[248:251], v[184:187], v[56:59]
    v_mfma_f32_16x16x32_bf16 v[88:91], v[248:251], v[188:191], v[88:91]
    v_mfma_f32_16x16x32_bf16 v[60:63], v[252:255], v[184:187], v[60:63]
    v_exp_f32 v20, v128
    v_exp_f32 v21, v129
    v_exp_f32 v22, v130
    v_add_f32 v168, v170, v20
    v_exp_f32 v23, v131
    v_add_f32 v168, v168, v21
    v_cvt_pk_bf16_f32 v176, v20, v21
    v_exp_f32 v24, v132
    v_add_f32 v168, v168, v22
    v_exp_f32 v25, v133
    v_mfma_f32_16x16x32_bf16 v[92:95], v[252:255], v[188:191], v[92:95]
    v_add_f32 v168, v168, v23
    v_cvt_pk_bf16_f32 v177, v22, v23
    v_exp_f32 v26, v134
    v_add_f32 v168, v168, v24
    v_exp_f32 v27, v135
    v_add_f32 v168, v168, v25
    v_cvt_pk_bf16_f32 v178, v24, v25
    v_exp_f32 v20, v136
    v_add_f32 v168, v168, v26
    s_waitcnt vmcnt(12) lgkmcnt(0)
    s_barrier
    v_mfma_f32_16x16x32_bf16 v[144:147], v[192:195], v[96:99], v[160:163]
    s_mov_b32 s46, 229376
    s_add_u32 m0, s52, 33792
    v_mfma_f32_16x16x32_bf16 v[152:155], v[192:195], v[112:115], v[164:167]
    buffer_load_dwordx4 v6, s[8:11], s46 offen offset:0 nt lds
    v_mfma_f32_16x16x32_bf16 v[148:151], v[196:199], v[96:99], v[160:163]
    s_add_u32 m0, s52, 34592
    v_mfma_f32_16x16x32_bf16 v[156:159], v[196:199], v[112:115], v[164:167]
    buffer_load_dwordx4 v6, s[8:11], s46 offen offset:256 nt lds
    v_mfma_f32_16x16x32_bf16 v[144:147], v[200:203], v[100:103], v[144:147]
    s_mov_b32 s46, 212992
    s_add_u32 m0, s52, 42240
    v_mfma_f32_16x16x32_bf16 v[152:155], v[200:203], v[116:119], v[152:155]
    buffer_load_dwordx4 v6, s[12:15], s46 offen offset:0 nt lds
    v_mfma_f32_16x16x32_bf16 v[148:151], v[204:207], v[100:103], v[148:151]
    s_add_u32 m0, s52, 43040
    v_mfma_f32_16x16x32_bf16 v[156:159], v[204:207], v[116:119], v[156:159]
    buffer_load_dwordx4 v6, s[12:15], s46 offen offset:256 nt lds
    v_mfma_f32_16x16x32_bf16 v[144:147], v[208:211], v[104:107], v[144:147]
    ds_read_b64_tr_b16 v[224:225], v16 offset:16896
    ds_read_b64_tr_b16 v[226:227], v16 offset:17408
    ds_read_b64_tr_b16 v[228:229], v16 offset:16928
    ds_read_b64_tr_b16 v[230:231], v16 offset:17440
    v_mfma_f32_16x16x32_bf16 v[152:155], v[208:211], v[120:123], v[152:155]
    ds_read_b64_tr_b16 v[232:233], v16 offset:16960
    ds_read_b64_tr_b16 v[234:235], v16 offset:17472
    ds_read_b64_tr_b16 v[236:237], v16 offset:16992
    ds_read_b64_tr_b16 v[238:239], v16 offset:17504
    v_mfma_f32_16x16x32_bf16 v[148:151], v[212:215], v[104:107], v[148:151]
    ds_read_b64_tr_b16 v[240:241], v16 offset:17024
    ds_read_b64_tr_b16 v[242:243], v16 offset:17536
    ds_read_b64_tr_b16 v[244:245], v16 offset:17056
    ds_read_b64_tr_b16 v[246:247], v16 offset:17568
    v_exp_f32 v21, v137
    v_add_f32 v168, v168, v27
    v_cvt_pk_bf16_f32 v179, v26, v27
    v_exp_f32 v22, v138
    v_add_f32 v169, v171, v20
    v_exp_f32 v23, v139
    v_add_f32 v169, v169, v21
    v_mfma_f32_16x16x32_bf16 v[156:159], v[212:215], v[120:123], v[156:159]
    ds_read_b64_tr_b16 v[248:249], v16 offset:17088
    ds_read_b64_tr_b16 v[250:251], v16 offset:17600
    ds_read_b64_tr_b16 v[252:253], v16 offset:17120
    ds_read_b64_tr_b16 v[254:255], v16 offset:17632
    v_cvt_pk_bf16_f32 v180, v20, v21
    v_exp_f32 v24, v140
    v_add_f32 v169, v169, v22
    v_exp_f32 v25, v141
    v_add_f32 v169, v169, v23
    v_cvt_pk_bf16_f32 v181, v22, v23
    v_exp_f32 v26, v142
    v_mfma_f32_16x16x32_bf16 v[144:147], v[216:219], v[108:111], v[144:147]
    v_add_f32 v169, v169, v24
    v_exp_f32 v27, v143
    v_add_f32 v169, v169, v25
    v_cvt_pk_bf16_f32 v182, v24, v25
    v_add_f32 v169, v169, v26
    v_add_f32 v169, v169, v27
    v_cvt_pk_bf16_f32 v183, v26, v27
    v_mfma_f32_16x16x32_bf16 v[152:155], v[216:219], v[124:127], v[152:155]
    v_max_f32 v30, v168, v169
    v_cmp_lt_f32 vcc, s49, v30
    v_mfma_f32_16x16x32_bf16 v[148:151], v[220:223], v[108:111], v[148:151]
    s_cbranch_vccnz LP_r22
LP_b22:
    v_mfma_f32_16x16x32_bf16 v[156:159], v[220:223], v[124:127], v[156:159]
    s_waitcnt lgkmcnt(0)
    v_mfma_f32_16x16x32_bf16 v[32:35], v[224:227], v[176:179], v[32:35]
    ds_read_b128 v[192:195], v2 offset:16896
    ds_read_b128 v[196:199], v2 offset:17408
    v_mfma_f32_16x16x32_bf16 v[64:67], v[224:227], v[180:183], v[64:67]
    ds_read_b128 v[200:203], v2 offset:16960
    ds_read_b128 v[204:207], v2 offset:17472
    v_mfma_f32_16x16x32_bf16 v[36:39], v[228:231], v[176:179], v[36:39]
    ds_read_b128 v[208:211], v2 offset:17024
    ds_read_b128 v[212:215], v2 offset:17536
    v_mfma_f32_16x16x32_bf16 v[68:71], v[228:231], v[180:183], v[68:71]
    ds_read_b128 v[216:219], v2 offset:17088
    ds_read_b128 v[220:223], v2 offset:17600
    v_mfma_f32_16x16x32_bf16 v[40:43], v[232:235], v[176:179], v[40:43]
    v_mfma_f32_16x16x32_bf16 v[72:75], v[232:235], v[180:183], v[72:75]
    v_mfma_f32_16x16x32_bf16 v[44:47], v[236:239], v[176:179], v[44:47]
    v_mfma_f32_16x16x32_bf16 v[76:79], v[236:239], v[180:183], v[76:79]
    v_mfma_f32_16x16x32_bf16 v[48:51], v[240:243], v[176:179], v[48:51]
    v_mfma_f32_16x16x32_bf16 v[80:83], v[240:243], v[180:183], v[80:83]
    v_mfma_f32_16x16x32_bf16 v[52:55], v[244:247], v[176:179], v[52:55]
    v_mfma_f32_16x16x32_bf16 v[84:87], v[244:247], v[180:183], v[84:87]
    v_mfma_f32_16x16x32_bf16 v[56:59], v[248:251], v[176:179], v[56:59]
    v_mfma_f32_16x16x32_bf16 v[88:91], v[248:251], v[180:183], v[88:91]
    v_mfma_f32_16x16x32_bf16 v[60:63], v[252:255], v[176:179], v[60:63]
    v_exp_f32 v20, v144
    v_exp_f32 v21, v145
    v_exp_f32 v22, v146
    v_add_f32 v170, v168, v20
    v_exp_f32 v23, v147
    v_add_f32 v170, v170, v21
    v_cvt_pk_bf16_f32 v184, v20, v21
    v_exp_f32 v24, v148
    v_add_f32 v170, v170, v22
    v_exp_f32 v25, v149
    v_mfma_f32_16x16x32_bf16 v[92:95], v[252:255], v[180:183], v[92:95]
    global_load_dword v9, v8, s[0:1]
    v_add_f32 v170, v170, v23
    v_cvt_pk_bf16_f32 v185, v22, v23
    v_exp_f32 v26, v150
    v_add_f32 v170, v170, v24
    v_exp_f32 v27, v151
    v_add_f32 v170, v170, v25
    v_cvt_pk_bf16_f32 v186, v24, v25
    v_exp_f32 v20, v152
    v_add_f32 v170, v170, v26
    s_waitcnt vmcnt(13) lgkmcnt(0)
    s_barrier
    v_mfma_f32_16x16x32_bf16 v[128:131], v[192:195], v[96:99], v[160:163]
    s_mov_b32 s46, 237568
    s_add_u32 m0, s52, 101376
    v_mfma_f32_16x16x32_bf16 v[136:139], v[192:195], v[112:115], v[164:167]
    buffer_load_dwordx4 v6, s[8:11], s46 offen offset:0 nt lds
    v_mfma_f32_16x16x32_bf16 v[132:135], v[196:199], v[96:99], v[160:163]
    s_add_u32 m0, s52, 102176
    v_mfma_f32_16x16x32_bf16 v[140:143], v[196:199], v[112:115], v[164:167]
    buffer_load_dwordx4 v6, s[8:11], s46 offen offset:256 nt lds
    v_mfma_f32_16x16x32_bf16 v[128:131], v[200:203], v[100:103], v[128:131]
    s_mov_b32 s46, 221184
    s_add_u32 m0, s52, 109824
    v_mfma_f32_16x16x32_bf16 v[136:139], v[200:203], v[116:119], v[136:139]
    buffer_load_dwordx4 v6, s[12:15], s46 offen offset:0 nt lds
    v_mfma_f32_16x16x32_bf16 v[132:135], v[204:207], v[100:103], v[132:135]
    s_add_u32 m0, s52, 110624
    v_mfma_f32_16x16x32_bf16 v[140:143], v[204:207], v[116:119], v[140:143]
    buffer_load_dwordx4 v6, s[12:15], s46 offen offset:256 nt lds
    v_mfma_f32_16x16x32_bf16 v[128:131], v[208:211], v[104:107], v[128:131]
    ds_read_b64_tr_b16 v[224:225], v18 offset:33792
    ds_read_b64_tr_b16 v[226:227], v18 offset:34304
    ds_read_b64_tr_b16 v[228:229], v18 offset:33824
    ds_read_b64_tr_b16 v[230:231], v18 offset:34336
    v_mfma_f32_16x16x32_bf16 v[136:139], v[208:211], v[120:123], v[136:139]
    ds_read_b64_tr_b16 v[232:233], v18 offset:33856
    ds_read_b64_tr_b16 v[234:235], v18 offset:34368
    ds_read_b64_tr_b16 v[236:237], v18 offset:33888
    ds_read_b64_tr_b16 v[238:239], v18 offset:34400
    v_mfma_f32_16x16x32_bf16 v[132:135], v[212:215], v[104:107], v[132:135]
    ds_read_b64_tr_b16 v[240:241], v18 offset:33920
    ds_read_b64_tr_b16 v[242:243], v18 offset:34432
    ds_read_b64_tr_b16 v[244:245], v18 offset:33952
    ds_read_b64_tr_b16 v[246:247], v18 offset:34464
    v_exp_f32 v21, v153
    v_add_f32 v170, v170, v27
    v_cvt_pk_bf16_f32 v187, v26, v27
    v_exp_f32 v22, v154
    v_add_f32 v171, v169, v20
    v_exp_f32 v23, v155
    v_add_f32 v171, v171, v21
    v_mfma_f32_16x16x32_bf16 v[140:143], v[212:215], v[120:123], v[140:143]
    ds_read_b64_tr_b16 v[248:249], v18 offset:33984
    ds_read_b64_tr_b16 v[250:251], v18 offset:34496
    ds_read_b64_tr_b16 v[252:253], v18 offset:34016
    ds_read_b64_tr_b16 v[254:255], v18 offset:34528
    v_cvt_pk_bf16_f32 v188, v20, v21
    v_exp_f32 v24, v156
    v_add_f32 v171, v171, v22
    v_exp_f32 v25, v157
    v_add_f32 v171, v171, v23
    v_cvt_pk_bf16_f32 v189, v22, v23
    v_exp_f32 v26, v158
    v_mfma_f32_16x16x32_bf16 v[128:131], v[216:219], v[108:111], v[128:131]
    v_add_f32 v171, v171, v24
    v_exp_f32 v27, v159
    v_add_f32 v171, v171, v25
    v_cvt_pk_bf16_f32 v190, v24, v25
    v_add_f32 v171, v171, v26
    v_add_f32 v171, v171, v27
    v_cvt_pk_bf16_f32 v191, v26, v27
    v_mfma_f32_16x16x32_bf16 v[136:139], v[216:219], v[124:127], v[136:139]
    v_max_f32 v30, v170, v171
    v_cmp_lt_f32 vcc, s49, v30
    v_mfma_f32_16x16x32_bf16 v[132:135], v[220:223], v[108:111], v[132:135]
    s_cbranch_vccnz LP_r23
LP_b23:
    v_mfma_f32_16x16x32_bf16 v[140:143], v[220:223], v[124:127], v[140:143]
    s_waitcnt lgkmcnt(0)
    v_mfma_f32_16x16x32_bf16 v[32:35], v[224:227], v[184:187], v[32:35]
    ds_read_b128 v[192:195], v4 offset:33792
    ds_read_b128 v[196:199], v4 offset:34304
    v_mfma_f32_16x16x32_bf16 v[64:67], v[224:227], v[188:191], v[64:67]
    ds_read_b128 v[200:203], v4 offset:33856
    ds_read_b128 v[204:207], v4 offset:34368
    v_mfma_f32_16x16x32_bf16 v[36:39], v[228:231], v[184:187], v[36:39]
    ds_read_b128 v[208:211], v4 offset:33920
    ds_read_b128 v[212:215], v4 offset:34432
    v_mfma_f32_16x16x32_bf16 v[68:71], v[228:231], v[188:191], v[68:71]
    ds_read_b128 v[216:219], v4 offset:33984
    ds_read_b128 v[220:223], v4 offset:34496
    v_mfma_f32_16x16x32_bf16 v[40:43], v[232:235], v[184:187], v[40:43]
    v_mfma_f32_16x16x32_bf16 v[72:75], v[232:235], v[188:191], v[72:75]
    v_mfma_f32_16x16x32_bf16 v[44:47], v[236:239], v[184:187], v[44:47]
    v_mfma_f32_16x16x32_bf16 v[76:79], v[236:239], v[188:191], v[76:79]
    v_mfma_f32_16x16x32_bf16 v[48:51], v[240:243], v[184:187], v[48:51]
    v_mfma_f32_16x16x32_bf16 v[80:83], v[240:243], v[188:191], v[80:83]
    v_mfma_f32_16x16x32_bf16 v[52:55], v[244:247], v[184:187], v[52:55]
    v_mfma_f32_16x16x32_bf16 v[84:87], v[244:247], v[188:191], v[84:87]
    v_mfma_f32_16x16x32_bf16 v[56:59], v[248:251], v[184:187], v[56:59]
    v_mfma_f32_16x16x32_bf16 v[88:91], v[248:251], v[188:191], v[88:91]
    v_mfma_f32_16x16x32_bf16 v[60:63], v[252:255], v[184:187], v[60:63]
    v_exp_f32 v20, v128
    v_exp_f32 v21, v129
    v_exp_f32 v22, v130
    v_add_f32 v168, v170, v20
    v_exp_f32 v23, v131
    v_add_f32 v168, v168, v21
    v_cvt_pk_bf16_f32 v176, v20, v21
    v_exp_f32 v24, v132
    v_add_f32 v168, v168, v22
    v_exp_f32 v25, v133
    v_mfma_f32_16x16x32_bf16 v[92:95], v[252:255], v[188:191], v[92:95]
    v_add_f32 v168, v168, v23
    v_cvt_pk_bf16_f32 v177, v22, v23
    v_exp_f32 v26, v134
    v_add_f32 v168, v168, v24
    v_exp_f32 v27, v135
    v_add_f32 v168, v168, v25
    v_cvt_pk_bf16_f32 v178, v24, v25
    v_exp_f32 v20, v136
    v_add_f32 v168, v168, v26
    s_waitcnt vmcnt(13) lgkmcnt(0)
    s_barrier
    v_mfma_f32_16x16x32_bf16 v[144:147], v[192:195], v[96:99], v[160:163]
    s_mov_b32 s46, 245760
    s_add_u32 m0, s52, 0
    ds_read_b64_tr_b16 v[224:225], v17 offset:33792
    ds_read_b64_tr_b16 v[226:227], v17 offset:34304
    v_exp_f32 v21, v137
    v_add_f32 v168, v168, v27
    v_mfma_f32_16x16x32_bf16 v[152:155], v[192:195], v[112:115], v[164:167]
    buffer_load_dwordx4 v6, s[8:11], s46 offen offset:0 nt lds
    ds_read_b64_tr_b16 v[228:229], v17 offset:33824
    v_cvt_pk_bf16_f32 v179, v26, v27
    v_exp_f32 v22, v138
    v_mfma_f32_16x16x32_bf16 v[148:151], v[196:199], v[96:99], v[160:163]
    s_add_u32 m0, s52, 800
    ds_read_b64_tr_b16 v[230:231], v17 offset:34336
    v_add_f32 v169, v171, v20
    v_mfma_f32_16x16x32_bf16 v[156:159], v[196:199], v[112:115], v[164:167]
    buffer_load_dwordx4 v6, s[8:11], s46 offen offset:256 nt lds
    ds_read_b64_tr_b16 v[232:233], v17 offset:33856
    ds_read_b64_tr_b16 v[234:235], v17 offset:34368
    v_exp_f32 v23, v139
    v_add_f32 v169, v169, v21
    v_mfma_f32_16x16x32_bf16 v[144:147], v[200:203], v[100:103], v[144:147]
    s_mov_b32 s46, 229376
    s_add_u32 m0, s52, 8448
    ds_read_b64_tr_b16 v[236:237], v17 offset:33888
    v_cvt_pk_bf16_f32 v180, v20, v21
    v_exp_f32 v24, v140
    v_mfma_f32_16x16x32_bf16 v[152:155], v[200:203], v[116:119], v[152:155]
    buffer_load_dwordx4 v6, s[12:15], s46 offen offset:0 nt lds
    ds_read_b64_tr_b16 v[238:239], v17 offset:34400
    v_add_f32 v169, v169, v22
    v_mfma_f32_16x16x32_bf16 v[148:151], v[204:207], v[100:103], v[148:151]
    s_add_u32 m0, s52, 9248
    ds_read_b64_tr_b16 v[240:241], v17 offset:33920
    ds_read_b64_tr_b16 v[242:243], v17 offset:34432
    v_exp_f32 v25, v141
    v_add_f32 v169, v169, v23
    v_mfma_f32_16x16x32_bf16 v[156:159], v[204:207], v[116:119], v[156:159]
    buffer_load_dwordx4 v6, s[12:15], s46 offen offset:256 nt lds
    ds_read_b64_tr_b16 v[244:245], v17 offset:33952
    v_cvt_pk_bf16_f32 v181, v22, v23
    v_mfma_f32_16x16x32_bf16 v[144:147], v[208:211], v[104:107], v[144:147]
    ds_read_b64_tr_b16 v[246:247], v17 offset:34464
    v_exp_f32 v26, v142
    v_add_f32 v169, v169, v24
    v_mfma_f32_16x16x32_bf16 v[152:155], v[208:211], v[120:123], v[152:155]
    ds_read_b64_tr_b16 v[248:249], v17 offset:33984
    ds_read_b64_tr_b16 v[250:251], v17 offset:34496
    v_exp_f32 v27, v143
    v_add_f32 v169, v169, v25
    v_mfma_f32_16x16x32_bf16 v[148:151], v[212:215], v[104:107], v[148:151]
    ds_read_b64_tr_b16 v[252:253], v17 offset:34016
    v_cvt_pk_bf16_f32 v182, v24, v25
    v_mfma_f32_16x16x32_bf16 v[156:159], v[212:215], v[120:123], v[156:159]
    ds_read_b64_tr_b16 v[254:255], v17 offset:34528
    v_add_f32 v169, v169, v26
    v_add_f32 v169, v169, v27
    v_mfma_f32_16x16x32_bf16 v[144:147], v[216:219], v[108:111], v[144:147]
    v_cvt_pk_bf16_f32 v183, v26, v27
    v_mfma_f32_16x16x32_bf16 v[152:155], v[216:219], v[124:127], v[152:155]
    v_max_f32 v30, v168, v169
    v_cmp_lt_f32 vcc, s49, v30
    v_mfma_f32_16x16x32_bf16 v[148:151], v[220:223], v[108:111], v[148:151]
    s_cbranch_vccnz LP_r24
LP_b24:
    v_mfma_f32_16x16x32_bf16 v[156:159], v[220:223], v[124:127], v[156:159]
    s_waitcnt lgkmcnt(0)
    v_mfma_f32_16x16x32_bf16 v[32:35], v[224:227], v[176:179], v[32:35]
    ds_read_b128 v[192:195], v3 offset:33792
    ds_read_b128 v[196:199], v3 offset:34304
    v_mfma_f32_16x16x32_bf16 v[64:67], v[224:227], v[180:183], v[64:67]
    ds_read_b128 v[200:203], v3 offset:33856
    ds_read_b128 v[204:207], v3 offset:34368
    v_mfma_f32_16x16x32_bf16 v[36:39], v[228:231], v[176:179], v[36:39]
    ds_read_b128 v[208:211], v3 offset:33920
    ds_read_b128 v[212:215], v3 offset:34432
    v_mfma_f32_16x16x32_bf16 v[68:71], v[228:231], v[180:183], v[68:71]
    ds_read_b128 v[216:219], v3 offset:33984
    ds_read_b128 v[220:223], v3 offset:34496
    v_exp_f32 v20, v144
    v_exp_f32 v21, v145
    v_mfma_f32_16x16x32_bf16 v[40:43], v[232:235], v[176:179], v[40:43]
    v_exp_f32 v22, v146
    v_mfma_f32_16x16x32_bf16 v[72:75], v[232:235], v[180:183], v[72:75]
    v_add_f32 v170, v168, v20
    v_exp_f32 v23, v147
    v_mfma_f32_16x16x32_bf16 v[44:47], v[236:239], v[176:179], v[44:47]
    v_add_f32 v170, v170, v21
    v_mfma_f32_16x16x32_bf16 v[76:79], v[236:239], v[180:183], v[76:79]
    v_cvt_pk_bf16_f32 v184, v20, v21
    v_exp_f32 v24, v148
    v_mfma_f32_16x16x32_bf16 v[48:51], v[240:243], v[176:179], v[48:51]
    v_add_f32 v170, v170, v22
    v_mfma_f32_16x16x32_bf16 v[80:83], v[240:243], v[180:183], v[80:83]
    v_exp_f32 v25, v149
    v_add_f32 v170, v170, v23
    v_mfma_f32_16x16x32_bf16 v[52:55], v[244:247], v[176:179], v[52:55]
    v_cvt_pk_bf16_f32 v185, v22, v23
    v_mfma_f32_16x16x32_bf16 v[84:87], v[244:247], v[180:183], v[84:87]
    v_exp_f32 v26, v150
    v_add_f32 v170, v170, v24
    v_mfma_f32_16x16x32_bf16 v[56:59], v[248:251], v[176:179], v[56:59]
    v_exp_f32 v27, v151
    v_mfma_f32_16x16x32_bf16 v[88:91], v[248:251], v[180:183], v[88:91]
    v_add_f32 v170, v170, v25
    v_cvt_pk_bf16_f32 v186, v24, v25
    v_mfma_f32_16x16x32_bf16 v[60:63], v[252:255], v[176:179], v[60:63]
    v_exp_f32 v20, v152
    v_mfma_f32_16x16x32_bf16 v[92:95], v[252:255], v[180:183], v[92:95]
    v_add_f32 v170, v170, v26
    s_waitcnt vmcnt(13) lgkmcnt(0)
    s_barrier
    v_mfma_f32_16x16x32_bf16 v[128:131], v[192:195], v[96:99], v[160:163]
    s_mov_b32 s46, 237568
    s_add_u32 m0, s52, 126720
    ds_read_b64_tr_b16 v[224:225], v17 offset:16896
    ds_read_b64_tr_b16 v[226:227], v17 offset:17408
    v_exp_f32 v21, v153
    v_add_f32 v170, v170, v27
    v_mfma_f32_16x16x32_bf16 v[136:139], v[192:195], v[112:115], v[164:167]
    buffer_load_dwordx4 v6, s[12:15], s46 offen offset:0 nt lds
    ds_read_b64_tr_b16 v[228:229], v17 offset:16928
    v_cvt_pk_bf16_f32 v187, v26, v27
    v_exp_f32 v22, v154
    v_mfma_f32_16x16x32_bf16 v[132:135], v[196:199], v[96:99], v[160:163]
    s_add_u32 m0, s52, 127520
    ds_read_b64_tr_b16 v[230:231], v17 offset:17440
    v_add_f32 v171, v169, v20
    v_mfma_f32_16x16x32_bf16 v[140:143], v[196:199], v[112:115], v[164:167]
    buffer_load_dwordx4 v6, s[12:15], s46 offen offset:256 nt lds
    ds_read_b64_tr_b16 v[232:233], v17 offset:16960
    ds_read_b64_tr_b16 v[234:235], v17 offset:17472
    v_exp_f32 v23, v155
    v_add_f32 v171, v171, v21
    v_mfma_f32_16x16x32_bf16 v[128:131], v[200:203], v[100:103], v[128:131]
    ds_read_b64_tr_b16 v[236:237], v17 offset:16992
    v_cvt_pk_bf16_f32 v188, v20, v21
    v_exp_f32 v24, v156
    v_mfma_f32_16x16x32_bf16 v[136:139], v[200:203], v[116:119], v[136:139]
    ds_read_b64_tr_b16 v[238:239], v17 offset:17504
    v_add_f32 v171, v171, v22
    v_mfma_f32_16x16x32_bf16 v[132:135], v[204:207], v[100:103], v[132:135]
    ds_read_b64_tr_b16 v[240:241], v17 offset:17024
    ds_read_b64_tr_b16 v[242:243], v17 offset:17536
    v_exp_f32 v25, v157
    v_add_f32 v171, v171, v23
    v_mfma_f32_16x16x32_bf16 v[140:143], v[204:207], v[116:119], v[140:143]
    ds_read_b64_tr_b16 v[244:245], v17 offset:17056
    v_cvt_pk_bf16_f32 v189, v22, v23
    v_mfma_f32_16x16x32_bf16 v[128:131], v[208:211], v[104:107], v[128:131]
    ds_read_b64_tr_b16 v[246:247], v17 offset:17568
    v_exp_f32 v26, v158
    v_add_f32 v171, v171, v24
    v_mfma_f32_16x16x32_bf16 v[136:139], v[208:211], v[120:123], v[136:139]
    ds_read_b64_tr_b16 v[248:249], v17 offset:17088
    ds_read_b64_tr_b16 v[250:251], v17 offset:17600
    v_exp_f32 v27, v159
    v_add_f32 v171, v171, v25
    v_mfma_f32_16x16x32_bf16 v[132:135], v[212:215], v[104:107], v[132:135]
    ds_read_b64_tr_b16 v[252:253], v17 offset:17120
    v_cvt_pk_bf16_f32 v190, v24, v25
    v_mfma_f32_16x16x32_bf16 v[140:143], v[212:215], v[120:123], v[140:143]
    ds_read_b64_tr_b16 v[254:255], v17 offset:17632
    v_add_f32 v171, v171, v26
    v_add_f32 v171, v171, v27
    v_mfma_f32_16x16x32_bf16 v[128:131], v[216:219], v[108:111], v[128:131]
    v_cvt_pk_bf16_f32 v191, v26, v27
    v_mfma_f32_16x16x32_bf16 v[136:139], v[216:219], v[124:127], v[136:139]
    v_max_f32 v30, v170, v171
    v_cmp_lt_f32 vcc, s49, v30
    v_mfma_f32_16x16x32_bf16 v[132:135], v[220:223], v[108:111], v[132:135]
    s_cbranch_vccnz LP_r25
LP_b25:
    v_mfma_f32_16x16x32_bf16 v[140:143], v[220:223], v[124:127], v[140:143]
    s_waitcnt lgkmcnt(0)
    v_mfma_f32_16x16x32_bf16 v[32:35], v[224:227], v[184:187], v[32:35]
    ds_read_b128 v[192:195], v3 offset:16896
    ds_read_b128 v[196:199], v3 offset:17408
    v_mfma_f32_16x16x32_bf16 v[64:67], v[224:227], v[188:191], v[64:67]
    ds_read_b128 v[200:203], v3 offset:16960
    ds_read_b128 v[204:207], v3 offset:17472
    v_mfma_f32_16x16x32_bf16 v[36:39], v[228:231], v[184:187], v[36:39]
    ds_read_b128 v[208:211], v3 offset:17024
    ds_read_b128 v[212:215], v3 offset:17536
    v_mfma_f32_16x16x32_bf16 v[68:71], v[228:231], v[188:191], v[68:71]
    ds_read_b128 v[216:219], v3 offset:17088
    ds_read_b128 v[220:223], v3 offset:17600
    v_exp_f32 v20, v128
    v_exp_f32 v21, v129
    v_mfma_f32_16x16x32_bf16 v[40:43], v[232:235], v[184:187], v[40:43]
    v_exp_f32 v22, v130
    v_mfma_f32_16x16x32_bf16 v[72:75], v[232:235], v[188:191], v[72:75]
    v_add_f32 v168, v170, v20
    v_exp_f32 v23, v131
    v_mfma_f32_16x16x32_bf16 v[44:47], v[236:239], v[184:187], v[44:47]
    v_add_f32 v168, v168, v21
    v_mfma_f32_16x16x32_bf16 v[76:79], v[236:239], v[188:191], v[76:79]
    v_cvt_pk_bf16_f32 v176, v20, v21
    v_exp_f32 v24, v132
    v_mfma_f32_16x16x32_bf16 v[48:51], v[240:243], v[184:187], v[48:51]
    v_add_f32 v168, v168, v22
    v_mfma_f32_16x16x32_bf16 v[80:83], v[240:243], v[188:191], v[80:83]
    v_exp_f32 v25, v133
    v_add_f32 v168, v168, v23
    v_mfma_f32_16x16x32_bf16 v[52:55], v[244:247], v[184:187], v[52:55]
    v_cvt_pk_bf16_f32 v177, v22, v23
    v_mfma_f32_16x16x32_bf16 v[84:87], v[244:247], v[188:191], v[84:87]
    v_exp_f32 v26, v134
    v_add_f32 v168, v168, v24
    v_mfma_f32_16x16x32_bf16 v[56:59], v[248:251], v[184:187], v[56:59]
    v_exp_f32 v27, v135
    v_mfma_f32_16x16x32_bf16 v[88:91], v[248:251], v[188:191], v[88:91]
    v_add_f32 v168, v168, v25
    v_cvt_pk_bf16_f32 v178, v24, v25
    v_mfma_f32_16x16x32_bf16 v[60:63], v[252:255], v[184:187], v[60:63]
    v_exp_f32 v20, v136
    v_mfma_f32_16x16x32_bf16 v[92:95], v[252:255], v[188:191], v[92:95]
    v_add_f32 v168, v168, v26
    s_waitcnt vmcnt(11) lgkmcnt(0)
    s_barrier
    v_mfma_f32_16x16x32_bf16 v[144:147], v[192:195], v[96:99], v[160:163]
    s_mov_b32 s46, 245760
    s_add_u32 m0, s52, 59136
    ds_read_b64_tr_b16 v[224:225], v16 offset:33792
    ds_read_b64_tr_b16 v[226:227], v16 offset:34304
    v_exp_f32 v21, v137
    v_add_f32 v168, v168, v27
    v_mfma_f32_16x16x32_bf16 v[152:155], v[192:195], v[112:115], v[164:167]
    buffer_load_dwordx4 v6, s[12:15], s46 offen offset:0 nt lds
    ds_read_b64_tr_b16 v[228:229], v16 offset:33824
    v_cvt_pk_bf16_f32 v179, v26, v27
    v_exp_f32 v22, v138
    v_mfma_f32_16x16x32_bf16 v[148:151], v[196:199], v[96:99], v[160:163]
    s_add_u32 m0, s52, 59936
    ds_read_b64_tr_b16 v[230:231], v16 offset:34336
    v_add_f32 v169, v171, v20
    v_mfma_f32_16x16x32_bf16 v[156:159], v[196:199], v[112:115], v[164:167]
    buffer_load_dwordx4 v6, s[12:15], s46 offen offset:256 nt lds
    ds_read_b64_tr_b16 v[232:233], v16 offset:33856
    ds_read_b64_tr_b16 v[234:235], v16 offset:34368
    v_exp_f32 v23, v139
    v_add_f32 v169, v169, v21
    v_mfma_f32_16x16x32_bf16 v[144:147], v[200:203], v[100:103], v[144:147]
    ds_read_b64_tr_b16 v[236:237], v16 offset:33888
    v_cvt_pk_bf16_f32 v180, v20, v21
    v_exp_f32 v24, v140
    v_mfma_f32_16x16x32_bf16 v[152:155], v[200:203], v[116:119], v[152:155]
    ds_read_b64_tr_b16 v[238:239], v16 offset:34400
    v_add_f32 v169, v169, v22
    v_mfma_f32_16x16x32_bf16 v[148:151], v[204:207], v[100:103], v[148:151]
    ds_read_b64_tr_b16 v[240:241], v16 offset:33920
    ds_read_b64_tr_b16 v[242:243], v16 offset:34432
    v_exp_f32 v25, v141
    v_add_f32 v169, v169, v23
    v_mfma_f32_16x16x32_bf16 v[156:159], v[204:207], v[116:119], v[156:159]
    ds_read_b64_tr_b16 v[244:245], v16 offset:33952
    v_cvt_pk_bf16_f32 v181, v22, v23
    v_mfma_f32_16x16x32_bf16 v[144:147], v[208:211], v[104:107], v[144:147]
    ds_read_b64_tr_b16 v[246:247], v16 offset:34464
    v_exp_f32 v26, v142
    v_add_f32 v169, v169, v24
    v_mfma_f32_16x16x32_bf16 v[152:155], v[208:211], v[120:123], v[152:155]
    ds_read_b64_tr_b16 v[248:249], v16 offset:33984
    ds_read_b64_tr_b16 v[250:251], v16 offset:34496
    v_exp_f32 v27, v143
    v_add_f32 v169, v169, v25
    v_mfma_f32_16x16x32_bf16 v[148:151], v[212:215], v[104:107], v[148:151]
    ds_read_b64_tr_b16 v[252:253], v16 offset:34016
    v_cvt_pk_bf16_f32 v182, v24, v25
    v_mfma_f32_16x16x32_bf16 v[156:159], v[212:215], v[120:123], v[156:159]
    ds_read_b64_tr_b16 v[254:255], v16 offset:34528
    v_add_f32 v169, v169, v26
    v_add_f32 v169, v169, v27
    v_mfma_f32_16x16x32_bf16 v[144:147], v[216:219], v[108:111], v[144:147]
    v_cvt_pk_bf16_f32 v183, v26, v27
    v_mfma_f32_16x16x32_bf16 v[152:155], v[216:219], v[124:127], v[152:155]
    v_max_f32 v30, v168, v169
    v_cmp_lt_f32 vcc, s49, v30
    v_mfma_f32_16x16x32_bf16 v[148:151], v[220:223], v[108:111], v[148:151]
    s_cbranch_vccnz LP_r26
LP_b26:
    v_mfma_f32_16x16x32_bf16 v[156:159], v[220:223], v[124:127], v[156:159]
    s_waitcnt lgkmcnt(0)
    v_mfma_f32_16x16x32_bf16 v[32:35], v[224:227], v[176:179], v[32:35]
    ds_read_b128 v[192:195], v2 offset:33792
    ds_read_b128 v[196:199], v2 offset:34304
    v_mfma_f32_16x16x32_bf16 v[64:67], v[224:227], v[180:183], v[64:67]
    ds_read_b128 v[200:203], v2 offset:33856
    ds_read_b128 v[204:207], v2 offset:34368
    v_mfma_f32_16x16x32_bf16 v[36:39], v[228:231], v[176:179], v[36:39]
    ds_read_b128 v[208:211], v2 offset:33920
    ds_read_b128 v[212:215], v2 offset:34432
    v_mfma_f32_16x16x32_bf16 v[68:71], v[228:231], v[180:183], v[68:71]
    ds_read_b128 v[216:219], v2 offset:33984
    ds_read_b128 v[220:223], v2 offset:34496
    v_exp_f32 v20, v144
    v_exp_f32 v21, v145
    v_mfma_f32_16x16x32_bf16 v[40:43], v[232:235], v[176:179], v[40:43]
    v_exp_f32 v22, v146
    v_mfma_f32_16x16x32_bf16 v[72:75], v[232:235], v[180:183], v[72:75]
    v_add_f32 v170, v168, v20
    v_exp_f32 v23, v147
    v_mfma_f32_16x16x32_bf16 v[44:47], v[236:239], v[176:179], v[44:47]
    v_add_f32 v170, v170, v21
    v_mfma_f32_16x16x32_bf16 v[76:79], v[236:239], v[180:183], v[76:79]
    v_cvt_pk_bf16_f32 v184, v20, v21
    v_exp_f32 v24, v148
    v_mfma_f32_16x16x32_bf16 v[48:51], v[240:243], v[176:179], v[48:51]
    v_add_f32 v170, v170, v22
    v_mfma_f32_16x16x32_bf16 v[80:83], v[240:243], v[180:183], v[80:83]
    v_exp_f32 v25, v149
    v_add_f32 v170, v170, v23
    v_mfma_f32_16x16x32_bf16 v[52:55], v[244:247], v[176:179], v[52:55]
    s_cmp_lg_u32 s39, 0
    s_cselect_b32 s62, 0, 33554432
    v_cvt_pk_bf16_f32 v185, v22, v23
    v_mfma_f32_16x16x32_bf16 v[84:87], v[244:247], v[180:183], v[84:87]
    s_add_u32 s63, s62, s51
    s_add_u32 s62, s62, s47
    v_lshlrev_b32 v31, 7, v1
    v_exp_f32 v26, v150
    v_add_f32 v170, v170, v24
    v_mfma_f32_16x16x32_bf16 v[56:59], v[248:251], v[176:179], v[56:59]
    buffer_load_dword v9, v31, s[28:31], s62 offen sc1
    v_exp_f32 v27, v151
    v_mfma_f32_16x16x32_bf16 v[88:91], v[248:251], v[180:183], v[88:91]
    v_and_b32 v31, 0x380, v31
    v_add_f32 v170, v170, v25
    v_cvt_pk_bf16_f32 v186, v24, v25
    v_mfma_f32_16x16x32_bf16 v[60:63], v[252:255], v[176:179], v[60:63]
    buffer_load_dword v9, v31, s[28:31], s63 offen sc1
    v_exp_f32 v20, v152
    v_mfma_f32_16x16x32_bf16 v[92:95], v[252:255], v[180:183], v[92:95]
    buffer_load_dword v9, off, s[28:31], s42 sc1
    v_add_f32 v170, v170, v26
    s_waitcnt vmcnt(11) lgkmcnt(0)
    s_barrier
    v_mfma_f32_16x16x32_bf16 v[128:131], v[192:195], v[96:99], v[160:163]
    ds_read_b64_tr_b16 v[224:225], v18 offset:0
    ds_read_b64_tr_b16 v[226:227], v18 offset:512
    v_exp_f32 v21, v153
    v_add_f32 v170, v170, v27
    v_mfma_f32_16x16x32_bf16 v[136:139], v[192:195], v[112:115], v[164:167]
    ds_read_b64_tr_b16 v[228:229], v18 offset:32
    v_cvt_pk_bf16_f32 v187, v26, v27
    v_exp_f32 v22, v154
    v_mfma_f32_16x16x32_bf16 v[132:135], v[196:199], v[96:99], v[160:163]
    ds_read_b64_tr_b16 v[230:231], v18 offset:544
    v_add_f32 v171, v169, v20
    v_mfma_f32_16x16x32_bf16 v[140:143], v[196:199], v[112:115], v[164:167]
    ds_read_b64_tr_b16 v[232:233], v18 offset:64
    ds_read_b64_tr_b16 v[234:235], v18 offset:576
    v_exp_f32 v23, v155
    v_add_f32 v171, v171, v21
    v_mfma_f32_16x16x32_bf16 v[128:131], v[200:203], v[100:103], v[128:131]
    ds_read_b64_tr_b16 v[236:237], v18 offset:96
    v_cvt_pk_bf16_f32 v188, v20, v21
    v_exp_f32 v24, v156
    v_mfma_f32_16x16x32_bf16 v[136:139], v[200:203], v[116:119], v[136:139]
    ds_read_b64_tr_b16 v[238:239], v18 offset:608
    v_add_f32 v171, v171, v22
    v_mfma_f32_16x16x32_bf16 v[132:135], v[204:207], v[100:103], v[132:135]
    ds_read_b64_tr_b16 v[240:241], v18 offset:128
    ds_read_b64_tr_b16 v[242:243], v18 offset:640
    v_exp_f32 v25, v157
    v_add_f32 v171, v171, v23
    v_mfma_f32_16x16x32_bf16 v[140:143], v[204:207], v[116:119], v[140:143]
    ds_read_b64_tr_b16 v[244:245], v18 offset:160
    v_cvt_pk_bf16_f32 v189, v22, v23
    v_mfma_f32_16x16x32_bf16 v[128:131], v[208:211], v[104:107], v[128:131]
    ds_read_b64_tr_b16 v[246:247], v18 offset:672
    v_exp_f32 v26, v158
    v_add_f32 v171, v171, v24
    v_mfma_f32_16x16x32_bf16 v[136:139], v[208:211], v[120:123], v[136:139]
    ds_read_b64_tr_b16 v[248:249], v18 offset:192
    ds_read_b64_tr_b16 v[250:251], v18 offset:704
    v_exp_f32 v27, v159
    v_add_f32 v171, v171, v25
    v_mfma_f32_16x16x32_bf16 v[132:135], v[212:215], v[104:107], v[132:135]
    ds_read_b64_tr_b16 v[252:253], v18 offset:224
    v_cvt_pk_bf16_f32 v190, v24, v25
    v_mfma_f32_16x16x32_bf16 v[140:143], v[212:215], v[120:123], v[140:143]
    ds_read_b64_tr_b16 v[254:255], v18 offset:736
    v_add_f32 v171, v171, v26
    v_add_f32 v171, v171, v27
    v_mfma_f32_16x16x32_bf16 v[128:131], v[216:219], v[108:111], v[128:131]
    v_cvt_pk_bf16_f32 v191, v26, v27
    v_mfma_f32_16x16x32_bf16 v[136:139], v[216:219], v[124:127], v[136:139]
    v_max_f32 v30, v170, v171
    v_cmp_lt_f32 vcc, s49, v30
    v_mfma_f32_16x16x32_bf16 v[132:135], v[220:223], v[108:111], v[132:135]
    s_cbranch_vccnz LP_r27
LP_b27:
    v_mfma_f32_16x16x32_bf16 v[140:143], v[220:223], v[124:127], v[140:143]
    s_waitcnt lgkmcnt(0)
    v_mfma_f32_16x16x32_bf16 v[32:35], v[224:227], v[184:187], v[32:35]
    ds_read_b128 v[192:195], v4 offset:0
    ds_read_b128 v[196:199], v4 offset:512
    v_mfma_f32_16x16x32_bf16 v[64:67], v[224:227], v[188:191], v[64:67]
    ds_read_b128 v[200:203], v4 offset:64
    ds_read_b128 v[204:207], v4 offset:576
    v_mfma_f32_16x16x32_bf16 v[36:39], v[228:231], v[184:187], v[36:39]
    ds_read_b128 v[208:211], v4 offset:128
    ds_read_b128 v[212:215], v4 offset:640
    v_mfma_f32_16x16x32_bf16 v[68:71], v[228:231], v[188:191], v[68:71]
    ds_read_b128 v[216:219], v4 offset:192
    ds_read_b128 v[220:223], v4 offset:704
    v_exp_f32 v20, v128
    v_exp_f32 v21, v129
    v_mfma_f32_16x16x32_bf16 v[40:43], v[232:235], v[184:187], v[40:43]
    v_exp_f32 v22, v130
    v_mfma_f32_16x16x32_bf16 v[72:75], v[232:235], v[188:191], v[72:75]
    v_add_f32 v168, v170, v20
    v_exp_f32 v23, v131
    v_mfma_f32_16x16x32_bf16 v[44:47], v[236:239], v[184:187], v[44:47]
    v_add_f32 v168, v168, v21
    v_mfma_f32_16x16x32_bf16 v[76:79], v[236:239], v[188:191], v[76:79]
    v_cvt_pk_bf16_f32 v176, v20, v21
    v_exp_f32 v24, v132
    v_mfma_f32_16x16x32_bf16 v[48:51], v[240:243], v[184:187], v[48:51]
    v_add_f32 v168, v168, v22
    v_mfma_f32_16x16x32_bf16 v[80:83], v[240:243], v[188:191], v[80:83]
    v_exp_f32 v25, v133
    v_add_f32 v168, v168, v23
    v_mfma_f32_16x16x32_bf16 v[52:55], v[244:247], v[184:187], v[52:55]
    v_cvt_pk_bf16_f32 v177, v22, v23
    v_mfma_f32_16x16x32_bf16 v[84:87], v[244:247], v[188:191], v[84:87]
    v_exp_f32 v26, v134
    v_add_f32 v168, v168, v24
    v_mfma_f32_16x16x32_bf16 v[56:59], v[248:251], v[184:187], v[56:59]
    v_exp_f32 v27, v135
    v_mfma_f32_16x16x32_bf16 v[88:91], v[248:251], v[188:191], v[88:91]
    v_add_f32 v168, v168, v25
    v_cvt_pk_bf16_f32 v178, v24, v25
    v_mfma_f32_16x16x32_bf16 v[60:63], v[252:255], v[184:187], v[60:63]
    v_exp_f32 v20, v136
    v_mfma_f32_16x16x32_bf16 v[92:95], v[252:255], v[188:191], v[92:95]
    v_add_f32 v168, v168, v26
    s_waitcnt vmcnt(7) lgkmcnt(0)
    s_barrier
    v_mfma_f32_16x16x32_bf16 v[144:147], v[192:195], v[96:99], v[160:163]
    ds_read_b64_tr_b16 v[224:225], v16 offset:0
    ds_read_b64_tr_b16 v[226:227], v16 offset:512
    v_exp_f32 v21, v137
    v_add_f32 v168, v168, v27
    v_mfma_f32_16x16x32_bf16 v[152:155], v[192:195], v[112:115], v[164:167]
    ds_read_b64_tr_b16 v[228:229], v16 offset:32
    v_cvt_pk_bf16_f32 v179, v26, v27
    v_exp_f32 v22, v138
    v_mfma_f32_16x16x32_bf16 v[148:151], v[196:199], v[96:99], v[160:163]
    ds_read_b64_tr_b16 v[230:231], v16 offset:544
    v_add_f32 v169, v171, v20
    v_mfma_f32_16x16x32_bf16 v[156:159], v[196:199], v[112:115], v[164:167]
    ds_read_b64_tr_b16 v[232:233], v16 offset:64
    ds_read_b64_tr_b16 v[234:235], v16 offset:576
    v_exp_f32 v23, v139
    v_add_f32 v169, v169, v21
    v_mfma_f32_16x16x32_bf16 v[144:147], v[200:203], v[100:103], v[144:147]
    ds_read_b64_tr_b16 v[236:237], v16 offset:96
    v_cvt_pk_bf16_f32 v180, v20, v21
    v_exp_f32 v24, v140
    v_mfma_f32_16x16x32_bf16 v[152:155], v[200:203], v[116:119], v[152:155]
    ds_read_b64_tr_b16 v[238:239], v16 offset:608
    v_add_f32 v169, v169, v22
    v_mfma_f32_16x16x32_bf16 v[148:151], v[204:207], v[100:103], v[148:151]
    ds_read_b64_tr_b16 v[240:241], v16 offset:128
    ds_read_b64_tr_b16 v[242:243], v16 offset:640
    v_exp_f32 v25, v141
    v_add_f32 v169, v169, v23
    v_mfma_f32_16x16x32_bf16 v[156:159], v[204:207], v[116:119], v[156:159]
    ds_read_b64_tr_b16 v[244:245], v16 offset:160
    v_cvt_pk_bf16_f32 v181, v22, v23
    v_mfma_f32_16x16x32_bf16 v[144:147], v[208:211], v[104:107], v[144:147]
    ds_read_b64_tr_b16 v[246:247], v16 offset:672
    v_exp_f32 v26, v142
    v_add_f32 v169, v169, v24
    v_mfma_f32_16x16x32_bf16 v[152:155], v[208:211], v[120:123], v[152:155]
    ds_read_b64_tr_b16 v[248:249], v16 offset:192
    ds_read_b64_tr_b16 v[250:251], v16 offset:704
    v_exp_f32 v27, v143
    v_add_f32 v169, v169, v25
    v_mfma_f32_16x16x32_bf16 v[148:151], v[212:215], v[104:107], v[148:151]
    ds_read_b64_tr_b16 v[252:253], v16 offset:224
    v_cvt_pk_bf16_f32 v182, v24, v25
    v_mfma_f32_16x16x32_bf16 v[156:159], v[212:215], v[120:123], v[156:159]
    ds_read_b64_tr_b16 v[254:255], v16 offset:736
    v_add_f32 v169, v169, v26
    v_add_f32 v169, v169, v27
    v_mfma_f32_16x16x32_bf16 v[144:147], v[216:219], v[108:111], v[144:147]
    v_cvt_pk_bf16_f32 v183, v26, v27
    v_mfma_f32_16x16x32_bf16 v[152:155], v[216:219], v[124:127], v[152:155]
    v_max_f32 v30, v168, v169
    v_cmp_lt_f32 vcc, s49, v30
    v_mfma_f32_16x16x32_bf16 v[148:151], v[220:223], v[108:111], v[148:151]
    s_cbranch_vccnz LP_r28
LP_b28:
    v_mfma_f32_16x16x32_bf16 v[156:159], v[220:223], v[124:127], v[156:159]
    s_waitcnt lgkmcnt(0)
    v_mfma_f32_16x16x32_bf16 v[32:35], v[224:227], v[176:179], v[32:35]
    ds_read_b128 v[192:195], v2 offset:0
    ds_read_b128 v[196:199], v2 offset:512
    v_mfma_f32_16x16x32_bf16 v[64:67], v[224:227], v[180:183], v[64:67]
    ds_read_b128 v[200:203], v2 offset:64
    ds_read_b128 v[204:207], v2 offset:576
    v_mfma_f32_16x16x32_bf16 v[36:39], v[228:231], v[176:179], v[36:39]
    ds_read_b128 v[208:211], v2 offset:128
    ds_read_b128 v[212:215], v2 offset:640
    v_mfma_f32_16x16x32_bf16 v[68:71], v[228:231], v[180:183], v[68:71]
    ds_read_b128 v[216:219], v2 offset:192
    ds_read_b128 v[220:223], v2 offset:704
    v_exp_f32 v20, v144
    v_exp_f32 v21, v145
    v_mfma_f32_16x16x32_bf16 v[40:43], v[232:235], v[176:179], v[40:43]
    v_exp_f32 v22, v146
    v_mfma_f32_16x16x32_bf16 v[72:75], v[232:235], v[180:183], v[72:75]
    v_add_f32 v170, v168, v20
    v_exp_f32 v23, v147
    v_mfma_f32_16x16x32_bf16 v[44:47], v[236:239], v[176:179], v[44:47]
    v_add_f32 v170, v170, v21
    v_mfma_f32_16x16x32_bf16 v[76:79], v[236:239], v[180:183], v[76:79]
    v_cvt_pk_bf16_f32 v184, v20, v21
    v_exp_f32 v24, v148
    v_mfma_f32_16x16x32_bf16 v[48:51], v[240:243], v[176:179], v[48:51]
    v_add_f32 v170, v170, v22
    v_mfma_f32_16x16x32_bf16 v[80:83], v[240:243], v[180:183], v[80:83]
    v_exp_f32 v25, v149
    v_add_f32 v170, v170, v23
    v_mfma_f32_16x16x32_bf16 v[52:55], v[244:247], v[176:179], v[52:55]
    v_cvt_pk_bf16_f32 v185, v22, v23
    v_mfma_f32_16x16x32_bf16 v[84:87], v[244:247], v[180:183], v[84:87]
    v_exp_f32 v26, v150
    v_add_f32 v170, v170, v24
    v_mfma_f32_16x16x32_bf16 v[56:59], v[248:251], v[176:179], v[56:59]
    v_exp_f32 v27, v151
    v_mfma_f32_16x16x32_bf16 v[88:91], v[248:251], v[180:183], v[88:91]
    v_add_f32 v170, v170, v25
    v_cvt_pk_bf16_f32 v186, v24, v25
    v_mfma_f32_16x16x32_bf16 v[60:63], v[252:255], v[176:179], v[60:63]
    v_exp_f32 v20, v152
    v_mfma_f32_16x16x32_bf16 v[92:95], v[252:255], v[180:183], v[92:95]
    v_add_f32 v170, v170, v26
    s_waitcnt vmcnt(5) lgkmcnt(0)
    s_barrier
    v_mfma_f32_16x16x32_bf16 v[128:131], v[192:195], v[96:99], v[160:163]
    ds_read_b64_tr_b16 v[224:225], v18 offset:16896
    ds_read_b64_tr_b16 v[226:227], v18 offset:17408
    v_exp_f32 v21, v153
    v_add_f32 v170, v170, v27
    v_mfma_f32_16x16x32_bf16 v[136:139], v[192:195], v[112:115], v[164:167]
    ds_read_b64_tr_b16 v[228:229], v18 offset:16928
    v_cvt_pk_bf16_f32 v187, v26, v27
    v_exp_f32 v22, v154
    v_mfma_f32_16x16x32_bf16 v[132:135], v[196:199], v[96:99], v[160:163]
    ds_read_b64_tr_b16 v[230:231], v18 offset:17440
    v_add_f32 v171, v169, v20
    v_mfma_f32_16x16x32_bf16 v[140:143], v[196:199], v[112:115], v[164:167]
    ds_read_b64_tr_b16 v[232:233], v18 offset:16960
    ds_read_b64_tr_b16 v[234:235], v18 offset:17472
    v_exp_f32 v23, v155
    v_add_f32 v171, v171, v21
    v_mfma_f32_16x16x32_bf16 v[128:131], v[200:203], v[100:103], v[128:131]
    ds_read_b64_tr_b16 v[236:237], v18 offset:16992
    v_cvt_pk_bf16_f32 v188, v20, v21
    v_exp_f32 v24, v156
    v_mfma_f32_16x16x32_bf16 v[136:139], v[200:203], v[116:119], v[136:139]
    ds_read_b64_tr_b16 v[238:239], v18 offset:17504
    v_add_f32 v171, v171, v22
    v_mfma_f32_16x16x32_bf16 v[132:135], v[204:207], v[100:103], v[132:135]
    s_buffer_load_dwordx2 s[68:69], s[28:31], s42
    ds_read_b64_tr_b16 v[240:241], v18 offset:17024
    ds_read_b64_tr_b16 v[242:243], v18 offset:17536
    v_exp_f32 v25, v157
    v_add_f32 v171, v171, v23
    v_mfma_f32_16x16x32_bf16 v[140:143], v[204:207], v[116:119], v[140:143]
    ds_read_b64_tr_b16 v[244:245], v18 offset:17056
    v_cvt_pk_bf16_f32 v189, v22, v23
    v_mfma_f32_16x16x32_bf16 v[128:131], v[208:211], v[104:107], v[128:131]
    ds_read_b64_tr_b16 v[246:247], v18 offset:17568
    v_exp_f32 v26, v158
    v_add_f32 v171, v171, v24
    v_mfma_f32_16x16x32_bf16 v[136:139], v[208:211], v[120:123], v[136:139]
    ds_read_b64_tr_b16 v[248:249], v18 offset:17088
    ds_read_b64_tr_b16 v[250:251], v18 offset:17600
    v_exp_f32 v27, v159
    v_add_f32 v171, v171, v25
    v_mfma_f32_16x16x32_bf16 v[132:135], v[212:215], v[104:107], v[132:135]
    ds_read_b64_tr_b16 v[252:253], v18 offset:17120
    v_cvt_pk_bf16_f32 v190, v24, v25
    v_mfma_f32_16x16x32_bf16 v[140:143], v[212:215], v[120:123], v[140:143]
    ds_read_b64_tr_b16 v[254:255], v18 offset:17632
    v_add_f32 v171, v171, v26
    v_add_f32 v171, v171, v27
    v_mfma_f32_16x16x32_bf16 v[128:131], v[216:219], v[108:111], v[128:131]
    v_cvt_pk_bf16_f32 v191, v26, v27
    v_mfma_f32_16x16x32_bf16 v[136:139], v[216:219], v[124:127], v[136:139]
    v_max_f32 v30, v170, v171
    v_cmp_lt_f32 vcc, s49, v30
    v_mfma_f32_16x16x32_bf16 v[132:135], v[220:223], v[108:111], v[132:135]
    s_cbranch_vccnz LP_r29
LP_b29:
    v_mfma_f32_16x16x32_bf16 v[140:143], v[220:223], v[124:127], v[140:143]
    s_waitcnt lgkmcnt(0)
    v_mfma_f32_16x16x32_bf16 v[32:35], v[224:227], v[184:187], v[32:35]
    s_xor_b64 s[68:69], s[68:69], s[40:41]
    v_mfma_f32_16x16x32_bf16 v[64:67], v[224:227], v[188:191], v[64:67]
    s_nop 3
    v_mfma_f32_16x16x32_bf16 v[36:39], v[228:231], v[184:187], v[36:39]
    s_cmp_eq_u64 s[68:69], 0
    s_cselect_b32 s62, 1, s39
    s_cmp_lg_u32 s62, 0
    s_cselect_b32 s62, 0, 33554432
    v_mfma_f32_16x16x32_bf16 v[68:71], v[228:231], v[188:191], v[68:71]
    s_add_u32 s63, s62, s51
    s_add_u32 s64, s62, s47
    s_add_u32 s65, s62, s48
    v_exp_f32 v20, v128
    v_exp_f32 v21, v129
    v_mfma_f32_16x16x32_bf16 v[40:43], v[232:235], v[184:187], v[40:43]
    buffer_load_dwordx4 v[96:99], v15, s[28:31], s63 offen sc1
    v_exp_f32 v22, v130
    v_mfma_f32_16x16x32_bf16 v[72:75], v[232:235], v[188:191], v[72:75]
    buffer_load_dwordx4 v[192:195], v15, s[28:31], s64 offen offset:0 sc1
    v_add_f32 v168, v170, v20
    v_exp_f32 v23, v131
    v_mfma_f32_16x16x32_bf16 v[44:47], v[236:239], v[184:187], v[44:47]
    buffer_load_dwordx4 v[196:199], v15, s[28:31], s64 offen offset:1024 sc1
    v_add_f32 v168, v168, v21
    v_mfma_f32_16x16x32_bf16 v[76:79], v[236:239], v[188:191], v[76:79]
    v_cvt_pk_bf16_f32 v176, v20, v21
    v_exp_f32 v24, v132
    v_mfma_f32_16x16x32_bf16 v[48:51], v[240:243], v[184:187], v[48:51]
    buffer_load_dwordx4 v[200:203], v15, s[28:31], s64 offen offset:2048 sc1
    v_add_f32 v168, v168, v22
    v_mfma_f32_16x16x32_bf16 v[80:83], v[240:243], v[188:191], v[80:83]
    buffer_load_dwordx4 v[204:207], v15, s[28:31], s64 offen offset:3072 sc1
    v_exp_f32 v25, v133
    v_add_f32 v168, v168, v23
    v_mfma_f32_16x16x32_bf16 v[52:55], v[244:247], v[184:187], v[52:55]
    buffer_load_dwordx4 v[208:211], v15, s[28:31], s65 offen offset:0 sc1
    v_cvt_pk_bf16_f32 v177, v22, v23
    v_mfma_f32_16x16x32_bf16 v[84:87], v[244:247], v[188:191], v[84:87]
    v_exp_f32 v26, v134
    v_add_f32 v168, v168, v24
    v_mfma_f32_16x16x32_bf16 v[56:59], v[248:251], v[184:187], v[56:59]
    buffer_load_dwordx4 v[212:215], v15, s[28:31], s65 offen offset:1024 sc1
    v_exp_f32 v27, v135
    v_mfma_f32_16x16x32_bf16 v[88:91], v[248:251], v[188:191], v[88:91]
    buffer_load_dwordx4 v[216:219], v15, s[28:31], s65 offen offset:2048 sc1
    v_add_f32 v168, v168, v25
    v_cvt_pk_bf16_f32 v178, v24, v25
    v_mfma_f32_16x16x32_bf16 v[60:63], v[252:255], v[184:187], v[60:63]
    buffer_load_dwordx4 v[220:223], v15, s[28:31], s65 offen offset:3072 sc1
    v_exp_f32 v20, v136
    v_mfma_f32_16x16x32_bf16 v[92:95], v[252:255], v[188:191], v[92:95]
    v_add_f32 v168, v168, v26
    s_waitcnt vmcnt(12) lgkmcnt(0)
    s_barrier
    ds_read_b64_tr_b16 v[224:225], v17 offset:0
    ds_read_b64_tr_b16 v[226:227], v17 offset:512
    v_exp_f32 v21, v137
    v_add_f32 v168, v168, v27
    ds_read_b64_tr_b16 v[228:229], v17 offset:32
    v_cvt_pk_bf16_f32 v179, v26, v27
    v_exp_f32 v22, v138
    ds_read_b64_tr_b16 v[230:231], v17 offset:544
    v_add_f32 v169, v171, v20
    ds_read_b64_tr_b16 v[232:233], v17 offset:64
    ds_read_b64_tr_b16 v[234:235], v17 offset:576
    v_exp_f32 v23, v139
    v_add_f32 v169, v169, v21
    ds_read_b64_tr_b16 v[236:237], v17 offset:96
    v_cvt_pk_bf16_f32 v180, v20, v21
    v_exp_f32 v24, v140
    ds_read_b64_tr_b16 v[238:239], v17 offset:608
    v_add_f32 v169, v169, v22
    ds_read_b64_tr_b16 v[240:241], v17 offset:128
    ds_read_b64_tr_b16 v[242:243], v17 offset:640
    v_exp_f32 v25, v141
    v_add_f32 v169, v169, v23
    ds_read_b64_tr_b16 v[244:245], v17 offset:160
    v_cvt_pk_bf16_f32 v181, v22, v23
    ds_read_b64_tr_b16 v[246:247], v17 offset:672
    v_exp_f32 v26, v142
    v_add_f32 v169, v169, v24
    ds_read_b64_tr_b16 v[248:249], v17 offset:192
    ds_read_b64_tr_b16 v[250:251], v17 offset:704
    v_exp_f32 v27, v143
    v_add_f32 v169, v169, v25
    ds_read_b64_tr_b16 v[252:253], v17 offset:224
    v_cvt_pk_bf16_f32 v182, v24, v25
    ds_read_b64_tr_b16 v[254:255], v17 offset:736
    v_add_f32 v169, v169, v26
    v_add_f32 v169, v169, v27
    v_cvt_pk_bf16_f32 v183, v26, v27
    v_max_f32 v30, v168, v169
    v_cmp_lt_f32 vcc, s49, v30
    s_cbranch_vccnz LP_r30
LP_b30:
    s_waitcnt vmcnt(0)
    v_lshlrev_b32 v108, 16, v192
    v_and_b32 v109, 0xffff0000, v192
    v_lshlrev_b32 v110, 16, v193
    v_and_b32 v111, 0xffff0000, v193
    v_lshlrev_b32 v112, 16, v194
    v_and_b32 v113, 0xffff0000, v194
    v_lshlrev_b32 v114, 16, v195
    v_and_b32 v115, 0xffff0000, v195
    v_lshlrev_b32 v116, 16, v196
    v_and_b32 v117, 0xffff0000, v196
    v_lshlrev_b32 v118, 16, v197
    v_and_b32 v119, 0xffff0000, v197
    v_lshlrev_b32 v120, 16, v198
    v_and_b32 v121, 0xffff0000, v198
    v_lshlrev_b32 v122, 16, v199
    v_and_b32 v123, 0xffff0000, v199
    v_lshlrev_b32 v144, 16, v200
    v_and_b32 v145, 0xffff0000, v200
    v_lshlrev_b32 v146, 16, v201
    v_and_b32 v147, 0xffff0000, v201
    v_lshlrev_b32 v148, 16, v202
    v_and_b32 v149, 0xffff0000, v202
    v_lshlrev_b32 v150, 16, v203
    v_and_b32 v151, 0xffff0000, v203
    v_lshlrev_b32 v152, 16, v204
    v_and_b32 v153, 0xffff0000, v204
    v_lshlrev_b32 v154, 16, v205
    v_and_b32 v155, 0xffff0000, v205
    v_lshlrev_b32 v156, 16, v206
    v_and_b32 v157, 0xffff0000, v206
    v_lshlrev_b32 v158, 16, v207
    v_and_b32 v159, 0xffff0000, v207
    s_waitcnt lgkmcnt(0)
    v_mfma_f32_16x16x32_bf16 v[32:35], v[224:227], v[176:179], v[32:35]
    v_min_f32 v104, v160, v96
    v_min_f32 v105, v164, v98
    v_sub_f32 v100, v104, v160
    v_mfma_f32_16x16x32_bf16 v[36:39], v[228:231], v[176:179], v[36:39]
    s_nop 3
    v_sub_f32 v102, v104, v96
    v_sub_f32 v101, v105, v164
    v_mfma_f32_16x16x32_bf16 v[40:43], v[232:235], v[176:179], v[40:43]
    v_sub_f32 v103, v105, v98
    v_exp_f32 v100, v100
    v_mfma_f32_16x16x32_bf16 v[44:47], v[236:239], v[176:179], v[44:47]
    v_exp_f32 v101, v101
    v_exp_f32 v102, v102
    v_mfma_f32_16x16x32_bf16 v[48:51], v[240:243], v[176:179], v[48:51]
    v_exp_f32 v103, v103
    s_nop 0
    v_mul_f32 v104, v102, v97
    v_mfma_f32_16x16x32_bf16 v[52:55], v[244:247], v[176:179], v[52:55]
    v_mul_f32 v105, v103, v99
    v_fmac_f32 v104, v168, v100
    v_mfma_f32_16x16x32_bf16 v[56:59], v[248:251], v[176:179], v[56:59]
    v_fmac_f32 v105, v169, v101
    v_mov_b32 v106, v104
    v_mfma_f32_16x16x32_bf16 v[60:63], v[252:255], v[176:179], v[60:63]
    v_mov_b32 v107, v105
    s_nop 0
    v_mfma_f32_16x16x32_bf16 v[64:67], v[224:227], v[180:183], v[64:67]
    v_permlane16_swap_b32 v104, v106
    v_permlane16_swap_b32 v105, v107
    v_add_f32 v104, v104, v106
    v_mfma_f32_16x16x32_bf16 v[68:71], v[228:231], v[180:183], v[68:71]
    v_add_f32 v105, v105, v107
    v_mov_b32 v106, v104
    v_mfma_f32_16x16x32_bf16 v[72:75], v[232:235], v[180:183], v[72:75]
    v_mov_b32 v107, v105
    s_nop 0
    v_mfma_f32_16x16x32_bf16 v[76:79], v[236:239], v[180:183], v[76:79]
    v_permlane32_swap_b32 v104, v106
    v_permlane32_swap_b32 v105, v107
    v_mfma_f32_16x16x32_bf16 v[80:83], v[240:243], v[180:183], v[80:83]
    v_add_f32 v104, v104, v106
    v_add_f32 v105, v105, v107
    v_rcp_f32 v104, v104
    v_mfma_f32_16x16x32_bf16 v[84:87], v[244:247], v[180:183], v[84:87]
    v_rcp_f32 v105, v105
    s_nop 0
    v_mfma_f32_16x16x32_bf16 v[88:91], v[248:251], v[180:183], v[88:91]
    v_mul_f32 v100, v100, v104
    v_mul_f32 v102, v102, v104
    v_mfma_f32_16x16x32_bf16 v[92:95], v[252:255], v[180:183], v[92:95]
    v_mul_f32 v101, v101, v105
    v_mul_f32 v103, v103, v105
    s_cmp_eq_u64 s[68:69], 0
    s_cbranch_scc1 L_spok
    v_and_b32 v30, 0, v1
    v_lshlrev_b32 v30, 3, v30
    s_mov_b32 s62, 0
Lsp_w:
    buffer_load_dwordx2 v[28:29], v30, s[28:31], s42 offen sc1
    s_add_u32 s62, s62, 1
    s_cmp_ge_u32 s62, 2097152
    s_cbranch_scc1 Lsp_wx
    s_waitcnt vmcnt(0)
    v_cmp_ne_u64 vcc, s[40:41], v[28:29]
    s_cbranch_vccnz Lsp_w
Lsp_wx:
    s_waitcnt vmcnt(0)
    buffer_load_dwordx4 v[96:99], v15, s[28:31], s51 offen sc1
    buffer_load_dwordx4 v[192:195], v15, s[28:31], s47 offen offset:0 sc1
    buffer_load_dwordx4 v[196:199], v15, s[28:31], s47 offen offset:1024 sc1
    buffer_load_dwordx4 v[200:203], v15, s[28:31], s47 offen offset:2048 sc1
    buffer_load_dwordx4 v[204:207], v15, s[28:31], s47 offen offset:3072 sc1
    buffer_load_dwordx4 v[208:211], v15, s[28:31], s48 offen offset:0 sc1
    buffer_load_dwordx4 v[212:215], v15, s[28:31], s48 offen offset:1024 sc1
    buffer_load_dwordx4 v[216:219], v15, s[28:31], s48 offen offset:2048 sc1
    buffer_load_dwordx4 v[220:223], v15, s[28:31], s48 offen offset:3072 sc1
    s_waitcnt vmcnt(8)
    v_min_f32 v104, v160, v96
    v_min_f32 v105, v164, v98
    v_sub_f32 v100, v104, v160
    v_sub_f32 v102, v104, v96
    v_sub_f32 v101, v105, v164
    v_sub_f32 v103, v105, v98
    v_exp_f32 v100, v100
    v_exp_f32 v101, v101
    v_exp_f32 v102, v102
    v_exp_f32 v103, v103
    s_nop 0
    v_mul_f32 v104, v102, v97
    v_mul_f32 v105, v103, v99
    v_fmac_f32 v104, v168, v100
    v_fmac_f32 v105, v169, v101
    v_mov_b32 v106, v104
    v_mov_b32 v107, v105
    s_nop 0
    v_permlane16_swap_b32 v104, v106
    v_permlane16_swap_b32 v105, v107
    v_add_f32 v104, v104, v106
    v_add_f32 v105, v105, v107
    v_mov_b32 v106, v104
    v_mov_b32 v107, v105
    s_nop 0
    v_permlane32_swap_b32 v104, v106
    v_permlane32_swap_b32 v105, v107
    v_add_f32 v104, v104, v106
    v_add_f32 v105, v105, v107
    v_rcp_f32 v104, v104
    v_rcp_f32 v105, v105
    s_nop 0
    v_mul_f32 v100, v100, v104
    v_mul_f32 v102, v102, v104
    v_mul_f32 v101, v101, v105
    v_mul_f32 v103, v103, v105
    s_waitcnt vmcnt(0)
    v_lshlrev_b32 v108, 16, v192
    v_and_b32 v109, 0xffff0000, v192
    v_lshlrev_b32 v110, 16, v193
    v_and_b32 v111, 0xffff0000, v193
    v_lshlrev_b32 v112, 16, v194
    v_and_b32 v113, 0xffff0000, v194
    v_lshlrev_b32 v114, 16, v195
    v_and_b32 v115, 0xffff0000, v195
    v_lshlrev_b32 v116, 16, v196
    v_and_b32 v117, 0xffff0000, v196
    v_lshlrev_b32 v118, 16, v197
    v_and_b32 v119, 0xffff0000, v197
    v_lshlrev_b32 v120, 16, v198
    v_and_b32 v121, 0xffff0000, v198
    v_lshlrev_b32 v122, 16, v199
    v_and_b32 v123, 0xffff0000, v199
    v_lshlrev_b32 v144, 16, v200
    v_and_b32 v145, 0xffff0000, v200
    v_lshlrev_b32 v146, 16, v201
    v_and_b32 v147, 0xffff0000, v201
    v_lshlrev_b32 v148, 16, v202
    v_and_b32 v149, 0xffff0000, v202
    v_lshlrev_b32 v150, 16, v203
    v_and_b32 v151, 0xffff0000, v203
    v_lshlrev_b32 v152, 16, v204
    v_and_b32 v153, 0xffff0000, v204
    v_lshlrev_b32 v154, 16, v205
    v_and_b32 v155, 0xffff0000, v205
    v_lshlrev_b32 v156, 16, v206
    v_and_b32 v157, 0xffff0000, v206
    v_lshlrev_b32 v158, 16, v207
    v_and_b32 v159, 0xffff0000, v207
L_spok:
    s_cmp_eq_u32 s39, 0
    s_cbranch_scc1 Lep_far
    v_pk_mul_f32 v[108:109], v[108:109], v[102:103] op_sel:[0,0] op_sel_hi:[1,0]
    v_pk_mul_f32 v[110:111], v[110:111], v[102:103] op_sel:[0,0] op_sel_hi:[1,0]
    v_pk_mul_f32 v[112:113], v[112:113], v[102:103] op_sel:[0,0] op_sel_hi:[1,0]
    v_pk_mul_f32 v[114:115], v[114:115], v[102:103] op_sel:[0,0] op_sel_hi:[1,0]
    v_pk_fma_f32 v[108:109], v[32:33], v[100:101], v[108:109] op_sel:[0,0,0] op_sel_hi:[1,0,1]
    v_pk_fma_f32 v[110:111], v[34:35], v[100:101], v[110:111] op_sel:[0,0,0] op_sel_hi:[1,0,1]
    v_pk_fma_f32 v[112:113], v[36:37], v[100:101], v[112:113] op_sel:[0,0,0] op_sel_hi:[1,0,1]
    v_pk_fma_f32 v[114:115], v[38:39], v[100:101], v[114:115] op_sel:[0,0,0] op_sel_hi:[1,0,1]
    v_cvt_pk_bf16_f32 v224, v108, v109
    v_cvt_pk_bf16_f32 v225, v110, v111
    v_cvt_pk_bf16_f32 v226, v112, v113
    v_cvt_pk_bf16_f32 v227, v114, v115
    buffer_store_dwordx4 v[224:227], v15, s[28:31], s43 offen offset:0
    v_pk_mul_f32 v[116:117], v[116:117], v[102:103] op_sel:[0,0] op_sel_hi:[1,0]
    v_pk_mul_f32 v[118:119], v[118:119], v[102:103] op_sel:[0,0] op_sel_hi:[1,0]
    v_pk_mul_f32 v[120:121], v[120:121], v[102:103] op_sel:[0,0] op_sel_hi:[1,0]
    v_pk_mul_f32 v[122:123], v[122:123], v[102:103] op_sel:[0,0] op_sel_hi:[1,0]
    v_pk_fma_f32 v[116:117], v[40:41], v[100:101], v[116:117] op_sel:[0,0,0] op_sel_hi:[1,0,1]
    v_pk_fma_f32 v[118:119], v[42:43], v[100:101], v[118:119] op_sel:[0,0,0] op_sel_hi:[1,0,1]
    v_pk_fma_f32 v[120:121], v[44:45], v[100:101], v[120:121] op_sel:[0,0,0] op_sel_hi:[1,0,1]
    v_pk_fma_f32 v[122:123], v[46:47], v[100:101], v[122:123] op_sel:[0,0,0] op_sel_hi:[1,0,1]
    v_cvt_pk_bf16_f32 v228, v116, v117
    v_cvt_pk_bf16_f32 v229, v118, v119
    v_cvt_pk_bf16_f32 v230, v120, v121
    v_cvt_pk_bf16_f32 v231, v122, v123
    buffer_store_dwordx4 v[228:231], v15, s[28:31], s43 offen offset:1024
    v_pk_mul_f32 v[144:145], v[144:145], v[102:103] op_sel:[0,0] op_sel_hi:[1,0]
    v_pk_mul_f32 v[146:147], v[146:147], v[102:103] op_sel:[0,0] op_sel_hi:[1,0]
    v_pk_mul_f32 v[148:149], v[148:149], v[102:103] op_sel:[0,0] op_sel_hi:[1,0]
    v_pk_mul_f32 v[150:151], v[150:151], v[102:103] op_sel:[0,0] op_sel_hi:[1,0]
    v_pk_fma_f32 v[144:145], v[48:49], v[100:101], v[144:145] op_sel:[0,0,0] op_sel_hi:[1,0,1]
    v_pk_fma_f32 v[146:147], v[50:51], v[100:101], v[146:147] op_sel:[0,0,0] op_sel_hi:[1,0,1]
    v_pk_fma_f32 v[148:149], v[52:53], v[100:101], v[148:149] op_sel:[0,0,0] op_sel_hi:[1,0,1]
    v_pk_fma_f32 v[150:151], v[54:55], v[100:101], v[150:151] op_sel:[0,0,0] op_sel_hi:[1,0,1]
    v_cvt_pk_bf16_f32 v232, v144, v145
    v_cvt_pk_bf16_f32 v233, v146, v147
    v_cvt_pk_bf16_f32 v234, v148, v149
    v_cvt_pk_bf16_f32 v235, v150, v151
    buffer_store_dwordx4 v[232:235], v15, s[28:31], s43 offen offset:2048
    v_pk_mul_f32 v[152:153], v[152:153], v[102:103] op_sel:[0,0] op_sel_hi:[1,0]
    v_pk_mul_f32 v[154:155], v[154:155], v[102:103] op_sel:[0,0] op_sel_hi:[1,0]
    v_pk_mul_f32 v[156:157], v[156:157], v[102:103] op_sel:[0,0] op_sel_hi:[1,0]
    v_pk_mul_f32 v[158:159], v[158:159], v[102:103] op_sel:[0,0] op_sel_hi:[1,0]
    v_pk_fma_f32 v[152:153], v[56:57], v[100:101], v[152:153] op_sel:[0,0,0] op_sel_hi:[1,0,1]
    v_pk_fma_f32 v[154:155], v[58:59], v[100:101], v[154:155] op_sel:[0,0,0] op_sel_hi:[1,0,1]
    v_pk_fma_f32 v[156:157], v[60:61], v[100:101], v[156:157] op_sel:[0,0,0] op_sel_hi:[1,0,1]
    v_pk_fma_f32 v[158:159], v[62:63], v[100:101], v[158:159] op_sel:[0,0,0] op_sel_hi:[1,0,1]
    v_cvt_pk_bf16_f32 v236, v152, v153
    v_cvt_pk_bf16_f32 v237, v154, v155
    v_cvt_pk_bf16_f32 v238, v156, v157
    v_cvt_pk_bf16_f32 v239, v158, v159
    buffer_store_dwordx4 v[236:239], v15, s[28:31], s43 offen offset:3072
    v_lshlrev_b32 v128, 16, v208
    v_and_b32 v129, 0xffff0000, v208
    v_lshlrev_b32 v130, 16, v209
    v_and_b32 v131, 0xffff0000, v209
    v_lshlrev_b32 v132, 16, v210
    v_and_b32 v133, 0xffff0000, v210
    v_lshlrev_b32 v134, 16, v211
    v_and_b32 v135, 0xffff0000, v211
    v_pk_mul_f32 v[128:129], v[128:129], v[102:103] op_sel:[0,1] op_sel_hi:[1,1]
    v_pk_mul_f32 v[130:131], v[130:131], v[102:103] op_sel:[0,1] op_sel_hi:[1,1]
    v_pk_mul_f32 v[132:133], v[132:133], v[102:103] op_sel:[0,1] op_sel_hi:[1,1]
    v_pk_mul_f32 v[134:135], v[134:135], v[102:103] op_sel:[0,1] op_sel_hi:[1,1]
    v_pk_fma_f32 v[128:129], v[64:65], v[100:101], v[128:129] op_sel:[0,1,0] op_sel_hi:[1,1,1]
    v_pk_fma_f32 v[130:131], v[66:67], v[100:101], v[130:131] op_sel:[0,1,0] op_sel_hi:[1,1,1]
    v_pk_fma_f32 v[132:133], v[68:69], v[100:101], v[132:133] op_sel:[0,1,0] op_sel_hi:[1,1,1]
    v_pk_fma_f32 v[134:135], v[70:71], v[100:101], v[134:135] op_sel:[0,1,0] op_sel_hi:[1,1,1]
    v_cvt_pk_bf16_f32 v240, v128, v129
    v_cvt_pk_bf16_f32 v241, v130, v131
    v_cvt_pk_bf16_f32 v242, v132, v133
    v_cvt_pk_bf16_f32 v243, v134, v135
    buffer_store_dwordx4 v[240:243], v15, s[28:31], s66 offen offset:0
    v_lshlrev_b32 v136, 16, v212
    v_and_b32 v137, 0xffff0000, v212
    v_lshlrev_b32 v138, 16, v213
    v_and_b32 v139, 0xffff0000, v213
    v_lshlrev_b32 v140, 16, v214
    v_and_b32 v141, 0xffff0000, v214
    v_lshlrev_b32 v142, 16, v215
    v_and_b32 v143, 0xffff0000, v215
    v_pk_mul_f32 v[136:137], v[136:137], v[102:103] op_sel:[0,1] op_sel_hi:[1,1]
    v_pk_mul_f32 v[138:139], v[138:139], v[102:103] op_sel:[0,1] op_sel_hi:[1,1]
    v_pk_mul_f32 v[140:141], v[140:141], v[102:103] op_sel:[0,1] op_sel_hi:[1,1]
    v_pk_mul_f32 v[142:143], v[142:143], v[102:103] op_sel:[0,1] op_sel_hi:[1,1]
    v_pk_fma_f32 v[136:137], v[72:73], v[100:101], v[136:137] op_sel:[0,1,0] op_sel_hi:[1,1,1]
    v_pk_fma_f32 v[138:139], v[74:75], v[100:101], v[138:139] op_sel:[0,1,0] op_sel_hi:[1,1,1]
    v_pk_fma_f32 v[140:141], v[76:77], v[100:101], v[140:141] op_sel:[0,1,0] op_sel_hi:[1,1,1]
    v_pk_fma_f32 v[142:143], v[78:79], v[100:101], v[142:143] op_sel:[0,1,0] op_sel_hi:[1,1,1]
    v_cvt_pk_bf16_f32 v244, v136, v137
    v_cvt_pk_bf16_f32 v245, v138, v139
    v_cvt_pk_bf16_f32 v246, v140, v141
    v_cvt_pk_bf16_f32 v247, v142, v143
    buffer_store_dwordx4 v[244:247], v15, s[28:31], s66 offen offset:1024
    v_lshlrev_b32 v128, 16, v216
    v_and_b32 v129, 0xffff0000, v216
    v_lshlrev_b32 v130, 16, v217
    v_and_b32 v131, 0xffff0000, v217
    v_lshlrev_b32 v132, 16, v218
    v_and_b32 v133, 0xffff0000, v218
    v_lshlrev_b32 v134, 16, v219
    v_and_b32 v135, 0xffff0000, v219
    v_pk_mul_f32 v[128:129], v[128:129], v[102:103] op_sel:[0,1] op_sel_hi:[1,1]
    v_pk_mul_f32 v[130:131], v[130:131], v[102:103] op_sel:[0,1] op_sel_hi:[1,1]
    v_pk_mul_f32 v[132:133], v[132:133], v[102:103] op_sel:[0,1] op_sel_hi:[1,1]
    v_pk_mul_f32 v[134:135], v[134:135], v[102:103] op_sel:[0,1] op_sel_hi:[1,1]
    v_pk_fma_f32 v[128:129], v[80:81], v[100:101], v[128:129] op_sel:[0,1,0] op_sel_hi:[1,1,1]
    v_pk_fma_f32 v[130:131], v[82:83], v[100:101], v[130:131] op_sel:[0,1,0] op_sel_hi:[1,1,1]
    v_pk_fma_f32 v[132:133], v[84:85], v[100:101], v[132:133] op_sel:[0,1,0] op_sel_hi:[1,1,1]
    v_pk_fma_f32 v[134:135], v[86:87], v[100:101], v[134:135] op_sel:[0,1,0] op_sel_hi:[1,1,1]
    v_cvt_pk_bf16_f32 v248, v128, v129
    v_cvt_pk_bf16_f32 v249, v130, v131
    v_cvt_pk_bf16_f32 v250, v132, v133
    v_cvt_pk_bf16_f32 v251, v134, v135
    buffer_store_dwordx4 v[248:251], v15, s[28:31], s66 offen offset:2048
    v_lshlrev_b32 v136, 16, v220
    v_and_b32 v137, 0xffff0000, v220
    v_lshlrev_b32 v138, 16, v221
    v_and_b32 v139, 0xffff0000, v221
    v_lshlrev_b32 v140, 16, v222
    v_and_b32 v141, 0xffff0000, v222
    v_lshlrev_b32 v142, 16, v223
    v_and_b32 v143, 0xffff0000, v223
    v_pk_mul_f32 v[136:137], v[136:137], v[102:103] op_sel:[0,1] op_sel_hi:[1,1]
    v_pk_mul_f32 v[138:139], v[138:139], v[102:103] op_sel:[0,1] op_sel_hi:[1,1]
    v_pk_mul_f32 v[140:141], v[140:141], v[102:103] op_sel:[0,1] op_sel_hi:[1,1]
    v_pk_mul_f32 v[142:143], v[142:143], v[102:103] op_sel:[0,1] op_sel_hi:[1,1]
    v_pk_fma_f32 v[136:137], v[88:89], v[100:101], v[136:137] op_sel:[0,1,0] op_sel_hi:[1,1,1]
    v_pk_fma_f32 v[138:139], v[90:91], v[100:101], v[138:139] op_sel:[0,1,0] op_sel_hi:[1,1,1]
    v_pk_fma_f32 v[140:141], v[92:93], v[100:101], v[140:141] op_sel:[0,1,0] op_sel_hi:[1,1,1]
    v_pk_fma_f32 v[142:143], v[94:95], v[100:101], v[142:143] op_sel:[0,1,0] op_sel_hi:[1,1,1]
    v_cvt_pk_bf16_f32 v252, v136, v137
    v_cvt_pk_bf16_f32 v253, v138, v139
    v_cvt_pk_bf16_f32 v254, v140, v141
    v_cvt_pk_bf16_f32 v255, v142, v143
    buffer_store_dwordx4 v[252:255], v15, s[28:31], s66 offen offset:3072
    v_mov_b32 v28, s40
    v_mov_b32 v29, s41
    v_mov_b32 v30, 0
    s_waitcnt vmcnt(0)
    s_mov_b64 exec, 1
    buffer_store_dwordx2 v[28:29], v30, s[28:31], s67 offen
    s_mov_b64 exec, -1
    s_branch Lep_j
Lep_far:
    v_pk_mul_f32 v[108:109], v[108:109], v[102:103] op_sel:[0,0] op_sel_hi:[1,0]
    v_pk_mul_f32 v[110:111], v[110:111], v[102:103] op_sel:[0,0] op_sel_hi:[1,0]
    v_pk_mul_f32 v[112:113], v[112:113], v[102:103] op_sel:[0,0] op_sel_hi:[1,0]
    v_pk_mul_f32 v[114:115], v[114:115], v[102:103] op_sel:[0,0] op_sel_hi:[1,0]
    v_pk_fma_f32 v[108:109], v[32:33], v[100:101], v[108:109] op_sel:[0,0,0] op_sel_hi:[1,0,1]
    v_pk_fma_f32 v[110:111], v[34:35], v[100:101], v[110:111] op_sel:[0,0,0] op_sel_hi:[1,0,1]
    v_pk_fma_f32 v[112:113], v[36:37], v[100:101], v[112:113] op_sel:[0,0,0] op_sel_hi:[1,0,1]
    v_pk_fma_f32 v[114:115], v[38:39], v[100:101], v[114:115] op_sel:[0,0,0] op_sel_hi:[1,0,1]
    v_cvt_pk_bf16_f32 v224, v108, v109
    v_cvt_pk_bf16_f32 v225, v110, v111
    v_cvt_pk_bf16_f32 v226, v112, v113
    v_cvt_pk_bf16_f32 v227, v114, v115
    buffer_store_dwordx4 v[224:227], v15, s[28:31], s43 offen offset:0 sc1
    v_pk_mul_f32 v[116:117], v[116:117], v[102:103] op_sel:[0,0] op_sel_hi:[1,0]
    v_pk_mul_f32 v[118:119], v[118:119], v[102:103] op_sel:[0,0] op_sel_hi:[1,0]
    v_pk_mul_f32 v[120:121], v[120:121], v[102:103] op_sel:[0,0] op_sel_hi:[1,0]
    v_pk_mul_f32 v[122:123], v[122:123], v[102:103] op_sel:[0,0] op_sel_hi:[1,0]
    v_pk_fma_f32 v[116:117], v[40:41], v[100:101], v[116:117] op_sel:[0,0,0] op_sel_hi:[1,0,1]
    v_pk_fma_f32 v[118:119], v[42:43], v[100:101], v[118:119] op_sel:[0,0,0] op_sel_hi:[1,0,1]
    v_pk_fma_f32 v[120:121], v[44:45], v[100:101], v[120:121] op_sel:[0,0,0] op_sel_hi:[1,0,1]
    v_pk_fma_f32 v[122:123], v[46:47], v[100:101], v[122:123] op_sel:[0,0,0] op_sel_hi:[1,0,1]
    v_cvt_pk_bf16_f32 v228, v116, v117
    v_cvt_pk_bf16_f32 v229, v118, v119
    v_cvt_pk_bf16_f32 v230, v120, v121
    v_cvt_pk_bf16_f32 v231, v122, v123
    buffer_store_dwordx4 v[228:231], v15, s[28:31], s43 offen offset:1024 sc1
    v_pk_mul_f32 v[144:145], v[144:145], v[102:103] op_sel:[0,0] op_sel_hi:[1,0]
    v_pk_mul_f32 v[146:147], v[146:147], v[102:103] op_sel:[0,0] op_sel_hi:[1,0]
    v_pk_mul_f32 v[148:149], v[148:149], v[102:103] op_sel:[0,0] op_sel_hi:[1,0]
    v_pk_mul_f32 v[150:151], v[150:151], v[102:103] op_sel:[0,0] op_sel_hi:[1,0]
    v_pk_fma_f32 v[144:145], v[48:49], v[100:101], v[144:145] op_sel:[0,0,0] op_sel_hi:[1,0,1]
    v_pk_fma_f32 v[146:147], v[50:51], v[100:101], v[146:147] op_sel:[0,0,0] op_sel_hi:[1,0,1]
    v_pk_fma_f32 v[148:149], v[52:53], v[100:101], v[148:149] op_sel:[0,0,0] op_sel_hi:[1,0,1]
    v_pk_fma_f32 v[150:151], v[54:55], v[100:101], v[150:151] op_sel:[0,0,0] op_sel_hi:[1,0,1]
    v_cvt_pk_bf16_f32 v232, v144, v145
    v_cvt_pk_bf16_f32 v233, v146, v147
    v_cvt_pk_bf16_f32 v234, v148, v149
    v_cvt_pk_bf16_f32 v235, v150, v151
    buffer_store_dwordx4 v[232:235], v15, s[28:31], s43 offen offset:2048 sc1
    v_pk_mul_f32 v[152:153], v[152:153], v[102:103] op_sel:[0,0] op_sel_hi:[1,0]
    v_pk_mul_f32 v[154:155], v[154:155], v[102:103] op_sel:[0,0] op_sel_hi:[1,0]
    v_pk_mul_f32 v[156:157], v[156:157], v[102:103] op_sel:[0,0] op_sel_hi:[1,0]
    v_pk_mul_f32 v[158:159], v[158:159], v[102:103] op_sel:[0,0] op_sel_hi:[1,0]
    v_pk_fma_f32 v[152:153], v[56:57], v[100:101], v[152:153] op_sel:[0,0,0] op_sel_hi:[1,0,1]
    v_pk_fma_f32 v[154:155], v[58:59], v[100:101], v[154:155] op_sel:[0,0,0] op_sel_hi:[1,0,1]
    v_pk_fma_f32 v[156:157], v[60:61], v[100:101], v[156:157] op_sel:[0,0,0] op_sel_hi:[1,0,1]
    v_pk_fma_f32 v[158:159], v[62:63], v[100:101], v[158:159] op_sel:[0,0,0] op_sel_hi:[1,0,1]
    v_cvt_pk_bf16_f32 v236, v152, v153
    v_cvt_pk_bf16_f32 v237, v154, v155
    v_cvt_pk_bf16_f32 v238, v156, v157
    v_cvt_pk_bf16_f32 v239, v158, v159
    buffer_store_dwordx4 v[236:239], v15, s[28:31], s43 offen offset:3072 sc1
    v_lshlrev_b32 v128, 16, v208
    v_and_b32 v129, 0xffff0000, v208
    v_lshlrev_b32 v130, 16, v209
    v_and_b32 v131, 0xffff0000, v209
    v_lshlrev_b32 v132, 16, v210
    v_and_b32 v133, 0xffff0000, v210
    v_lshlrev_b32 v134, 16, v211
    v_and_b32 v135, 0xffff0000, v211
    v_pk_mul_f32 v[128:129], v[128:129], v[102:103] op_sel:[0,1] op_sel_hi:[1,1]
    v_pk_mul_f32 v[130:131], v[130:131], v[102:103] op_sel:[0,1] op_sel_hi:[1,1]
    v_pk_mul_f32 v[132:133], v[132:133], v[102:103] op_sel:[0,1] op_sel_hi:[1,1]
    v_pk_mul_f32 v[134:135], v[134:135], v[102:103] op_sel:[0,1] op_sel_hi:[1,1]
    v_pk_fma_f32 v[128:129], v[64:65], v[100:101], v[128:129] op_sel:[0,1,0] op_sel_hi:[1,1,1]
    v_pk_fma_f32 v[130:131], v[66:67], v[100:101], v[130:131] op_sel:[0,1,0] op_sel_hi:[1,1,1]
    v_pk_fma_f32 v[132:133], v[68:69], v[100:101], v[132:133] op_sel:[0,1,0] op_sel_hi:[1,1,1]
    v_pk_fma_f32 v[134:135], v[70:71], v[100:101], v[134:135] op_sel:[0,1,0] op_sel_hi:[1,1,1]
    v_cvt_pk_bf16_f32 v240, v128, v129
    v_cvt_pk_bf16_f32 v241, v130, v131
    v_cvt_pk_bf16_f32 v242, v132, v133
    v_cvt_pk_bf16_f32 v243, v134, v135
    buffer_store_dwordx4 v[240:243], v15, s[28:31], s66 offen offset:0 sc1
    v_lshlrev_b32 v136, 16, v212
    v_and_b32 v137, 0xffff0000, v212
    v_lshlrev_b32 v138, 16, v213
    v_and_b32 v139, 0xffff0000, v213
    v_lshlrev_b32 v140, 16, v214
    v_and_b32 v141, 0xffff0000, v214
    v_lshlrev_b32 v142, 16, v215
    v_and_b32 v143, 0xffff0000, v215
    v_pk_mul_f32 v[136:137], v[136:137], v[102:103] op_sel:[0,1] op_sel_hi:[1,1]
    v_pk_mul_f32 v[138:139], v[138:139], v[102:103] op_sel:[0,1] op_sel_hi:[1,1]
    v_pk_mul_f32 v[140:141], v[140:141], v[102:103] op_sel:[0,1] op_sel_hi:[1,1]
    v_pk_mul_f32 v[142:143], v[142:143], v[102:103] op_sel:[0,1] op_sel_hi:[1,1]
    v_pk_fma_f32 v[136:137], v[72:73], v[100:101], v[136:137] op_sel:[0,1,0] op_sel_hi:[1,1,1]
    v_pk_fma_f32 v[138:139], v[74:75], v[100:101], v[138:139] op_sel:[0,1,0] op_sel_hi:[1,1,1]
    v_pk_fma_f32 v[140:141], v[76:77], v[100:101], v[140:141] op_sel:[0,1,0] op_sel_hi:[1,1,1]
    v_pk_fma_f32 v[142:143], v[78:79], v[100:101], v[142:143] op_sel:[0,1,0] op_sel_hi:[1,1,1]
    v_cvt_pk_bf16_f32 v244, v136, v137
    v_cvt_pk_bf16_f32 v245, v138, v139
    v_cvt_pk_bf16_f32 v246, v140, v141
    v_cvt_pk_bf16_f32 v247, v142, v143
    buffer_store_dwordx4 v[244:247], v15, s[28:31], s66 offen offset:1024 sc1
    v_lshlrev_b32 v128, 16, v216
    v_and_b32 v129, 0xffff0000, v216
    v_lshlrev_b32 v130, 16, v217
    v_and_b32 v131, 0xffff0000, v217
    v_lshlrev_b32 v132, 16, v218
    v_and_b32 v133, 0xffff0000, v218
    v_lshlrev_b32 v134, 16, v219
    v_and_b32 v135, 0xffff0000, v219
    v_pk_mul_f32 v[128:129], v[128:129], v[102:103] op_sel:[0,1] op_sel_hi:[1,1]
    v_pk_mul_f32 v[130:131], v[130:131], v[102:103] op_sel:[0,1] op_sel_hi:[1,1]
    v_pk_mul_f32 v[132:133], v[132:133], v[102:103] op_sel:[0,1] op_sel_hi:[1,1]
    v_pk_mul_f32 v[134:135], v[134:135], v[102:103] op_sel:[0,1] op_sel_hi:[1,1]
    v_pk_fma_f32 v[128:129], v[80:81], v[100:101], v[128:129] op_sel:[0,1,0] op_sel_hi:[1,1,1]
    v_pk_fma_f32 v[130:131], v[82:83], v[100:101], v[130:131] op_sel:[0,1,0] op_sel_hi:[1,1,1]
    v_pk_fma_f32 v[132:133], v[84:85], v[100:101], v[132:133] op_sel:[0,1,0] op_sel_hi:[1,1,1]
    v_pk_fma_f32 v[134:135], v[86:87], v[100:101], v[134:135] op_sel:[0,1,0] op_sel_hi:[1,1,1]
    v_cvt_pk_bf16_f32 v248, v128, v129
    v_cvt_pk_bf16_f32 v249, v130, v131
    v_cvt_pk_bf16_f32 v250, v132, v133
    v_cvt_pk_bf16_f32 v251, v134, v135
    buffer_store_dwordx4 v[248:251], v15, s[28:31], s66 offen offset:2048 sc1
    v_lshlrev_b32 v136, 16, v220
    v_and_b32 v137, 0xffff0000, v220
    v_lshlrev_b32 v138, 16, v221
    v_and_b32 v139, 0xffff0000, v221
    v_lshlrev_b32 v140, 16, v222
    v_and_b32 v141, 0xffff0000, v222
    v_lshlrev_b32 v142, 16, v223
    v_and_b32 v143, 0xffff0000, v223
    v_pk_mul_f32 v[136:137], v[136:137], v[102:103] op_sel:[0,1] op_sel_hi:[1,1]
    v_pk_mul_f32 v[138:139], v[138:139], v[102:103] op_sel:[0,1] op_sel_hi:[1,1]
    v_pk_mul_f32 v[140:141], v[140:141], v[102:103] op_sel:[0,1] op_sel_hi:[1,1]
    v_pk_mul_f32 v[142:143], v[142:143], v[102:103] op_sel:[0,1] op_sel_hi:[1,1]
    v_pk_fma_f32 v[136:137], v[88:89], v[100:101], v[136:137] op_sel:[0,1,0] op_sel_hi:[1,1,1]
    v_pk_fma_f32 v[138:139], v[90:91], v[100:101], v[138:139] op_sel:[0,1,0] op_sel_hi:[1,1,1]
    v_pk_fma_f32 v[140:141], v[92:93], v[100:101], v[140:141] op_sel:[0,1,0] op_sel_hi:[1,1,1]
    v_pk_fma_f32 v[142:143], v[94:95], v[100:101], v[142:143] op_sel:[0,1,0] op_sel_hi:[1,1,1]
    v_cvt_pk_bf16_f32 v252, v136, v137
    v_cvt_pk_bf16_f32 v253, v138, v139
    v_cvt_pk_bf16_f32 v254, v140, v141
    v_cvt_pk_bf16_f32 v255, v142, v143
    buffer_store_dwordx4 v[252:255], v15, s[28:31], s66 offen offset:3072 sc1
    v_mov_b32 v28, s40
    v_mov_b32 v29, s41
    v_mov_b32 v30, 0
    s_waitcnt vmcnt(0)
    s_mov_b64 exec, 1
    buffer_store_dwordx2 v[28:29], v30, s[28:31], s67 offen sc1
    s_mov_b64 exec, -1
Lep_j:
    s_waitcnt lgkmcnt(0)
    s_barrier
    s_branch L_join
L_S:
    s_lshr_b32 s45, s35, 1
    s_and_b32 s44, s35, 1
    s_lshl_b32 s44, s44, 4
    s_add_u32 s44, s44, s38
    s_lshl_b32 s62, s44, 2
    s_add_u32 s62, s62, s45
    s_lshl_b32 s62, s62, 19
    s_mul_i32 s63, s37, 270336
    s_add_u32 s62, s62, s63
    s_mov_b32 s63, 270336
    s_cmp_eq_u32 s37, 0
    s_cselect_b32 s63, s63, 253952
    s_add_u32 s8, s8, s62
    s_addc_u32 s9, s9, 0
    s_mov_b32 s10, s63
    s_add_u32 s12, s12, s62
    s_addc_u32 s13, s13, 0
    s_mov_b32 s14, s63
    s_mul_i32 s52, s34, 2112
    v_lshrrev_b32 v28, 4, v1
    v_and_b32 v29, 15, v1
    v_lshlrev_b32 v29, 4, v29
    v_lshl_add_u32 v29, v28, 11, v29
    s_lshl_b32 s62, s34, 9
    v_add_u32 v6, s62, v29
    v_lshlrev_b32 v7, 7, v0
    s_mov_b32 s10, 524288
    s_mov_b32 s14, 524288
    s_mov_b32 s46, 0
    s_add_u32 m0, s52, 0
    s_nop 0
    buffer_load_dwordx4 v6, s[8:11], s46 offen offset:0 nt lds
    s_add_u32 m0, s52, 800
    s_nop 0
    buffer_load_dwordx4 v6, s[8:11], s46 offen offset:256 nt lds
    s_mov_b32 s46, 8192
    s_add_u32 m0, s52, 8448
    s_nop 0
    buffer_load_dwordx4 v6, s[8:11], s46 offen offset:0 nt lds
    s_add_u32 m0, s52, 9248
    s_nop 0
    buffer_load_dwordx4 v6, s[8:11], s46 offen offset:256 nt lds
    v_lshlrev_b32 v15, 4, v1
    s_lshl_b32 s62, s44, 2
    s_add_u32 s62, s62, s45
    s_lshl_b32 s62, s62, 2
    s_add_u32 s62, s62, s34
    s_lshl_b32 s63, s62, 13
    s_add_u32 s47, s63, 4194304
    s_add_u32 s48, s47, 4096
    s_add_u32 s43, s63, 4194304
    s_add_u32 s66, s43, 4096
    s_lshl_b32 s51, s62, 10
    s_add_u32 s51, s51, 12582912
    s_lshl_b32 s42, s45, 5
    s_add_u32 s42, s42, s44
    s_lshl_b32 s42, s42, 2
    s_add_u32 s42, s42, s34
    s_lshl_b32 s42, s42, 3
    s_add_u32 s42, s42, 23076864
    s_lshl_b32 s67, s45, 2
    s_add_u32 s67, s67, s34
    s_lshl_b32 s67, s67, 5
    s_add_u32 s67, s67, s44
    s_lshl_b32 s67, s67, 3
    s_add_u32 s67, s67, 23085056
    s_lshr_b32 s57, s35, 1
    s_and_b32 s56, s35, 1
    s_lshl_b32 s56, s56, 2
    s_and_b32 s62, s38, 3
    s_add_u32 s56, s56, s62
    s_lshr_b32 s55, s38, 2
    s_lshl_b32 s55, s55, 1
    s_add_u32 s55, s55, s37
    s_xor_b32 s55, s55, 1
    s_lshl_b32 s58, s56, 3
    s_add_u32 s58, s58, s55
    s_lshl_b32 s55, s55, 7
    s_lshl_b32 s54, s57, 21
    s_lshl_b32 s62, s34, 15
    s_add_u32 s54, s54, s62
    s_lshl_b32 s62, s55, 1
    s_add_u32 s54, s54, s62
    s_add_u32 s62, s38, 0
    s_and_b32 s62, s62, 3
    s_lshl_b32 s62, s62, 19
    s_add_u32 s4, s54, s62
    s_add_u32 s62, s38, 1
    s_and_b32 s62, s62, 3
    s_lshl_b32 s62, s62, 19
    s_add_u32 s5, s54, s62
    s_add_u32 s62, s38, 2
    s_and_b32 s62, s62, 3
    s_lshl_b32 s62, s62, 19
    s_add_u32 s6, s54, s62
    s_add_u32 s62, s38, 3
    s_and_b32 s62, s62, 3
    s_lshl_b32 s62, s62, 19
    s_add_u32 s7, s54, s62
    s_lshl_b32 s59, s34, 12
    v_lshrrev_b32 v28, 4, v1
    v_and_b32 v29, 15, v1
    v_lshlrev_b32 v30, 2, v28
    v_xor_b32 v30, v29, v30
    v_lshlrev_b32 v30, 4, v30
    v_lshl_add_u32 v10, v28, 11, v30
    v_add_u32 v11, 7168, v10
    v_add_u32 v12, 14336, v10
    v_add_u32 v13, 21504, v10
    v_lshrrev_b32 v28, 4, v1
    v_and_b32 v30, 7, v1
    v_mul_u32_u24 v30, 1056, v30
    v_bfe_u32 v31, v1, 3, 1
    v_lshl_add_u32 v30, v31, 8, v30
    v_lshl_add_u32 v2, v28, 4, v30
    v_bfe_u32 v30, v1, 2, 3
    v_mul_u32_u24 v30, 1056, v30
    v_lshrrev_b32 v31, 5, v1
    v_lshl_add_u32 v30, v31, 8, v30
    v_and_b32 v31, 3, v1
    v_lshl_add_u32 v30, v31, 3, v30
    v_add_u32 v16, 8448, v30
    v_lshrrev_b32 v30, 2, v1
    v_lshlrev_b32 v30, 8, v30
    v_lshl_add_u32 v30, v31, 4, v30
    v_bfe_u32 v31, v1, 2, 2
    v_xor_b32 v31, s34, v31
    v_lshl_add_u32 v14, v31, 6, v30
    v_add_u32 v3, 50688, v2
    v_add_u32 v17, 50688, v16
    v_add_u32 v19, 50688, v14
    v_add_u32 v4, 101376, v2
    v_add_u32 v18, 101376, v16
    v_add_u32 v5, 101376, v14
    v_mov_b32 v8, v254
    v_mov_b32 v160, 0
    v_mov_b32 v161, 0
    v_mov_b32 v162, 0
    v_mov_b32 v163, 0
    v_mov_b32 v164, 0
    v_mov_b32 v165, 0
    v_mov_b32 v166, 0
    v_mov_b32 v167, 0
    v_mov_b32 v168, 0
    v_mov_b32 v169, 0
    v_mov_b32 v170, 0
    v_mov_b32 v171, 0
    v_mov_b32 v20, 0
    v_mov_b32 v21, 0
    v_mov_b32 v22, 0
    v_mov_b32 v23, 0
    v_mov_b32 v24, 0
    v_mov_b32 v25, 0
    v_mov_b32 v26, 0
    v_mov_b32 v27, 0
    s_mov_b32 s49, 0xbf800000
    s_mov_b32 s50, 0xff800000
    s_mov_b32 s46, 16384
    s_add_u32 m0, s52, 16896
    s_nop 0
    buffer_load_dwordx4 v6, s[8:11], s46 offen offset:0 nt lds
    s_add_u32 m0, s52, 17696
    s_nop 0
    buffer_load_dwordx4 v6, s[8:11], s46 offen offset:256 nt lds
    s_mov_b32 s46, 0
    s_add_u32 m0, s52, 25344
    s_nop 0
    buffer_load_dwordx4 v6, s[12:15], s46 offen offset:0 nt lds
    s_add_u32 m0, s52, 26144
    s_nop 0
    buffer_load_dwordx4 v6, s[12:15], s46 offen offset:256 nt lds
    s_load_dwordx2 s[40:41], s[32:33], 0
    s_mov_b32 s46, 24576
    s_add_u32 m0, s52, 33792
    s_nop 0
    buffer_load_dwordx4 v6, s[8:11], s46 offen offset:0 nt lds
    s_add_u32 m0, s52, 34592
    s_nop 0
    buffer_load_dwordx4 v6, s[8:11], s46 offen offset:256 nt lds
    s_mov_b32 s46, 8192
    s_add_u32 m0, s52, 42240
    s_nop 0
    buffer_load_dwordx4 v6, s[12:15], s46 offen offset:0 nt lds
    s_add_u32 m0, s52, 43040
    s_nop 0
    buffer_load_dwordx4 v6, s[12:15], s46 offen offset:256 nt lds
    s_waitcnt lgkmcnt(0)
    s_and_b32 s63, s40, 1
    s_lshr_b32 s64, s41, 31
    s_and_b32 s63, s63, s64
    s_cbranch_scc1 Ls_ngx
    v_mov_b32 v30, 0
    s_mov_b32 s62, 0
Ls_ng:
    global_load_dwordx2 v[28:29], v30, s[32:33] sc1
    s_add_u32 s62, s62, 1
    s_waitcnt vmcnt(0)
    v_readfirstlane_b32 s40, v28
    v_readfirstlane_b32 s41, v29
    s_cmp_ge_u32 s62, 2097152
    s_cbranch_scc1 Ls_ngx
    s_and_b32 s63, s40, 1
    s_lshr_b32 s64, s41, 31
    s_and_b32 s63, s63, s64
    s_cbranch_scc0 Ls_ng
Ls_ngx:
    s_getreg_b32 s3, hwreg(HW_REG_XCC_ID, 0, 4)
    s_xor_b32 s3, s3, s41
    s_lshl_b32 s62, s35, 5
    s_add_u32 s62, s62, s36
    s_lshl_b32 s62, s62, 3
    s_add_u32 s62, s62, 23101440
    v_mov_b32 v28, s40
    v_mov_b32 v29, s3
    s_mov_b64 exec, 1
    buffer_store_dwordx2 v[28:29], off, s[28:31], s62
    s_mov_b64 exec, -1
    s_add_u32 s63, s34, s38
    s_and_b32 s63, s63, 3
    s_lshl_b32 s100, s57, 2
    s_add_u32 s100, s100, s63
    s_lshl_b32 s64, s100, 13
    s_add_u32 s64, s64, 4194304
    s_lshl_b32 s62, s56, 19
    s_add_u32 s64, s64, s62
    s_lshl_b32 s100, s100, 5
    s_lshl_b32 s62, s56, 2
    s_add_u32 s100, s100, s62
    s_lshl_b32 s100, s100, 3
    s_add_u32 s100, s100, 23085056
    s_lshl_b32 s101, s34, 13
    s_add_u32 s62, s57, 1
    s_and_b32 s62, s62, 3
    s_lshl_b32 s62, s62, 17
    s_add_u32 s16, s64, s62
    s_add_u32 s62, s57, 2
    s_and_b32 s62, s62, 3
    s_lshl_b32 s62, s62, 17
    s_add_u32 s17, s64, s62
    s_add_u32 s62, s57, 3
    s_and_b32 s62, s62, 3
    s_lshl_b32 s62, s62, 17
    s_add_u32 s18, s64, s62
    s_add_u32 s62, s57, 4
    s_and_b32 s62, s62, 3
    s_lshl_b32 s62, s62, 17
    s_add_u32 s19, s64, s62
    s_mov_b32 s46, 32768
    s_add_u32 m0, s52, 50688
    s_nop 0
    buffer_load_dwordx4 v6, s[8:11], s46 offen offset:0 nt lds
    s_add_u32 m0, s52, 51488
    s_nop 0
    buffer_load_dwordx4 v6, s[8:11], s46 offen offset:256 nt lds
    s_mov_b32 s46, 16384
    s_add_u32 m0, s52, 59136
    s_nop 0
    buffer_load_dwordx4 v6, s[12:15], s46 offen offset:0 nt lds
    s_add_u32 m0, s52, 59936
    s_nop 0
    buffer_load_dwordx4 v6, s[12:15], s46 offen offset:256 nt lds
    s_mov_b32 s46, 40960
    s_add_u32 m0, s52, 67584
    s_nop 0
    buffer_load_dwordx4 v6, s[8:11], s46 offen offset:0 nt lds
    s_add_u32 m0, s52, 68384
    s_nop 0
    buffer_load_dwordx4 v6, s[8:11], s46 offen offset:256 nt lds
    s_mov_b32 s46, 24576
    s_add_u32 m0, s52, 76032
    s_nop 0
    buffer_load_dwordx4 v6, s[12:15], s46 offen offset:0 nt lds
    s_add_u32 m0, s52, 76832
    s_nop 0
    buffer_load_dwordx4 v6, s[12:15], s46 offen offset:256 nt lds
    s_mov_b32 s62, 270336
    buffer_load_dword v203, v7, s[8:11], s62 offen
    s_mov_b32 s62, 270336
    buffer_load_dword v204, v7, s[12:15], s62 offen
    s_mov_b32 s46, 49152
    s_add_u32 m0, s52, 84480
    s_nop 0
    buffer_load_dwordx4 v6, s[8:11], s46 offen offset:0 nt lds
    s_add_u32 m0, s52, 85280
    s_nop 0
    buffer_load_dwordx4 v6, s[8:11], s46 offen offset:256 nt lds
    s_mov_b32 s46, 32768
    s_add_u32 m0, s52, 92928
    s_nop 0
    buffer_load_dwordx4 v6, s[12:15], s46 offen offset:0 nt lds
    s_add_u32 m0, s52, 93728
    s_nop 0
    buffer_load_dwordx4 v6, s[12:15], s46 offen offset:256 nt lds
    s_mov_b32 s46, 57344
    s_add_u32 m0, s52, 101376
    s_nop 0
    buffer_load_dwordx4 v6, s[8:11], s46 offen offset:0 nt lds
    s_add_u32 m0, s52, 102176
    s_nop 0
    buffer_load_dwordx4 v6, s[8:11], s46 offen offset:256 nt lds
    s_mov_b32 s46, 40960
    s_add_u32 m0, s52, 109824
    s_nop 0
    buffer_load_dwordx4 v6, s[12:15], s46 offen offset:0 nt lds
    s_add_u32 m0, s52, 110624
    s_nop 0
    buffer_load_dwordx4 v6, s[12:15], s46 offen offset:256 nt lds
    s_mov_b32 s46, 65536
    s_add_u32 m0, s52, 118272
    s_nop 0
    buffer_load_dwordx4 v6, s[8:11], s46 offen offset:0 nt lds
    s_add_u32 m0, s52, 119072
    s_nop 0
    buffer_load_dwordx4 v6, s[8:11], s46 offen offset:256 nt lds
    s_mov_b32 s46, 49152
    s_add_u32 m0, s52, 126720
    s_nop 0
    buffer_load_dwordx4 v6, s[12:15], s46 offen offset:0 nt lds
    s_add_u32 m0, s52, 127520
    s_nop 0
    buffer_load_dwordx4 v6, s[12:15], s46 offen offset:256 nt lds
    s_mov_b32 s46, 73728
    s_add_u32 m0, s52, 135168
    s_nop 0
    buffer_load_dwordx4 v6, s[8:11], s46 offen offset:0 nt lds
    s_add_u32 m0, s52, 135968
    s_nop 0
    buffer_load_dwordx4 v6, s[8:11], s46 offen offset:256 nt lds
    s_mov_b32 s46, 57344
    s_add_u32 m0, s52, 143616
    s_nop 0
    buffer_load_dwordx4 v6, s[12:15], s46 offen offset:0 nt lds
    s_add_u32 m0, s52, 144416
    s_nop 0
    buffer_load_dwordx4 v6, s[12:15], s46 offen offset:256 nt lds
    v_and_b32 v26, 31, v1
    v_lshlrev_b32 v26, 3, v26
    s_lshl_b32 s62, s35, 8
    s_add_u32 s62, s62, 23101440
    buffer_load_dwordx2 v[24:25], v26, s[28:31], s62 offen sc1
    s_lshr_b32 s65, s44, 2
    s_lshl_b32 s65, s65, 5
    s_lshl_b32 s64, s45, 3
    s_add_u32 s65, s65, s64
    s_lshl_b32 s64, s34, 1
    s_add_u32 s65, s65, s64
    s_lshl_b32 s65, s65, 4
    s_add_u32 s65, s65, 23068672
    v_and_b32 v30, 3, v1
    v_lshlrev_b32 v30, 3, v30
    s_mov_b32 s62, 0
Lws_w:
    buffer_load_dwordx2 v[28:29], v30, s[28:31], s65 offen sc1
    s_add_u32 s62, s62, 1
    s_cmp_ge_u32 s62, 2097152
    s_cbranch_scc1 Lws_wx
    s_waitcnt vmcnt(0)
    v_cmp_ne_u64 vcc, s[40:41], v[28:29]
    s_cbranch_vccnz Lws_w
Lws_wx:
    s_waitcnt vmcnt(0)
    s_sub_u32 s62, s43, 4194304
    s_add_u32 s63, s62, 4096
    buffer_load_dwordx4 v[96:99], v15, s[28:31], s62 offen offset:0 sc1
    buffer_load_dwordx4 v[100:103], v15, s[28:31], s62 offen offset:1024 sc1
    buffer_load_dwordx4 v[104:107], v15, s[28:31], s62 offen offset:2048 sc1
    buffer_load_dwordx4 v[108:111], v15, s[28:31], s62 offen offset:3072 sc1
    buffer_load_dwordx4 v[112:115], v15, s[28:31], s63 offen offset:0 sc1
    buffer_load_dwordx4 v[116:119], v15, s[28:31], s63 offen offset:1024 sc1
    buffer_load_dwordx4 v[120:123], v15, s[28:31], s63 offen offset:2048 sc1
    buffer_load_dwordx4 v[124:127], v15, s[28:31], s63 offen offset:3072 sc1
    v_cmp_ne_u32 vcc, s40, v24
    v_cmp_ne_u32 s[62:63], s3, v25
    s_nop 0
    s_or_b64 s[62:63], s[62:63], vcc
    s_cselect_b32 s39, 0, 1
    v_mov_b32 v24, 0
    v_mov_b32 v25, 0
    v_mov_b32 v26, 0
    s_mov_b32 s10, 270336
    s_mov_b32 s14, 270336
    s_waitcnt vmcnt(0)
    s_barrier
    ds_read_b128 v[192:195], v2 offset:0
    ds_read_b128 v[196:199], v2 offset:512
    ds_read_b128 v[200:203], v2 offset:64
    ds_read_b128 v[204:207], v2 offset:576
    ds_read_b128 v[208:211], v2 offset:128
    ds_read_b128 v[212:215], v2 offset:640
    ds_read_b128 v[216:219], v2 offset:192
    ds_read_b128 v[220:223], v2 offset:704
    s_mov_b32 s62, 81920
    buffer_load_dword v9, v7, s[8:11], s62 offen
    s_mov_b32 s62, 65536
    buffer_load_dword v9, v7, s[12:15], s62 offen
    s_waitcnt lgkmcnt(7)
    v_mfma_f32_16x16x32_bf16 v[128:131], v[192:195], v[96:99], v[160:163]
    v_mfma_f32_16x16x32_bf16 v[136:139], v[192:195], v[112:115], v[164:167]
    ds_read_b128 v[192:195], v2 offset:8448
    s_waitcnt lgkmcnt(7)
    v_mfma_f32_16x16x32_bf16 v[132:135], v[196:199], v[96:99], v[160:163]
    v_mfma_f32_16x16x32_bf16 v[140:143], v[196:199], v[112:115], v[164:167]
    ds_read_b128 v[196:199], v2 offset:8960
    s_waitcnt lgkmcnt(7)
    v_mfma_f32_16x16x32_bf16 v[128:131], v[200:203], v[100:103], v[128:131]
    v_mfma_f32_16x16x32_bf16 v[136:139], v[200:203], v[116:119], v[136:139]
    ds_read_b128 v[200:203], v2 offset:8512
    s_waitcnt lgkmcnt(7)
    v_mfma_f32_16x16x32_bf16 v[132:135], v[204:207], v[100:103], v[132:135]
    v_mfma_f32_16x16x32_bf16 v[140:143], v[204:207], v[116:119], v[140:143]
    ds_read_b128 v[204:207], v2 offset:9024
    s_waitcnt lgkmcnt(7)
    v_mfma_f32_16x16x32_bf16 v[128:131], v[208:211], v[104:107], v[128:131]
    v_mfma_f32_16x16x32_bf16 v[136:139], v[208:211], v[120:123], v[136:139]
    ds_read_b128 v[208:211], v2 offset:8576
    s_waitcnt lgkmcnt(7)
    v_mfma_f32_16x16x32_bf16 v[132:135], v[212:215], v[104:107], v[132:135]
    v_mfma_f32_16x16x32_bf16 v[140:143], v[212:215], v[120:123], v[140:143]
    ds_read_b128 v[212:215], v2 offset:9088
    s_waitcnt lgkmcnt(7)
    v_mfma_f32_16x16x32_bf16 v[128:131], v[216:219], v[108:111], v[128:131]
    v_mfma_f32_16x16x32_bf16 v[136:139], v[216:219], v[124:127], v[136:139]
    ds_read_b128 v[216:219], v2 offset:8640
    s_waitcnt lgkmcnt(7)
    v_mfma_f32_16x16x32_bf16 v[132:135], v[220:223], v[108:111], v[132:135]
    v_mfma_f32_16x16x32_bf16 v[140:143], v[220:223], v[124:127], v[140:143]
    ds_read_b128 v[220:223], v2 offset:9152
    s_nop 5
    s_waitcnt vmcnt(38) lgkmcnt(0)
    s_barrier
    v_mfma_f32_16x16x32_bf16 v[144:147], v[192:195], v[96:99], v[160:163]
    v_mfma_f32_16x16x32_bf16 v[152:155], v[192:195], v[112:115], v[164:167]
    v_mfma_f32_16x16x32_bf16 v[148:151], v[196:199], v[96:99], v[160:163]
    v_mfma_f32_16x16x32_bf16 v[156:159], v[196:199], v[112:115], v[164:167]
    v_mfma_f32_16x16x32_bf16 v[144:147], v[200:203], v[100:103], v[144:147]
    v_mfma_f32_16x16x32_bf16 v[152:155], v[200:203], v[116:119], v[152:155]
    v_mfma_f32_16x16x32_bf16 v[148:151], v[204:207], v[100:103], v[148:151]
    v_mfma_f32_16x16x32_bf16 v[156:159], v[204:207], v[116:119], v[156:159]
    v_mfma_f32_16x16x32_bf16 v[144:147], v[208:211], v[104:107], v[144:147]
    ds_read_b64_tr_b16 v[224:225], v16 offset:16896
    ds_read_b64_tr_b16 v[226:227], v16 offset:17408
    ds_read_b64_tr_b16 v[228:229], v16 offset:16928
    ds_read_b64_tr_b16 v[230:231], v16 offset:17440
    v_mfma_f32_16x16x32_bf16 v[152:155], v[208:211], v[120:123], v[152:155]
    ds_read_b64_tr_b16 v[232:233], v16 offset:16960
    ds_read_b64_tr_b16 v[234:235], v16 offset:17472
    ds_read_b64_tr_b16 v[236:237], v16 offset:16992
    ds_read_b64_tr_b16 v[238:239], v16 offset:17504
    v_mfma_f32_16x16x32_bf16 v[148:151], v[212:215], v[104:107], v[148:151]
    ds_read_b64_tr_b16 v[240:241], v16 offset:17024
    ds_read_b64_tr_b16 v[242:243], v16 offset:17536
    ds_read_b64_tr_b16 v[244:245], v16 offset:17056
    ds_read_b64_tr_b16 v[246:247], v16 offset:17568
    v_exp_f32 v21, v137
    v_add_f32 v168, v168, v27
    v_cvt_pk_bf16_f32 v179, v26, v27
    v_exp_f32 v22, v138
    v_add_f32 v169, v171, v20
    v_exp_f32 v23, v139
    v_add_f32 v169, v169, v21
    v_mfma_f32_16x16x32_bf16 v[156:159], v[212:215], v[120:123], v[156:159]
    ds_read_b64_tr_b16 v[248:249], v16 offset:17088
    ds_read_b64_tr_b16 v[250:251], v16 offset:17600
    ds_read_b64_tr_b16 v[252:253], v16 offset:17120
    ds_read_b64_tr_b16 v[254:255], v16 offset:17632
    v_cvt_pk_bf16_f32 v180, v20, v21
    v_exp_f32 v24, v140
    v_add_f32 v169, v169, v22
    v_exp_f32 v25, v141
    v_add_f32 v169, v169, v23
    v_cvt_pk_bf16_f32 v181, v22, v23
    v_exp_f32 v26, v142
    v_mfma_f32_16x16x32_bf16 v[144:147], v[216:219], v[108:111], v[144:147]
    v_add_f32 v169, v169, v24
    v_exp_f32 v27, v143
    v_add_f32 v169, v169, v25
    v_cvt_pk_bf16_f32 v182, v24, v25
    v_add_f32 v169, v169, v26
    v_add_f32 v169, v169, v27
    v_cvt_pk_bf16_f32 v183, v26, v27
    v_mfma_f32_16x16x32_bf16 v[152:155], v[216:219], v[124:127], v[152:155]
    v_max_f32 v30, v168, v169
    v_cmp_lt_f32 vcc, s49, v30
    v_mfma_f32_16x16x32_bf16 v[148:151], v[220:223], v[108:111], v[148:151]
    s_cbranch_vccnz LS_r0
LS_b0:
    v_mfma_f32_16x16x32_bf16 v[156:159], v[220:223], v[124:127], v[156:159]
    s_waitcnt lgkmcnt(0)
    v_mfma_f32_16x16x32_bf16 v[32:35], v[224:227], v[176:179], 0
    ds_read_b128 v[192:195], v2 offset:16896
    ds_read_b128 v[196:199], v2 offset:17408
    v_mfma_f32_16x16x32_bf16 v[64:67], v[224:227], v[180:183], 0
    ds_read_b128 v[200:203], v2 offset:16960
    ds_read_b128 v[204:207], v2 offset:17472
    v_mfma_f32_16x16x32_bf16 v[36:39], v[228:231], v[176:179], 0
    ds_read_b128 v[208:211], v2 offset:17024
    ds_read_b128 v[212:215], v2 offset:17536
    v_mfma_f32_16x16x32_bf16 v[68:71], v[228:231], v[180:183], 0
    ds_read_b128 v[216:219], v2 offset:17088
    ds_read_b128 v[220:223], v2 offset:17600
    v_mfma_f32_16x16x32_bf16 v[40:43], v[232:235], v[176:179], 0
    v_mfma_f32_16x16x32_bf16 v[72:75], v[232:235], v[180:183], 0
    v_mfma_f32_16x16x32_bf16 v[44:47], v[236:239], v[176:179], 0
    v_mfma_f32_16x16x32_bf16 v[76:79], v[236:239], v[180:183], 0
    v_mfma_f32_16x16x32_bf16 v[48:51], v[240:243], v[176:179], 0
    v_mfma_f32_16x16x32_bf16 v[80:83], v[240:243], v[180:183], 0
    v_mfma_f32_16x16x32_bf16 v[52:55], v[244:247], v[176:179], 0
    v_mfma_f32_16x16x32_bf16 v[84:87], v[244:247], v[180:183], 0
    v_mfma_f32_16x16x32_bf16 v[56:59], v[248:251], v[176:179], 0
    v_mfma_f32_16x16x32_bf16 v[88:91], v[248:251], v[180:183], 0
    v_mfma_f32_16x16x32_bf16 v[60:63], v[252:255], v[176:179], 0
    v_exp_f32 v20, v144
    v_exp_f32 v21, v145
    v_exp_f32 v22, v146
    v_add_f32 v170, v168, v20
    v_exp_f32 v23, v147
    v_add_f32 v170, v170, v21
    v_cvt_pk_bf16_f32 v184, v20, v21
    v_exp_f32 v24, v148
    v_add_f32 v170, v170, v22
    v_exp_f32 v25, v149
    v_mfma_f32_16x16x32_bf16 v[92:95], v[252:255], v[180:183], 0
    v_add_f32 v170, v170, v23
    v_cvt_pk_bf16_f32 v185, v22, v23
    v_exp_f32 v26, v150
    v_add_f32 v170, v170, v24
    v_exp_f32 v27, v151
    v_add_f32 v170, v170, v25
    v_cvt_pk_bf16_f32 v186, v24, v25
    v_exp_f32 v20, v152
    v_add_f32 v170, v170, v26
    s_waitcnt vmcnt(34) lgkmcnt(0)
    s_barrier
    v_mfma_f32_16x16x32_bf16 v[128:131], v[192:195], v[96:99], v[160:163]
    v_mfma_f32_16x16x32_bf16 v[136:139], v[192:195], v[112:115], v[164:167]
    v_mfma_f32_16x16x32_bf16 v[132:135], v[196:199], v[96:99], v[160:163]
    v_mfma_f32_16x16x32_bf16 v[140:143], v[196:199], v[112:115], v[164:167]
    v_mfma_f32_16x16x32_bf16 v[128:131], v[200:203], v[100:103], v[128:131]
    v_mfma_f32_16x16x32_bf16 v[136:139], v[200:203], v[116:119], v[136:139]
    v_mfma_f32_16x16x32_bf16 v[132:135], v[204:207], v[100:103], v[132:135]
    v_mfma_f32_16x16x32_bf16 v[140:143], v[204:207], v[116:119], v[140:143]
    v_mfma_f32_16x16x32_bf16 v[128:131], v[208:211], v[104:107], v[128:131]
    ds_read_b64_tr_b16 v[224:225], v16 offset:33792
    ds_read_b64_tr_b16 v[226:227], v16 offset:34304
    ds_read_b64_tr_b16 v[228:229], v16 offset:33824
    ds_read_b64_tr_b16 v[230:231], v16 offset:34336
    v_mfma_f32_16x16x32_bf16 v[136:139], v[208:211], v[120:123], v[136:139]
    ds_read_b64_tr_b16 v[232:233], v16 offset:33856
    ds_read_b64_tr_b16 v[234:235], v16 offset:34368
    ds_read_b64_tr_b16 v[236:237], v16 offset:33888
    ds_read_b64_tr_b16 v[238:239], v16 offset:34400
    v_mfma_f32_16x16x32_bf16 v[132:135], v[212:215], v[104:107], v[132:135]
    ds_read_b64_tr_b16 v[240:241], v16 offset:33920
    ds_read_b64_tr_b16 v[242:243], v16 offset:34432
    ds_read_b64_tr_b16 v[244:245], v16 offset:33952
    ds_read_b64_tr_b16 v[246:247], v16 offset:34464
    v_exp_f32 v21, v153
    v_add_f32 v170, v170, v27
    v_cvt_pk_bf16_f32 v187, v26, v27
    v_exp_f32 v22, v154
    v_add_f32 v171, v169, v20
    v_exp_f32 v23, v155
    v_add_f32 v171, v171, v21
    v_mfma_f32_16x16x32_bf16 v[140:143], v[212:215], v[120:123], v[140:143]
    ds_read_b64_tr_b16 v[248:249], v16 offset:33984
    ds_read_b64_tr_b16 v[250:251], v16 offset:34496
    ds_read_b64_tr_b16 v[252:253], v16 offset:34016
    ds_read_b64_tr_b16 v[254:255], v16 offset:34528
    v_cvt_pk_bf16_f32 v188, v20, v21
    v_exp_f32 v24, v156
    v_add_f32 v171, v171, v22
    v_exp_f32 v25, v157
    v_add_f32 v171, v171, v23
    v_cvt_pk_bf16_f32 v189, v22, v23
    v_exp_f32 v26, v158
    v_mfma_f32_16x16x32_bf16 v[128:131], v[216:219], v[108:111], v[128:131]
    v_add_f32 v171, v171, v24
    v_exp_f32 v27, v159
    v_add_f32 v171, v171, v25
    v_cvt_pk_bf16_f32 v190, v24, v25
    v_add_f32 v171, v171, v26
    v_add_f32 v171, v171, v27
    v_cvt_pk_bf16_f32 v191, v26, v27
    v_mfma_f32_16x16x32_bf16 v[136:139], v[216:219], v[124:127], v[136:139]
    v_max_f32 v30, v170, v171
    v_cmp_lt_f32 vcc, s49, v30
    v_mfma_f32_16x16x32_bf16 v[132:135], v[220:223], v[108:111], v[132:135]
    s_cbranch_vccnz LS_r1
LS_b1:
    v_mfma_f32_16x16x32_bf16 v[140:143], v[220:223], v[124:127], v[140:143]
    s_waitcnt lgkmcnt(0)
    v_mfma_f32_16x16x32_bf16 v[32:35], v[224:227], v[184:187], v[32:35]
    ds_read_b128 v[192:195], v2 offset:33792
    ds_read_b128 v[196:199], v2 offset:34304
    v_mfma_f32_16x16x32_bf16 v[64:67], v[224:227], v[188:191], v[64:67]
    ds_read_b128 v[200:203], v2 offset:33856
    ds_read_b128 v[204:207], v2 offset:34368
    v_mfma_f32_16x16x32_bf16 v[36:39], v[228:231], v[184:187], v[36:39]
    ds_read_b128 v[208:211], v2 offset:33920
    ds_read_b128 v[212:215], v2 offset:34432
    v_mfma_f32_16x16x32_bf16 v[68:71], v[228:231], v[188:191], v[68:71]
    ds_read_b128 v[216:219], v2 offset:33984
    ds_read_b128 v[220:223], v2 offset:34496
    v_mfma_f32_16x16x32_bf16 v[40:43], v[232:235], v[184:187], v[40:43]
    v_mfma_f32_16x16x32_bf16 v[72:75], v[232:235], v[188:191], v[72:75]
    v_mfma_f32_16x16x32_bf16 v[44:47], v[236:239], v[184:187], v[44:47]
    v_mfma_f32_16x16x32_bf16 v[76:79], v[236:239], v[188:191], v[76:79]
    v_mfma_f32_16x16x32_bf16 v[48:51], v[240:243], v[184:187], v[48:51]
    v_mfma_f32_16x16x32_bf16 v[80:83], v[240:243], v[188:191], v[80:83]
    v_mfma_f32_16x16x32_bf16 v[52:55], v[244:247], v[184:187], v[52:55]
    v_mfma_f32_16x16x32_bf16 v[84:87], v[244:247], v[188:191], v[84:87]
    v_mfma_f32_16x16x32_bf16 v[56:59], v[248:251], v[184:187], v[56:59]
    v_mfma_f32_16x16x32_bf16 v[88:91], v[248:251], v[188:191], v[88:91]
    v_mfma_f32_16x16x32_bf16 v[60:63], v[252:255], v[184:187], v[60:63]
    v_exp_f32 v20, v128
    v_exp_f32 v21, v129
    v_exp_f32 v22, v130
    v_add_f32 v168, v170, v20
    v_exp_f32 v23, v131
    v_add_f32 v168, v168, v21
    v_cvt_pk_bf16_f32 v176, v20, v21
    v_exp_f32 v24, v132
    v_add_f32 v168, v168, v22
    v_exp_f32 v25, v133
    v_mfma_f32_16x16x32_bf16 v[92:95], v[252:255], v[188:191], v[92:95]
    global_load_dword v9, v8, s[0:1]
    v_add_f32 v168, v168, v23
    v_cvt_pk_bf16_f32 v177, v22, v23
    v_exp_f32 v26, v134
    v_add_f32 v168, v168, v24
    v_exp_f32 v27, v135
    v_add_f32 v168, v168, v25
    v_cvt_pk_bf16_f32 v178, v24, v25
    v_exp_f32 v20, v136
    v_add_f32 v168, v168, v26
    s_waitcnt vmcnt(31) lgkmcnt(0)
    s_barrier
    v_mfma_f32_16x16x32_bf16 v[144:147], v[192:195], v[96:99], v[160:163]
    s_mov_b32 s46, 81920
    s_add_u32 m0, s52, 0
    v_mfma_f32_16x16x32_bf16 v[152:155], v[192:195], v[112:115], v[164:167]
    buffer_load_dwordx4 v6, s[8:11], s46 offen offset:0 nt lds
    v_mfma_f32_16x16x32_bf16 v[148:151], v[196:199], v[96:99], v[160:163]
    s_add_u32 m0, s52, 800
    v_mfma_f32_16x16x32_bf16 v[156:159], v[196:199], v[112:115], v[164:167]
    buffer_load_dwordx4 v6, s[8:11], s46 offen offset:256 nt lds
    v_mfma_f32_16x16x32_bf16 v[144:147], v[200:203], v[100:103], v[144:147]
    s_mov_b32 s46, 65536
    s_add_u32 m0, s52, 8448
    v_mfma_f32_16x16x32_bf16 v[152:155], v[200:203], v[116:119], v[152:155]
    buffer_load_dwordx4 v6, s[12:15], s46 offen offset:0 nt lds
    v_mfma_f32_16x16x32_bf16 v[148:151], v[204:207], v[100:103], v[148:151]
    s_add_u32 m0, s52, 9248
    v_mfma_f32_16x16x32_bf16 v[156:159], v[204:207], v[116:119], v[156:159]
    buffer_load_dwordx4 v6, s[12:15], s46 offen offset:256 nt lds
    v_mfma_f32_16x16x32_bf16 v[144:147], v[208:211], v[104:107], v[144:147]
    ds_read_b64_tr_b16 v[224:225], v17 offset:0
    ds_read_b64_tr_b16 v[226:227], v17 offset:512
    ds_read_b64_tr_b16 v[228:229], v17 offset:32
    ds_read_b64_tr_b16 v[230:231], v17 offset:544
    v_mfma_f32_16x16x32_bf16 v[152:155], v[208:211], v[120:123], v[152:155]
    ds_read_b64_tr_b16 v[232:233], v17 offset:64
    ds_read_b64_tr_b16 v[234:235], v17 offset:576
    ds_read_b64_tr_b16 v[236:237], v17 offset:96
    ds_read_b64_tr_b16 v[238:239], v17 offset:608
    v_mfma_f32_16x16x32_bf16 v[148:151], v[212:215], v[104:107], v[148:151]
    ds_read_b64_tr_b16 v[240:241], v17 offset:128
    ds_read_b64_tr_b16 v[242:243], v17 offset:640
    ds_read_b64_tr_b16 v[244:245], v17 offset:160
    ds_read_b64_tr_b16 v[246:247], v17 offset:672
    v_exp_f32 v21, v137
    v_add_f32 v168, v168, v27
    v_cvt_pk_bf16_f32 v179, v26, v27
    v_exp_f32 v22, v138
    v_add_f32 v169, v171, v20
    v_exp_f32 v23, v139
    v_add_f32 v169, v169, v21
    v_mfma_f32_16x16x32_bf16 v[156:159], v[212:215], v[120:123], v[156:159]
    ds_read_b64_tr_b16 v[248:249], v17 offset:192
    ds_read_b64_tr_b16 v[250:251], v17 offset:704
    ds_read_b64_tr_b16 v[252:253], v17 offset:224
    ds_read_b64_tr_b16 v[254:255], v17 offset:736
    v_cvt_pk_bf16_f32 v180, v20, v21
    v_exp_f32 v24, v140
    v_add_f32 v169, v169, v22
    v_exp_f32 v25, v141
    v_add_f32 v169, v169, v23
    v_cvt_pk_bf16_f32 v181, v22, v23
    v_exp_f32 v26, v142
    v_mfma_f32_16x16x32_bf16 v[144:147], v[216:219], v[108:111], v[144:147]
    v_add_f32 v169, v169, v24
    v_exp_f32 v27, v143
    v_add_f32 v169, v169, v25
    v_cvt_pk_bf16_f32 v182, v24, v25
    v_add_f32 v169, v169, v26
    v_add_f32 v169, v169, v27
    v_cvt_pk_bf16_f32 v183, v26, v27
    v_mfma_f32_16x16x32_bf16 v[152:155], v[216:219], v[124:127], v[152:155]
    v_max_f32 v30, v168, v169
    v_cmp_lt_f32 vcc, s49, v30
    v_mfma_f32_16x16x32_bf16 v[148:151], v[220:223], v[108:111], v[148:151]
    s_cbranch_vccnz LS_r2
LS_b2:
    v_mfma_f32_16x16x32_bf16 v[156:159], v[220:223], v[124:127], v[156:159]
    s_waitcnt lgkmcnt(0)
    v_mfma_f32_16x16x32_bf16 v[32:35], v[224:227], v[176:179], v[32:35]
    ds_read_b128 v[192:195], v3 offset:0
    ds_read_b128 v[196:199], v3 offset:512
    v_mfma_f32_16x16x32_bf16 v[64:67], v[224:227], v[180:183], v[64:67]
    ds_read_b128 v[200:203], v3 offset:64
    ds_read_b128 v[204:207], v3 offset:576
    v_mfma_f32_16x16x32_bf16 v[36:39], v[228:231], v[176:179], v[36:39]
    ds_read_b128 v[208:211], v3 offset:128
    ds_read_b128 v[212:215], v3 offset:640
    v_mfma_f32_16x16x32_bf16 v[68:71], v[228:231], v[180:183], v[68:71]
    ds_read_b128 v[216:219], v3 offset:192
    ds_read_b128 v[220:223], v3 offset:704
    v_mfma_f32_16x16x32_bf16 v[40:43], v[232:235], v[176:179], v[40:43]
    v_mfma_f32_16x16x32_bf16 v[72:75], v[232:235], v[180:183], v[72:75]
    v_mfma_f32_16x16x32_bf16 v[44:47], v[236:239], v[176:179], v[44:47]
    v_mfma_f32_16x16x32_bf16 v[76:79], v[236:239], v[180:183], v[76:79]
    v_mfma_f32_16x16x32_bf16 v[48:51], v[240:243], v[176:179], v[48:51]
    v_mfma_f32_16x16x32_bf16 v[80:83], v[240:243], v[180:183], v[80:83]
    v_mfma_f32_16x16x32_bf16 v[52:55], v[244:247], v[176:179], v[52:55]
    v_mfma_f32_16x16x32_bf16 v[84:87], v[244:247], v[180:183], v[84:87]
    v_mfma_f32_16x16x32_bf16 v[56:59], v[248:251], v[176:179], v[56:59]
    v_mfma_f32_16x16x32_bf16 v[88:91], v[248:251], v[180:183], v[88:91]
    v_mfma_f32_16x16x32_bf16 v[60:63], v[252:255], v[176:179], v[60:63]
    v_exp_f32 v20, v144
    v_exp_f32 v21, v145
    v_exp_f32 v22, v146
    v_add_f32 v170, v168, v20
    v_exp_f32 v23, v147
    v_add_f32 v170, v170, v21
    v_cvt_pk_bf16_f32 v184, v20, v21
    v_exp_f32 v24, v148
    v_add_f32 v170, v170, v22
    v_exp_f32 v25, v149
    v_mfma_f32_16x16x32_bf16 v[92:95], v[252:255], v[180:183], v[92:95]
    v_add_f32 v170, v170, v23
    v_cvt_pk_bf16_f32 v185, v22, v23
    v_exp_f32 v26, v150
    v_add_f32 v170, v170, v24
    v_exp_f32 v27, v151
    v_add_f32 v170, v170, v25
    v_cvt_pk_bf16_f32 v186, v24, v25
    v_exp_f32 v20, v152
    v_add_f32 v170, v170, v26
    s_waitcnt vmcnt(31) lgkmcnt(0)
    s_barrier
    v_mfma_f32_16x16x32_bf16 v[128:131], v[192:195], v[96:99], v[160:163]
    s_mov_b32 s46, 90112
    s_add_u32 m0, s52, 16896
    v_mfma_f32_16x16x32_bf16 v[136:139], v[192:195], v[112:115], v[164:167]
    buffer_load_dwordx4 v6, s[8:11], s46 offen offset:0 nt lds
    v_mfma_f32_16x16x32_bf16 v[132:135], v[196:199], v[96:99], v[160:163]
    s_add_u32 m0, s52, 17696
    v_mfma_f32_16x16x32_bf16 v[140:143], v[196:199], v[112:115], v[164:167]
    buffer_load_dwordx4 v6, s[8:11], s46 offen offset:256 nt lds
    v_mfma_f32_16x16x32_bf16 v[128:131], v[200:203], v[100:103], v[128:131]
    s_mov_b32 s46, 73728
    s_add_u32 m0, s52, 25344
    v_mfma_f32_16x16x32_bf16 v[136:139], v[200:203], v[116:119], v[136:139]
    buffer_load_dwordx4 v6, s[12:15], s46 offen offset:0 nt lds
    v_mfma_f32_16x16x32_bf16 v[132:135], v[204:207], v[100:103], v[132:135]
    s_add_u32 m0, s52, 26144
    v_mfma_f32_16x16x32_bf16 v[140:143], v[204:207], v[116:119], v[140:143]
    buffer_load_dwordx4 v6, s[12:15], s46 offen offset:256 nt lds
    v_mfma_f32_16x16x32_bf16 v[128:131], v[208:211], v[104:107], v[128:131]
    ds_read_b64_tr_b16 v[224:225], v17 offset:16896
    ds_read_b64_tr_b16 v[226:227], v17 offset:17408
    ds_read_b64_tr_b16 v[228:229], v17 offset:16928
    ds_read_b64_tr_b16 v[230:231], v17 offset:17440
    v_mfma_f32_16x16x32_bf16 v[136:139], v[208:211], v[120:123], v[136:139]
    ds_read_b64_tr_b16 v[232:233], v17 offset:16960
    ds_read_b64_tr_b16 v[234:235], v17 offset:17472
    ds_read_b64_tr_b16 v[236:237], v17 offset:16992
    ds_read_b64_tr_b16 v[238:239], v17 offset:17504
    v_mfma_f32_16x16x32_bf16 v[132:135], v[212:215], v[104:107], v[132:135]
    ds_read_b64_tr_b16 v[240:241], v17 offset:17024
    ds_read_b64_tr_b16 v[242:243], v17 offset:17536
    ds_read_b64_tr_b16 v[244:245], v17 offset:17056
    ds_read_b64_tr_b16 v[246:247], v17 offset:17568
    v_exp_f32 v21, v153
    v_add_f32 v170, v170, v27
    v_cvt_pk_bf16_f32 v187, v26, v27
    v_exp_f32 v22, v154
    v_add_f32 v171, v169, v20
    v_exp_f32 v23, v155
    v_add_f32 v171, v171, v21
    v_mfma_f32_16x16x32_bf16 v[140:143], v[212:215], v[120:123], v[140:143]
    ds_read_b64_tr_b16 v[248:249], v17 offset:17088
    ds_read_b64_tr_b16 v[250:251], v17 offset:17600
    ds_read_b64_tr_b16 v[252:253], v17 offset:17120
    ds_read_b64_tr_b16 v[254:255], v17 offset:17632
    v_cvt_pk_bf16_f32 v188, v20, v21
    v_exp_f32 v24, v156
    v_add_f32 v171, v171, v22
    v_exp_f32 v25, v157
    v_add_f32 v171, v171, v23
    v_cvt_pk_bf16_f32 v189, v22, v23
    v_exp_f32 v26, v158
    v_mfma_f32_16x16x32_bf16 v[128:131], v[216:219], v[108:111], v[128:131]
    v_add_f32 v171, v171, v24
    v_exp_f32 v27, v159
    v_add_f32 v171, v171, v25
    v_cvt_pk_bf16_f32 v190, v24, v25
    v_add_f32 v171, v171, v26
    v_add_f32 v171, v171, v27
    v_cvt_pk_bf16_f32 v191, v26, v27
    v_mfma_f32_16x16x32_bf16 v[136:139], v[216:219], v[124:127], v[136:139]
    v_max_f32 v30, v170, v171
    v_cmp_lt_f32 vcc, s49, v30
    v_mfma_f32_16x16x32_bf16 v[132:135], v[220:223], v[108:111], v[132:135]
    s_cbranch_vccnz LS_r3
LS_b3:
    v_mfma_f32_16x16x32_bf16 v[140:143], v[220:223], v[124:127], v[140:143]
    s_waitcnt lgkmcnt(0)
    v_mfma_f32_16x16x32_bf16 v[32:35], v[224:227], v[184:187], v[32:35]
    ds_read_b128 v[192:195], v3 offset:16896
    ds_read_b128 v[196:199], v3 offset:17408
    v_mfma_f32_16x16x32_bf16 v[64:67], v[224:227], v[188:191], v[64:67]
    ds_read_b128 v[200:203], v3 offset:16960
    ds_read_b128 v[204:207], v3 offset:17472
    v_mfma_f32_16x16x32_bf16 v[36:39], v[228:231], v[184:187], v[36:39]
    ds_read_b128 v[208:211], v3 offset:17024
    ds_read_b128 v[212:215], v3 offset:17536
    v_mfma_f32_16x16x32_bf16 v[68:71], v[228:231], v[188:191], v[68:71]
    ds_read_b128 v[216:219], v3 offset:17088
    ds_read_b128 v[220:223], v3 offset:17600
    v_mfma_f32_16x16x32_bf16 v[40:43], v[232:235], v[184:187], v[40:43]
    v_mfma_f32_16x16x32_bf16 v[72:75], v[232:235], v[188:191], v[72:75]
    v_mfma_f32_16x16x32_bf16 v[44:47], v[236:239], v[184:187], v[44:47]
    v_mfma_f32_16x16x32_bf16 v[76:79], v[236:239], v[188:191], v[76:79]
    v_mfma_f32_16x16x32_bf16 v[48:51], v[240:243], v[184:187], v[48:51]
    v_mfma_f32_16x16x32_bf16 v[80:83], v[240:243], v[188:191], v[80:83]
    v_mfma_f32_16x16x32_bf16 v[52:55], v[244:247], v[184:187], v[52:55]
    v_mfma_f32_16x16x32_bf16 v[84:87], v[244:247], v[188:191], v[84:87]
    v_mfma_f32_16x16x32_bf16 v[56:59], v[248:251], v[184:187], v[56:59]
    v_mfma_f32_16x16x32_bf16 v[88:91], v[248:251], v[188:191], v[88:91]
    v_mfma_f32_16x16x32_bf16 v[60:63], v[252:255], v[184:187], v[60:63]
    v_exp_f32 v20, v128
    v_exp_f32 v21, v129
    v_exp_f32 v22, v130
    v_add_f32 v168, v170, v20
    v_exp_f32 v23, v131
    v_add_f32 v168, v168, v21
    v_cvt_pk_bf16_f32 v176, v20, v21
    v_exp_f32 v24, v132
    v_add_f32 v168, v168, v22
    v_exp_f32 v25, v133
    v_mfma_f32_16x16x32_bf16 v[92:95], v[252:255], v[188:191], v[92:95]
    v_add_f32 v168, v168, v23
    v_cvt_pk_bf16_f32 v177, v22, v23
    v_exp_f32 v26, v134
    v_add_f32 v168, v168, v24
    v_exp_f32 v27, v135
    v_add_f32 v168, v168, v25
    v_cvt_pk_bf16_f32 v178, v24, v25
    v_exp_f32 v20, v136
    v_add_f32 v168, v168, v26
    s_waitcnt vmcnt(31) lgkmcnt(0)
    s_barrier
    v_mfma_f32_16x16x32_bf16 v[144:147], v[192:195], v[96:99], v[160:163]
    s_mov_b32 s46, 98304
    s_add_u32 m0, s52, 33792
    v_mfma_f32_16x16x32_bf16 v[152:155], v[192:195], v[112:115], v[164:167]
    buffer_load_dwordx4 v6, s[8:11], s46 offen offset:0 nt lds
    v_mfma_f32_16x16x32_bf16 v[148:151], v[196:199], v[96:99], v[160:163]
    s_add_u32 m0, s52, 34592
    v_mfma_f32_16x16x32_bf16 v[156:159], v[196:199], v[112:115], v[164:167]
    buffer_load_dwordx4 v6, s[8:11], s46 offen offset:256 nt lds
    v_mfma_f32_16x16x32_bf16 v[144:147], v[200:203], v[100:103], v[144:147]
    s_mov_b32 s46, 81920
    s_add_u32 m0, s52, 42240
    v_mfma_f32_16x16x32_bf16 v[152:155], v[200:203], v[116:119], v[152:155]
    buffer_load_dwordx4 v6, s[12:15], s46 offen offset:0 nt lds
    v_mfma_f32_16x16x32_bf16 v[148:151], v[204:207], v[100:103], v[148:151]
    s_add_u32 m0, s52, 43040
    v_mfma_f32_16x16x32_bf16 v[156:159], v[204:207], v[116:119], v[156:159]
    buffer_load_dwordx4 v6, s[12:15], s46 offen offset:256 nt lds
    v_mfma_f32_16x16x32_bf16 v[144:147], v[208:211], v[104:107], v[144:147]
    ds_read_b64_tr_b16 v[224:225], v17 offset:33792
    ds_read_b64_tr_b16 v[226:227], v17 offset:34304
    ds_read_b64_tr_b16 v[228:229], v17 offset:33824
    ds_read_b64_tr_b16 v[230:231], v17 offset:34336
    v_mfma_f32_16x16x32_bf16 v[152:155], v[208:211], v[120:123], v[152:155]
    ds_read_b64_tr_b16 v[232:233], v17 offset:33856
    ds_read_b64_tr_b16 v[234:235], v17 offset:34368
    ds_read_b64_tr_b16 v[236:237], v17 offset:33888
    ds_read_b64_tr_b16 v[238:239], v17 offset:34400
    v_mfma_f32_16x16x32_bf16 v[148:151], v[212:215], v[104:107], v[148:151]
    ds_read_b64_tr_b16 v[240:241], v17 offset:33920
    ds_read_b64_tr_b16 v[242:243], v17 offset:34432
    ds_read_b64_tr_b16 v[244:245], v17 offset:33952
    ds_read_b64_tr_b16 v[246:247], v17 offset:34464
    v_exp_f32 v21, v137
    v_add_f32 v168, v168, v27
    v_cvt_pk_bf16_f32 v179, v26, v27
    v_exp_f32 v22, v138
    v_add_f32 v169, v171, v20
    v_exp_f32 v23, v139
    v_add_f32 v169, v169, v21
    v_mfma_f32_16x16x32_bf16 v[156:159], v[212:215], v[120:123], v[156:159]
    ds_read_b64_tr_b16 v[248:249], v17 offset:33984
    ds_read_b64_tr_b16 v[250:251], v17 offset:34496
    ds_read_b64_tr_b16 v[252:253], v17 offset:34016
    ds_read_b64_tr_b16 v[254:255], v17 offset:34528
    v_cvt_pk_bf16_f32 v180, v20, v21
    v_exp_f32 v24, v140
    v_add_f32 v169, v169, v22
    v_exp_f32 v25, v141
    v_add_f32 v169, v169, v23
    v_cvt_pk_bf16_f32 v181, v22, v23
    v_exp_f32 v26, v142
    v_mfma_f32_16x16x32_bf16 v[144:147], v[216:219], v[108:111], v[144:147]
    v_add_f32 v169, v169, v24
    v_exp_f32 v27, v143
    v_add_f32 v169, v169, v25
    v_cvt_pk_bf16_f32 v182, v24, v25
    v_add_f32 v169, v169, v26
    v_add_f32 v169, v169, v27
    v_cvt_pk_bf16_f32 v183, v26, v27
    v_mfma_f32_16x16x32_bf16 v[152:155], v[216:219], v[124:127], v[152:155]
    v_max_f32 v30, v168, v169
    v_cmp_lt_f32 vcc, s49, v30
    v_mfma_f32_16x16x32_bf16 v[148:151], v[220:223], v[108:111], v[148:151]
    s_cbranch_vccnz LS_r4
LS_b4:
    v_mfma_f32_16x16x32_bf16 v[156:159], v[220:223], v[124:127], v[156:159]
    s_waitcnt lgkmcnt(0)
    v_mfma_f32_16x16x32_bf16 v[32:35], v[224:227], v[176:179], v[32:35]
    ds_read_b128 v[192:195], v3 offset:33792
    ds_read_b128 v[196:199], v3 offset:34304
    v_mfma_f32_16x16x32_bf16 v[64:67], v[224:227], v[180:183], v[64:67]
    ds_read_b128 v[200:203], v3 offset:33856
    ds_read_b128 v[204:207], v3 offset:34368
    v_mfma_f32_16x16x32_bf16 v[36:39], v[228:231], v[176:179], v[36:39]
    ds_read_b128 v[208:211], v3 offset:33920
    ds_read_b128 v[212:215], v3 offset:34432
    v_mfma_f32_16x16x32_bf16 v[68:71], v[228:231], v[180:183], v[68:71]
    ds_read_b128 v[216:219], v3 offset:33984
    ds_read_b128 v[220:223], v3 offset:34496
    v_mfma_f32_16x16x32_bf16 v[40:43], v[232:235], v[176:179], v[40:43]
    v_mfma_f32_16x16x32_bf16 v[72:75], v[232:235], v[180:183], v[72:75]
    v_mfma_f32_16x16x32_bf16 v[44:47], v[236:239], v[176:179], v[44:47]
    v_mfma_f32_16x16x32_bf16 v[76:79], v[236:239], v[180:183], v[76:79]
    v_mfma_f32_16x16x32_bf16 v[48:51], v[240:243], v[176:179], v[48:51]
    v_mfma_f32_16x16x32_bf16 v[80:83], v[240:243], v[180:183], v[80:83]
    v_mfma_f32_16x16x32_bf16 v[52:55], v[244:247], v[176:179], v[52:55]
    v_mfma_f32_16x16x32_bf16 v[84:87], v[244:247], v[180:183], v[84:87]
    v_mfma_f32_16x16x32_bf16 v[56:59], v[248:251], v[176:179], v[56:59]
    v_mfma_f32_16x16x32_bf16 v[88:91], v[248:251], v[180:183], v[88:91]
    v_mfma_f32_16x16x32_bf16 v[60:63], v[252:255], v[176:179], v[60:63]
    v_exp_f32 v20, v144
    v_exp_f32 v21, v145
    v_exp_f32 v22, v146
    v_add_f32 v170, v168, v20
    v_exp_f32 v23, v147
    v_add_f32 v170, v170, v21
    v_cvt_pk_bf16_f32 v184, v20, v21
    v_exp_f32 v24, v148
    v_add_f32 v170, v170, v22
    v_exp_f32 v25, v149
    v_mfma_f32_16x16x32_bf16 v[92:95], v[252:255], v[180:183], v[92:95]
    v_add_f32 v170, v170, v23
    v_cvt_pk_bf16_f32 v185, v22, v23
    v_exp_f32 v26, v150
    v_add_f32 v170, v170, v24
    v_exp_f32 v27, v151
    v_add_f32 v170, v170, v25
    v_cvt_pk_bf16_f32 v186, v24, v25
    v_exp_f32 v20, v152
    v_add_f32 v170, v170, v26
    s_waitcnt vmcnt(31) lgkmcnt(0)
    s_barrier
    v_mfma_f32_16x16x32_bf16 v[128:131], v[192:195], v[96:99], v[160:163]
    s_mov_b32 s46, 106496
    s_add_u32 m0, s52, 50688
    v_mfma_f32_16x16x32_bf16 v[136:139], v[192:195], v[112:115], v[164:167]
    buffer_load_dwordx4 v6, s[8:11], s46 offen offset:0 nt lds
    v_mfma_f32_16x16x32_bf16 v[132:135], v[196:199], v[96:99], v[160:163]
    s_add_u32 m0, s52, 51488
    v_mfma_f32_16x16x32_bf16 v[140:143], v[196:199], v[112:115], v[164:167]
    buffer_load_dwordx4 v6, s[8:11], s46 offen offset:256 nt lds
    v_mfma_f32_16x16x32_bf16 v[128:131], v[200:203], v[100:103], v[128:131]
    s_mov_b32 s46, 90112
    s_add_u32 m0, s52, 59136
    v_mfma_f32_16x16x32_bf16 v[136:139], v[200:203], v[116:119], v[136:139]
    buffer_load_dwordx4 v6, s[12:15], s46 offen offset:0 nt lds
    v_mfma_f32_16x16x32_bf16 v[132:135], v[204:207], v[100:103], v[132:135]
    s_add_u32 m0, s52, 59936
    v_mfma_f32_16x16x32_bf16 v[140:143], v[204:207], v[116:119], v[140:143]
    buffer_load_dwordx4 v6, s[12:15], s46 offen offset:256 nt lds
    v_mfma_f32_16x16x32_bf16 v[128:131], v[208:211], v[104:107], v[128:131]
    ds_read_b64_tr_b16 v[224:225], v18 offset:0
    ds_read_b64_tr_b16 v[226:227], v18 offset:512
    ds_read_b64_tr_b16 v[228:229], v18 offset:32
    ds_read_b64_tr_b16 v[230:231], v18 offset:544
    v_mfma_f32_16x16x32_bf16 v[136:139], v[208:211], v[120:123], v[136:139]
    ds_read_b64_tr_b16 v[232:233], v18 offset:64
    ds_read_b64_tr_b16 v[234:235], v18 offset:576
    ds_read_b64_tr_b16 v[236:237], v18 offset:96
    ds_read_b64_tr_b16 v[238:239], v18 offset:608
    v_mfma_f32_16x16x32_bf16 v[132:135], v[212:215], v[104:107], v[132:135]
    ds_read_b64_tr_b16 v[240:241], v18 offset:128
    ds_read_b64_tr_b16 v[242:243], v18 offset:640
    ds_read_b64_tr_b16 v[244:245], v18 offset:160
    ds_read_b64_tr_b16 v[246:247], v18 offset:672
    v_exp_f32 v21, v153
    v_add_f32 v170, v170, v27
    v_cvt_pk_bf16_f32 v187, v26, v27
    v_exp_f32 v22, v154
    v_add_f32 v171, v169, v20
    v_exp_f32 v23, v155
    v_add_f32 v171, v171, v21
    v_mfma_f32_16x16x32_bf16 v[140:143], v[212:215], v[120:123], v[140:143]
    ds_read_b64_tr_b16 v[248:249], v18 offset:192
    ds_read_b64_tr_b16 v[250:251], v18 offset:704
    ds_read_b64_tr_b16 v[252:253], v18 offset:224
    ds_read_b64_tr_b16 v[254:255], v18 offset:736
    v_cvt_pk_bf16_f32 v188, v20, v21
    v_exp_f32 v24, v156
    v_add_f32 v171, v171, v22
    v_exp_f32 v25, v157
    v_add_f32 v171, v171, v23
    v_cvt_pk_bf16_f32 v189, v22, v23
    v_exp_f32 v26, v158
    v_mfma_f32_16x16x32_bf16 v[128:131], v[216:219], v[108:111], v[128:131]
    v_add_f32 v171, v171, v24
    v_exp_f32 v27, v159
    v_add_f32 v171, v171, v25
    v_cvt_pk_bf16_f32 v190, v24, v25
    v_add_f32 v171, v171, v26
    v_add_f32 v171, v171, v27
    v_cvt_pk_bf16_f32 v191, v26, v27
    v_mfma_f32_16x16x32_bf16 v[136:139], v[216:219], v[124:127], v[136:139]
    v_max_f32 v30, v170, v171
    v_cmp_lt_f32 vcc, s49, v30
    v_mfma_f32_16x16x32_bf16 v[132:135], v[220:223], v[108:111], v[132:135]
    s_cbranch_vccnz LS_r5
LS_b5:
    v_mfma_f32_16x16x32_bf16 v[140:143], v[220:223], v[124:127], v[140:143]
    s_waitcnt lgkmcnt(0)
    v_mfma_f32_16x16x32_bf16 v[32:35], v[224:227], v[184:187], v[32:35]
    ds_read_b128 v[192:195], v4 offset:0
    ds_read_b128 v[196:199], v4 offset:512
    v_mfma_f32_16x16x32_bf16 v[64:67], v[224:227], v[188:191], v[64:67]
    ds_read_b128 v[200:203], v4 offset:64
    ds_read_b128 v[204:207], v4 offset:576
    v_mfma_f32_16x16x32_bf16 v[36:39], v[228:231], v[184:187], v[36:39]
    ds_read_b128 v[208:211], v4 offset:128
    ds_read_b128 v[212:215], v4 offset:640
    v_mfma_f32_16x16x32_bf16 v[68:71], v[228:231], v[188:191], v[68:71]
    ds_read_b128 v[216:219], v4 offset:192
    ds_read_b128 v[220:223], v4 offset:704
    v_mfma_f32_16x16x32_bf16 v[40:43], v[232:235], v[184:187], v[40:43]
    v_mfma_f32_16x16x32_bf16 v[72:75], v[232:235], v[188:191], v[72:75]
    v_mfma_f32_16x16x32_bf16 v[44:47], v[236:239], v[184:187], v[44:47]
    v_mfma_f32_16x16x32_bf16 v[76:79], v[236:239], v[188:191], v[76:79]
    v_mfma_f32_16x16x32_bf16 v[48:51], v[240:243], v[184:187], v[48:51]
    v_mfma_f32_16x16x32_bf16 v[80:83], v[240:243], v[188:191], v[80:83]
    v_mfma_f32_16x16x32_bf16 v[52:55], v[244:247], v[184:187], v[52:55]
    v_mfma_f32_16x16x32_bf16 v[84:87], v[244:247], v[188:191], v[84:87]
    v_mfma_f32_16x16x32_bf16 v[56:59], v[248:251], v[184:187], v[56:59]
    v_mfma_f32_16x16x32_bf16 v[88:91], v[248:251], v[188:191], v[88:91]
    v_mfma_f32_16x16x32_bf16 v[60:63], v[252:255], v[184:187], v[60:63]
    v_exp_f32 v20, v128
    v_exp_f32 v21, v129
    v_exp_f32 v22, v130
    v_add_f32 v168, v170, v20
    v_exp_f32 v23, v131
    v_add_f32 v168, v168, v21
    v_cvt_pk_bf16_f32 v176, v20, v21
    v_exp_f32 v24, v132
    v_add_f32 v168, v168, v22
    v_exp_f32 v25, v133
    v_mfma_f32_16x16x32_bf16 v[92:95], v[252:255], v[188:191], v[92:95]
    v_add_f32 v168, v168, v23
    v_cvt_pk_bf16_f32 v177, v22, v23
    v_exp_f32 v26, v134
    v_add_f32 v168, v168, v24
    v_exp_f32 v27, v135
    v_add_f32 v168, v168, v25
    v_cvt_pk_bf16_f32 v178, v24, v25
    v_exp_f32 v20, v136
    v_add_f32 v168, v168, v26
    s_waitcnt vmcnt(31) lgkmcnt(0)
    s_barrier
    v_mfma_f32_16x16x32_bf16 v[144:147], v[192:195], v[96:99], v[160:163]
    v_mfma_f32_16x16x32_bf16 v[152:155], v[192:195], v[112:115], v[164:167]
    v_mfma_f32_16x16x32_bf16 v[148:151], v[196:199], v[96:99], v[160:163]
    v_mfma_f32_16x16x32_bf16 v[156:159], v[196:199], v[112:115], v[164:167]
    v_mfma_f32_16x16x32_bf16 v[144:147], v[200:203], v[100:103], v[144:147]
    v_mfma_f32_16x16x32_bf16 v[152:155], v[200:203], v[116:119], v[152:155]
    v_mfma_f32_16x16x32_bf16 v[148:151], v[204:207], v[100:103], v[148:151]
    v_mfma_f32_16x16x32_bf16 v[156:159], v[204:207], v[116:119], v[156:159]
    v_mfma_f32_16x16x32_bf16 v[144:147], v[208:211], v[104:107], v[144:147]
    ds_read_b64_tr_b16 v[224:225], v18 offset:16896
    ds_read_b64_tr_b16 v[226:227], v18 offset:17408
    ds_read_b64_tr_b16 v[228:229], v18 offset:16928
    ds_read_b64_tr_b16 v[230:231], v18 offset:17440
    v_mfma_f32_16x16x32_bf16 v[152:155], v[208:211], v[120:123], v[152:155]
    ds_read_b64_tr_b16 v[232:233], v18 offset:16960
    ds_read_b64_tr_b16 v[234:235], v18 offset:17472
    ds_read_b64_tr_b16 v[236:237], v18 offset:16992
    ds_read_b64_tr_b16 v[238:239], v18 offset:17504
    v_mfma_f32_16x16x32_bf16 v[148:151], v[212:215], v[104:107], v[148:151]
    ds_read_b64_tr_b16 v[240:241], v18 offset:17024
    ds_read_b64_tr_b16 v[242:243], v18 offset:17536
    ds_read_b64_tr_b16 v[244:245], v18 offset:17056
    ds_read_b64_tr_b16 v[246:247], v18 offset:17568
    v_exp_f32 v21, v137
    v_add_f32 v168, v168, v27
    v_cvt_pk_bf16_f32 v179, v26, v27
    v_exp_f32 v22, v138
    v_add_f32 v169, v171, v20
    v_exp_f32 v23, v139
    v_add_f32 v169, v169, v21
    v_mfma_f32_16x16x32_bf16 v[156:159], v[212:215], v[120:123], v[156:159]
    ds_read_b64_tr_b16 v[248:249], v18 offset:17088
    ds_read_b64_tr_b16 v[250:251], v18 offset:17600
    ds_read_b64_tr_b16 v[252:253], v18 offset:17120
    ds_read_b64_tr_b16 v[254:255], v18 offset:17632
    v_cvt_pk_bf16_f32 v180, v20, v21
    v_exp_f32 v24, v140
    v_add_f32 v169, v169, v22
    v_exp_f32 v25, v141
    v_add_f32 v169, v169, v23
    v_cvt_pk_bf16_f32 v181, v22, v23
    v_exp_f32 v26, v142
    v_mfma_f32_16x16x32_bf16 v[144:147], v[216:219], v[108:111], v[144:147]
    v_add_f32 v169, v169, v24
    v_exp_f32 v27, v143
    v_add_f32 v169, v169, v25
    v_cvt_pk_bf16_f32 v182, v24, v25
    v_add_f32 v169, v169, v26
    v_add_f32 v169, v169, v27
    v_cvt_pk_bf16_f32 v183, v26, v27
    v_mfma_f32_16x16x32_bf16 v[152:155], v[216:219], v[124:127], v[152:155]
    v_max_f32 v30, v168, v169
    v_cmp_lt_f32 vcc, s49, v30
    v_mfma_f32_16x16x32_bf16 v[148:151], v[220:223], v[108:111], v[148:151]
    s_cbranch_vccnz LS_r6
LS_b6:
    v_mfma_f32_16x16x32_bf16 v[156:159], v[220:223], v[124:127], v[156:159]
    s_waitcnt lgkmcnt(0)
    v_mfma_f32_16x16x32_bf16 v[32:35], v[224:227], v[176:179], v[32:35]
    ds_read_b128 v[192:195], v4 offset:16896
    ds_read_b128 v[196:199], v4 offset:17408
    v_mfma_f32_16x16x32_bf16 v[64:67], v[224:227], v[180:183], v[64:67]
    ds_read_b128 v[200:203], v4 offset:16960
    ds_read_b128 v[204:207], v4 offset:17472
    v_mfma_f32_16x16x32_bf16 v[36:39], v[228:231], v[176:179], v[36:39]
    ds_read_b128 v[208:211], v4 offset:17024
    ds_read_b128 v[212:215], v4 offset:17536
    v_mfma_f32_16x16x32_bf16 v[68:71], v[228:231], v[180:183], v[68:71]
    ds_read_b128 v[216:219], v4 offset:17088
    ds_read_b128 v[220:223], v4 offset:17600
    v_mfma_f32_16x16x32_bf16 v[40:43], v[232:235], v[176:179], v[40:43]
    v_mfma_f32_16x16x32_bf16 v[72:75], v[232:235], v[180:183], v[72:75]
    v_mfma_f32_16x16x32_bf16 v[44:47], v[236:239], v[176:179], v[44:47]
    v_mfma_f32_16x16x32_bf16 v[76:79], v[236:239], v[180:183], v[76:79]
    v_mfma_f32_16x16x32_bf16 v[48:51], v[240:243], v[176:179], v[48:51]
    v_mfma_f32_16x16x32_bf16 v[80:83], v[240:243], v[180:183], v[80:83]
    v_mfma_f32_16x16x32_bf16 v[52:55], v[244:247], v[176:179], v[52:55]
    v_mfma_f32_16x16x32_bf16 v[84:87], v[244:247], v[180:183], v[84:87]
    v_mfma_f32_16x16x32_bf16 v[56:59], v[248:251], v[176:179], v[56:59]
    v_mfma_f32_16x16x32_bf16 v[88:91], v[248:251], v[180:183], v[88:91]
    v_mfma_f32_16x16x32_bf16 v[60:63], v[252:255], v[176:179], v[60:63]
    v_exp_f32 v20, v144
    v_exp_f32 v21, v145
    v_exp_f32 v22, v146
    v_add_f32 v170, v168, v20
    v_exp_f32 v23, v147
    v_add_f32 v170, v170, v21
    v_cvt_pk_bf16_f32 v184, v20, v21
    v_exp_f32 v24, v148
    v_add_f32 v170, v170, v22
    v_exp_f32 v25, v149
    v_mfma_f32_16x16x32_bf16 v[92:95], v[252:255], v[180:183], v[92:95]
    v_add_f32 v170, v170, v23
    v_cvt_pk_bf16_f32 v185, v22, v23
    v_exp_f32 v26, v150
    v_add_f32 v170, v170, v24
    v_exp_f32 v27, v151
    v_add_f32 v170, v170, v25
    v_cvt_pk_bf16_f32 v186, v24, v25
    v_exp_f32 v20, v152
    v_add_f32 v170, v170, v26
    s_waitcnt vmcnt(27) lgkmcnt(0)
    s_barrier
    v_mfma_f32_16x16x32_bf16 v[128:131], v[192:195], v[96:99], v[160:163]
    s_mov_b32 s46, 114688
    s_add_u32 m0, s52, 67584
    v_mfma_f32_16x16x32_bf16 v[136:139], v[192:195], v[112:115], v[164:167]
    buffer_load_dwordx4 v6, s[8:11], s46 offen offset:0 nt lds
    v_mfma_f32_16x16x32_bf16 v[132:135], v[196:199], v[96:99], v[160:163]
    s_add_u32 m0, s52, 68384
    v_mfma_f32_16x16x32_bf16 v[140:143], v[196:199], v[112:115], v[164:167]
    buffer_load_dwordx4 v6, s[8:11], s46 offen offset:256 nt lds
    v_mfma_f32_16x16x32_bf16 v[128:131], v[200:203], v[100:103], v[128:131]
    s_mov_b32 s46, 98304
    s_add_u32 m0, s52, 76032
    v_mfma_f32_16x16x32_bf16 v[136:139], v[200:203], v[116:119], v[136:139]
    buffer_load_dwordx4 v6, s[12:15], s46 offen offset:0 nt lds
    v_mfma_f32_16x16x32_bf16 v[132:135], v[204:207], v[100:103], v[132:135]
    s_add_u32 m0, s52, 76832
    v_mfma_f32_16x16x32_bf16 v[140:143], v[204:207], v[116:119], v[140:143]
    buffer_load_dwordx4 v6, s[12:15], s46 offen offset:256 nt lds
    v_mfma_f32_16x16x32_bf16 v[128:131], v[208:211], v[104:107], v[128:131]
    ds_read_b64_tr_b16 v[224:225], v18 offset:33792
    ds_read_b64_tr_b16 v[226:227], v18 offset:34304
    ds_read_b64_tr_b16 v[228:229], v18 offset:33824
    ds_read_b64_tr_b16 v[230:231], v18 offset:34336
    v_mfma_f32_16x16x32_bf16 v[136:139], v[208:211], v[120:123], v[136:139]
    ds_read_b64_tr_b16 v[232:233], v18 offset:33856
    ds_read_b64_tr_b16 v[234:235], v18 offset:34368
    ds_read_b64_tr_b16 v[236:237], v18 offset:33888
    ds_read_b64_tr_b16 v[238:239], v18 offset:34400
    v_mfma_f32_16x16x32_bf16 v[132:135], v[212:215], v[104:107], v[132:135]
    ds_read_b64_tr_b16 v[240:241], v18 offset:33920
    ds_read_b64_tr_b16 v[242:243], v18 offset:34432
    ds_read_b64_tr_b16 v[244:245], v18 offset:33952
    ds_read_b64_tr_b16 v[246:247], v18 offset:34464
    v_exp_f32 v21, v153
    v_add_f32 v170, v170, v27
    v_cvt_pk_bf16_f32 v187, v26, v27
    v_exp_f32 v22, v154
    v_add_f32 v171, v169, v20
    v_exp_f32 v23, v155
    v_add_f32 v171, v171, v21
    v_mfma_f32_16x16x32_bf16 v[140:143], v[212:215], v[120:123], v[140:143]
    ds_read_b64_tr_b16 v[248:249], v18 offset:33984
    ds_read_b64_tr_b16 v[250:251], v18 offset:34496
    ds_read_b64_tr_b16 v[252:253], v18 offset:34016
    ds_read_b64_tr_b16 v[254:255], v18 offset:34528
    v_cvt_pk_bf16_f32 v188, v20, v21
    v_exp_f32 v24, v156
    v_add_f32 v171, v171, v22
    v_exp_f32 v25, v157
    v_add_f32 v171, v171, v23
    v_cvt_pk_bf16_f32 v189, v22, v23
    v_exp_f32 v26, v158
    v_mfma_f32_16x16x32_bf16 v[128:131], v[216:219], v[108:111], v[128:131]
    v_add_f32 v171, v171, v24
    v_exp_f32 v27, v159
    v_add_f32 v171, v171, v25
    v_cvt_pk_bf16_f32 v190, v24, v25
    v_add_f32 v171, v171, v26
    v_add_f32 v171, v171, v27
    v_cvt_pk_bf16_f32 v191, v26, v27
    v_mfma_f32_16x16x32_bf16 v[136:139], v[216:219], v[124:127], v[136:139]
    v_max_f32 v30, v170, v171
    v_cmp_lt_f32 vcc, s49, v30
    v_mfma_f32_16x16x32_bf16 v[132:135], v[220:223], v[108:111], v[132:135]
    s_cbranch_vccnz LS_r7
LS_b7:
    v_mfma_f32_16x16x32_bf16 v[140:143], v[220:223], v[124:127], v[140:143]
    s_waitcnt lgkmcnt(0)
    v_mfma_f32_16x16x32_bf16 v[32:35], v[224:227], v[184:187], v[32:35]
    ds_read_b128 v[192:195], v4 offset:33792
    ds_read_b128 v[196:199], v4 offset:34304
    v_mfma_f32_16x16x32_bf16 v[64:67], v[224:227], v[188:191], v[64:67]
    ds_read_b128 v[200:203], v4 offset:33856
    ds_read_b128 v[204:207], v4 offset:34368
    v_mfma_f32_16x16x32_bf16 v[36:39], v[228:231], v[184:187], v[36:39]
    ds_read_b128 v[208:211], v4 offset:33920
    ds_read_b128 v[212:215], v4 offset:34432
    v_mfma_f32_16x16x32_bf16 v[68:71], v[228:231], v[188:191], v[68:71]
    ds_read_b128 v[216:219], v4 offset:33984
    ds_read_b128 v[220:223], v4 offset:34496
    v_mfma_f32_16x16x32_bf16 v[40:43], v[232:235], v[184:187], v[40:43]
    v_mfma_f32_16x16x32_bf16 v[72:75], v[232:235], v[188:191], v[72:75]
    v_mfma_f32_16x16x32_bf16 v[44:47], v[236:239], v[184:187], v[44:47]
    v_mfma_f32_16x16x32_bf16 v[76:79], v[236:239], v[188:191], v[76:79]
    v_mfma_f32_16x16x32_bf16 v[48:51], v[240:243], v[184:187], v[48:51]
    v_mfma_f32_16x16x32_bf16 v[80:83], v[240:243], v[188:191], v[80:83]
    v_mfma_f32_16x16x32_bf16 v[52:55], v[244:247], v[184:187], v[52:55]
    v_mfma_f32_16x16x32_bf16 v[84:87], v[244:247], v[188:191], v[84:87]
    v_mfma_f32_16x16x32_bf16 v[56:59], v[248:251], v[184:187], v[56:59]
    v_mfma_f32_16x16x32_bf16 v[88:91], v[248:251], v[188:191], v[88:91]
    v_mfma_f32_16x16x32_bf16 v[60:63], v[252:255], v[184:187], v[60:63]
    v_exp_f32 v20, v128
    v_exp_f32 v21, v129
    v_exp_f32 v22, v130
    v_add_f32 v168, v170, v20
    v_exp_f32 v23, v131
    v_add_f32 v168, v168, v21
    v_cvt_pk_bf16_f32 v176, v20, v21
    v_exp_f32 v24, v132
    v_add_f32 v168, v168, v22
    v_exp_f32 v25, v133
    v_mfma_f32_16x16x32_bf16 v[92:95], v[252:255], v[188:191], v[92:95]
    v_add_f32 v168, v168, v23
    v_cvt_pk_bf16_f32 v177, v22, v23
    v_exp_f32 v26, v134
    v_add_f32 v168, v168, v24
    v_exp_f32 v27, v135
    v_add_f32 v168, v168, v25
    v_cvt_pk_bf16_f32 v178, v24, v25
    v_exp_f32 v20, v136
    v_add_f32 v168, v168, v26
    s_waitcnt vmcnt(16) lgkmcnt(0)
    s_barrier
    v_mfma_f32_16x16x32_bf16 v[144:147], v[192:195], v[96:99], v[160:163]
    s_mov_b32 s46, 122880
    s_add_u32 m0, s52, 84480
    v_mfma_f32_16x16x32_bf16 v[152:155], v[192:195], v[112:115], v[164:167]
    buffer_load_dwordx4 v6, s[8:11], s46 offen offset:0 nt lds
    v_mfma_f32_16x16x32_bf16 v[148:151], v[196:199], v[96:99], v[160:163]
    s_add_u32 m0, s52, 85280
    v_mfma_f32_16x16x32_bf16 v[156:159], v[196:199], v[112:115], v[164:167]
    buffer_load_dwordx4 v6, s[8:11], s46 offen offset:256 nt lds
    v_mfma_f32_16x16x32_bf16 v[144:147], v[200:203], v[100:103], v[144:147]
    s_mov_b32 s46, 106496
    s_add_u32 m0, s52, 92928
    v_mfma_f32_16x16x32_bf16 v[152:155], v[200:203], v[116:119], v[152:155]
    buffer_load_dwordx4 v6, s[12:15], s46 offen offset:0 nt lds
    v_mfma_f32_16x16x32_bf16 v[148:151], v[204:207], v[100:103], v[148:151]
    s_add_u32 m0, s52, 93728
    v_mfma_f32_16x16x32_bf16 v[156:159], v[204:207], v[116:119], v[156:159]
    buffer_load_dwordx4 v6, s[12:15], s46 offen offset:256 nt lds
    v_mfma_f32_16x16x32_bf16 v[144:147], v[208:211], v[104:107], v[144:147]
    ds_read_b64_tr_b16 v[224:225], v16 offset:0
    ds_read_b64_tr_b16 v[226:227], v16 offset:512
    ds_read_b64_tr_b16 v[228:229], v16 offset:32
    ds_read_b64_tr_b16 v[230:231], v16 offset:544
    v_mfma_f32_16x16x32_bf16 v[152:155], v[208:211], v[120:123], v[152:155]
    ds_read_b64_tr_b16 v[232:233], v16 offset:64
    ds_read_b64_tr_b16 v[234:235], v16 offset:576
    ds_read_b64_tr_b16 v[236:237], v16 offset:96
    ds_read_b64_tr_b16 v[238:239], v16 offset:608
    v_mfma_f32_16x16x32_bf16 v[148:151], v[212:215], v[104:107], v[148:151]
    ds_read_b64_tr_b16 v[240:241], v16 offset:128
    ds_read_b64_tr_b16 v[242:243], v16 offset:640
    ds_read_b64_tr_b16 v[244:245], v16 offset:160
    ds_read_b64_tr_b16 v[246:247], v16 offset:672
    v_exp_f32 v21, v137
    v_add_f32 v168, v168, v27
    v_cvt_pk_bf16_f32 v179, v26, v27
    v_exp_f32 v22, v138
    v_add_f32 v169, v171, v20
    v_exp_f32 v23, v139
    v_add_f32 v169, v169, v21
    v_mfma_f32_16x16x32_bf16 v[156:159], v[212:215], v[120:123], v[156:159]
    ds_read_b64_tr_b16 v[248:249], v16 offset:192
    ds_read_b64_tr_b16 v[250:251], v16 offset:704
    ds_read_b64_tr_b16 v[252:253], v16 offset:224
    ds_read_b64_tr_b16 v[254:255], v16 offset:736
    v_cvt_pk_bf16_f32 v180, v20, v21
    v_exp_f32 v24, v140
    v_add_f32 v169, v169, v22
    v_exp_f32 v25, v141
    v_add_f32 v169, v169, v23
    v_cvt_pk_bf16_f32 v181, v22, v23
    v_exp_f32 v26, v142
    v_mfma_f32_16x16x32_bf16 v[144:147], v[216:219], v[108:111], v[144:147]
    v_add_f32 v169, v169, v24
    v_exp_f32 v27, v143
    v_add_f32 v169, v169, v25
    v_cvt_pk_bf16_f32 v182, v24, v25
    v_add_f32 v169, v169, v26
    v_add_f32 v169, v169, v27
    v_cvt_pk_bf16_f32 v183, v26, v27
    v_mfma_f32_16x16x32_bf16 v[152:155], v[216:219], v[124:127], v[152:155]
    v_max_f32 v30, v168, v169
    v_cmp_lt_f32 vcc, s49, v30
    v_mfma_f32_16x16x32_bf16 v[148:151], v[220:223], v[108:111], v[148:151]
    s_cbranch_vccnz LS_r8
LS_b8:
    v_mfma_f32_16x16x32_bf16 v[156:159], v[220:223], v[124:127], v[156:159]
    s_waitcnt lgkmcnt(0)
    v_mfma_f32_16x16x32_bf16 v[32:35], v[224:227], v[176:179], v[32:35]
    ds_read_b128 v[192:195], v2 offset:0
    ds_read_b128 v[196:199], v2 offset:512
    v_mfma_f32_16x16x32_bf16 v[64:67], v[224:227], v[180:183], v[64:67]
    ds_read_b128 v[200:203], v2 offset:64
    ds_read_b128 v[204:207], v2 offset:576
    v_mfma_f32_16x16x32_bf16 v[36:39], v[228:231], v[176:179], v[36:39]
    ds_read_b128 v[208:211], v2 offset:128
    ds_read_b128 v[212:215], v2 offset:640
    v_mfma_f32_16x16x32_bf16 v[68:71], v[228:231], v[180:183], v[68:71]
    ds_read_b128 v[216:219], v2 offset:192
    ds_read_b128 v[220:223], v2 offset:704
    v_mfma_f32_16x16x32_bf16 v[40:43], v[232:235], v[176:179], v[40:43]
    v_mfma_f32_16x16x32_bf16 v[72:75], v[232:235], v[180:183], v[72:75]
    v_mfma_f32_16x16x32_bf16 v[44:47], v[236:239], v[176:179], v[44:47]
    v_mfma_f32_16x16x32_bf16 v[76:79], v[236:239], v[180:183], v[76:79]
    v_mfma_f32_16x16x32_bf16 v[48:51], v[240:243], v[176:179], v[48:51]
    v_mfma_f32_16x16x32_bf16 v[80:83], v[240:243], v[180:183], v[80:83]
    v_mfma_f32_16x16x32_bf16 v[52:55], v[244:247], v[176:179], v[52:55]
    v_mfma_f32_16x16x32_bf16 v[84:87], v[244:247], v[180:183], v[84:87]
    v_mfma_f32_16x16x32_bf16 v[56:59], v[248:251], v[176:179], v[56:59]
    v_mfma_f32_16x16x32_bf16 v[88:91], v[248:251], v[180:183], v[88:91]
    v_mfma_f32_16x16x32_bf16 v[60:63], v[252:255], v[176:179], v[60:63]
    v_exp_f32 v20, v144
    v_exp_f32 v21, v145
    v_exp_f32 v22, v146
    v_add_f32 v170, v168, v20
    v_exp_f32 v23, v147
    v_add_f32 v170, v170, v21
    v_cvt_pk_bf16_f32 v184, v20, v21
    v_exp_f32 v24, v148
    v_add_f32 v170, v170, v22
    v_exp_f32 v25, v149
    v_mfma_f32_16x16x32_bf16 v[92:95], v[252:255], v[180:183], v[92:95]
    global_load_dword v9, v8, s[0:1]
    v_add_f32 v170, v170, v23
    v_cvt_pk_bf16_f32 v185, v22, v23
    v_exp_f32 v26, v150
    v_add_f32 v170, v170, v24
    v_exp_f32 v27, v151
    v_add_f32 v170, v170, v25
    v_cvt_pk_bf16_f32 v186, v24, v25
    v_exp_f32 v20, v152
    v_add_f32 v170, v170, v26
    s_waitcnt vmcnt(17) lgkmcnt(0)
    s_barrier
    v_mfma_f32_16x16x32_bf16 v[128:131], v[192:195], v[96:99], v[160:163]
    s_mov_b32 s46, 131072
    s_add_u32 m0, s52, 101376
    v_mfma_f32_16x16x32_bf16 v[136:139], v[192:195], v[112:115], v[164:167]
    buffer_load_dwordx4 v6, s[8:11], s46 offen offset:0 nt lds
    v_mfma_f32_16x16x32_bf16 v[132:135], v[196:199], v[96:99], v[160:163]
    s_add_u32 m0, s52, 102176
    v_mfma_f32_16x16x32_bf16 v[140:143], v[196:199], v[112:115], v[164:167]
    buffer_load_dwordx4 v6, s[8:11], s46 offen offset:256 nt lds
    v_mfma_f32_16x16x32_bf16 v[128:131], v[200:203], v[100:103], v[128:131]
    s_mov_b32 s46, 114688
    s_add_u32 m0, s52, 109824
    v_mfma_f32_16x16x32_bf16 v[136:139], v[200:203], v[116:119], v[136:139]
    buffer_load_dwordx4 v6, s[12:15], s46 offen offset:0 nt lds
    v_mfma_f32_16x16x32_bf16 v[132:135], v[204:207], v[100:103], v[132:135]
    s_add_u32 m0, s52, 110624
    v_mfma_f32_16x16x32_bf16 v[140:143], v[204:207], v[116:119], v[140:143]
    buffer_load_dwordx4 v6, s[12:15], s46 offen offset:256 nt lds
    v_mfma_f32_16x16x32_bf16 v[128:131], v[208:211], v[104:107], v[128:131]
    ds_read_b64_tr_b16 v[224:225], v16 offset:16896
    ds_read_b64_tr_b16 v[226:227], v16 offset:17408
    ds_read_b64_tr_b16 v[228:229], v16 offset:16928
    ds_read_b64_tr_b16 v[230:231], v16 offset:17440
    v_mfma_f32_16x16x32_bf16 v[136:139], v[208:211], v[120:123], v[136:139]
    ds_read_b64_tr_b16 v[232:233], v16 offset:16960
    ds_read_b64_tr_b16 v[234:235], v16 offset:17472
    ds_read_b64_tr_b16 v[236:237], v16 offset:16992
    ds_read_b64_tr_b16 v[238:239], v16 offset:17504
    v_mfma_f32_16x16x32_bf16 v[132:135], v[212:215], v[104:107], v[132:135]
    ds_read_b64_tr_b16 v[240:241], v16 offset:17024
    ds_read_b64_tr_b16 v[242:243], v16 offset:17536
    ds_read_b64_tr_b16 v[244:245], v16 offset:17056
    ds_read_b64_tr_b16 v[246:247], v16 offset:17568
    v_exp_f32 v21, v153
    v_add_f32 v170, v170, v27
    v_cvt_pk_bf16_f32 v187, v26, v27
    v_exp_f32 v22, v154
    v_add_f32 v171, v169, v20
    v_exp_f32 v23, v155
    v_add_f32 v171, v171, v21
    v_mfma_f32_16x16x32_bf16 v[140:143], v[212:215], v[120:123], v[140:143]
    ds_read_b64_tr_b16 v[248:249], v16 offset:17088
    ds_read_b64_tr_b16 v[250:251], v16 offset:17600
    ds_read_b64_tr_b16 v[252:253], v16 offset:17120
    ds_read_b64_tr_b16 v[254:255], v16 offset:17632
    v_cvt_pk_bf16_f32 v188, v20, v21
    v_exp_f32 v24, v156
    v_add_f32 v171, v171, v22
    v_exp_f32 v25, v157
    v_add_f32 v171, v171, v23
    v_cvt_pk_bf16_f32 v189, v22, v23
    v_exp_f32 v26, v158
    v_mfma_f32_16x16x32_bf16 v[128:131], v[216:219], v[108:111], v[128:131]
    v_add_f32 v171, v171, v24
    v_exp_f32 v27, v159
    v_add_f32 v171, v171, v25
    v_cvt_pk_bf16_f32 v190, v24, v25
    v_add_f32 v171, v171, v26
    v_add_f32 v171, v171, v27
    v_cvt_pk_bf16_f32 v191, v26, v27
    v_mfma_f32_16x16x32_bf16 v[136:139], v[216:219], v[124:127], v[136:139]
    v_max_f32 v30, v170, v171
    v_cmp_lt_f32 vcc, s49, v30
    v_mfma_f32_16x16x32_bf16 v[132:135], v[220:223], v[108:111], v[132:135]
    s_cbranch_vccnz LS_r9
LS_b9:
    v_mfma_f32_16x16x32_bf16 v[140:143], v[220:223], v[124:127], v[140:143]
    s_waitcnt lgkmcnt(0)
    v_mfma_f32_16x16x32_bf16 v[32:35], v[224:227], v[184:187], v[32:35]
    ds_read_b128 v[192:195], v2 offset:16896
    ds_read_b128 v[196:199], v2 offset:17408
    v_mfma_f32_16x16x32_bf16 v[64:67], v[224:227], v[188:191], v[64:67]
    ds_read_b128 v[200:203], v2 offset:16960
    ds_read_b128 v[204:207], v2 offset:17472
    v_mfma_f32_16x16x32_bf16 v[36:39], v[228:231], v[184:187], v[36:39]
    ds_read_b128 v[208:211], v2 offset:17024
    ds_read_b128 v[212:215], v2 offset:17536
    v_mfma_f32_16x16x32_bf16 v[68:71], v[228:231], v[188:191], v[68:71]
    ds_read_b128 v[216:219], v2 offset:17088
    ds_read_b128 v[220:223], v2 offset:17600
    v_mfma_f32_16x16x32_bf16 v[40:43], v[232:235], v[184:187], v[40:43]
    v_mfma_f32_16x16x32_bf16 v[72:75], v[232:235], v[188:191], v[72:75]
    v_mfma_f32_16x16x32_bf16 v[44:47], v[236:239], v[184:187], v[44:47]
    v_mfma_f32_16x16x32_bf16 v[76:79], v[236:239], v[188:191], v[76:79]
    v_mfma_f32_16x16x32_bf16 v[48:51], v[240:243], v[184:187], v[48:51]
    v_mfma_f32_16x16x32_bf16 v[80:83], v[240:243], v[188:191], v[80:83]
    v_mfma_f32_16x16x32_bf16 v[52:55], v[244:247], v[184:187], v[52:55]
    v_mfma_f32_16x16x32_bf16 v[84:87], v[244:247], v[188:191], v[84:87]
    v_mfma_f32_16x16x32_bf16 v[56:59], v[248:251], v[184:187], v[56:59]
    v_mfma_f32_16x16x32_bf16 v[88:91], v[248:251], v[188:191], v[88:91]
    v_mfma_f32_16x16x32_bf16 v[60:63], v[252:255], v[184:187], v[60:63]
    v_exp_f32 v20, v128
    v_exp_f32 v21, v129
    v_exp_f32 v22, v130
    v_add_f32 v168, v170, v20
    v_exp_f32 v23, v131
    v_add_f32 v168, v168, v21
    v_cvt_pk_bf16_f32 v176, v20, v21
    v_exp_f32 v24, v132
    v_add_f32 v168, v168, v22
    v_exp_f32 v25, v133
    v_mfma_f32_16x16x32_bf16 v[92:95], v[252:255], v[188:191], v[92:95]
    v_add_f32 v168, v168, v23
    v_cvt_pk_bf16_f32 v177, v22, v23
    v_exp_f32 v26, v134
    v_add_f32 v168, v168, v24
    v_exp_f32 v27, v135
    v_add_f32 v168, v168, v25
    v_cvt_pk_bf16_f32 v178, v24, v25
    v_exp_f32 v20, v136
    v_add_f32 v168, v168, v26
    s_waitcnt vmcnt(17) lgkmcnt(0)
    s_barrier
    v_mfma_f32_16x16x32_bf16 v[144:147], v[192:195], v[96:99], v[160:163]
    s_mov_b32 s46, 139264
    s_add_u32 m0, s52, 118272
    v_mfma_f32_16x16x32_bf16 v[152:155], v[192:195], v[112:115], v[164:167]
    buffer_load_dwordx4 v6, s[8:11], s46 offen offset:0 nt lds
    v_mfma_f32_16x16x32_bf16 v[148:151], v[196:199], v[96:99], v[160:163]
    s_add_u32 m0, s52, 119072
    v_mfma_f32_16x16x32_bf16 v[156:159], v[196:199], v[112:115], v[164:167]
    buffer_load_dwordx4 v6, s[8:11], s46 offen offset:256 nt lds
    v_mfma_f32_16x16x32_bf16 v[144:147], v[200:203], v[100:103], v[144:147]
    s_mov_b32 s46, 122880
    s_add_u32 m0, s52, 126720
    v_mfma_f32_16x16x32_bf16 v[152:155], v[200:203], v[116:119], v[152:155]
    buffer_load_dwordx4 v6, s[12:15], s46 offen offset:0 nt lds
    v_mfma_f32_16x16x32_bf16 v[148:151], v[204:207], v[100:103], v[148:151]
    s_add_u32 m0, s52, 127520
    v_mfma_f32_16x16x32_bf16 v[156:159], v[204:207], v[116:119], v[156:159]
    buffer_load_dwordx4 v6, s[12:15], s46 offen offset:256 nt lds
    v_mfma_f32_16x16x32_bf16 v[144:147], v[208:211], v[104:107], v[144:147]
    ds_read_b64_tr_b16 v[224:225], v16 offset:33792
    ds_read_b64_tr_b16 v[226:227], v16 offset:34304
    ds_read_b64_tr_b16 v[228:229], v16 offset:33824
    ds_read_b64_tr_b16 v[230:231], v16 offset:34336
    v_mfma_f32_16x16x32_bf16 v[152:155], v[208:211], v[120:123], v[152:155]
    ds_read_b64_tr_b16 v[232:233], v16 offset:33856
    ds_read_b64_tr_b16 v[234:235], v16 offset:34368
    ds_read_b64_tr_b16 v[236:237], v16 offset:33888
    ds_read_b64_tr_b16 v[238:239], v16 offset:34400
    v_mfma_f32_16x16x32_bf16 v[148:151], v[212:215], v[104:107], v[148:151]
    ds_read_b64_tr_b16 v[240:241], v16 offset:33920
    ds_read_b64_tr_b16 v[242:243], v16 offset:34432
    ds_read_b64_tr_b16 v[244:245], v16 offset:33952
    ds_read_b64_tr_b16 v[246:247], v16 offset:34464
    v_exp_f32 v21, v137
    v_add_f32 v168, v168, v27
    v_cvt_pk_bf16_f32 v179, v26, v27
    v_exp_f32 v22, v138
    v_add_f32 v169, v171, v20
    v_exp_f32 v23, v139
    v_add_f32 v169, v169, v21
    v_mfma_f32_16x16x32_bf16 v[156:159], v[212:215], v[120:123], v[156:159]
    ds_read_b64_tr_b16 v[248:249], v16 offset:33984
    ds_read_b64_tr_b16 v[250:251], v16 offset:34496
    ds_read_b64_tr_b16 v[252:253], v16 offset:34016
    ds_read_b64_tr_b16 v[254:255], v16 offset:34528
    v_cvt_pk_bf16_f32 v180, v20, v21
    v_exp_f32 v24, v140
    v_add_f32 v169, v169, v22
    v_exp_f32 v25, v141
    v_add_f32 v169, v169, v23
    v_cvt_pk_bf16_f32 v181, v22, v23
    v_exp_f32 v26, v142
    v_mfma_f32_16x16x32_bf16 v[144:147], v[216:219], v[108:111], v[144:147]
    v_add_f32 v169, v169, v24
    v_exp_f32 v27, v143
    v_add_f32 v169, v169, v25
    v_cvt_pk_bf16_f32 v182, v24, v25
    v_add_f32 v169, v169, v26
    v_add_f32 v169, v169, v27
    v_cvt_pk_bf16_f32 v183, v26, v27
    v_mfma_f32_16x16x32_bf16 v[152:155], v[216:219], v[124:127], v[152:155]
    v_max_f32 v30, v168, v169
    v_cmp_lt_f32 vcc, s49, v30
    v_mfma_f32_16x16x32_bf16 v[148:151], v[220:223], v[108:111], v[148:151]
    s_cbranch_vccnz LS_r10
LS_b10:
    v_mfma_f32_16x16x32_bf16 v[156:159], v[220:223], v[124:127], v[156:159]
    s_waitcnt lgkmcnt(0)
    v_mfma_f32_16x16x32_bf16 v[32:35], v[224:227], v[176:179], v[32:35]
    ds_read_b128 v[192:195], v2 offset:33792
    ds_read_b128 v[196:199], v2 offset:34304
    v_mfma_f32_16x16x32_bf16 v[64:67], v[224:227], v[180:183], v[64:67]
    ds_read_b128 v[200:203], v2 offset:33856
    ds_read_b128 v[204:207], v2 offset:34368
    v_mfma_f32_16x16x32_bf16 v[36:39], v[228:231], v[176:179], v[36:39]
    ds_read_b128 v[208:211], v2 offset:33920
    ds_read_b128 v[212:215], v2 offset:34432
    v_mfma_f32_16x16x32_bf16 v[68:71], v[228:231], v[180:183], v[68:71]
    ds_read_b128 v[216:219], v2 offset:33984
    ds_read_b128 v[220:223], v2 offset:34496
    v_mfma_f32_16x16x32_bf16 v[40:43], v[232:235], v[176:179], v[40:43]
    v_mfma_f32_16x16x32_bf16 v[72:75], v[232:235], v[180:183], v[72:75]
    v_mfma_f32_16x16x32_bf16 v[44:47], v[236:239], v[176:179], v[44:47]
    v_mfma_f32_16x16x32_bf16 v[76:79], v[236:239], v[180:183], v[76:79]
    v_mfma_f32_16x16x32_bf16 v[48:51], v[240:243], v[176:179], v[48:51]
    v_mfma_f32_16x16x32_bf16 v[80:83], v[240:243], v[180:183], v[80:83]
    v_mfma_f32_16x16x32_bf16 v[52:55], v[244:247], v[176:179], v[52:55]
    v_mfma_f32_16x16x32_bf16 v[84:87], v[244:247], v[180:183], v[84:87]
    v_mfma_f32_16x16x32_bf16 v[56:59], v[248:251], v[176:179], v[56:59]
    v_mfma_f32_16x16x32_bf16 v[88:91], v[248:251], v[180:183], v[88:91]
    v_mfma_f32_16x16x32_bf16 v[60:63], v[252:255], v[176:179], v[60:63]
    v_exp_f32 v20, v144
    v_exp_f32 v21, v145
    v_exp_f32 v22, v146
    v_add_f32 v170, v168, v20
    v_exp_f32 v23, v147
    v_add_f32 v170, v170, v21
    v_cvt_pk_bf16_f32 v184, v20, v21
    v_exp_f32 v24, v148
    v_add_f32 v170, v170, v22
    v_exp_f32 v25, v149
    v_mfma_f32_16x16x32_bf16 v[92:95], v[252:255], v[180:183], v[92:95]
    v_add_f32 v170, v170, v23
    v_cvt_pk_bf16_f32 v185, v22, v23
    v_exp_f32 v26, v150
    v_add_f32 v170, v170, v24
    v_exp_f32 v27, v151
    v_add_f32 v170, v170, v25
    v_cvt_pk_bf16_f32 v186, v24, v25
    v_exp_f32 v20, v152
    v_add_f32 v170, v170, v26
    s_waitcnt vmcnt(17) lgkmcnt(0)
    s_barrier
    v_mfma_f32_16x16x32_bf16 v[128:131], v[192:195], v[96:99], v[160:163]
    s_mov_b32 s46, 147456
    s_add_u32 m0, s52, 135168
    v_mfma_f32_16x16x32_bf16 v[136:139], v[192:195], v[112:115], v[164:167]
    buffer_load_dwordx4 v6, s[8:11], s46 offen offset:0 nt lds
    v_mfma_f32_16x16x32_bf16 v[132:135], v[196:199], v[96:99], v[160:163]
    s_add_u32 m0, s52, 135968
    v_mfma_f32_16x16x32_bf16 v[140:143], v[196:199], v[112:115], v[164:167]
    buffer_load_dwordx4 v6, s[8:11], s46 offen offset:256 nt lds
    v_mfma_f32_16x16x32_bf16 v[128:131], v[200:203], v[100:103], v[128:131]
    s_mov_b32 s46, 131072
    s_add_u32 m0, s52, 143616
    v_mfma_f32_16x16x32_bf16 v[136:139], v[200:203], v[116:119], v[136:139]
    buffer_load_dwordx4 v6, s[12:15], s46 offen offset:0 nt lds
    v_mfma_f32_16x16x32_bf16 v[132:135], v[204:207], v[100:103], v[132:135]
    s_add_u32 m0, s52, 144416
    v_mfma_f32_16x16x32_bf16 v[140:143], v[204:207], v[116:119], v[140:143]
    buffer_load_dwordx4 v6, s[12:15], s46 offen offset:256 nt lds
    v_mfma_f32_16x16x32_bf16 v[128:131], v[208:211], v[104:107], v[128:131]
    ds_read_b64_tr_b16 v[224:225], v17 offset:0
    ds_read_b64_tr_b16 v[226:227], v17 offset:512
    ds_read_b64_tr_b16 v[228:229], v17 offset:32
    ds_read_b64_tr_b16 v[230:231], v17 offset:544
    v_mfma_f32_16x16x32_bf16 v[136:139], v[208:211], v[120:123], v[136:139]
    ds_read_b64_tr_b16 v[232:233], v17 offset:64
    ds_read_b64_tr_b16 v[234:235], v17 offset:576
    ds_read_b64_tr_b16 v[236:237], v17 offset:96
    ds_read_b64_tr_b16 v[238:239], v17 offset:608
    v_mfma_f32_16x16x32_bf16 v[132:135], v[212:215], v[104:107], v[132:135]
    ds_read_b64_tr_b16 v[240:241], v17 offset:128
    ds_read_b64_tr_b16 v[242:243], v17 offset:640
    ds_read_b64_tr_b16 v[244:245], v17 offset:160
    ds_read_b64_tr_b16 v[246:247], v17 offset:672
    v_exp_f32 v21, v153
    v_add_f32 v170, v170, v27
    v_cvt_pk_bf16_f32 v187, v26, v27
    v_exp_f32 v22, v154
    v_add_f32 v171, v169, v20
    v_exp_f32 v23, v155
    v_add_f32 v171, v171, v21
    v_mfma_f32_16x16x32_bf16 v[140:143], v[212:215], v[120:123], v[140:143]
    ds_read_b64_tr_b16 v[248:249], v17 offset:192
    ds_read_b64_tr_b16 v[250:251], v17 offset:704
    ds_read_b64_tr_b16 v[252:253], v17 offset:224
    ds_read_b64_tr_b16 v[254:255], v17 offset:736
    v_cvt_pk_bf16_f32 v188, v20, v21
    v_exp_f32 v24, v156
    v_add_f32 v171, v171, v22
    v_exp_f32 v25, v157
    v_add_f32 v171, v171, v23
    v_cvt_pk_bf16_f32 v189, v22, v23
    v_exp_f32 v26, v158
    v_mfma_f32_16x16x32_bf16 v[128:131], v[216:219], v[108:111], v[128:131]
    v_add_f32 v171, v171, v24
    v_exp_f32 v27, v159
    v_add_f32 v171, v171, v25
    v_cvt_pk_bf16_f32 v190, v24, v25
    v_add_f32 v171, v171, v26
    v_add_f32 v171, v171, v27
    v_cvt_pk_bf16_f32 v191, v26, v27
    v_mfma_f32_16x16x32_bf16 v[136:139], v[216:219], v[124:127], v[136:139]
    v_max_f32 v30, v170, v171
    v_cmp_lt_f32 vcc, s49, v30
    v_mfma_f32_16x16x32_bf16 v[132:135], v[220:223], v[108:111], v[132:135]
    s_cbranch_vccnz LS_r11
LS_b11:
    v_mfma_f32_16x16x32_bf16 v[140:143], v[220:223], v[124:127], v[140:143]
    s_waitcnt lgkmcnt(0)
    v_mfma_f32_16x16x32_bf16 v[32:35], v[224:227], v[184:187], v[32:35]
    ds_read_b128 v[192:195], v3 offset:0
    ds_read_b128 v[196:199], v3 offset:512
    v_mfma_f32_16x16x32_bf16 v[64:67], v[224:227], v[188:191], v[64:67]
    ds_read_b128 v[200:203], v3 offset:64
    ds_read_b128 v[204:207], v3 offset:576
    v_mfma_f32_16x16x32_bf16 v[36:39], v[228:231], v[184:187], v[36:39]
    ds_read_b128 v[208:211], v3 offset:128
    ds_read_b128 v[212:215], v3 offset:640
    v_mfma_f32_16x16x32_bf16 v[68:71], v[228:231], v[188:191], v[68:71]
    ds_read_b128 v[216:219], v3 offset:192
    ds_read_b128 v[220:223], v3 offset:704
    v_mfma_f32_16x16x32_bf16 v[40:43], v[232:235], v[184:187], v[40:43]
    v_mfma_f32_16x16x32_bf16 v[72:75], v[232:235], v[188:191], v[72:75]
    v_mfma_f32_16x16x32_bf16 v[44:47], v[236:239], v[184:187], v[44:47]
    v_mfma_f32_16x16x32_bf16 v[76:79], v[236:239], v[188:191], v[76:79]
    v_mfma_f32_16x16x32_bf16 v[48:51], v[240:243], v[184:187], v[48:51]
    v_mfma_f32_16x16x32_bf16 v[80:83], v[240:243], v[188:191], v[80:83]
    v_mfma_f32_16x16x32_bf16 v[52:55], v[244:247], v[184:187], v[52:55]
    v_mfma_f32_16x16x32_bf16 v[84:87], v[244:247], v[188:191], v[84:87]
    v_mfma_f32_16x16x32_bf16 v[56:59], v[248:251], v[184:187], v[56:59]
    v_mfma_f32_16x16x32_bf16 v[88:91], v[248:251], v[188:191], v[88:91]
    v_mfma_f32_16x16x32_bf16 v[60:63], v[252:255], v[184:187], v[60:63]
    v_exp_f32 v20, v128
    v_exp_f32 v21, v129
    v_exp_f32 v22, v130
    v_add_f32 v168, v170, v20
    v_exp_f32 v23, v131
    v_add_f32 v168, v168, v21
    v_cvt_pk_bf16_f32 v176, v20, v21
    v_exp_f32 v24, v132
    v_add_f32 v168, v168, v22
    v_exp_f32 v25, v133
    v_mfma_f32_16x16x32_bf16 v[92:95], v[252:255], v[188:191], v[92:95]
    v_add_f32 v168, v168, v23
    v_cvt_pk_bf16_f32 v177, v22, v23
    v_exp_f32 v26, v134
    v_add_f32 v168, v168, v24
    v_exp_f32 v27, v135
    v_add_f32 v168, v168, v25
    v_cvt_pk_bf16_f32 v178, v24, v25
    v_exp_f32 v20, v136
    v_add_f32 v168, v168, v26
    s_waitcnt vmcnt(17) lgkmcnt(0)
    s_barrier
    v_mfma_f32_16x16x32_bf16 v[144:147], v[192:195], v[96:99], v[160:163]
    v_mfma_f32_16x16x32_bf16 v[152:155], v[192:195], v[112:115], v[164:167]
    v_mfma_f32_16x16x32_bf16 v[148:151], v[196:199], v[96:99], v[160:163]
    v_mfma_f32_16x16x32_bf16 v[156:159], v[196:199], v[112:115], v[164:167]
    v_mfma_f32_16x16x32_bf16 v[144:147], v[200:203], v[100:103], v[144:147]
    v_mfma_f32_16x16x32_bf16 v[152:155], v[200:203], v[116:119], v[152:155]
    v_mfma_f32_16x16x32_bf16 v[148:151], v[204:207], v[100:103], v[148:151]
    v_mfma_f32_16x16x32_bf16 v[156:159], v[204:207], v[116:119], v[156:159]
    v_mfma_f32_16x16x32_bf16 v[144:147], v[208:211], v[104:107], v[144:147]
    ds_read_b64_tr_b16 v[224:225], v17 offset:16896
    ds_read_b64_tr_b16 v[226:227], v17 offset:17408
    ds_read_b64_tr_b16 v[228:229], v17 offset:16928
    ds_read_b64_tr_b16 v[230:231], v17 offset:17440
    v_mfma_f32_16x16x32_bf16 v[152:155], v[208:211], v[120:123], v[152:155]
    ds_read_b64_tr_b16 v[232:233], v17 offset:16960
    ds_read_b64_tr_b16 v[234:235], v17 offset:17472
    ds_read_b64_tr_b16 v[236:237], v17 offset:16992
    ds_read_b64_tr_b16 v[238:239], v17 offset:17504
    v_mfma_f32_16x16x32_bf16 v[148:151], v[212:215], v[104:107], v[148:151]
    ds_read_b64_tr_b16 v[240:241], v17 offset:17024
    ds_read_b64_tr_b16 v[242:243], v17 offset:17536
    ds_read_b64_tr_b16 v[244:245], v17 offset:17056
    ds_read_b64_tr_b16 v[246:247], v17 offset:17568
    v_exp_f32 v21, v137
    v_add_f32 v168, v168, v27
    v_cvt_pk_bf16_f32 v179, v26, v27
    v_exp_f32 v22, v138
    v_add_f32 v169, v171, v20
    v_exp_f32 v23, v139
    v_add_f32 v169, v169, v21
    v_mfma_f32_16x16x32_bf16 v[156:159], v[212:215], v[120:123], v[156:159]
    ds_read_b64_tr_b16 v[248:249], v17 offset:17088
    ds_read_b64_tr_b16 v[250:251], v17 offset:17600
    ds_read_b64_tr_b16 v[252:253], v17 offset:17120
    ds_read_b64_tr_b16 v[254:255], v17 offset:17632
    v_cvt_pk_bf16_f32 v180, v20, v21
    v_exp_f32 v24, v140
    v_add_f32 v169, v169, v22
    v_exp_f32 v25, v141
    v_add_f32 v169, v169, v23
    v_cvt_pk_bf16_f32 v181, v22, v23
    v_exp_f32 v26, v142
    v_mfma_f32_16x16x32_bf16 v[144:147], v[216:219], v[108:111], v[144:147]
    v_add_f32 v169, v169, v24
    v_exp_f32 v27, v143
    v_add_f32 v169, v169, v25
    v_cvt_pk_bf16_f32 v182, v24, v25
    v_add_f32 v169, v169, v26
    v_add_f32 v169, v169, v27
    v_cvt_pk_bf16_f32 v183, v26, v27
    v_mfma_f32_16x16x32_bf16 v[152:155], v[216:219], v[124:127], v[152:155]
    v_max_f32 v30, v168, v169
    v_cmp_lt_f32 vcc, s49, v30
    v_mfma_f32_16x16x32_bf16 v[148:151], v[220:223], v[108:111], v[148:151]
    s_cbranch_vccnz LS_r12
LS_b12:
    v_mfma_f32_16x16x32_bf16 v[156:159], v[220:223], v[124:127], v[156:159]
    s_waitcnt lgkmcnt(0)
    v_mfma_f32_16x16x32_bf16 v[32:35], v[224:227], v[176:179], v[32:35]
    ds_read_b128 v[192:195], v3 offset:16896
    ds_read_b128 v[196:199], v3 offset:17408
    v_mfma_f32_16x16x32_bf16 v[64:67], v[224:227], v[180:183], v[64:67]
    ds_read_b128 v[200:203], v3 offset:16960
    ds_read_b128 v[204:207], v3 offset:17472
    v_mfma_f32_16x16x32_bf16 v[36:39], v[228:231], v[176:179], v[36:39]
    ds_read_b128 v[208:211], v3 offset:17024
    ds_read_b128 v[212:215], v3 offset:17536
    v_mfma_f32_16x16x32_bf16 v[68:71], v[228:231], v[180:183], v[68:71]
    ds_read_b128 v[216:219], v3 offset:17088
    ds_read_b128 v[220:223], v3 offset:17600
    v_mfma_f32_16x16x32_bf16 v[40:43], v[232:235], v[176:179], v[40:43]
    v_mfma_f32_16x16x32_bf16 v[72:75], v[232:235], v[180:183], v[72:75]
    v_mfma_f32_16x16x32_bf16 v[44:47], v[236:239], v[176:179], v[44:47]
    v_mfma_f32_16x16x32_bf16 v[76:79], v[236:239], v[180:183], v[76:79]
    v_mfma_f32_16x16x32_bf16 v[48:51], v[240:243], v[176:179], v[48:51]
    v_mfma_f32_16x16x32_bf16 v[80:83], v[240:243], v[180:183], v[80:83]
    v_mfma_f32_16x16x32_bf16 v[52:55], v[244:247], v[176:179], v[52:55]
    v_mfma_f32_16x16x32_bf16 v[84:87], v[244:247], v[180:183], v[84:87]
    v_mfma_f32_16x16x32_bf16 v[56:59], v[248:251], v[176:179], v[56:59]
    v_mfma_f32_16x16x32_bf16 v[88:91], v[248:251], v[180:183], v[88:91]
    v_mfma_f32_16x16x32_bf16 v[60:63], v[252:255], v[176:179], v[60:63]
    v_exp_f32 v20, v144
    v_exp_f32 v21, v145
    v_exp_f32 v22, v146
    v_add_f32 v170, v168, v20
    v_exp_f32 v23, v147
    v_add_f32 v170, v170, v21
    v_cvt_pk_bf16_f32 v184, v20, v21
    v_exp_f32 v24, v148
    v_add_f32 v170, v170, v22
    v_exp_f32 v25, v149
    v_mfma_f32_16x16x32_bf16 v[92:95], v[252:255], v[180:183], v[92:95]
    v_add_f32 v170, v170, v23
    v_cvt_pk_bf16_f32 v185, v22, v23
    v_exp_f32 v26, v150
    v_add_f32 v170, v170, v24
    v_exp_f32 v27, v151
    v_add_f32 v170, v170, v25
    v_cvt_pk_bf16_f32 v186, v24, v25
    v_exp_f32 v20, v152
    v_add_f32 v170, v170, v26
    s_waitcnt vmcnt(13) lgkmcnt(0)
    s_barrier
    v_mfma_f32_16x16x32_bf16 v[128:131], v[192:195], v[96:99], v[160:163]
    s_mov_b32 s46, 155648
    s_add_u32 m0, s52, 0
    v_mfma_f32_16x16x32_bf16 v[136:139], v[192:195], v[112:115], v[164:167]
    buffer_load_dwordx4 v6, s[8:11], s46 offen offset:0 nt lds
    v_mfma_f32_16x16x32_bf16 v[132:135], v[196:199], v[96:99], v[160:163]
    s_add_u32 m0, s52, 800
    v_mfma_f32_16x16x32_bf16 v[140:143], v[196:199], v[112:115], v[164:167]
    buffer_load_dwordx4 v6, s[8:11], s46 offen offset:256 nt lds
    v_mfma_f32_16x16x32_bf16 v[128:131], v[200:203], v[100:103], v[128:131]
    s_mov_b32 s46, 139264
    s_add_u32 m0, s52, 8448
    v_mfma_f32_16x16x32_bf16 v[136:139], v[200:203], v[116:119], v[136:139]
    buffer_load_dwordx4 v6, s[12:15], s46 offen offset:0 nt lds
    v_mfma_f32_16x16x32_bf16 v[132:135], v[204:207], v[100:103], v[132:135]
    s_add_u32 m0, s52, 9248
    v_mfma_f32_16x16x32_bf16 v[140:143], v[204:207], v[116:119], v[140:143]
    buffer_load_dwordx4 v6, s[12:15], s46 offen offset:256 nt lds
    v_mfma_f32_16x16x32_bf16 v[128:131], v[208:211], v[104:107], v[128:131]
    ds_read_b64_tr_b16 v[224:225], v17 offset:33792
    ds_read_b64_tr_b16 v[226:227], v17 offset:34304
    ds_read_b64_tr_b16 v[228:229], v17 offset:33824
    ds_read_b64_tr_b16 v[230:231], v17 offset:34336
    v_mfma_f32_16x16x32_bf16 v[136:139], v[208:211], v[120:123], v[136:139]
    ds_read_b64_tr_b16 v[232:233], v17 offset:33856
    ds_read_b64_tr_b16 v[234:235], v17 offset:34368
    ds_read_b64_tr_b16 v[236:237], v17 offset:33888
    ds_read_b64_tr_b16 v[238:239], v17 offset:34400
    v_mfma_f32_16x16x32_bf16 v[132:135], v[212:215], v[104:107], v[132:135]
    ds_read_b64_tr_b16 v[240:241], v17 offset:33920
    ds_read_b64_tr_b16 v[242:243], v17 offset:34432
    ds_read_b64_tr_b16 v[244:245], v17 offset:33952
    ds_read_b64_tr_b16 v[246:247], v17 offset:34464
    v_exp_f32 v21, v153
    v_add_f32 v170, v170, v27
    v_cvt_pk_bf16_f32 v187, v26, v27
    v_exp_f32 v22, v154
    v_add_f32 v171, v169, v20
    v_exp_f32 v23, v155
    v_add_f32 v171, v171, v21
    v_mfma_f32_16x16x32_bf16 v[140:143], v[212:215], v[120:123], v[140:143]
    ds_read_b64_tr_b16 v[248:249], v17 offset:33984
    ds_read_b64_tr_b16 v[250:251], v17 offset:34496
    ds_read_b64_tr_b16 v[252:253], v17 offset:34016
    ds_read_b64_tr_b16 v[254:255], v17 offset:34528
    v_cvt_pk_bf16_f32 v188, v20, v21
    v_exp_f32 v24, v156
    v_add_f32 v171, v171, v22
    v_exp_f32 v25, v157
    v_add_f32 v171, v171, v23
    v_cvt_pk_bf16_f32 v189, v22, v23
    v_exp_f32 v26, v158
    v_mfma_f32_16x16x32_bf16 v[128:131], v[216:219], v[108:111], v[128:131]
    v_add_f32 v171, v171, v24
    v_exp_f32 v27, v159
    v_add_f32 v171, v171, v25
    v_cvt_pk_bf16_f32 v190, v24, v25
    v_add_f32 v171, v171, v26
    v_add_f32 v171, v171, v27
    v_cvt_pk_bf16_f32 v191, v26, v27
    v_mfma_f32_16x16x32_bf16 v[136:139], v[216:219], v[124:127], v[136:139]
    v_max_f32 v30, v170, v171
    v_cmp_lt_f32 vcc, s49, v30
    v_mfma_f32_16x16x32_bf16 v[132:135], v[220:223], v[108:111], v[132:135]
    s_cbranch_vccnz LS_r13
LS_b13:
    v_mfma_f32_16x16x32_bf16 v[140:143], v[220:223], v[124:127], v[140:143]
    s_waitcnt lgkmcnt(0)
    v_mfma_f32_16x16x32_bf16 v[32:35], v[224:227], v[184:187], v[32:35]
    ds_read_b128 v[192:195], v3 offset:33792
    ds_read_b128 v[196:199], v3 offset:34304
    v_mfma_f32_16x16x32_bf16 v[64:67], v[224:227], v[188:191], v[64:67]
    ds_read_b128 v[200:203], v3 offset:33856
    ds_read_b128 v[204:207], v3 offset:34368
    v_mfma_f32_16x16x32_bf16 v[36:39], v[228:231], v[184:187], v[36:39]
    ds_read_b128 v[208:211], v3 offset:33920
    ds_read_b128 v[212:215], v3 offset:34432
    v_mfma_f32_16x16x32_bf16 v[68:71], v[228:231], v[188:191], v[68:71]
    ds_read_b128 v[216:219], v3 offset:33984
    ds_read_b128 v[220:223], v3 offset:34496
    v_mfma_f32_16x16x32_bf16 v[40:43], v[232:235], v[184:187], v[40:43]
    v_mfma_f32_16x16x32_bf16 v[72:75], v[232:235], v[188:191], v[72:75]
    v_mfma_f32_16x16x32_bf16 v[44:47], v[236:239], v[184:187], v[44:47]
    v_mfma_f32_16x16x32_bf16 v[76:79], v[236:239], v[188:191], v[76:79]
    v_mfma_f32_16x16x32_bf16 v[48:51], v[240:243], v[184:187], v[48:51]
    v_mfma_f32_16x16x32_bf16 v[80:83], v[240:243], v[188:191], v[80:83]
    v_mfma_f32_16x16x32_bf16 v[52:55], v[244:247], v[184:187], v[52:55]
    v_mfma_f32_16x16x32_bf16 v[84:87], v[244:247], v[188:191], v[84:87]
    v_mfma_f32_16x16x32_bf16 v[56:59], v[248:251], v[184:187], v[56:59]
    v_mfma_f32_16x16x32_bf16 v[88:91], v[248:251], v[188:191], v[88:91]
    v_mfma_f32_16x16x32_bf16 v[60:63], v[252:255], v[184:187], v[60:63]
    v_exp_f32 v20, v128
    v_exp_f32 v21, v129
    v_exp_f32 v22, v130
    v_add_f32 v168, v170, v20
    v_exp_f32 v23, v131
    v_add_f32 v168, v168, v21
    v_cvt_pk_bf16_f32 v176, v20, v21
    v_exp_f32 v24, v132
    v_add_f32 v168, v168, v22
    v_exp_f32 v25, v133
    v_mfma_f32_16x16x32_bf16 v[92:95], v[252:255], v[188:191], v[92:95]
    v_add_f32 v168, v168, v23
    v_cvt_pk_bf16_f32 v177, v22, v23
    v_exp_f32 v26, v134
    v_add_f32 v168, v168, v24
    v_exp_f32 v27, v135
    v_add_f32 v168, v168, v25
    v_cvt_pk_bf16_f32 v178, v24, v25
    v_exp_f32 v20, v136
    v_add_f32 v168, v168, v26
    s_waitcnt vmcnt(12) lgkmcnt(0)
    s_barrier
    v_mfma_f32_16x16x32_bf16 v[144:147], v[192:195], v[96:99], v[160:163]
    s_mov_b32 s46, 163840
    s_add_u32 m0, s52, 16896
    v_mfma_f32_16x16x32_bf16 v[152:155], v[192:195], v[112:115], v[164:167]
    buffer_load_dwordx4 v6, s[8:11], s46 offen offset:0 nt lds
    v_mfma_f32_16x16x32_bf16 v[148:151], v[196:199], v[96:99], v[160:163]
    s_add_u32 m0, s52, 17696
    v_mfma_f32_16x16x32_bf16 v[156:159], v[196:199], v[112:115], v[164:167]
    buffer_load_dwordx4 v6, s[8:11], s46 offen offset:256 nt lds
    v_mfma_f32_16x16x32_bf16 v[144:147], v[200:203], v[100:103], v[144:147]
    s_mov_b32 s46, 147456
    s_add_u32 m0, s52, 25344
    v_mfma_f32_16x16x32_bf16 v[152:155], v[200:203], v[116:119], v[152:155]
    buffer_load_dwordx4 v6, s[12:15], s46 offen offset:0 nt lds
    v_mfma_f32_16x16x32_bf16 v[148:151], v[204:207], v[100:103], v[148:151]
    s_add_u32 m0, s52, 26144
    v_mfma_f32_16x16x32_bf16 v[156:159], v[204:207], v[116:119], v[156:159]
    buffer_load_dwordx4 v6, s[12:15], s46 offen offset:256 nt lds
    v_mfma_f32_16x16x32_bf16 v[144:147], v[208:211], v[104:107], v[144:147]
    ds_read_b64_tr_b16 v[224:225], v18 offset:0
    ds_read_b64_tr_b16 v[226:227], v18 offset:512
    ds_read_b64_tr_b16 v[228:229], v18 offset:32
    ds_read_b64_tr_b16 v[230:231], v18 offset:544
    v_mfma_f32_16x16x32_bf16 v[152:155], v[208:211], v[120:123], v[152:155]
    ds_read_b64_tr_b16 v[232:233], v18 offset:64
    ds_read_b64_tr_b16 v[234:235], v18 offset:576
    ds_read_b64_tr_b16 v[236:237], v18 offset:96
    ds_read_b64_tr_b16 v[238:239], v18 offset:608
    v_mfma_f32_16x16x32_bf16 v[148:151], v[212:215], v[104:107], v[148:151]
    ds_read_b64_tr_b16 v[240:241], v18 offset:128
    ds_read_b64_tr_b16 v[242:243], v18 offset:640
    ds_read_b64_tr_b16 v[244:245], v18 offset:160
    ds_read_b64_tr_b16 v[246:247], v18 offset:672
    v_exp_f32 v21, v137
    v_add_f32 v168, v168, v27
    v_cvt_pk_bf16_f32 v179, v26, v27
    v_exp_f32 v22, v138
    v_add_f32 v169, v171, v20
    v_exp_f32 v23, v139
    v_add_f32 v169, v169, v21
    v_mfma_f32_16x16x32_bf16 v[156:159], v[212:215], v[120:123], v[156:159]
    ds_read_b64_tr_b16 v[248:249], v18 offset:192
    ds_read_b64_tr_b16 v[250:251], v18 offset:704
    ds_read_b64_tr_b16 v[252:253], v18 offset:224
    ds_read_b64_tr_b16 v[254:255], v18 offset:736
    v_cvt_pk_bf16_f32 v180, v20, v21
    v_exp_f32 v24, v140
    v_add_f32 v169, v169, v22
    v_exp_f32 v25, v141
    v_add_f32 v169, v169, v23
    v_cvt_pk_bf16_f32 v181, v22, v23
    v_exp_f32 v26, v142
    v_mfma_f32_16x16x32_bf16 v[144:147], v[216:219], v[108:111], v[144:147]
    v_add_f32 v169, v169, v24
    v_exp_f32 v27, v143
    v_add_f32 v169, v169, v25
    v_cvt_pk_bf16_f32 v182, v24, v25
    v_add_f32 v169, v169, v26
    v_add_f32 v169, v169, v27
    v_cvt_pk_bf16_f32 v183, v26, v27
    v_mfma_f32_16x16x32_bf16 v[152:155], v[216:219], v[124:127], v[152:155]
    v_max_f32 v30, v168, v169
    v_cmp_lt_f32 vcc, s49, v30
    v_mfma_f32_16x16x32_bf16 v[148:151], v[220:223], v[108:111], v[148:151]
    s_cbranch_vccnz LS_r14
LS_b14:
    v_mfma_f32_16x16x32_bf16 v[156:159], v[220:223], v[124:127], v[156:159]
    s_waitcnt lgkmcnt(0)
    v_mfma_f32_16x16x32_bf16 v[32:35], v[224:227], v[176:179], v[32:35]
    ds_read_b128 v[192:195], v4 offset:0
    ds_read_b128 v[196:199], v4 offset:512
    v_mfma_f32_16x16x32_bf16 v[64:67], v[224:227], v[180:183], v[64:67]
    ds_read_b128 v[200:203], v4 offset:64
    ds_read_b128 v[204:207], v4 offset:576
    v_mfma_f32_16x16x32_bf16 v[36:39], v[228:231], v[176:179], v[36:39]
    ds_read_b128 v[208:211], v4 offset:128
    ds_read_b128 v[212:215], v4 offset:640
    v_mfma_f32_16x16x32_bf16 v[68:71], v[228:231], v[180:183], v[68:71]
    ds_read_b128 v[216:219], v4 offset:192
    ds_read_b128 v[220:223], v4 offset:704
    v_mfma_f32_16x16x32_bf16 v[40:43], v[232:235], v[176:179], v[40:43]
    v_mfma_f32_16x16x32_bf16 v[72:75], v[232:235], v[180:183], v[72:75]
    v_mfma_f32_16x16x32_bf16 v[44:47], v[236:239], v[176:179], v[44:47]
    v_mfma_f32_16x16x32_bf16 v[76:79], v[236:239], v[180:183], v[76:79]
    v_mfma_f32_16x16x32_bf16 v[48:51], v[240:243], v[176:179], v[48:51]
    v_mfma_f32_16x16x32_bf16 v[80:83], v[240:243], v[180:183], v[80:83]
    v_mfma_f32_16x16x32_bf16 v[52:55], v[244:247], v[176:179], v[52:55]
    v_mfma_f32_16x16x32_bf16 v[84:87], v[244:247], v[180:183], v[84:87]
    v_mfma_f32_16x16x32_bf16 v[56:59], v[248:251], v[176:179], v[56:59]
    v_mfma_f32_16x16x32_bf16 v[88:91], v[248:251], v[180:183], v[88:91]
    v_mfma_f32_16x16x32_bf16 v[60:63], v[252:255], v[176:179], v[60:63]
    v_exp_f32 v20, v144
    v_exp_f32 v21, v145
    v_exp_f32 v22, v146
    v_add_f32 v170, v168, v20
    v_exp_f32 v23, v147
    v_add_f32 v170, v170, v21
    v_cvt_pk_bf16_f32 v184, v20, v21
    v_exp_f32 v24, v148
    v_add_f32 v170, v170, v22
    v_exp_f32 v25, v149
    v_mfma_f32_16x16x32_bf16 v[92:95], v[252:255], v[180:183], v[92:95]
    v_add_f32 v170, v170, v23
    v_cvt_pk_bf16_f32 v185, v22, v23
    v_exp_f32 v26, v150
    v_add_f32 v170, v170, v24
    v_exp_f32 v27, v151
    v_add_f32 v170, v170, v25
    v_cvt_pk_bf16_f32 v186, v24, v25
    v_exp_f32 v20, v152
    v_add_f32 v170, v170, v26
    s_waitcnt vmcnt(12) lgkmcnt(0)
    s_barrier
    v_mfma_f32_16x16x32_bf16 v[128:131], v[192:195], v[96:99], v[160:163]
    s_mov_b32 s46, 172032
    s_add_u32 m0, s52, 33792
    v_mfma_f32_16x16x32_bf16 v[136:139], v[192:195], v[112:115], v[164:167]
    buffer_load_dwordx4 v6, s[8:11], s46 offen offset:0 nt lds
    v_mfma_f32_16x16x32_bf16 v[132:135], v[196:199], v[96:99], v[160:163]
    s_add_u32 m0, s52, 34592
    v_mfma_f32_16x16x32_bf16 v[140:143], v[196:199], v[112:115], v[164:167]
    buffer_load_dwordx4 v6, s[8:11], s46 offen offset:256 nt lds
    v_mfma_f32_16x16x32_bf16 v[128:131], v[200:203], v[100:103], v[128:131]
    s_mov_b32 s46, 155648
    s_add_u32 m0, s52, 42240
    v_mfma_f32_16x16x32_bf16 v[136:139], v[200:203], v[116:119], v[136:139]
    buffer_load_dwordx4 v6, s[12:15], s46 offen offset:0 nt lds
    v_mfma_f32_16x16x32_bf16 v[132:135], v[204:207], v[100:103], v[132:135]
    s_add_u32 m0, s52, 43040
    v_mfma_f32_16x16x32_bf16 v[140:143], v[204:207], v[116:119], v[140:143]
    buffer_load_dwordx4 v6, s[12:15], s46 offen offset:256 nt lds
    v_mfma_f32_16x16x32_bf16 v[128:131], v[208:211], v[104:107], v[128:131]
    ds_read_b64_tr_b16 v[224:225], v18 offset:16896
    ds_read_b64_tr_b16 v[226:227], v18 offset:17408
    ds_read_b64_tr_b16 v[228:229], v18 offset:16928
    ds_read_b64_tr_b16 v[230:231], v18 offset:17440
    v_mfma_f32_16x16x32_bf16 v[136:139], v[208:211], v[120:123], v[136:139]
    ds_read_b64_tr_b16 v[232:233], v18 offset:16960
    ds_read_b64_tr_b16 v[234:235], v18 offset:17472
    ds_read_b64_tr_b16 v[236:237], v18 offset:16992
    ds_read_b64_tr_b16 v[238:239], v18 offset:17504
    v_mfma_f32_16x16x32_bf16 v[132:135], v[212:215], v[104:107], v[132:135]
    ds_read_b64_tr_b16 v[240:241], v18 offset:17024
    ds_read_b64_tr_b16 v[242:243], v18 offset:17536
    ds_read_b64_tr_b16 v[244:245], v18 offset:17056
    ds_read_b64_tr_b16 v[246:247], v18 offset:17568
    v_exp_f32 v21, v153
    v_add_f32 v170, v170, v27
    v_cvt_pk_bf16_f32 v187, v26, v27
    v_exp_f32 v22, v154
    v_add_f32 v171, v169, v20
    v_exp_f32 v23, v155
    v_add_f32 v171, v171, v21
    v_mfma_f32_16x16x32_bf16 v[140:143], v[212:215], v[120:123], v[140:143]
    ds_read_b64_tr_b16 v[248:249], v18 offset:17088
    ds_read_b64_tr_b16 v[250:251], v18 offset:17600
    ds_read_b64_tr_b16 v[252:253], v18 offset:17120
    ds_read_b64_tr_b16 v[254:255], v18 offset:17632
    v_cvt_pk_bf16_f32 v188, v20, v21
    v_exp_f32 v24, v156
    v_add_f32 v171, v171, v22
    v_exp_f32 v25, v157
    v_add_f32 v171, v171, v23
    v_cvt_pk_bf16_f32 v189, v22, v23
    v_exp_f32 v26, v158
    v_mfma_f32_16x16x32_bf16 v[128:131], v[216:219], v[108:111], v[128:131]
    v_add_f32 v171, v171, v24
    v_exp_f32 v27, v159
    v_add_f32 v171, v171, v25
    v_cvt_pk_bf16_f32 v190, v24, v25
    v_add_f32 v171, v171, v26
    v_add_f32 v171, v171, v27
    v_cvt_pk_bf16_f32 v191, v26, v27
    v_mfma_f32_16x16x32_bf16 v[136:139], v[216:219], v[124:127], v[136:139]
    v_max_f32 v30, v170, v171
    v_cmp_lt_f32 vcc, s49, v30
    v_mfma_f32_16x16x32_bf16 v[132:135], v[220:223], v[108:111], v[132:135]
    s_cbranch_vccnz LS_r15
LS_b15:
    v_mfma_f32_16x16x32_bf16 v[140:143], v[220:223], v[124:127], v[140:143]
    s_waitcnt lgkmcnt(0)
    v_mfma_f32_16x16x32_bf16 v[32:35], v[224:227], v[184:187], v[32:35]
    ds_read_b128 v[192:195], v4 offset:16896
    ds_read_b128 v[196:199], v4 offset:17408
    v_mfma_f32_16x16x32_bf16 v[64:67], v[224:227], v[188:191], v[64:67]
    ds_read_b128 v[200:203], v4 offset:16960
    ds_read_b128 v[204:207], v4 offset:17472
    v_mfma_f32_16x16x32_bf16 v[36:39], v[228:231], v[184:187], v[36:39]
    ds_read_b128 v[208:211], v4 offset:17024
    ds_read_b128 v[212:215], v4 offset:17536
    v_mfma_f32_16x16x32_bf16 v[68:71], v[228:231], v[188:191], v[68:71]
    ds_read_b128 v[216:219], v4 offset:17088
    ds_read_b128 v[220:223], v4 offset:17600
    v_mfma_f32_16x16x32_bf16 v[40:43], v[232:235], v[184:187], v[40:43]
    v_mfma_f32_16x16x32_bf16 v[72:75], v[232:235], v[188:191], v[72:75]
    v_mfma_f32_16x16x32_bf16 v[44:47], v[236:239], v[184:187], v[44:47]
    v_mfma_f32_16x16x32_bf16 v[76:79], v[236:239], v[188:191], v[76:79]
    v_mfma_f32_16x16x32_bf16 v[48:51], v[240:243], v[184:187], v[48:51]
    v_mfma_f32_16x16x32_bf16 v[80:83], v[240:243], v[188:191], v[80:83]
    v_mfma_f32_16x16x32_bf16 v[52:55], v[244:247], v[184:187], v[52:55]
    v_mfma_f32_16x16x32_bf16 v[84:87], v[244:247], v[188:191], v[84:87]
    v_mfma_f32_16x16x32_bf16 v[56:59], v[248:251], v[184:187], v[56:59]
    v_mfma_f32_16x16x32_bf16 v[88:91], v[248:251], v[188:191], v[88:91]
    v_mfma_f32_16x16x32_bf16 v[60:63], v[252:255], v[184:187], v[60:63]
    v_exp_f32 v20, v128
    v_exp_f32 v21, v129
    v_exp_f32 v22, v130
    v_add_f32 v168, v170, v20
    v_exp_f32 v23, v131
    v_add_f32 v168, v168, v21
    v_cvt_pk_bf16_f32 v176, v20, v21
    v_exp_f32 v24, v132
    v_add_f32 v168, v168, v22
    v_exp_f32 v25, v133
    v_mfma_f32_16x16x32_bf16 v[92:95], v[252:255], v[188:191], v[92:95]
    global_load_dword v9, v8, s[0:1]
    v_add_f32 v168, v168, v23
    v_cvt_pk_bf16_f32 v177, v22, v23
    v_exp_f32 v26, v134
    v_add_f32 v168, v168, v24
    v_exp_f32 v27, v135
    v_add_f32 v168, v168, v25
    v_cvt_pk_bf16_f32 v178, v24, v25
    v_exp_f32 v20, v136
    v_add_f32 v168, v168, v26
    s_waitcnt vmcnt(13) lgkmcnt(0)
    s_barrier
    v_mfma_f32_16x16x32_bf16 v[144:147], v[192:195], v[96:99], v[160:163]
    v_mfma_f32_16x16x32_bf16 v[152:155], v[192:195], v[112:115], v[164:167]
    v_mfma_f32_16x16x32_bf16 v[148:151], v[196:199], v[96:99], v[160:163]
    v_mfma_f32_16x16x32_bf16 v[156:159], v[196:199], v[112:115], v[164:167]
    v_mfma_f32_16x16x32_bf16 v[144:147], v[200:203], v[100:103], v[144:147]
    v_mfma_f32_16x16x32_bf16 v[152:155], v[200:203], v[116:119], v[152:155]
    v_mfma_f32_16x16x32_bf16 v[148:151], v[204:207], v[100:103], v[148:151]
    v_mfma_f32_16x16x32_bf16 v[156:159], v[204:207], v[116:119], v[156:159]
    v_mfma_f32_16x16x32_bf16 v[144:147], v[208:211], v[104:107], v[144:147]
    ds_read_b64_tr_b16 v[224:225], v18 offset:33792
    ds_read_b64_tr_b16 v[226:227], v18 offset:34304
    ds_read_b64_tr_b16 v[228:229], v18 offset:33824
    ds_read_b64_tr_b16 v[230:231], v18 offset:34336
    v_mfma_f32_16x16x32_bf16 v[152:155], v[208:211], v[120:123], v[152:155]
    ds_read_b64_tr_b16 v[232:233], v18 offset:33856
    ds_read_b64_tr_b16 v[234:235], v18 offset:34368
    ds_read_b64_tr_b16 v[236:237], v18 offset:33888
    ds_read_b64_tr_b16 v[238:239], v18 offset:34400
    v_mfma_f32_16x16x32_bf16 v[148:151], v[212:215], v[104:107], v[148:151]
    ds_read_b64_tr_b16 v[240:241], v18 offset:33920
    ds_read_b64_tr_b16 v[242:243], v18 offset:34432
    ds_read_b64_tr_b16 v[244:245], v18 offset:33952
    ds_read_b64_tr_b16 v[246:247], v18 offset:34464
    v_exp_f32 v21, v137
    v_add_f32 v168, v168, v27
    v_cvt_pk_bf16_f32 v179, v26, v27
    v_exp_f32 v22, v138
    v_add_f32 v169, v171, v20
    v_exp_f32 v23, v139
    v_add_f32 v169, v169, v21
    v_mfma_f32_16x16x32_bf16 v[156:159], v[212:215], v[120:123], v[156:159]
    ds_read_b64_tr_b16 v[248:249], v18 offset:33984
    ds_read_b64_tr_b16 v[250:251], v18 offset:34496
    ds_read_b64_tr_b16 v[252:253], v18 offset:34016
    ds_read_b64_tr_b16 v[254:255], v18 offset:34528
    v_cvt_pk_bf16_f32 v180, v20, v21
    v_exp_f32 v24, v140
    v_add_f32 v169, v169, v22
    v_exp_f32 v25, v141
    v_add_f32 v169, v169, v23
    v_cvt_pk_bf16_f32 v181, v22, v23
    v_exp_f32 v26, v142
    v_mfma_f32_16x16x32_bf16 v[144:147], v[216:219], v[108:111], v[144:147]
    v_add_f32 v169, v169, v24
    v_exp_f32 v27, v143
    v_add_f32 v169, v169, v25
    v_cvt_pk_bf16_f32 v182, v24, v25
    v_add_f32 v169, v169, v26
    v_add_f32 v169, v169, v27
    v_cvt_pk_bf16_f32 v183, v26, v27
    v_mfma_f32_16x16x32_bf16 v[152:155], v[216:219], v[124:127], v[152:155]
    v_max_f32 v30, v168, v169
    v_cmp_lt_f32 vcc, s49, v30
    v_mfma_f32_16x16x32_bf16 v[148:151], v[220:223], v[108:111], v[148:151]
    s_cbranch_vccnz LS_r16
LS_b16:
    v_mfma_f32_16x16x32_bf16 v[156:159], v[220:223], v[124:127], v[156:159]
    s_waitcnt lgkmcnt(0)
    v_mfma_f32_16x16x32_bf16 v[32:35], v[224:227], v[176:179], v[32:35]
    ds_read_b128 v[192:195], v4 offset:33792
    ds_read_b128 v[196:199], v4 offset:34304
    v_mfma_f32_16x16x32_bf16 v[64:67], v[224:227], v[180:183], v[64:67]
    ds_read_b128 v[200:203], v4 offset:33856
    ds_read_b128 v[204:207], v4 offset:34368
    v_mfma_f32_16x16x32_bf16 v[36:39], v[228:231], v[176:179], v[36:39]
    ds_read_b128 v[208:211], v4 offset:33920
    ds_read_b128 v[212:215], v4 offset:34432
    v_mfma_f32_16x16x32_bf16 v[68:71], v[228:231], v[180:183], v[68:71]
    ds_read_b128 v[216:219], v4 offset:33984
    ds_read_b128 v[220:223], v4 offset:34496
    v_mfma_f32_16x16x32_bf16 v[40:43], v[232:235], v[176:179], v[40:43]
    v_mfma_f32_16x16x32_bf16 v[72:75], v[232:235], v[180:183], v[72:75]
    v_mfma_f32_16x16x32_bf16 v[44:47], v[236:239], v[176:179], v[44:47]
    v_mfma_f32_16x16x32_bf16 v[76:79], v[236:239], v[180:183], v[76:79]
    v_mfma_f32_16x16x32_bf16 v[48:51], v[240:243], v[176:179], v[48:51]
    v_mfma_f32_16x16x32_bf16 v[80:83], v[240:243], v[180:183], v[80:83]
    v_mfma_f32_16x16x32_bf16 v[52:55], v[244:247], v[176:179], v[52:55]
    v_mfma_f32_16x16x32_bf16 v[84:87], v[244:247], v[180:183], v[84:87]
    v_mfma_f32_16x16x32_bf16 v[56:59], v[248:251], v[176:179], v[56:59]
    v_mfma_f32_16x16x32_bf16 v[88:91], v[248:251], v[180:183], v[88:91]
    v_mfma_f32_16x16x32_bf16 v[60:63], v[252:255], v[176:179], v[60:63]
    v_exp_f32 v20, v144
    v_exp_f32 v21, v145
    v_exp_f32 v22, v146
    v_add_f32 v170, v168, v20
    v_exp_f32 v23, v147
    v_add_f32 v170, v170, v21
    v_cvt_pk_bf16_f32 v184, v20, v21
    v_exp_f32 v24, v148
    v_add_f32 v170, v170, v22
    v_exp_f32 v25, v149
    v_mfma_f32_16x16x32_bf16 v[92:95], v[252:255], v[180:183], v[92:95]
    v_add_f32 v170, v170, v23
    v_cvt_pk_bf16_f32 v185, v22, v23
    v_exp_f32 v26, v150
    v_add_f32 v170, v170, v24
    v_exp_f32 v27, v151
    v_add_f32 v170, v170, v25
    v_cvt_pk_bf16_f32 v186, v24, v25
    v_exp_f32 v20, v152
    v_add_f32 v170, v170, v26
    s_waitcnt vmcnt(9) lgkmcnt(0)
    s_barrier
    v_mfma_f32_16x16x32_bf16 v[128:131], v[192:195], v[96:99], v[160:163]
    s_mov_b32 s46, 180224
    s_add_u32 m0, s52, 50688
    v_mfma_f32_16x16x32_bf16 v[136:139], v[192:195], v[112:115], v[164:167]
    buffer_load_dwordx4 v6, s[8:11], s46 offen offset:0 nt lds
    v_mfma_f32_16x16x32_bf16 v[132:135], v[196:199], v[96:99], v[160:163]
    s_add_u32 m0, s52, 51488
    v_mfma_f32_16x16x32_bf16 v[140:143], v[196:199], v[112:115], v[164:167]
    buffer_load_dwordx4 v6, s[8:11], s46 offen offset:256 nt lds
    v_mfma_f32_16x16x32_bf16 v[128:131], v[200:203], v[100:103], v[128:131]
    s_mov_b32 s46, 163840
    s_add_u32 m0, s52, 59136
    v_mfma_f32_16x16x32_bf16 v[136:139], v[200:203], v[116:119], v[136:139]
    buffer_load_dwordx4 v6, s[12:15], s46 offen offset:0 nt lds
    v_mfma_f32_16x16x32_bf16 v[132:135], v[204:207], v[100:103], v[132:135]
    s_add_u32 m0, s52, 59936
    v_mfma_f32_16x16x32_bf16 v[140:143], v[204:207], v[116:119], v[140:143]
    buffer_load_dwordx4 v6, s[12:15], s46 offen offset:256 nt lds
    v_mfma_f32_16x16x32_bf16 v[128:131], v[208:211], v[104:107], v[128:131]
    ds_read_b64_tr_b16 v[224:225], v16 offset:0
    ds_read_b64_tr_b16 v[226:227], v16 offset:512
    ds_read_b64_tr_b16 v[228:229], v16 offset:32
    ds_read_b64_tr_b16 v[230:231], v16 offset:544
    v_mfma_f32_16x16x32_bf16 v[136:139], v[208:211], v[120:123], v[136:139]
    ds_read_b64_tr_b16 v[232:233], v16 offset:64
    ds_read_b64_tr_b16 v[234:235], v16 offset:576
    ds_read_b64_tr_b16 v[236:237], v16 offset:96
    ds_read_b64_tr_b16 v[238:239], v16 offset:608
    v_mfma_f32_16x16x32_bf16 v[132:135], v[212:215], v[104:107], v[132:135]
    ds_read_b64_tr_b16 v[240:241], v16 offset:128
    ds_read_b64_tr_b16 v[242:243], v16 offset:640
    ds_read_b64_tr_b16 v[244:245], v16 offset:160
    ds_read_b64_tr_b16 v[246:247], v16 offset:672
    v_exp_f32 v21, v153
    v_add_f32 v170, v170, v27
    v_cvt_pk_bf16_f32 v187, v26, v27
    v_exp_f32 v22, v154
    v_add_f32 v171, v169, v20
    v_exp_f32 v23, v155
    v_add_f32 v171, v171, v21
    v_mfma_f32_16x16x32_bf16 v[140:143], v[212:215], v[120:123], v[140:143]
    ds_read_b64_tr_b16 v[248:249], v16 offset:192
    ds_read_b64_tr_b16 v[250:251], v16 offset:704
    ds_read_b64_tr_b16 v[252:253], v16 offset:224
    ds_read_b64_tr_b16 v[254:255], v16 offset:736
    v_cvt_pk_bf16_f32 v188, v20, v21
    v_exp_f32 v24, v156
    v_add_f32 v171, v171, v22
    v_exp_f32 v25, v157
    v_add_f32 v171, v171, v23
    v_cvt_pk_bf16_f32 v189, v22, v23
    v_exp_f32 v26, v158
    v_mfma_f32_16x16x32_bf16 v[128:131], v[216:219], v[108:111], v[128:131]
    v_add_f32 v171, v171, v24
    v_exp_f32 v27, v159
    v_add_f32 v171, v171, v25
    v_cvt_pk_bf16_f32 v190, v24, v25
    v_add_f32 v171, v171, v26
    v_add_f32 v171, v171, v27
    v_cvt_pk_bf16_f32 v191, v26, v27
    v_mfma_f32_16x16x32_bf16 v[136:139], v[216:219], v[124:127], v[136:139]
    v_max_f32 v30, v170, v171
    v_cmp_lt_f32 vcc, s49, v30
    v_mfma_f32_16x16x32_bf16 v[132:135], v[220:223], v[108:111], v[132:135]
    s_cbranch_vccnz LS_r17
LS_b17:
    v_mfma_f32_16x16x32_bf16 v[140:143], v[220:223], v[124:127], v[140:143]
    s_waitcnt lgkmcnt(0)
    v_mfma_f32_16x16x32_bf16 v[32:35], v[224:227], v[184:187], v[32:35]
    ds_read_b128 v[192:195], v2 offset:0
    ds_read_b128 v[196:199], v2 offset:512
    v_mfma_f32_16x16x32_bf16 v[64:67], v[224:227], v[188:191], v[64:67]
    ds_read_b128 v[200:203], v2 offset:64
    ds_read_b128 v[204:207], v2 offset:576
    v_mfma_f32_16x16x32_bf16 v[36:39], v[228:231], v[184:187], v[36:39]
    ds_read_b128 v[208:211], v2 offset:128
    ds_read_b128 v[212:215], v2 offset:640
    v_mfma_f32_16x16x32_bf16 v[68:71], v[228:231], v[188:191], v[68:71]
    ds_read_b128 v[216:219], v2 offset:192
    ds_read_b128 v[220:223], v2 offset:704
    v_mfma_f32_16x16x32_bf16 v[40:43], v[232:235], v[184:187], v[40:43]
    v_mfma_f32_16x16x32_bf16 v[72:75], v[232:235], v[188:191], v[72:75]
    v_mfma_f32_16x16x32_bf16 v[44:47], v[236:239], v[184:187], v[44:47]
    v_mfma_f32_16x16x32_bf16 v[76:79], v[236:239], v[188:191], v[76:79]
    v_mfma_f32_16x16x32_bf16 v[48:51], v[240:243], v[184:187], v[48:51]
    v_mfma_f32_16x16x32_bf16 v[80:83], v[240:243], v[188:191], v[80:83]
    v_mfma_f32_16x16x32_bf16 v[52:55], v[244:247], v[184:187], v[52:55]
    v_mfma_f32_16x16x32_bf16 v[84:87], v[244:247], v[188:191], v[84:87]
    v_mfma_f32_16x16x32_bf16 v[56:59], v[248:251], v[184:187], v[56:59]
    v_mfma_f32_16x16x32_bf16 v[88:91], v[248:251], v[188:191], v[88:91]
    v_mfma_f32_16x16x32_bf16 v[60:63], v[252:255], v[184:187], v[60:63]
    v_exp_f32 v20, v128
    v_exp_f32 v21, v129
    v_exp_f32 v22, v130
    v_add_f32 v168, v170, v20
    v_exp_f32 v23, v131
    v_add_f32 v168, v168, v21
    v_cvt_pk_bf16_f32 v176, v20, v21
    v_exp_f32 v24, v132
    v_add_f32 v168, v168, v22
    v_exp_f32 v25, v133
    v_mfma_f32_16x16x32_bf16 v[92:95], v[252:255], v[188:191], v[92:95]
    v_add_f32 v168, v168, v23
    v_cvt_pk_bf16_f32 v177, v22, v23
    v_exp_f32 v26, v134
    v_add_f32 v168, v168, v24
    v_exp_f32 v27, v135
    v_add_f32 v168, v168, v25
    v_cvt_pk_bf16_f32 v178, v24, v25
    v_exp_f32 v20, v136
    v_add_f32 v168, v168, v26
    s_waitcnt vmcnt(9) lgkmcnt(0)
    s_barrier
    v_mfma_f32_16x16x32_bf16 v[144:147], v[192:195], v[96:99], v[160:163]
    s_mov_b32 s46, 188416
    s_add_u32 m0, s52, 67584
    v_mfma_f32_16x16x32_bf16 v[152:155], v[192:195], v[112:115], v[164:167]
    buffer_load_dwordx4 v6, s[8:11], s46 offen offset:0 nt lds
    v_mfma_f32_16x16x32_bf16 v[148:151], v[196:199], v[96:99], v[160:163]
    s_add_u32 m0, s52, 68384
    v_mfma_f32_16x16x32_bf16 v[156:159], v[196:199], v[112:115], v[164:167]
    buffer_load_dwordx4 v6, s[8:11], s46 offen offset:256 nt lds
    v_mfma_f32_16x16x32_bf16 v[144:147], v[200:203], v[100:103], v[144:147]
    s_mov_b32 s46, 172032
    s_add_u32 m0, s52, 76032
    v_mfma_f32_16x16x32_bf16 v[152:155], v[200:203], v[116:119], v[152:155]
    buffer_load_dwordx4 v6, s[12:15], s46 offen offset:0 nt lds
    v_mfma_f32_16x16x32_bf16 v[148:151], v[204:207], v[100:103], v[148:151]
    s_add_u32 m0, s52, 76832
    v_mfma_f32_16x16x32_bf16 v[156:159], v[204:207], v[116:119], v[156:159]
    buffer_load_dwordx4 v6, s[12:15], s46 offen offset:256 nt lds
    v_mfma_f32_16x16x32_bf16 v[144:147], v[208:211], v[104:107], v[144:147]
    ds_read_b64_tr_b16 v[224:225], v16 offset:16896
    ds_read_b64_tr_b16 v[226:227], v16 offset:17408
    ds_read_b64_tr_b16 v[228:229], v16 offset:16928
    ds_read_b64_tr_b16 v[230:231], v16 offset:17440
    v_mfma_f32_16x16x32_bf16 v[152:155], v[208:211], v[120:123], v[152:155]
    ds_read_b64_tr_b16 v[232:233], v16 offset:16960
    ds_read_b64_tr_b16 v[234:235], v16 offset:17472
    ds_read_b64_tr_b16 v[236:237], v16 offset:16992
    ds_read_b64_tr_b16 v[238:239], v16 offset:17504
    v_mfma_f32_16x16x32_bf16 v[148:151], v[212:215], v[104:107], v[148:151]
    ds_read_b64_tr_b16 v[240:241], v16 offset:17024
    ds_read_b64_tr_b16 v[242:243], v16 offset:17536
    ds_read_b64_tr_b16 v[244:245], v16 offset:17056
    ds_read_b64_tr_b16 v[246:247], v16 offset:17568
    v_exp_f32 v21, v137
    v_add_f32 v168, v168, v27
    v_cvt_pk_bf16_f32 v179, v26, v27
    v_exp_f32 v22, v138
    v_add_f32 v169, v171, v20
    v_exp_f32 v23, v139
    v_add_f32 v169, v169, v21
    v_mfma_f32_16x16x32_bf16 v[156:159], v[212:215], v[120:123], v[156:159]
    ds_read_b64_tr_b16 v[248:249], v16 offset:17088
    ds_read_b64_tr_b16 v[250:251], v16 offset:17600
    ds_read_b64_tr_b16 v[252:253], v16 offset:17120
    ds_read_b64_tr_b16 v[254:255], v16 offset:17632
    v_cvt_pk_bf16_f32 v180, v20, v21
    v_exp_f32 v24, v140
    v_add_f32 v169, v169, v22
    v_exp_f32 v25, v141
    v_add_f32 v169, v169, v23
    v_cvt_pk_bf16_f32 v181, v22, v23
    v_exp_f32 v26, v142
    v_mfma_f32_16x16x32_bf16 v[144:147], v[216:219], v[108:111], v[144:147]
    v_add_f32 v169, v169, v24
    v_exp_f32 v27, v143
    v_add_f32 v169, v169, v25
    v_cvt_pk_bf16_f32 v182, v24, v25
    v_add_f32 v169, v169, v26
    v_add_f32 v169, v169, v27
    v_cvt_pk_bf16_f32 v183, v26, v27
    v_mfma_f32_16x16x32_bf16 v[152:155], v[216:219], v[124:127], v[152:155]
    v_max_f32 v30, v168, v169
    v_cmp_lt_f32 vcc, s49, v30
    v_mfma_f32_16x16x32_bf16 v[148:151], v[220:223], v[108:111], v[148:151]
    s_cbranch_vccnz LS_r18
LS_b18:
    v_mfma_f32_16x16x32_bf16 v[156:159], v[220:223], v[124:127], v[156:159]
    s_waitcnt lgkmcnt(0)
    v_mfma_f32_16x16x32_bf16 v[32:35], v[224:227], v[176:179], v[32:35]
    ds_read_b128 v[192:195], v2 offset:16896
    ds_read_b128 v[196:199], v2 offset:17408
    v_mfma_f32_16x16x32_bf16 v[64:67], v[224:227], v[180:183], v[64:67]
    ds_read_b128 v[200:203], v2 offset:16960
    ds_read_b128 v[204:207], v2 offset:17472
    v_mfma_f32_16x16x32_bf16 v[36:39], v[228:231], v[176:179], v[36:39]
    ds_read_b128 v[208:211], v2 offset:17024
    ds_read_b128 v[212:215], v2 offset:17536
    v_mfma_f32_16x16x32_bf16 v[68:71], v[228:231], v[180:183], v[68:71]
    ds_read_b128 v[216:219], v2 offset:17088
    ds_read_b128 v[220:223], v2 offset:17600
    v_mfma_f32_16x16x32_bf16 v[40:43], v[232:235], v[176:179], v[40:43]
    v_mfma_f32_16x16x32_bf16 v[72:75], v[232:235], v[180:183], v[72:75]
    v_mfma_f32_16x16x32_bf16 v[44:47], v[236:239], v[176:179], v[44:47]
    v_mfma_f32_16x16x32_bf16 v[76:79], v[236:239], v[180:183], v[76:79]
    v_mfma_f32_16x16x32_bf16 v[48:51], v[240:243], v[176:179], v[48:51]
    v_mfma_f32_16x16x32_bf16 v[80:83], v[240:243], v[180:183], v[80:83]
    v_mfma_f32_16x16x32_bf16 v[52:55], v[244:247], v[176:179], v[52:55]
    v_mfma_f32_16x16x32_bf16 v[84:87], v[244:247], v[180:183], v[84:87]
    v_mfma_f32_16x16x32_bf16 v[56:59], v[248:251], v[176:179], v[56:59]
    v_mfma_f32_16x16x32_bf16 v[88:91], v[248:251], v[180:183], v[88:91]
    v_mfma_f32_16x16x32_bf16 v[60:63], v[252:255], v[176:179], v[60:63]
    v_exp_f32 v20, v144
    v_exp_f32 v21, v145
    v_exp_f32 v22, v146
    v_add_f32 v170, v168, v20
    v_exp_f32 v23, v147
    v_add_f32 v170, v170, v21
    v_cvt_pk_bf16_f32 v184, v20, v21
    v_exp_f32 v24, v148
    v_add_f32 v170, v170, v22
    v_exp_f32 v25, v149
    v_mfma_f32_16x16x32_bf16 v[92:95], v[252:255], v[180:183], v[92:95]
    v_add_f32 v170, v170, v23
    v_cvt_pk_bf16_f32 v185, v22, v23
    v_exp_f32 v26, v150
    v_add_f32 v170, v170, v24
    v_exp_f32 v27, v151
    v_add_f32 v170, v170, v25
    v_cvt_pk_bf16_f32 v186, v24, v25
    v_exp_f32 v20, v152
    v_add_f32 v170, v170, v26
    s_waitcnt vmcnt(9) lgkmcnt(0)
    s_barrier
    v_mfma_f32_16x16x32_bf16 v[128:131], v[192:195], v[96:99], v[160:163]
    s_mov_b32 s46, 196608
    s_add_u32 m0, s52, 84480
    v_mfma_f32_16x16x32_bf16 v[136:139], v[192:195], v[112:115], v[164:167]
    buffer_load_dwordx4 v6, s[8:11], s46 offen offset:0 nt lds
    v_mfma_f32_16x16x32_bf16 v[132:135], v[196:199], v[96:99], v[160:163]
    s_add_u32 m0, s52, 85280
    v_mfma_f32_16x16x32_bf16 v[140:143], v[196:199], v[112:115], v[164:167]
    buffer_load_dwordx4 v6, s[8:11], s46 offen offset:256 nt lds
    v_mfma_f32_16x16x32_bf16 v[128:131], v[200:203], v[100:103], v[128:131]
    s_mov_b32 s46, 180224
    s_add_u32 m0, s52, 92928
    v_mfma_f32_16x16x32_bf16 v[136:139], v[200:203], v[116:119], v[136:139]
    buffer_load_dwordx4 v6, s[12:15], s46 offen offset:0 nt lds
    v_mfma_f32_16x16x32_bf16 v[132:135], v[204:207], v[100:103], v[132:135]
    s_add_u32 m0, s52, 93728
    v_mfma_f32_16x16x32_bf16 v[140:143], v[204:207], v[116:119], v[140:143]
    buffer_load_dwordx4 v6, s[12:15], s46 offen offset:256 nt lds
    v_mfma_f32_16x16x32_bf16 v[128:131], v[208:211], v[104:107], v[128:131]
    ds_read_b64_tr_b16 v[224:225], v16 offset:33792
    ds_read_b64_tr_b16 v[226:227], v16 offset:34304
    ds_read_b64_tr_b16 v[228:229], v16 offset:33824
    ds_read_b64_tr_b16 v[230:231], v16 offset:34336
    v_mfma_f32_16x16x32_bf16 v[136:139], v[208:211], v[120:123], v[136:139]
    ds_read_b64_tr_b16 v[232:233], v16 offset:33856
    ds_read_b64_tr_b16 v[234:235], v16 offset:34368
    ds_read_b64_tr_b16 v[236:237], v16 offset:33888
    ds_read_b64_tr_b16 v[238:239], v16 offset:34400
    v_mfma_f32_16x16x32_bf16 v[132:135], v[212:215], v[104:107], v[132:135]
    ds_read_b64_tr_b16 v[240:241], v16 offset:33920
    ds_read_b64_tr_b16 v[242:243], v16 offset:34432
    ds_read_b64_tr_b16 v[244:245], v16 offset:33952
    ds_read_b64_tr_b16 v[246:247], v16 offset:34464
    v_exp_f32 v21, v153
    v_add_f32 v170, v170, v27
    v_cvt_pk_bf16_f32 v187, v26, v27
    v_exp_f32 v22, v154
    v_add_f32 v171, v169, v20
    v_exp_f32 v23, v155
    v_add_f32 v171, v171, v21
    v_mfma_f32_16x16x32_bf16 v[140:143], v[212:215], v[120:123], v[140:143]
    ds_read_b64_tr_b16 v[248:249], v16 offset:33984
    ds_read_b64_tr_b16 v[250:251], v16 offset:34496
    ds_read_b64_tr_b16 v[252:253], v16 offset:34016
    ds_read_b64_tr_b16 v[254:255], v16 offset:34528
    v_cvt_pk_bf16_f32 v188, v20, v21
    v_exp_f32 v24, v156
    v_add_f32 v171, v171, v22
    v_exp_f32 v25, v157
    v_add_f32 v171, v171, v23
    v_cvt_pk_bf16_f32 v189, v22, v23
    v_exp_f32 v26, v158
    v_mfma_f32_16x16x32_bf16 v[128:131], v[216:219], v[108:111], v[128:131]
    v_add_f32 v171, v171, v24
    v_exp_f32 v27, v159
    v_add_f32 v171, v171, v25
    v_cvt_pk_bf16_f32 v190, v24, v25
    v_add_f32 v171, v171, v26
    v_add_f32 v171, v171, v27
    v_cvt_pk_bf16_f32 v191, v26, v27
    v_mfma_f32_16x16x32_bf16 v[136:139], v[216:219], v[124:127], v[136:139]
    v_max_f32 v30, v170, v171
    v_cmp_lt_f32 vcc, s49, v30
    v_mfma_f32_16x16x32_bf16 v[132:135], v[220:223], v[108:111], v[132:135]
    s_cbranch_vccnz LS_r19
LS_b19:
    v_mfma_f32_16x16x32_bf16 v[140:143], v[220:223], v[124:127], v[140:143]
    s_waitcnt lgkmcnt(0)
    v_mfma_f32_16x16x32_bf16 v[32:35], v[224:227], v[184:187], v[32:35]
    ds_read_b128 v[192:195], v2 offset:33792
    ds_read_b128 v[196:199], v2 offset:34304
    v_mfma_f32_16x16x32_bf16 v[64:67], v[224:227], v[188:191], v[64:67]
    ds_read_b128 v[200:203], v2 offset:33856
    ds_read_b128 v[204:207], v2 offset:34368
    v_mfma_f32_16x16x32_bf16 v[36:39], v[228:231], v[184:187], v[36:39]
    ds_read_b128 v[208:211], v2 offset:33920
    ds_read_b128 v[212:215], v2 offset:34432
    v_mfma_f32_16x16x32_bf16 v[68:71], v[228:231], v[188:191], v[68:71]
    ds_read_b128 v[216:219], v2 offset:33984
    ds_read_b128 v[220:223], v2 offset:34496
    v_mfma_f32_16x16x32_bf16 v[40:43], v[232:235], v[184:187], v[40:43]
    v_mfma_f32_16x16x32_bf16 v[72:75], v[232:235], v[188:191], v[72:75]
    v_mfma_f32_16x16x32_bf16 v[44:47], v[236:239], v[184:187], v[44:47]
    v_mfma_f32_16x16x32_bf16 v[76:79], v[236:239], v[188:191], v[76:79]
    v_mfma_f32_16x16x32_bf16 v[48:51], v[240:243], v[184:187], v[48:51]
    v_mfma_f32_16x16x32_bf16 v[80:83], v[240:243], v[188:191], v[80:83]
    v_mfma_f32_16x16x32_bf16 v[52:55], v[244:247], v[184:187], v[52:55]
    v_mfma_f32_16x16x32_bf16 v[84:87], v[244:247], v[188:191], v[84:87]
    v_mfma_f32_16x16x32_bf16 v[56:59], v[248:251], v[184:187], v[56:59]
    v_mfma_f32_16x16x32_bf16 v[88:91], v[248:251], v[188:191], v[88:91]
    v_mfma_f32_16x16x32_bf16 v[60:63], v[252:255], v[184:187], v[60:63]
    v_exp_f32 v20, v128
    v_exp_f32 v21, v129
    v_exp_f32 v22, v130
    v_add_f32 v168, v170, v20
    v_exp_f32 v23, v131
    v_add_f32 v168, v168, v21
    v_cvt_pk_bf16_f32 v176, v20, v21
    v_exp_f32 v24, v132
    v_add_f32 v168, v168, v22
    v_exp_f32 v25, v133
    v_mfma_f32_16x16x32_bf16 v[92:95], v[252:255], v[188:191], v[92:95]
    v_add_f32 v168, v168, v23
    v_cvt_pk_bf16_f32 v177, v22, v23
    v_exp_f32 v26, v134
    v_add_f32 v168, v168, v24
    v_exp_f32 v27, v135
    v_add_f32 v168, v168, v25
    v_cvt_pk_bf16_f32 v178, v24, v25
    v_exp_f32 v20, v136
    v_add_f32 v168, v168, v26
    s_waitcnt vmcnt(8) lgkmcnt(0)
    s_barrier
    v_mfma_f32_16x16x32_bf16 v[144:147], v[192:195], v[96:99], v[160:163]
    s_mov_b32 s46, 204800
    s_add_u32 m0, s52, 101376
    v_mfma_f32_16x16x32_bf16 v[152:155], v[192:195], v[112:115], v[164:167]
    buffer_load_dwordx4 v6, s[8:11], s46 offen offset:0 nt lds
    v_mfma_f32_16x16x32_bf16 v[148:151], v[196:199], v[96:99], v[160:163]
    s_add_u32 m0, s52, 102176
    v_mfma_f32_16x16x32_bf16 v[156:159], v[196:199], v[112:115], v[164:167]
    buffer_load_dwordx4 v6, s[8:11], s46 offen offset:256 nt lds
    v_mfma_f32_16x16x32_bf16 v[144:147], v[200:203], v[100:103], v[144:147]
    s_mov_b32 s46, 188416
    s_add_u32 m0, s52, 109824
    v_mfma_f32_16x16x32_bf16 v[152:155], v[200:203], v[116:119], v[152:155]
    buffer_load_dwordx4 v6, s[12:15], s46 offen offset:0 nt lds
    v_mfma_f32_16x16x32_bf16 v[148:151], v[204:207], v[100:103], v[148:151]
    s_add_u32 m0, s52, 110624
    v_mfma_f32_16x16x32_bf16 v[156:159], v[204:207], v[116:119], v[156:159]
    buffer_load_dwordx4 v6, s[12:15], s46 offen offset:256 nt lds
    v_mfma_f32_16x16x32_bf16 v[144:147], v[208:211], v[104:107], v[144:147]
    ds_read_b64_tr_b16 v[224:225], v17 offset:0
    ds_read_b64_tr_b16 v[226:227], v17 offset:512
    ds_read_b64_tr_b16 v[228:229], v17 offset:32
    ds_read_b64_tr_b16 v[230:231], v17 offset:544
    v_mfma_f32_16x16x32_bf16 v[152:155], v[208:211], v[120:123], v[152:155]
    ds_read_b64_tr_b16 v[232:233], v17 offset:64
    ds_read_b64_tr_b16 v[234:235], v17 offset:576
    ds_read_b64_tr_b16 v[236:237], v17 offset:96
    ds_read_b64_tr_b16 v[238:239], v17 offset:608
    v_mfma_f32_16x16x32_bf16 v[148:151], v[212:215], v[104:107], v[148:151]
    ds_read_b64_tr_b16 v[240:241], v17 offset:128
    ds_read_b64_tr_b16 v[242:243], v17 offset:640
    ds_read_b64_tr_b16 v[244:245], v17 offset:160
    ds_read_b64_tr_b16 v[246:247], v17 offset:672
    v_exp_f32 v21, v137
    v_add_f32 v168, v168, v27
    v_cvt_pk_bf16_f32 v179, v26, v27
    v_exp_f32 v22, v138
    v_add_f32 v169, v171, v20
    v_exp_f32 v23, v139
    v_add_f32 v169, v169, v21
    v_mfma_f32_16x16x32_bf16 v[156:159], v[212:215], v[120:123], v[156:159]
    ds_read_b64_tr_b16 v[248:249], v17 offset:192
    ds_read_b64_tr_b16 v[250:251], v17 offset:704
    ds_read_b64_tr_b16 v[252:253], v17 offset:224
    ds_read_b64_tr_b16 v[254:255], v17 offset:736
    v_cvt_pk_bf16_f32 v180, v20, v21
    v_exp_f32 v24, v140
    v_add_f32 v169, v169, v22
    v_exp_f32 v25, v141
    v_add_f32 v169, v169, v23
    v_cvt_pk_bf16_f32 v181, v22, v23
    v_exp_f32 v26, v142
    v_mfma_f32_16x16x32_bf16 v[144:147], v[216:219], v[108:111], v[144:147]
    v_add_f32 v169, v169, v24
    v_exp_f32 v27, v143
    v_add_f32 v169, v169, v25
    v_cvt_pk_bf16_f32 v182, v24, v25
    v_add_f32 v169, v169, v26
    v_add_f32 v169, v169, v27
    v_cvt_pk_bf16_f32 v183, v26, v27
    v_mfma_f32_16x16x32_bf16 v[152:155], v[216:219], v[124:127], v[152:155]
    v_max_f32 v30, v168, v169
    v_cmp_lt_f32 vcc, s49, v30
    v_mfma_f32_16x16x32_bf16 v[148:151], v[220:223], v[108:111], v[148:151]
    s_cbranch_vccnz LS_r20
LS_b20:
    v_mfma_f32_16x16x32_bf16 v[156:159], v[220:223], v[124:127], v[156:159]
    s_waitcnt lgkmcnt(0)
    v_mfma_f32_16x16x32_bf16 v[32:35], v[224:227], v[176:179], v[32:35]
    ds_read_b128 v[192:195], v3 offset:0
    ds_read_b128 v[196:199], v3 offset:512
    v_mfma_f32_16x16x32_bf16 v[64:67], v[224:227], v[180:183], v[64:67]
    ds_read_b128 v[200:203], v3 offset:64
    ds_read_b128 v[204:207], v3 offset:576
    v_mfma_f32_16x16x32_bf16 v[36:39], v[228:231], v[176:179], v[36:39]
    ds_read_b128 v[208:211], v3 offset:128
    ds_read_b128 v[212:215], v3 offset:640
    v_mfma_f32_16x16x32_bf16 v[68:71], v[228:231], v[180:183], v[68:71]
    ds_read_b128 v[216:219], v3 offset:192
    ds_read_b128 v[220:223], v3 offset:704
    v_mfma_f32_16x16x32_bf16 v[40:43], v[232:235], v[176:179], v[40:43]
    v_mfma_f32_16x16x32_bf16 v[72:75], v[232:235], v[180:183], v[72:75]
    v_mfma_f32_16x16x32_bf16 v[44:47], v[236:239], v[176:179], v[44:47]
    v_mfma_f32_16x16x32_bf16 v[76:79], v[236:239], v[180:183], v[76:79]
    v_mfma_f32_16x16x32_bf16 v[48:51], v[240:243], v[176:179], v[48:51]
    v_mfma_f32_16x16x32_bf16 v[80:83], v[240:243], v[180:183], v[80:83]
    v_mfma_f32_16x16x32_bf16 v[52:55], v[244:247], v[176:179], v[52:55]
    v_mfma_f32_16x16x32_bf16 v[84:87], v[244:247], v[180:183], v[84:87]
    v_mfma_f32_16x16x32_bf16 v[56:59], v[248:251], v[176:179], v[56:59]
    v_mfma_f32_16x16x32_bf16 v[88:91], v[248:251], v[180:183], v[88:91]
    v_mfma_f32_16x16x32_bf16 v[60:63], v[252:255], v[176:179], v[60:63]
    v_exp_f32 v20, v144
    v_exp_f32 v21, v145
    v_exp_f32 v22, v146
    v_add_f32 v170, v168, v20
    v_exp_f32 v23, v147
    v_add_f32 v170, v170, v21
    v_cvt_pk_bf16_f32 v184, v20, v21
    v_exp_f32 v24, v148
    v_add_f32 v170, v170, v22
    v_exp_f32 v25, v149
    v_mfma_f32_16x16x32_bf16 v[92:95], v[252:255], v[180:183], v[92:95]
    v_add_f32 v170, v170, v23
    v_cvt_pk_bf16_f32 v185, v22, v23
    v_exp_f32 v26, v150
    v_add_f32 v170, v170, v24
    v_exp_f32 v27, v151
    v_add_f32 v170, v170, v25
    v_cvt_pk_bf16_f32 v186, v24, v25
    v_exp_f32 v20, v152
    v_add_f32 v170, v170, v26
    s_waitcnt vmcnt(8) lgkmcnt(0)
    s_barrier
    v_mfma_f32_16x16x32_bf16 v[128:131], v[192:195], v[96:99], v[160:163]
    s_mov_b32 s46, 212992
    s_add_u32 m0, s52, 118272
    v_mfma_f32_16x16x32_bf16 v[136:139], v[192:195], v[112:115], v[164:167]
    buffer_load_dwordx4 v6, s[8:11], s46 offen offset:0 nt lds
    v_mfma_f32_16x16x32_bf16 v[132:135], v[196:199], v[96:99], v[160:163]
    s_add_u32 m0, s52, 119072
    v_mfma_f32_16x16x32_bf16 v[140:143], v[196:199], v[112:115], v[164:167]
    buffer_load_dwordx4 v6, s[8:11], s46 offen offset:256 nt lds
    v_mfma_f32_16x16x32_bf16 v[128:131], v[200:203], v[100:103], v[128:131]
    s_mov_b32 s46, 196608
    s_add_u32 m0, s52, 126720
    v_mfma_f32_16x16x32_bf16 v[136:139], v[200:203], v[116:119], v[136:139]
    buffer_load_dwordx4 v6, s[12:15], s46 offen offset:0 nt lds
    v_mfma_f32_16x16x32_bf16 v[132:135], v[204:207], v[100:103], v[132:135]
    s_add_u32 m0, s52, 127520
    v_mfma_f32_16x16x32_bf16 v[140:143], v[204:207], v[116:119], v[140:143]
    buffer_load_dwordx4 v6, s[12:15], s46 offen offset:256 nt lds
    v_mfma_f32_16x16x32_bf16 v[128:131], v[208:211], v[104:107], v[128:131]
    ds_read_b64_tr_b16 v[224:225], v17 offset:16896
    ds_read_b64_tr_b16 v[226:227], v17 offset:17408
    ds_read_b64_tr_b16 v[228:229], v17 offset:16928
    ds_read_b64_tr_b16 v[230:231], v17 offset:17440
    v_mfma_f32_16x16x32_bf16 v[136:139], v[208:211], v[120:123], v[136:139]
    ds_read_b64_tr_b16 v[232:233], v17 offset:16960
    ds_read_b64_tr_b16 v[234:235], v17 offset:17472
    ds_read_b64_tr_b16 v[236:237], v17 offset:16992
    ds_read_b64_tr_b16 v[238:239], v17 offset:17504
    v_mfma_f32_16x16x32_bf16 v[132:135], v[212:215], v[104:107], v[132:135]
    ds_read_b64_tr_b16 v[240:241], v17 offset:17024
    ds_read_b64_tr_b16 v[242:243], v17 offset:17536
    ds_read_b64_tr_b16 v[244:245], v17 offset:17056
    ds_read_b64_tr_b16 v[246:247], v17 offset:17568
    v_exp_f32 v21, v153
    v_add_f32 v170, v170, v27
    v_cvt_pk_bf16_f32 v187, v26, v27
    v_exp_f32 v22, v154
    v_add_f32 v171, v169, v20
    v_exp_f32 v23, v155
    v_add_f32 v171, v171, v21
    v_mfma_f32_16x16x32_bf16 v[140:143], v[212:215], v[120:123], v[140:143]
    ds_read_b64_tr_b16 v[248:249], v17 offset:17088
    ds_read_b64_tr_b16 v[250:251], v17 offset:17600
    ds_read_b64_tr_b16 v[252:253], v17 offset:17120
    ds_read_b64_tr_b16 v[254:255], v17 offset:17632
    v_cvt_pk_bf16_f32 v188, v20, v21
    v_exp_f32 v24, v156
    v_add_f32 v171, v171, v22
    v_exp_f32 v25, v157
    v_add_f32 v171, v171, v23
    v_cvt_pk_bf16_f32 v189, v22, v23
    v_exp_f32 v26, v158
    v_mfma_f32_16x16x32_bf16 v[128:131], v[216:219], v[108:111], v[128:131]
    v_add_f32 v171, v171, v24
    v_exp_f32 v27, v159
    v_add_f32 v171, v171, v25
    v_cvt_pk_bf16_f32 v190, v24, v25
    v_add_f32 v171, v171, v26
    v_add_f32 v171, v171, v27
    v_cvt_pk_bf16_f32 v191, v26, v27
    v_mfma_f32_16x16x32_bf16 v[136:139], v[216:219], v[124:127], v[136:139]
    v_max_f32 v30, v170, v171
    v_cmp_lt_f32 vcc, s49, v30
    v_mfma_f32_16x16x32_bf16 v[132:135], v[220:223], v[108:111], v[132:135]
    s_cbranch_vccnz LS_r21
LS_b21:
    v_mfma_f32_16x16x32_bf16 v[140:143], v[220:223], v[124:127], v[140:143]
    s_waitcnt lgkmcnt(0)
    v_mfma_f32_16x16x32_bf16 v[32:35], v[224:227], v[184:187], v[32:35]
    ds_read_b128 v[192:195], v3 offset:16896
    ds_read_b128 v[196:199], v3 offset:17408
    v_mfma_f32_16x16x32_bf16 v[64:67], v[224:227], v[188:191], v[64:67]
    ds_read_b128 v[200:203], v3 offset:16960
    ds_read_b128 v[204:207], v3 offset:17472
    v_mfma_f32_16x16x32_bf16 v[36:39], v[228:231], v[184:187], v[36:39]
    ds_read_b128 v[208:211], v3 offset:17024
    ds_read_b128 v[212:215], v3 offset:17536
    v_mfma_f32_16x16x32_bf16 v[68:71], v[228:231], v[188:191], v[68:71]
    ds_read_b128 v[216:219], v3 offset:17088
    ds_read_b128 v[220:223], v3 offset:17600
    v_mfma_f32_16x16x32_bf16 v[40:43], v[232:235], v[184:187], v[40:43]
    v_mfma_f32_16x16x32_bf16 v[72:75], v[232:235], v[188:191], v[72:75]
    v_mfma_f32_16x16x32_bf16 v[44:47], v[236:239], v[184:187], v[44:47]
    v_mfma_f32_16x16x32_bf16 v[76:79], v[236:239], v[188:191], v[76:79]
    v_mfma_f32_16x16x32_bf16 v[48:51], v[240:243], v[184:187], v[48:51]
    v_mfma_f32_16x16x32_bf16 v[80:83], v[240:243], v[188:191], v[80:83]
    v_mfma_f32_16x16x32_bf16 v[52:55], v[244:247], v[184:187], v[52:55]
    v_mfma_f32_16x16x32_bf16 v[84:87], v[244:247], v[188:191], v[84:87]
    v_mfma_f32_16x16x32_bf16 v[56:59], v[248:251], v[184:187], v[56:59]
    v_mfma_f32_16x16x32_bf16 v[88:91], v[248:251], v[188:191], v[88:91]
    v_mfma_f32_16x16x32_bf16 v[60:63], v[252:255], v[184:187], v[60:63]
    v_exp_f32 v20, v128
    v_exp_f32 v21, v129
    v_exp_f32 v22, v130
    v_add_f32 v168, v170, v20
    v_exp_f32 v23, v131
    v_add_f32 v168, v168, v21
    v_cvt_pk_bf16_f32 v176, v20, v21
    v_exp_f32 v24, v132
    v_add_f32 v168, v168, v22
    v_exp_f32 v25, v133
    v_mfma_f32_16x16x32_bf16 v[92:95], v[252:255], v[188:191], v[92:95]
    v_add_f32 v168, v168, v23
    v_cvt_pk_bf16_f32 v177, v22, v23
    v_exp_f32 v26, v134
    v_add_f32 v168, v168, v24
    v_exp_f32 v27, v135
    v_add_f32 v168, v168, v25
    v_cvt_pk_bf16_f32 v178, v24, v25
    v_exp_f32 v20, v136
    v_add_f32 v168, v168, v26
    s_waitcnt vmcnt(8) lgkmcnt(0)
    s_barrier
    v_mfma_f32_16x16x32_bf16 v[144:147], v[192:195], v[96:99], v[160:163]
    s_mov_b32 s46, 221184
    s_add_u32 m0, s52, 135168
    v_mfma_f32_16x16x32_bf16 v[152:155], v[192:195], v[112:115], v[164:167]
    buffer_load_dwordx4 v6, s[8:11], s46 offen offset:0 nt lds
    v_mfma_f32_16x16x32_bf16 v[148:151], v[196:199], v[96:99], v[160:163]
    s_add_u32 m0, s52, 135968
    v_mfma_f32_16x16x32_bf16 v[156:159], v[196:199], v[112:115], v[164:167]
    buffer_load_dwordx4 v6, s[8:11], s46 offen offset:256 nt lds
    v_mfma_f32_16x16x32_bf16 v[144:147], v[200:203], v[100:103], v[144:147]
    s_mov_b32 s46, 204800
    s_add_u32 m0, s52, 143616
    v_mfma_f32_16x16x32_bf16 v[152:155], v[200:203], v[116:119], v[152:155]
    buffer_load_dwordx4 v6, s[12:15], s46 offen offset:0 nt lds
    v_mfma_f32_16x16x32_bf16 v[148:151], v[204:207], v[100:103], v[148:151]
    s_add_u32 m0, s52, 144416
    v_mfma_f32_16x16x32_bf16 v[156:159], v[204:207], v[116:119], v[156:159]
    buffer_load_dwordx4 v6, s[12:15], s46 offen offset:256 nt lds
    v_mfma_f32_16x16x32_bf16 v[144:147], v[208:211], v[104:107], v[144:147]
    ds_read_b64_tr_b16 v[224:225], v17 offset:33792
    ds_read_b64_tr_b16 v[226:227], v17 offset:34304
    ds_read_b64_tr_b16 v[228:229], v17 offset:33824
    ds_read_b64_tr_b16 v[230:231], v17 offset:34336
    v_mfma_f32_16x16x32_bf16 v[152:155], v[208:211], v[120:123], v[152:155]
    ds_read_b64_tr_b16 v[232:233], v17 offset:33856
    ds_read_b64_tr_b16 v[234:235], v17 offset:34368
    ds_read_b64_tr_b16 v[236:237], v17 offset:33888
    ds_read_b64_tr_b16 v[238:239], v17 offset:34400
    v_mfma_f32_16x16x32_bf16 v[148:151], v[212:215], v[104:107], v[148:151]
    ds_read_b64_tr_b16 v[240:241], v17 offset:33920
    ds_read_b64_tr_b16 v[242:243], v17 offset:34432
    ds_read_b64_tr_b16 v[244:245], v17 offset:33952
    ds_read_b64_tr_b16 v[246:247], v17 offset:34464
    v_exp_f32 v21, v137
    v_add_f32 v168, v168, v27
    v_cvt_pk_bf16_f32 v179, v26, v27
    v_exp_f32 v22, v138
    v_add_f32 v169, v171, v20
    v_exp_f32 v23, v139
    v_add_f32 v169, v169, v21
    v_mfma_f32_16x16x32_bf16 v[156:159], v[212:215], v[120:123], v[156:159]
    ds_read_b64_tr_b16 v[248:249], v17 offset:33984
    ds_read_b64_tr_b16 v[250:251], v17 offset:34496
    ds_read_b64_tr_b16 v[252:253], v17 offset:34016
    ds_read_b64_tr_b16 v[254:255], v17 offset:34528
    v_cvt_pk_bf16_f32 v180, v20, v21
    v_exp_f32 v24, v140
    v_add_f32 v169, v169, v22
    v_exp_f32 v25, v141
    v_add_f32 v169, v169, v23
    v_cvt_pk_bf16_f32 v181, v22, v23
    v_exp_f32 v26, v142
    v_mfma_f32_16x16x32_bf16 v[144:147], v[216:219], v[108:111], v[144:147]
    v_add_f32 v169, v169, v24
    v_exp_f32 v27, v143
    v_add_f32 v169, v169, v25
    v_cvt_pk_bf16_f32 v182, v24, v25
    v_add_f32 v169, v169, v26
    v_add_f32 v169, v169, v27
    v_cvt_pk_bf16_f32 v183, v26, v27
    v_mfma_f32_16x16x32_bf16 v[152:155], v[216:219], v[124:127], v[152:155]
    v_max_f32 v30, v168, v169
    v_cmp_lt_f32 vcc, s49, v30
    v_mfma_f32_16x16x32_bf16 v[148:151], v[220:223], v[108:111], v[148:151]
    s_cbranch_vccnz LS_r22
LS_b22:
    v_mfma_f32_16x16x32_bf16 v[156:159], v[220:223], v[124:127], v[156:159]
    s_waitcnt lgkmcnt(0)
    v_mfma_f32_16x16x32_bf16 v[32:35], v[224:227], v[176:179], v[32:35]
    ds_read_b128 v[192:195], v3 offset:33792
    ds_read_b128 v[196:199], v3 offset:34304
    v_mfma_f32_16x16x32_bf16 v[64:67], v[224:227], v[180:183], v[64:67]
    ds_read_b128 v[200:203], v3 offset:33856
    ds_read_b128 v[204:207], v3 offset:34368
    v_mfma_f32_16x16x32_bf16 v[36:39], v[228:231], v[176:179], v[36:39]
    ds_read_b128 v[208:211], v3 offset:33920
    ds_read_b128 v[212:215], v3 offset:34432
    v_mfma_f32_16x16x32_bf16 v[68:71], v[228:231], v[180:183], v[68:71]
    ds_read_b128 v[216:219], v3 offset:33984
    ds_read_b128 v[220:223], v3 offset:34496
    v_mfma_f32_16x16x32_bf16 v[40:43], v[232:235], v[176:179], v[40:43]
    v_mfma_f32_16x16x32_bf16 v[72:75], v[232:235], v[180:183], v[72:75]
    v_mfma_f32_16x16x32_bf16 v[44:47], v[236:239], v[176:179], v[44:47]
    v_mfma_f32_16x16x32_bf16 v[76:79], v[236:239], v[180:183], v[76:79]
    v_mfma_f32_16x16x32_bf16 v[48:51], v[240:243], v[176:179], v[48:51]
    v_mfma_f32_16x16x32_bf16 v[80:83], v[240:243], v[180:183], v[80:83]
    v_mfma_f32_16x16x32_bf16 v[52:55], v[244:247], v[176:179], v[52:55]
    v_mfma_f32_16x16x32_bf16 v[84:87], v[244:247], v[180:183], v[84:87]
    v_mfma_f32_16x16x32_bf16 v[56:59], v[248:251], v[176:179], v[56:59]
    v_mfma_f32_16x16x32_bf16 v[88:91], v[248:251], v[180:183], v[88:91]
    v_mfma_f32_16x16x32_bf16 v[60:63], v[252:255], v[176:179], v[60:63]
    v_exp_f32 v20, v144
    v_exp_f32 v21, v145
    v_exp_f32 v22, v146
    v_add_f32 v170, v168, v20
    v_exp_f32 v23, v147
    v_add_f32 v170, v170, v21
    v_cvt_pk_bf16_f32 v184, v20, v21
    v_exp_f32 v24, v148
    v_add_f32 v170, v170, v22
    v_exp_f32 v25, v149
    v_mfma_f32_16x16x32_bf16 v[92:95], v[252:255], v[180:183], v[92:95]
    global_load_dword v9, v8, s[0:1]
    v_add_f32 v170, v170, v23
    v_cvt_pk_bf16_f32 v185, v22, v23
    v_exp_f32 v26, v150
    v_add_f32 v170, v170, v24
    v_exp_f32 v27, v151
    v_add_f32 v170, v170, v25
    v_cvt_pk_bf16_f32 v186, v24, v25
    v_exp_f32 v20, v152
    v_add_f32 v170, v170, v26
    s_waitcnt vmcnt(9) lgkmcnt(0)
    s_barrier
    v_mfma_f32_16x16x32_bf16 v[128:131], v[192:195], v[96:99], v[160:163]
    s_mov_b32 s46, 229376
    s_add_u32 m0, s52, 0
    v_mfma_f32_16x16x32_bf16 v[136:139], v[192:195], v[112:115], v[164:167]
    buffer_load_dwordx4 v6, s[8:11], s46 offen offset:0 nt lds
    v_mfma_f32_16x16x32_bf16 v[132:135], v[196:199], v[96:99], v[160:163]
    s_add_u32 m0, s52, 800
    v_mfma_f32_16x16x32_bf16 v[140:143], v[196:199], v[112:115], v[164:167]
    buffer_load_dwordx4 v6, s[8:11], s46 offen offset:256 nt lds
    v_mfma_f32_16x16x32_bf16 v[128:131], v[200:203], v[100:103], v[128:131]
    s_mov_b32 s46, 212992
    s_add_u32 m0, s52, 8448
    v_mfma_f32_16x16x32_bf16 v[136:139], v[200:203], v[116:119], v[136:139]
    buffer_load_dwordx4 v6, s[12:15], s46 offen offset:0 nt lds
    v_mfma_f32_16x16x32_bf16 v[132:135], v[204:207], v[100:103], v[132:135]
    s_add_u32 m0, s52, 9248
    v_mfma_f32_16x16x32_bf16 v[140:143], v[204:207], v[116:119], v[140:143]
    buffer_load_dwordx4 v6, s[12:15], s46 offen offset:256 nt lds
    v_mfma_f32_16x16x32_bf16 v[128:131], v[208:211], v[104:107], v[128:131]
    ds_read_b64_tr_b16 v[224:225], v18 offset:0
    ds_read_b64_tr_b16 v[226:227], v18 offset:512
    ds_read_b64_tr_b16 v[228:229], v18 offset:32
    ds_read_b64_tr_b16 v[230:231], v18 offset:544
    v_mfma_f32_16x16x32_bf16 v[136:139], v[208:211], v[120:123], v[136:139]
    ds_read_b64_tr_b16 v[232:233], v18 offset:64
    ds_read_b64_tr_b16 v[234:235], v18 offset:576
    ds_read_b64_tr_b16 v[236:237], v18 offset:96
    ds_read_b64_tr_b16 v[238:239], v18 offset:608
    v_mfma_f32_16x16x32_bf16 v[132:135], v[212:215], v[104:107], v[132:135]
    ds_read_b64_tr_b16 v[240:241], v18 offset:128
    ds_read_b64_tr_b16 v[242:243], v18 offset:640
    ds_read_b64_tr_b16 v[244:245], v18 offset:160
    ds_read_b64_tr_b16 v[246:247], v18 offset:672
    v_exp_f32 v21, v153
    v_add_f32 v170, v170, v27
    v_cvt_pk_bf16_f32 v187, v26, v27
    v_exp_f32 v22, v154
    v_add_f32 v171, v169, v20
    v_exp_f32 v23, v155
    v_add_f32 v171, v171, v21
    v_mfma_f32_16x16x32_bf16 v[140:143], v[212:215], v[120:123], v[140:143]
    ds_read_b64_tr_b16 v[248:249], v18 offset:192
    ds_read_b64_tr_b16 v[250:251], v18 offset:704
    ds_read_b64_tr_b16 v[252:253], v18 offset:224
    ds_read_b64_tr_b16 v[254:255], v18 offset:736
    v_cvt_pk_bf16_f32 v188, v20, v21
    v_exp_f32 v24, v156
    v_add_f32 v171, v171, v22
    v_exp_f32 v25, v157
    v_add_f32 v171, v171, v23
    v_cvt_pk_bf16_f32 v189, v22, v23
    v_exp_f32 v26, v158
    v_mfma_f32_16x16x32_bf16 v[128:131], v[216:219], v[108:111], v[128:131]
    v_add_f32 v171, v171, v24
    v_exp_f32 v27, v159
    v_add_f32 v171, v171, v25
    v_cvt_pk_bf16_f32 v190, v24, v25
    v_add_f32 v171, v171, v26
    v_add_f32 v171, v171, v27
    v_cvt_pk_bf16_f32 v191, v26, v27
    v_mfma_f32_16x16x32_bf16 v[136:139], v[216:219], v[124:127], v[136:139]
    v_max_f32 v30, v170, v171
    v_cmp_lt_f32 vcc, s49, v30
    v_mfma_f32_16x16x32_bf16 v[132:135], v[220:223], v[108:111], v[132:135]
    s_cbranch_vccnz LS_r23
LS_b23:
    v_mfma_f32_16x16x32_bf16 v[140:143], v[220:223], v[124:127], v[140:143]
    s_waitcnt lgkmcnt(0)
    v_mfma_f32_16x16x32_bf16 v[32:35], v[224:227], v[184:187], v[32:35]
    ds_read_b128 v[192:195], v4 offset:0
    ds_read_b128 v[196:199], v4 offset:512
    v_mfma_f32_16x16x32_bf16 v[64:67], v[224:227], v[188:191], v[64:67]
    ds_read_b128 v[200:203], v4 offset:64
    ds_read_b128 v[204:207], v4 offset:576
    v_mfma_f32_16x16x32_bf16 v[36:39], v[228:231], v[184:187], v[36:39]
    ds_read_b128 v[208:211], v4 offset:128
    ds_read_b128 v[212:215], v4 offset:640
    v_mfma_f32_16x16x32_bf16 v[68:71], v[228:231], v[188:191], v[68:71]
    ds_read_b128 v[216:219], v4 offset:192
    ds_read_b128 v[220:223], v4 offset:704
    v_mfma_f32_16x16x32_bf16 v[40:43], v[232:235], v[184:187], v[40:43]
    v_mfma_f32_16x16x32_bf16 v[72:75], v[232:235], v[188:191], v[72:75]
    v_mfma_f32_16x16x32_bf16 v[44:47], v[236:239], v[184:187], v[44:47]
    v_mfma_f32_16x16x32_bf16 v[76:79], v[236:239], v[188:191], v[76:79]
    v_mfma_f32_16x16x32_bf16 v[48:51], v[240:243], v[184:187], v[48:51]
    v_mfma_f32_16x16x32_bf16 v[80:83], v[240:243], v[188:191], v[80:83]
    v_mfma_f32_16x16x32_bf16 v[52:55], v[244:247], v[184:187], v[52:55]
    v_mfma_f32_16x16x32_bf16 v[84:87], v[244:247], v[188:191], v[84:87]
    v_mfma_f32_16x16x32_bf16 v[56:59], v[248:251], v[184:187], v[56:59]
    v_mfma_f32_16x16x32_bf16 v[88:91], v[248:251], v[188:191], v[88:91]
    v_mfma_f32_16x16x32_bf16 v[60:63], v[252:255], v[184:187], v[60:63]
    v_exp_f32 v20, v128
    v_exp_f32 v21, v129
    v_exp_f32 v22, v130
    v_add_f32 v168, v170, v20
    v_exp_f32 v23, v131
    v_add_f32 v168, v168, v21
    v_cvt_pk_bf16_f32 v176, v20, v21
    v_exp_f32 v24, v132
    v_add_f32 v168, v168, v22
    v_exp_f32 v25, v133
    v_mfma_f32_16x16x32_bf16 v[92:95], v[252:255], v[188:191], v[92:95]
    v_add_f32 v168, v168, v23
    v_cvt_pk_bf16_f32 v177, v22, v23
    v_exp_f32 v26, v134
    v_add_f32 v168, v168, v24
    v_exp_f32 v27, v135
    v_add_f32 v168, v168, v25
    v_cvt_pk_bf16_f32 v178, v24, v25
    v_exp_f32 v20, v136
    v_add_f32 v168, v168, v26
    s_waitcnt vmcnt(9) lgkmcnt(0)
    s_barrier
    v_mfma_f32_16x16x32_bf16 v[144:147], v[192:195], v[96:99], v[160:163]
    s_mov_b32 s46, 237568
    s_add_u32 m0, s52, 16896
    v_mfma_f32_16x16x32_bf16 v[152:155], v[192:195], v[112:115], v[164:167]
    buffer_load_dwordx4 v6, s[8:11], s46 offen offset:0 nt lds
    v_mfma_f32_16x16x32_bf16 v[148:151], v[196:199], v[96:99], v[160:163]
    s_add_u32 m0, s52, 17696
    v_mfma_f32_16x16x32_bf16 v[156:159], v[196:199], v[112:115], v[164:167]
    buffer_load_dwordx4 v6, s[8:11], s46 offen offset:256 nt lds
    v_mfma_f32_16x16x32_bf16 v[144:147], v[200:203], v[100:103], v[144:147]
    s_mov_b32 s46, 221184
    s_add_u32 m0, s52, 25344
    v_mfma_f32_16x16x32_bf16 v[152:155], v[200:203], v[116:119], v[152:155]
    buffer_load_dwordx4 v6, s[12:15], s46 offen offset:0 nt lds
    v_mfma_f32_16x16x32_bf16 v[148:151], v[204:207], v[100:103], v[148:151]
    s_add_u32 m0, s52, 26144
    v_mfma_f32_16x16x32_bf16 v[156:159], v[204:207], v[116:119], v[156:159]
    buffer_load_dwordx4 v6, s[12:15], s46 offen offset:256 nt lds
    v_mfma_f32_16x16x32_bf16 v[144:147], v[208:211], v[104:107], v[144:147]
    ds_read_b64_tr_b16 v[224:225], v18 offset:16896
    ds_read_b64_tr_b16 v[226:227], v18 offset:17408
    ds_read_b64_tr_b16 v[228:229], v18 offset:16928
    ds_read_b64_tr_b16 v[230:231], v18 offset:17440
    v_mfma_f32_16x16x32_bf16 v[152:155], v[208:211], v[120:123], v[152:155]
    ds_read_b64_tr_b16 v[232:233], v18 offset:16960
    ds_read_b64_tr_b16 v[234:235], v18 offset:17472
    ds_read_b64_tr_b16 v[236:237], v18 offset:16992
    ds_read_b64_tr_b16 v[238:239], v18 offset:17504
    v_mfma_f32_16x16x32_bf16 v[148:151], v[212:215], v[104:107], v[148:151]
    ds_read_b64_tr_b16 v[240:241], v18 offset:17024
    ds_read_b64_tr_b16 v[242:243], v18 offset:17536
    ds_read_b64_tr_b16 v[244:245], v18 offset:17056
    ds_read_b64_tr_b16 v[246:247], v18 offset:17568
    v_exp_f32 v21, v137
    v_add_f32 v168, v168, v27
    v_cvt_pk_bf16_f32 v179, v26, v27
    v_exp_f32 v22, v138
    v_add_f32 v169, v171, v20
    v_exp_f32 v23, v139
    v_add_f32 v169, v169, v21
    v_mfma_f32_16x16x32_bf16 v[156:159], v[212:215], v[120:123], v[156:159]
    ds_read_b64_tr_b16 v[248:249], v18 offset:17088
    ds_read_b64_tr_b16 v[250:251], v18 offset:17600
    ds_read_b64_tr_b16 v[252:253], v18 offset:17120
    ds_read_b64_tr_b16 v[254:255], v18 offset:17632
    v_cvt_pk_bf16_f32 v180, v20, v21
    v_exp_f32 v24, v140
    v_add_f32 v169, v169, v22
    v_exp_f32 v25, v141
    v_add_f32 v169, v169, v23
    v_cvt_pk_bf16_f32 v181, v22, v23
    v_exp_f32 v26, v142
    v_mfma_f32_16x16x32_bf16 v[144:147], v[216:219], v[108:111], v[144:147]
    v_add_f32 v169, v169, v24
    v_exp_f32 v27, v143
    v_add_f32 v169, v169, v25
    v_cvt_pk_bf16_f32 v182, v24, v25
    v_add_f32 v169, v169, v26
    v_add_f32 v169, v169, v27
    v_cvt_pk_bf16_f32 v183, v26, v27
    v_mfma_f32_16x16x32_bf16 v[152:155], v[216:219], v[124:127], v[152:155]
    v_max_f32 v30, v168, v169
    v_cmp_lt_f32 vcc, s49, v30
    v_mfma_f32_16x16x32_bf16 v[148:151], v[220:223], v[108:111], v[148:151]
    s_cbranch_vccnz LS_r24
LS_b24:
    v_mfma_f32_16x16x32_bf16 v[156:159], v[220:223], v[124:127], v[156:159]
    s_waitcnt lgkmcnt(0)
    v_mfma_f32_16x16x32_bf16 v[32:35], v[224:227], v[176:179], v[32:35]
    ds_read_b128 v[192:195], v4 offset:16896
    ds_read_b128 v[196:199], v4 offset:17408
    v_mfma_f32_16x16x32_bf16 v[64:67], v[224:227], v[180:183], v[64:67]
    ds_read_b128 v[200:203], v4 offset:16960
    ds_read_b128 v[204:207], v4 offset:17472
    v_mfma_f32_16x16x32_bf16 v[36:39], v[228:231], v[176:179], v[36:39]
    ds_read_b128 v[208:211], v4 offset:17024
    ds_read_b128 v[212:215], v4 offset:17536
    v_mfma_f32_16x16x32_bf16 v[68:71], v[228:231], v[180:183], v[68:71]
    ds_read_b128 v[216:219], v4 offset:17088
    ds_read_b128 v[220:223], v4 offset:17600
    v_mfma_f32_16x16x32_bf16 v[40:43], v[232:235], v[176:179], v[40:43]
    v_mfma_f32_16x16x32_bf16 v[72:75], v[232:235], v[180:183], v[72:75]
    v_mfma_f32_16x16x32_bf16 v[44:47], v[236:239], v[176:179], v[44:47]
    v_mfma_f32_16x16x32_bf16 v[76:79], v[236:239], v[180:183], v[76:79]
    v_mfma_f32_16x16x32_bf16 v[48:51], v[240:243], v[176:179], v[48:51]
    v_mfma_f32_16x16x32_bf16 v[80:83], v[240:243], v[180:183], v[80:83]
    v_mfma_f32_16x16x32_bf16 v[52:55], v[244:247], v[176:179], v[52:55]
    v_mfma_f32_16x16x32_bf16 v[84:87], v[244:247], v[180:183], v[84:87]
    v_mfma_f32_16x16x32_bf16 v[56:59], v[248:251], v[176:179], v[56:59]
    v_mfma_f32_16x16x32_bf16 v[88:91], v[248:251], v[180:183], v[88:91]
    v_mfma_f32_16x16x32_bf16 v[60:63], v[252:255], v[176:179], v[60:63]
    v_exp_f32 v20, v144
    v_exp_f32 v21, v145
    v_exp_f32 v22, v146
    v_add_f32 v170, v168, v20
    v_exp_f32 v23, v147
    v_add_f32 v170, v170, v21
    v_cvt_pk_bf16_f32 v184, v20, v21
    v_exp_f32 v24, v148
    v_add_f32 v170, v170, v22
    v_exp_f32 v25, v149
    v_mfma_f32_16x16x32_bf16 v[92:95], v[252:255], v[180:183], v[92:95]
    v_add_f32 v170, v170, v23
    v_cvt_pk_bf16_f32 v185, v22, v23
    v_exp_f32 v26, v150
    v_add_f32 v170, v170, v24
    v_exp_f32 v27, v151
    v_add_f32 v170, v170, v25
    v_cvt_pk_bf16_f32 v186, v24, v25
    v_exp_f32 v20, v152
    v_add_f32 v170, v170, v26
    s_waitcnt vmcnt(9) lgkmcnt(0)
    s_barrier
    v_mfma_f32_16x16x32_bf16 v[128:131], v[192:195], v[96:99], v[160:163]
    s_mov_b32 s46, 245760
    s_add_u32 m0, s52, 33792
    v_mfma_f32_16x16x32_bf16 v[136:139], v[192:195], v[112:115], v[164:167]
    buffer_load_dwordx4 v6, s[8:11], s46 offen offset:0 nt lds
    v_mfma_f32_16x16x32_bf16 v[132:135], v[196:199], v[96:99], v[160:163]
    s_add_u32 m0, s52, 34592
    v_mfma_f32_16x16x32_bf16 v[140:143], v[196:199], v[112:115], v[164:167]
    buffer_load_dwordx4 v6, s[8:11], s46 offen offset:256 nt lds
    v_mfma_f32_16x16x32_bf16 v[128:131], v[200:203], v[100:103], v[128:131]
    s_mov_b32 s46, 229376
    s_add_u32 m0, s52, 42240
    v_mfma_f32_16x16x32_bf16 v[136:139], v[200:203], v[116:119], v[136:139]
    buffer_load_dwordx4 v6, s[12:15], s46 offen offset:0 nt lds
    v_mfma_f32_16x16x32_bf16 v[132:135], v[204:207], v[100:103], v[132:135]
    s_add_u32 m0, s52, 43040
    v_mfma_f32_16x16x32_bf16 v[140:143], v[204:207], v[116:119], v[140:143]
    buffer_load_dwordx4 v6, s[12:15], s46 offen offset:256 nt lds
    v_mfma_f32_16x16x32_bf16 v[128:131], v[208:211], v[104:107], v[128:131]
    ds_read_b64_tr_b16 v[224:225], v18 offset:33792
    ds_read_b64_tr_b16 v[226:227], v18 offset:34304
    ds_read_b64_tr_b16 v[228:229], v18 offset:33824
    ds_read_b64_tr_b16 v[230:231], v18 offset:34336
    v_mfma_f32_16x16x32_bf16 v[136:139], v[208:211], v[120:123], v[136:139]
    ds_read_b64_tr_b16 v[232:233], v18 offset:33856
    ds_read_b64_tr_b16 v[234:235], v18 offset:34368
    ds_read_b64_tr_b16 v[236:237], v18 offset:33888
    ds_read_b64_tr_b16 v[238:239], v18 offset:34400
    v_mfma_f32_16x16x32_bf16 v[132:135], v[212:215], v[104:107], v[132:135]
    ds_read_b64_tr_b16 v[240:241], v18 offset:33920
    ds_read_b64_tr_b16 v[242:243], v18 offset:34432
    ds_read_b64_tr_b16 v[244:245], v18 offset:33952
    ds_read_b64_tr_b16 v[246:247], v18 offset:34464
    v_exp_f32 v21, v153
    v_add_f32 v170, v170, v27
    v_cvt_pk_bf16_f32 v187, v26, v27
    v_exp_f32 v22, v154
    v_add_f32 v171, v169, v20
    v_exp_f32 v23, v155
    v_add_f32 v171, v171, v21
    v_mfma_f32_16x16x32_bf16 v[140:143], v[212:215], v[120:123], v[140:143]
    ds_read_b64_tr_b16 v[248:249], v18 offset:33984
    ds_read_b64_tr_b16 v[250:251], v18 offset:34496
    ds_read_b64_tr_b16 v[252:253], v18 offset:34016
    ds_read_b64_tr_b16 v[254:255], v18 offset:34528
    v_cvt_pk_bf16_f32 v188, v20, v21
    v_exp_f32 v24, v156
    v_add_f32 v171, v171, v22
    v_exp_f32 v25, v157
    v_add_f32 v171, v171, v23
    v_cvt_pk_bf16_f32 v189, v22, v23
    v_exp_f32 v26, v158
    v_mfma_f32_16x16x32_bf16 v[128:131], v[216:219], v[108:111], v[128:131]
    v_add_f32 v171, v171, v24
    v_exp_f32 v27, v159
    v_add_f32 v171, v171, v25
    v_cvt_pk_bf16_f32 v190, v24, v25
    v_add_f32 v171, v171, v26
    v_add_f32 v171, v171, v27
    v_cvt_pk_bf16_f32 v191, v26, v27
    v_mfma_f32_16x16x32_bf16 v[136:139], v[216:219], v[124:127], v[136:139]
    v_max_f32 v30, v170, v171
    v_cmp_lt_f32 vcc, s49, v30
    v_mfma_f32_16x16x32_bf16 v[132:135], v[220:223], v[108:111], v[132:135]
    s_cbranch_vccnz LS_r25
LS_b25:
    v_mfma_f32_16x16x32_bf16 v[140:143], v[220:223], v[124:127], v[140:143]
    s_waitcnt lgkmcnt(0)
    v_mfma_f32_16x16x32_bf16 v[32:35], v[224:227], v[184:187], v[32:35]
    ds_read_b128 v[192:195], v4 offset:33792
    ds_read_b128 v[196:199], v4 offset:34304
    v_mfma_f32_16x16x32_bf16 v[64:67], v[224:227], v[188:191], v[64:67]
    ds_read_b128 v[200:203], v4 offset:33856
    ds_read_b128 v[204:207], v4 offset:34368
    v_mfma_f32_16x16x32_bf16 v[36:39], v[228:231], v[184:187], v[36:39]
    ds_read_b128 v[208:211], v4 offset:33920
    ds_read_b128 v[212:215], v4 offset:34432
    v_mfma_f32_16x16x32_bf16 v[68:71], v[228:231], v[188:191], v[68:71]
    ds_read_b128 v[216:219], v4 offset:33984
    ds_read_b128 v[220:223], v4 offset:34496
    v_mfma_f32_16x16x32_bf16 v[40:43], v[232:235], v[184:187], v[40:43]
    v_mfma_f32_16x16x32_bf16 v[72:75], v[232:235], v[188:191], v[72:75]
    v_mfma_f32_16x16x32_bf16 v[44:47], v[236:239], v[184:187], v[44:47]
    v_mfma_f32_16x16x32_bf16 v[76:79], v[236:239], v[188:191], v[76:79]
    v_mfma_f32_16x16x32_bf16 v[48:51], v[240:243], v[184:187], v[48:51]
    v_mfma_f32_16x16x32_bf16 v[80:83], v[240:243], v[188:191], v[80:83]
    v_mfma_f32_16x16x32_bf16 v[52:55], v[244:247], v[184:187], v[52:55]
    v_mfma_f32_16x16x32_bf16 v[84:87], v[244:247], v[188:191], v[84:87]
    v_mfma_f32_16x16x32_bf16 v[56:59], v[248:251], v[184:187], v[56:59]
    v_mfma_f32_16x16x32_bf16 v[88:91], v[248:251], v[188:191], v[88:91]
    v_mfma_f32_16x16x32_bf16 v[60:63], v[252:255], v[184:187], v[60:63]
    v_exp_f32 v20, v128
    v_exp_f32 v21, v129
    v_exp_f32 v22, v130
    v_add_f32 v168, v170, v20
    v_exp_f32 v23, v131
    v_add_f32 v168, v168, v21
    v_cvt_pk_bf16_f32 v176, v20, v21
    v_exp_f32 v24, v132
    v_add_f32 v168, v168, v22
    v_exp_f32 v25, v133
    v_mfma_f32_16x16x32_bf16 v[92:95], v[252:255], v[188:191], v[92:95]
    v_add_f32 v168, v168, v23
    v_cvt_pk_bf16_f32 v177, v22, v23
    v_exp_f32 v26, v134
    v_add_f32 v168, v168, v24
    v_exp_f32 v27, v135
    v_add_f32 v168, v168, v25
    v_cvt_pk_bf16_f32 v178, v24, v25
    v_exp_f32 v20, v136
    v_add_f32 v168, v168, v26
    s_waitcnt vmcnt(8) lgkmcnt(0)
    s_barrier
    v_mfma_f32_16x16x32_bf16 v[144:147], v[192:195], v[96:99], v[160:163]
    s_mov_b32 s46, 253952
    s_add_u32 m0, s52, 50688
    ds_read_b64_tr_b16 v[224:225], v16 offset:0
    ds_read_b64_tr_b16 v[226:227], v16 offset:512
    v_exp_f32 v21, v137
    v_add_f32 v168, v168, v27
    v_mfma_f32_16x16x32_bf16 v[152:155], v[192:195], v[112:115], v[164:167]
    buffer_load_dwordx4 v6, s[8:11], s46 offen offset:0 nt lds
    ds_read_b64_tr_b16 v[228:229], v16 offset:32
    v_cvt_pk_bf16_f32 v179, v26, v27
    v_exp_f32 v22, v138
    v_mfma_f32_16x16x32_bf16 v[148:151], v[196:199], v[96:99], v[160:163]
    s_add_u32 m0, s52, 51488
    ds_read_b64_tr_b16 v[230:231], v16 offset:544
    v_add_f32 v169, v171, v20
    v_mfma_f32_16x16x32_bf16 v[156:159], v[196:199], v[112:115], v[164:167]
    buffer_load_dwordx4 v6, s[8:11], s46 offen offset:256 nt lds
    ds_read_b64_tr_b16 v[232:233], v16 offset:64
    ds_read_b64_tr_b16 v[234:235], v16 offset:576
    v_exp_f32 v23, v139
    v_add_f32 v169, v169, v21
    v_mfma_f32_16x16x32_bf16 v[144:147], v[200:203], v[100:103], v[144:147]
    s_mov_b32 s46, 237568
    s_add_u32 m0, s52, 59136
    ds_read_b64_tr_b16 v[236:237], v16 offset:96
    v_cvt_pk_bf16_f32 v180, v20, v21
    v_exp_f32 v24, v140
    v_mfma_f32_16x16x32_bf16 v[152:155], v[200:203], v[116:119], v[152:155]
    buffer_load_dwordx4 v6, s[12:15], s46 offen offset:0 nt lds
    ds_read_b64_tr_b16 v[238:239], v16 offset:608
    v_add_f32 v169, v169, v22
    v_mfma_f32_16x16x32_bf16 v[148:151], v[204:207], v[100:103], v[148:151]
    s_add_u32 m0, s52, 59936
    ds_read_b64_tr_b16 v[240:241], v16 offset:128
    ds_read_b64_tr_b16 v[242:243], v16 offset:640
    v_exp_f32 v25, v141
    v_add_f32 v169, v169, v23
    v_mfma_f32_16x16x32_bf16 v[156:159], v[204:207], v[116:119], v[156:159]
    buffer_load_dwordx4 v6, s[12:15], s46 offen offset:256 nt lds
    ds_read_b64_tr_b16 v[244:245], v16 offset:160
    v_cvt_pk_bf16_f32 v181, v22, v23
    v_mfma_f32_16x16x32_bf16 v[144:147], v[208:211], v[104:107], v[144:147]
    ds_read_b64_tr_b16 v[246:247], v16 offset:672
    v_exp_f32 v26, v142
    v_add_f32 v169, v169, v24
    v_mfma_f32_16x16x32_bf16 v[152:155], v[208:211], v[120:123], v[152:155]
    ds_read_b64_tr_b16 v[248:249], v16 offset:192
    ds_read_b64_tr_b16 v[250:251], v16 offset:704
    v_exp_f32 v27, v143
    v_add_f32 v169, v169, v25
    v_mfma_f32_16x16x32_bf16 v[148:151], v[212:215], v[104:107], v[148:151]
    ds_read_b64_tr_b16 v[252:253], v16 offset:224
    v_cvt_pk_bf16_f32 v182, v24, v25
    v_mfma_f32_16x16x32_bf16 v[156:159], v[212:215], v[120:123], v[156:159]
    ds_read_b64_tr_b16 v[254:255], v16 offset:736
    v_add_f32 v169, v169, v26
    v_add_f32 v169, v169, v27
    v_mfma_f32_16x16x32_bf16 v[144:147], v[216:219], v[108:111], v[144:147]
    v_cvt_pk_bf16_f32 v183, v26, v27
    v_mfma_f32_16x16x32_bf16 v[152:155], v[216:219], v[124:127], v[152:155]
    v_max_f32 v30, v168, v169
    v_cmp_lt_f32 vcc, s49, v30
    v_mfma_f32_16x16x32_bf16 v[148:151], v[220:223], v[108:111], v[148:151]
    s_cbranch_vccnz LS_r26
LS_b26:
    v_mfma_f32_16x16x32_bf16 v[156:159], v[220:223], v[124:127], v[156:159]
    s_waitcnt lgkmcnt(0)
    v_mfma_f32_16x16x32_bf16 v[32:35], v[224:227], v[176:179], v[32:35]
    ds_read_b128 v[192:195], v2 offset:0
    ds_read_b128 v[196:199], v2 offset:512
    v_mfma_f32_16x16x32_bf16 v[64:67], v[224:227], v[180:183], v[64:67]
    ds_read_b128 v[200:203], v2 offset:64
    ds_read_b128 v[204:207], v2 offset:576
    v_mfma_f32_16x16x32_bf16 v[36:39], v[228:231], v[176:179], v[36:39]
    ds_read_b128 v[208:211], v2 offset:128
    ds_read_b128 v[212:215], v2 offset:640
    v_mfma_f32_16x16x32_bf16 v[68:71], v[228:231], v[180:183], v[68:71]
    ds_read_b128 v[216:219], v2 offset:192
    ds_read_b128 v[220:223], v2 offset:704
    v_exp_f32 v20, v144
    v_exp_f32 v21, v145
    v_mfma_f32_16x16x32_bf16 v[40:43], v[232:235], v[176:179], v[40:43]
    v_exp_f32 v22, v146
    v_mfma_f32_16x16x32_bf16 v[72:75], v[232:235], v[180:183], v[72:75]
    v_add_f32 v170, v168, v20
    v_exp_f32 v23, v147
    v_mfma_f32_16x16x32_bf16 v[44:47], v[236:239], v[176:179], v[44:47]
    v_add_f32 v170, v170, v21
    v_mfma_f32_16x16x32_bf16 v[76:79], v[236:239], v[180:183], v[76:79]
    v_cvt_pk_bf16_f32 v184, v20, v21
    v_exp_f32 v24, v148
    v_mfma_f32_16x16x32_bf16 v[48:51], v[240:243], v[176:179], v[48:51]
    v_add_f32 v170, v170, v22
    v_mfma_f32_16x16x32_bf16 v[80:83], v[240:243], v[180:183], v[80:83]
    v_exp_f32 v25, v149
    v_add_f32 v170, v170, v23
    v_mfma_f32_16x16x32_bf16 v[52:55], v[244:247], v[176:179], v[52:55]
    v_cvt_pk_bf16_f32 v185, v22, v23
    v_mfma_f32_16x16x32_bf16 v[84:87], v[244:247], v[180:183], v[84:87]
    v_exp_f32 v26, v150
    v_add_f32 v170, v170, v24
    v_mfma_f32_16x16x32_bf16 v[56:59], v[248:251], v[176:179], v[56:59]
    v_exp_f32 v27, v151
    v_mfma_f32_16x16x32_bf16 v[88:91], v[248:251], v[180:183], v[88:91]
    v_add_f32 v170, v170, v25
    v_cvt_pk_bf16_f32 v186, v24, v25
    v_mfma_f32_16x16x32_bf16 v[60:63], v[252:255], v[176:179], v[60:63]
    v_exp_f32 v20, v152
    v_mfma_f32_16x16x32_bf16 v[92:95], v[252:255], v[180:183], v[92:95]
    v_add_f32 v170, v170, v26
    s_waitcnt vmcnt(8) lgkmcnt(0)
    s_barrier
    v_mfma_f32_16x16x32_bf16 v[128:131], v[192:195], v[96:99], v[160:163]
    s_mov_b32 s46, 262144
    s_add_u32 m0, s52, 67584
    ds_read_b64_tr_b16 v[224:225], v16 offset:16896
    ds_read_b64_tr_b16 v[226:227], v16 offset:17408
    v_exp_f32 v21, v153
    v_add_f32 v170, v170, v27
    v_mfma_f32_16x16x32_bf16 v[136:139], v[192:195], v[112:115], v[164:167]
    buffer_load_dwordx4 v6, s[8:11], s46 offen offset:0 nt lds
    ds_read_b64_tr_b16 v[228:229], v16 offset:16928
    v_cvt_pk_bf16_f32 v187, v26, v27
    v_exp_f32 v22, v154
    v_mfma_f32_16x16x32_bf16 v[132:135], v[196:199], v[96:99], v[160:163]
    s_add_u32 m0, s52, 68384
    ds_read_b64_tr_b16 v[230:231], v16 offset:17440
    v_add_f32 v171, v169, v20
    v_mfma_f32_16x16x32_bf16 v[140:143], v[196:199], v[112:115], v[164:167]
    buffer_load_dwordx4 v6, s[8:11], s46 offen offset:256 nt lds
    ds_read_b64_tr_b16 v[232:233], v16 offset:16960
    ds_read_b64_tr_b16 v[234:235], v16 offset:17472
    v_exp_f32 v23, v155
    v_add_f32 v171, v171, v21
    v_mfma_f32_16x16x32_bf16 v[128:131], v[200:203], v[100:103], v[128:131]
    s_mov_b32 s46, 245760
    s_add_u32 m0, s52, 76032
    ds_read_b64_tr_b16 v[236:237], v16 offset:16992
    v_cvt_pk_bf16_f32 v188, v20, v21
    v_exp_f32 v24, v156
    v_mfma_f32_16x16x32_bf16 v[136:139], v[200:203], v[116:119], v[136:139]
    buffer_load_dwordx4 v6, s[12:15], s46 offen offset:0 nt lds
    ds_read_b64_tr_b16 v[238:239], v16 offset:17504
    v_add_f32 v171, v171, v22
    v_mfma_f32_16x16x32_bf16 v[132:135], v[204:207], v[100:103], v[132:135]
    s_add_u32 m0, s52, 76832
    ds_read_b64_tr_b16 v[240:241], v16 offset:17024
    ds_read_b64_tr_b16 v[242:243], v16 offset:17536
    v_exp_f32 v25, v157
    v_add_f32 v171, v171, v23
    v_mfma_f32_16x16x32_bf16 v[140:143], v[204:207], v[116:119], v[140:143]
    buffer_load_dwordx4 v6, s[12:15], s46 offen offset:256 nt lds
    ds_read_b64_tr_b16 v[244:245], v16 offset:17056
    v_cvt_pk_bf16_f32 v189, v22, v23
    v_mfma_f32_16x16x32_bf16 v[128:131], v[208:211], v[104:107], v[128:131]
    ds_read_b64_tr_b16 v[246:247], v16 offset:17568
    v_exp_f32 v26, v158
    v_add_f32 v171, v171, v24
    v_mfma_f32_16x16x32_bf16 v[136:139], v[208:211], v[120:123], v[136:139]
    ds_read_b64_tr_b16 v[248:249], v16 offset:17088
    ds_read_b64_tr_b16 v[250:251], v16 offset:17600
    v_exp_f32 v27, v159
    v_add_f32 v171, v171, v25
    v_mfma_f32_16x16x32_bf16 v[132:135], v[212:215], v[104:107], v[132:135]
    ds_read_b64_tr_b16 v[252:253], v16 offset:17120
    v_cvt_pk_bf16_f32 v190, v24, v25
    v_mfma_f32_16x16x32_bf16 v[140:143], v[212:215], v[120:123], v[140:143]
    ds_read_b64_tr_b16 v[254:255], v16 offset:17632
    v_add_f32 v171, v171, v26
    v_add_f32 v171, v171, v27
    v_mfma_f32_16x16x32_bf16 v[128:131], v[216:219], v[108:111], v[128:131]
    v_cvt_pk_bf16_f32 v191, v26, v27
    v_mfma_f32_16x16x32_bf16 v[136:139], v[216:219], v[124:127], v[136:139]
    v_max_f32 v30, v170, v171
    v_cmp_lt_f32 vcc, s49, v30
    v_mfma_f32_16x16x32_bf16 v[132:135], v[220:223], v[108:111], v[132:135]
    s_cbranch_vccnz LS_r27
LS_b27:
    v_mfma_f32_16x16x32_bf16 v[140:143], v[220:223], v[124:127], v[140:143]
    s_waitcnt lgkmcnt(0)
    v_mfma_f32_16x16x32_bf16 v[32:35], v[224:227], v[184:187], v[32:35]
    ds_read_b128 v[192:195], v2 offset:16896
    ds_read_b128 v[196:199], v2 offset:17408
    v_mfma_f32_16x16x32_bf16 v[64:67], v[224:227], v[188:191], v[64:67]
    ds_read_b128 v[200:203], v2 offset:16960
    ds_read_b128 v[204:207], v2 offset:17472
    v_mfma_f32_16x16x32_bf16 v[36:39], v[228:231], v[184:187], v[36:39]
    ds_read_b128 v[208:211], v2 offset:17024
    ds_read_b128 v[212:215], v2 offset:17536
    v_mfma_f32_16x16x32_bf16 v[68:71], v[228:231], v[188:191], v[68:71]
    ds_read_b128 v[216:219], v2 offset:17088
    ds_read_b128 v[220:223], v2 offset:17600
    v_exp_f32 v20, v128
    v_exp_f32 v21, v129
    v_mfma_f32_16x16x32_bf16 v[40:43], v[232:235], v[184:187], v[40:43]
    v_exp_f32 v22, v130
    v_mfma_f32_16x16x32_bf16 v[72:75], v[232:235], v[188:191], v[72:75]
    v_add_f32 v168, v170, v20
    v_exp_f32 v23, v131
    v_mfma_f32_16x16x32_bf16 v[44:47], v[236:239], v[184:187], v[44:47]
    v_add_f32 v168, v168, v21
    v_mfma_f32_16x16x32_bf16 v[76:79], v[236:239], v[188:191], v[76:79]
    v_cvt_pk_bf16_f32 v176, v20, v21
    v_exp_f32 v24, v132
    v_mfma_f32_16x16x32_bf16 v[48:51], v[240:243], v[184:187], v[48:51]
    v_add_f32 v168, v168, v22
    v_mfma_f32_16x16x32_bf16 v[80:83], v[240:243], v[188:191], v[80:83]
    v_exp_f32 v25, v133
    v_add_f32 v168, v168, v23
    v_mfma_f32_16x16x32_bf16 v[52:55], v[244:247], v[184:187], v[52:55]
    v_cvt_pk_bf16_f32 v177, v22, v23
    v_mfma_f32_16x16x32_bf16 v[84:87], v[244:247], v[188:191], v[84:87]
    v_exp_f32 v26, v134
    v_add_f32 v168, v168, v24
    v_mfma_f32_16x16x32_bf16 v[56:59], v[248:251], v[184:187], v[56:59]
    v_exp_f32 v27, v135
    v_mfma_f32_16x16x32_bf16 v[88:91], v[248:251], v[188:191], v[88:91]
    v_add_f32 v168, v168, v25
    v_cvt_pk_bf16_f32 v178, v24, v25
    v_mfma_f32_16x16x32_bf16 v[60:63], v[252:255], v[184:187], v[60:63]
    v_exp_f32 v20, v136
    v_mfma_f32_16x16x32_bf16 v[92:95], v[252:255], v[188:191], v[92:95]
    v_add_f32 v168, v168, v26
    s_waitcnt vmcnt(8) lgkmcnt(0)
    s_barrier
    v_mfma_f32_16x16x32_bf16 v[144:147], v[192:195], v[96:99], v[160:163]
    s_mov_b32 s46, 253952
    s_add_u32 m0, s52, 92928
    ds_read_b64_tr_b16 v[224:225], v16 offset:33792
    ds_read_b64_tr_b16 v[226:227], v16 offset:34304
    v_exp_f32 v21, v137
    v_add_f32 v168, v168, v27
    v_mfma_f32_16x16x32_bf16 v[152:155], v[192:195], v[112:115], v[164:167]
    buffer_load_dwordx4 v6, s[12:15], s46 offen offset:0 nt lds
    ds_read_b64_tr_b16 v[228:229], v16 offset:33824
    v_cvt_pk_bf16_f32 v179, v26, v27
    v_exp_f32 v22, v138
    v_mfma_f32_16x16x32_bf16 v[148:151], v[196:199], v[96:99], v[160:163]
    s_add_u32 m0, s52, 93728
    ds_read_b64_tr_b16 v[230:231], v16 offset:34336
    v_add_f32 v169, v171, v20
    v_mfma_f32_16x16x32_bf16 v[156:159], v[196:199], v[112:115], v[164:167]
    buffer_load_dwordx4 v6, s[12:15], s46 offen offset:256 nt lds
    ds_read_b64_tr_b16 v[232:233], v16 offset:33856
    ds_read_b64_tr_b16 v[234:235], v16 offset:34368
    v_exp_f32 v23, v139
    v_add_f32 v169, v169, v21
    v_mfma_f32_16x16x32_bf16 v[144:147], v[200:203], v[100:103], v[144:147]
    ds_read_b64_tr_b16 v[236:237], v16 offset:33888
    v_cvt_pk_bf16_f32 v180, v20, v21
    v_exp_f32 v24, v140
    v_mfma_f32_16x16x32_bf16 v[152:155], v[200:203], v[116:119], v[152:155]
    ds_read_b64_tr_b16 v[238:239], v16 offset:34400
    v_add_f32 v169, v169, v22
    v_mfma_f32_16x16x32_bf16 v[148:151], v[204:207], v[100:103], v[148:151]
    ds_read_b64_tr_b16 v[240:241], v16 offset:33920
    ds_read_b64_tr_b16 v[242:243], v16 offset:34432
    v_exp_f32 v25, v141
    v_add_f32 v169, v169, v23
    v_mfma_f32_16x16x32_bf16 v[156:159], v[204:207], v[116:119], v[156:159]
    ds_read_b64_tr_b16 v[244:245], v16 offset:33952
    v_cvt_pk_bf16_f32 v181, v22, v23
    v_mfma_f32_16x16x32_bf16 v[144:147], v[208:211], v[104:107], v[144:147]
    ds_read_b64_tr_b16 v[246:247], v16 offset:34464
    v_exp_f32 v26, v142
    v_add_f32 v169, v169, v24
    v_mfma_f32_16x16x32_bf16 v[152:155], v[208:211], v[120:123], v[152:155]
    ds_read_b64_tr_b16 v[248:249], v16 offset:33984
    ds_read_b64_tr_b16 v[250:251], v16 offset:34496
    v_exp_f32 v27, v143
    v_add_f32 v169, v169, v25
    v_mfma_f32_16x16x32_bf16 v[148:151], v[212:215], v[104:107], v[148:151]
    ds_read_b64_tr_b16 v[252:253], v16 offset:34016
    v_cvt_pk_bf16_f32 v182, v24, v25
    v_mfma_f32_16x16x32_bf16 v[156:159], v[212:215], v[120:123], v[156:159]
    ds_read_b64_tr_b16 v[254:255], v16 offset:34528
    v_add_f32 v169, v169, v26
    v_add_f32 v169, v169, v27
    v_mfma_f32_16x16x32_bf16 v[144:147], v[216:219], v[108:111], v[144:147]
    v_cvt_pk_bf16_f32 v183, v26, v27
    v_mfma_f32_16x16x32_bf16 v[152:155], v[216:219], v[124:127], v[152:155]
    v_max_f32 v30, v168, v169
    v_cmp_lt_f32 vcc, s49, v30
    v_mfma_f32_16x16x32_bf16 v[148:151], v[220:223], v[108:111], v[148:151]
    s_cbranch_vccnz LS_r28
LS_b28:
    v_mfma_f32_16x16x32_bf16 v[156:159], v[220:223], v[124:127], v[156:159]
    s_waitcnt lgkmcnt(0)
    v_mfma_f32_16x16x32_bf16 v[32:35], v[224:227], v[176:179], v[32:35]
    ds_read_b128 v[192:195], v2 offset:33792
    ds_read_b128 v[196:199], v2 offset:34304
    v_mfma_f32_16x16x32_bf16 v[64:67], v[224:227], v[180:183], v[64:67]
    ds_read_b128 v[200:203], v2 offset:33856
    ds_read_b128 v[204:207], v2 offset:34368
    v_mfma_f32_16x16x32_bf16 v[36:39], v[228:231], v[176:179], v[36:39]
    ds_read_b128 v[208:211], v2 offset:33920
    ds_read_b128 v[212:215], v2 offset:34432
    v_mfma_f32_16x16x32_bf16 v[68:71], v[228:231], v[180:183], v[68:71]
    ds_read_b128 v[216:219], v2 offset:33984
    ds_read_b128 v[220:223], v2 offset:34496
    v_exp_f32 v20, v144
    v_exp_f32 v21, v145
    v_mfma_f32_16x16x32_bf16 v[40:43], v[232:235], v[176:179], v[40:43]
    v_exp_f32 v22, v146
    v_mfma_f32_16x16x32_bf16 v[72:75], v[232:235], v[180:183], v[72:75]
    v_add_f32 v170, v168, v20
    v_exp_f32 v23, v147
    v_mfma_f32_16x16x32_bf16 v[44:47], v[236:239], v[176:179], v[44:47]
    v_add_f32 v170, v170, v21
    v_mfma_f32_16x16x32_bf16 v[76:79], v[236:239], v[180:183], v[76:79]
    v_cvt_pk_bf16_f32 v184, v20, v21
    v_exp_f32 v24, v148
    v_mfma_f32_16x16x32_bf16 v[48:51], v[240:243], v[176:179], v[48:51]
    v_add_f32 v170, v170, v22
    v_mfma_f32_16x16x32_bf16 v[80:83], v[240:243], v[180:183], v[80:83]
    v_exp_f32 v25, v149
    v_add_f32 v170, v170, v23
    v_mfma_f32_16x16x32_bf16 v[52:55], v[244:247], v[176:179], v[52:55]
    v_cvt_pk_bf16_f32 v185, v22, v23
    v_mfma_f32_16x16x32_bf16 v[84:87], v[244:247], v[180:183], v[84:87]
    v_exp_f32 v26, v150
    v_add_f32 v170, v170, v24
    v_mfma_f32_16x16x32_bf16 v[56:59], v[248:251], v[176:179], v[56:59]
    v_exp_f32 v27, v151
    v_mfma_f32_16x16x32_bf16 v[88:91], v[248:251], v[180:183], v[88:91]
    v_add_f32 v170, v170, v25
    v_cvt_pk_bf16_f32 v186, v24, v25
    v_mfma_f32_16x16x32_bf16 v[60:63], v[252:255], v[176:179], v[60:63]
    v_exp_f32 v20, v152
    v_mfma_f32_16x16x32_bf16 v[92:95], v[252:255], v[180:183], v[92:95]
    v_add_f32 v170, v170, v26
    s_waitcnt vmcnt(6) lgkmcnt(0)
    s_barrier
    v_mfma_f32_16x16x32_bf16 v[128:131], v[192:195], v[96:99], v[160:163]
    s_mov_b32 s46, 262144
    s_add_u32 m0, s52, 109824
    ds_read_b64_tr_b16 v[224:225], v17 offset:0
    ds_read_b64_tr_b16 v[226:227], v17 offset:512
    v_exp_f32 v21, v153
    v_add_f32 v170, v170, v27
    v_mfma_f32_16x16x32_bf16 v[136:139], v[192:195], v[112:115], v[164:167]
    buffer_load_dwordx4 v6, s[12:15], s46 offen offset:0 nt lds
    ds_read_b64_tr_b16 v[228:229], v17 offset:32
    v_cvt_pk_bf16_f32 v187, v26, v27
    v_exp_f32 v22, v154
    v_mfma_f32_16x16x32_bf16 v[132:135], v[196:199], v[96:99], v[160:163]
    s_add_u32 m0, s52, 110624
    ds_read_b64_tr_b16 v[230:231], v17 offset:544
    v_add_f32 v171, v169, v20
    v_mfma_f32_16x16x32_bf16 v[140:143], v[196:199], v[112:115], v[164:167]
    buffer_load_dwordx4 v6, s[12:15], s46 offen offset:256 nt lds
    ds_read_b64_tr_b16 v[232:233], v17 offset:64
    ds_read_b64_tr_b16 v[234:235], v17 offset:576
    v_exp_f32 v23, v155
    v_add_f32 v171, v171, v21
    v_mfma_f32_16x16x32_bf16 v[128:131], v[200:203], v[100:103], v[128:131]
    ds_read_b64_tr_b16 v[236:237], v17 offset:96
    v_cvt_pk_bf16_f32 v188, v20, v21
    v_exp_f32 v24, v156
    v_mfma_f32_16x16x32_bf16 v[136:139], v[200:203], v[116:119], v[136:139]
    ds_read_b64_tr_b16 v[238:239], v17 offset:608
    v_add_f32 v171, v171, v22
    v_mfma_f32_16x16x32_bf16 v[132:135], v[204:207], v[100:103], v[132:135]
    ds_read_b64_tr_b16 v[240:241], v17 offset:128
    ds_read_b64_tr_b16 v[242:243], v17 offset:640
    v_exp_f32 v25, v157
    v_add_f32 v171, v171, v23
    v_mfma_f32_16x16x32_bf16 v[140:143], v[204:207], v[116:119], v[140:143]
    ds_read_b64_tr_b16 v[244:245], v17 offset:160
    v_cvt_pk_bf16_f32 v189, v22, v23
    v_mfma_f32_16x16x32_bf16 v[128:131], v[208:211], v[104:107], v[128:131]
    ds_read_b64_tr_b16 v[246:247], v17 offset:672
    v_exp_f32 v26, v158
    v_add_f32 v171, v171, v24
    v_mfma_f32_16x16x32_bf16 v[136:139], v[208:211], v[120:123], v[136:139]
    ds_read_b64_tr_b16 v[248:249], v17 offset:192
    ds_read_b64_tr_b16 v[250:251], v17 offset:704
    v_exp_f32 v27, v159
    v_add_f32 v171, v171, v25
    v_mfma_f32_16x16x32_bf16 v[132:135], v[212:215], v[104:107], v[132:135]
    ds_read_b64_tr_b16 v[252:253], v17 offset:224
    v_cvt_pk_bf16_f32 v190, v24, v25
    v_mfma_f32_16x16x32_bf16 v[140:143], v[212:215], v[120:123], v[140:143]
    ds_read_b64_tr_b16 v[254:255], v17 offset:736
    v_add_f32 v171, v171, v26
    v_add_f32 v171, v171, v27
    v_mfma_f32_16x16x32_bf16 v[128:131], v[216:219], v[108:111], v[128:131]
    v_cvt_pk_bf16_f32 v191, v26, v27
    v_mfma_f32_16x16x32_bf16 v[136:139], v[216:219], v[124:127], v[136:139]
    v_max_f32 v30, v170, v171
    v_cmp_lt_f32 vcc, s49, v30
    v_mfma_f32_16x16x32_bf16 v[132:135], v[220:223], v[108:111], v[132:135]
    s_cbranch_vccnz LS_r29
LS_b29:
    v_mfma_f32_16x16x32_bf16 v[140:143], v[220:223], v[124:127], v[140:143]
    s_waitcnt lgkmcnt(0)
    v_mfma_f32_16x16x32_bf16 v[32:35], v[224:227], v[184:187], v[32:35]
    ds_read_b128 v[192:195], v3 offset:0
    ds_read_b128 v[196:199], v3 offset:512
    v_mfma_f32_16x16x32_bf16 v[64:67], v[224:227], v[188:191], v[64:67]
    ds_read_b128 v[200:203], v3 offset:64
    ds_read_b128 v[204:207], v3 offset:576
    v_mfma_f32_16x16x32_bf16 v[36:39], v[228:231], v[184:187], v[36:39]
    ds_read_b128 v[208:211], v3 offset:128
    ds_read_b128 v[212:215], v3 offset:640
    v_mfma_f32_16x16x32_bf16 v[68:71], v[228:231], v[188:191], v[68:71]
    ds_read_b128 v[216:219], v3 offset:192
    ds_read_b128 v[220:223], v3 offset:704
    v_exp_f32 v20, v128
    v_exp_f32 v21, v129
    v_mfma_f32_16x16x32_bf16 v[40:43], v[232:235], v[184:187], v[40:43]
    v_exp_f32 v22, v130
    v_mfma_f32_16x16x32_bf16 v[72:75], v[232:235], v[188:191], v[72:75]
    v_add_f32 v168, v170, v20
    v_exp_f32 v23, v131
    v_mfma_f32_16x16x32_bf16 v[44:47], v[236:239], v[184:187], v[44:47]
    v_add_f32 v168, v168, v21
    v_mfma_f32_16x16x32_bf16 v[76:79], v[236:239], v[188:191], v[76:79]
    v_cvt_pk_bf16_f32 v176, v20, v21
    v_exp_f32 v24, v132
    v_mfma_f32_16x16x32_bf16 v[48:51], v[240:243], v[184:187], v[48:51]
    v_add_f32 v168, v168, v22
    v_mfma_f32_16x16x32_bf16 v[80:83], v[240:243], v[188:191], v[80:83]
    v_exp_f32 v25, v133
    v_add_f32 v168, v168, v23
    v_mfma_f32_16x16x32_bf16 v[52:55], v[244:247], v[184:187], v[52:55]
    v_cvt_pk_bf16_f32 v177, v22, v23
    v_mfma_f32_16x16x32_bf16 v[84:87], v[244:247], v[188:191], v[84:87]
    v_exp_f32 v26, v134
    v_add_f32 v168, v168, v24
    v_mfma_f32_16x16x32_bf16 v[56:59], v[248:251], v[184:187], v[56:59]
    v_exp_f32 v27, v135
    v_mfma_f32_16x16x32_bf16 v[88:91], v[248:251], v[188:191], v[88:91]
    v_add_f32 v168, v168, v25
    v_cvt_pk_bf16_f32 v178, v24, v25
    v_mfma_f32_16x16x32_bf16 v[60:63], v[252:255], v[184:187], v[60:63]
    v_exp_f32 v20, v136
    v_mfma_f32_16x16x32_bf16 v[92:95], v[252:255], v[188:191], v[92:95]
    global_load_dword v9, v8, s[0:1]
    v_add_f32 v168, v168, v26
    s_waitcnt vmcnt(5) lgkmcnt(0)
    s_barrier
    v_mfma_f32_16x16x32_bf16 v[144:147], v[192:195], v[96:99], v[160:163]
    s_add_u32 s46, s4, 0
    s_add_u32 m0, s59, 118272
    ds_read_b64_tr_b16 v[224:225], v17 offset:16896
    ds_read_b64_tr_b16 v[226:227], v17 offset:17408
    v_exp_f32 v21, v137
    v_add_f32 v168, v168, v27
    v_mfma_f32_16x16x32_bf16 v[152:155], v[192:195], v[112:115], v[164:167]
    buffer_load_dwordx4 v10, s[20:23], s46 offen offset:0  lds
    ds_read_b64_tr_b16 v[228:229], v17 offset:16928
    v_cvt_pk_bf16_f32 v179, v26, v27
    v_exp_f32 v22, v138
    v_mfma_f32_16x16x32_bf16 v[148:151], v[196:199], v[96:99], v[160:163]
    ds_read_b64_tr_b16 v[230:231], v17 offset:17440
    v_add_f32 v169, v171, v20
    v_mfma_f32_16x16x32_bf16 v[156:159], v[196:199], v[112:115], v[164:167]
    buffer_load_dwordx4 v11, s[20:23], s46 offen offset:1024  lds
    ds_read_b64_tr_b16 v[232:233], v17 offset:16960
    ds_read_b64_tr_b16 v[234:235], v17 offset:17472
    v_exp_f32 v23, v139
    v_add_f32 v169, v169, v21
    v_mfma_f32_16x16x32_bf16 v[144:147], v[200:203], v[100:103], v[144:147]
    ds_read_b64_tr_b16 v[236:237], v17 offset:16992
    v_cvt_pk_bf16_f32 v180, v20, v21
    v_exp_f32 v24, v140
    v_mfma_f32_16x16x32_bf16 v[152:155], v[200:203], v[116:119], v[152:155]
    buffer_load_dwordx4 v12, s[20:23], s46 offen offset:2048  lds
    ds_read_b64_tr_b16 v[238:239], v17 offset:17504
    v_add_f32 v169, v169, v22
    v_mfma_f32_16x16x32_bf16 v[148:151], v[204:207], v[100:103], v[148:151]
    ds_read_b64_tr_b16 v[240:241], v17 offset:17024
    ds_read_b64_tr_b16 v[242:243], v17 offset:17536
    v_exp_f32 v25, v141
    v_add_f32 v169, v169, v23
    v_mfma_f32_16x16x32_bf16 v[156:159], v[204:207], v[116:119], v[156:159]
    buffer_load_dwordx4 v13, s[20:23], s46 offen offset:3072  lds
    ds_read_b64_tr_b16 v[244:245], v17 offset:17056
    v_cvt_pk_bf16_f32 v181, v22, v23
    v_mfma_f32_16x16x32_bf16 v[144:147], v[208:211], v[104:107], v[144:147]
    ds_read_b64_tr_b16 v[246:247], v17 offset:17568
    v_exp_f32 v26, v142
    v_add_f32 v169, v169, v24
    v_mfma_f32_16x16x32_bf16 v[152:155], v[208:211], v[120:123], v[152:155]
    ds_read_b64_tr_b16 v[248:249], v17 offset:17088
    ds_read_b64_tr_b16 v[250:251], v17 offset:17600
    v_exp_f32 v27, v143
    v_add_f32 v169, v169, v25
    v_mfma_f32_16x16x32_bf16 v[148:151], v[212:215], v[104:107], v[148:151]
    ds_read_b64_tr_b16 v[252:253], v17 offset:17120
    v_cvt_pk_bf16_f32 v182, v24, v25
    v_mfma_f32_16x16x32_bf16 v[156:159], v[212:215], v[120:123], v[156:159]
    ds_read_b64_tr_b16 v[254:255], v17 offset:17632
    v_add_f32 v169, v169, v26
    v_add_f32 v169, v169, v27
    v_mfma_f32_16x16x32_bf16 v[144:147], v[216:219], v[108:111], v[144:147]
    v_cvt_pk_bf16_f32 v183, v26, v27
    v_mfma_f32_16x16x32_bf16 v[152:155], v[216:219], v[124:127], v[152:155]
    v_max_f32 v30, v168, v169
    v_cmp_lt_f32 vcc, s49, v30
    v_mfma_f32_16x16x32_bf16 v[148:151], v[220:223], v[108:111], v[148:151]
    s_cbranch_vccnz LS_r30
LS_b30:
    v_mfma_f32_16x16x32_bf16 v[156:159], v[220:223], v[124:127], v[156:159]
    s_waitcnt lgkmcnt(0)
    v_mfma_f32_16x16x32_bf16 v[32:35], v[224:227], v[176:179], v[32:35]
    ds_read_b128 v[192:195], v3 offset:16896
    ds_read_b128 v[196:199], v3 offset:17408
    v_mfma_f32_16x16x32_bf16 v[64:67], v[224:227], v[180:183], v[64:67]
    ds_read_b128 v[200:203], v3 offset:16960
    ds_read_b128 v[204:207], v3 offset:17472
    v_mfma_f32_16x16x32_bf16 v[36:39], v[228:231], v[176:179], v[36:39]
    ds_read_b128 v[208:211], v3 offset:17024
    ds_read_b128 v[212:215], v3 offset:17536
    v_mfma_f32_16x16x32_bf16 v[68:71], v[228:231], v[180:183], v[68:71]
    ds_read_b128 v[216:219], v3 offset:17088
    ds_read_b128 v[220:223], v3 offset:17600
    v_exp_f32 v20, v144
    v_exp_f32 v21, v145
    v_mfma_f32_16x16x32_bf16 v[40:43], v[232:235], v[176:179], v[40:43]
    v_exp_f32 v22, v146
    v_mfma_f32_16x16x32_bf16 v[72:75], v[232:235], v[180:183], v[72:75]
    v_add_f32 v170, v168, v20
    v_exp_f32 v23, v147
    v_mfma_f32_16x16x32_bf16 v[44:47], v[236:239], v[176:179], v[44:47]
    v_add_f32 v170, v170, v21
    v_mfma_f32_16x16x32_bf16 v[76:79], v[236:239], v[180:183], v[76:79]
    v_cvt_pk_bf16_f32 v184, v20, v21
    v_exp_f32 v24, v148
    v_mfma_f32_16x16x32_bf16 v[48:51], v[240:243], v[176:179], v[48:51]
    v_add_f32 v170, v170, v22
    v_mfma_f32_16x16x32_bf16 v[80:83], v[240:243], v[180:183], v[80:83]
    v_exp_f32 v25, v149
    v_add_f32 v170, v170, v23
    v_mfma_f32_16x16x32_bf16 v[52:55], v[244:247], v[176:179], v[52:55]
    v_cvt_pk_bf16_f32 v185, v22, v23
    v_mfma_f32_16x16x32_bf16 v[84:87], v[244:247], v[180:183], v[84:87]
    v_exp_f32 v26, v150
    v_add_f32 v170, v170, v24
    v_mfma_f32_16x16x32_bf16 v[56:59], v[248:251], v[176:179], v[56:59]
    v_exp_f32 v27, v151
    v_mfma_f32_16x16x32_bf16 v[88:91], v[248:251], v[180:183], v[88:91]
    v_add_f32 v170, v170, v25
    v_cvt_pk_bf16_f32 v186, v24, v25
    v_mfma_f32_16x16x32_bf16 v[60:63], v[252:255], v[176:179], v[60:63]
    v_exp_f32 v20, v152
    v_mfma_f32_16x16x32_bf16 v[92:95], v[252:255], v[180:183], v[92:95]
    v_add_f32 v170, v170, v26
    s_waitcnt vmcnt(7) lgkmcnt(0)
    s_barrier
    v_mfma_f32_16x16x32_bf16 v[128:131], v[192:195], v[96:99], v[160:163]
    s_add_u32 s46, s4, 131072
    s_add_u32 m0, s59, 135168
    ds_read_b64_tr_b16 v[224:225], v17 offset:33792
    ds_read_b64_tr_b16 v[226:227], v17 offset:34304
    v_exp_f32 v21, v153
    v_add_f32 v170, v170, v27
    v_mfma_f32_16x16x32_bf16 v[136:139], v[192:195], v[112:115], v[164:167]
    buffer_load_dwordx4 v10, s[20:23], s46 offen offset:0  lds
    ds_read_b64_tr_b16 v[228:229], v17 offset:33824
    v_cvt_pk_bf16_f32 v187, v26, v27
    v_exp_f32 v22, v154
    v_mfma_f32_16x16x32_bf16 v[132:135], v[196:199], v[96:99], v[160:163]
    ds_read_b64_tr_b16 v[230:231], v17 offset:34336
    v_add_f32 v171, v169, v20
    v_mfma_f32_16x16x32_bf16 v[140:143], v[196:199], v[112:115], v[164:167]
    buffer_load_dwordx4 v11, s[20:23], s46 offen offset:1024  lds
    ds_read_b64_tr_b16 v[232:233], v17 offset:33856
    ds_read_b64_tr_b16 v[234:235], v17 offset:34368
    v_exp_f32 v23, v155
    v_add_f32 v171, v171, v21
    v_mfma_f32_16x16x32_bf16 v[128:131], v[200:203], v[100:103], v[128:131]
    ds_read_b64_tr_b16 v[236:237], v17 offset:33888
    v_cvt_pk_bf16_f32 v188, v20, v21
    v_exp_f32 v24, v156
    v_mfma_f32_16x16x32_bf16 v[136:139], v[200:203], v[116:119], v[136:139]
    buffer_load_dwordx4 v12, s[20:23], s46 offen offset:2048  lds
    ds_read_b64_tr_b16 v[238:239], v17 offset:34400
    v_add_f32 v171, v171, v22
    v_mfma_f32_16x16x32_bf16 v[132:135], v[204:207], v[100:103], v[132:135]
    ds_read_b64_tr_b16 v[240:241], v17 offset:33920
    ds_read_b64_tr_b16 v[242:243], v17 offset:34432
    v_exp_f32 v25, v157
    v_add_f32 v171, v171, v23
    v_mfma_f32_16x16x32_bf16 v[140:143], v[204:207], v[116:119], v[140:143]
    buffer_load_dwordx4 v13, s[20:23], s46 offen offset:3072  lds
    ds_read_b64_tr_b16 v[244:245], v17 offset:33952
    v_cvt_pk_bf16_f32 v189, v22, v23
    v_mfma_f32_16x16x32_bf16 v[128:131], v[208:211], v[104:107], v[128:131]
    ds_read_b64_tr_b16 v[246:247], v17 offset:34464
    v_exp_f32 v26, v158
    v_add_f32 v171, v171, v24
    v_mfma_f32_16x16x32_bf16 v[136:139], v[208:211], v[120:123], v[136:139]
    ds_read_b64_tr_b16 v[248:249], v17 offset:33984
    ds_read_b64_tr_b16 v[250:251], v17 offset:34496
    v_exp_f32 v27, v159
    v_add_f32 v171, v171, v25
    v_mfma_f32_16x16x32_bf16 v[132:135], v[212:215], v[104:107], v[132:135]
    ds_read_b64_tr_b16 v[252:253], v17 offset:34016
    v_cvt_pk_bf16_f32 v190, v24, v25
    v_mfma_f32_16x16x32_bf16 v[140:143], v[212:215], v[120:123], v[140:143]
    ds_read_b64_tr_b16 v[254:255], v17 offset:34528
    v_add_f32 v171, v171, v26
    v_add_f32 v171, v171, v27
    v_mfma_f32_16x16x32_bf16 v[128:131], v[216:219], v[108:111], v[128:131]
    v_cvt_pk_bf16_f32 v191, v26, v27
    v_mfma_f32_16x16x32_bf16 v[136:139], v[216:219], v[124:127], v[136:139]
    v_max_f32 v30, v170, v171
    v_cmp_lt_f32 vcc, s49, v30
    v_mfma_f32_16x16x32_bf16 v[132:135], v[220:223], v[108:111], v[132:135]
    s_cbranch_vccnz LS_r31
LS_b31:
    v_mfma_f32_16x16x32_bf16 v[140:143], v[220:223], v[124:127], v[140:143]
    s_waitcnt lgkmcnt(0)
    v_mfma_f32_16x16x32_bf16 v[32:35], v[224:227], v[184:187], v[32:35]
    v_mfma_f32_16x16x32_bf16 v[64:67], v[224:227], v[188:191], v[64:67]
    s_nop 3
    v_mfma_f32_16x16x32_bf16 v[36:39], v[228:231], v[184:187], v[36:39]
    v_mfma_f32_16x16x32_bf16 v[68:71], v[228:231], v[188:191], v[68:71]
    v_exp_f32 v20, v128
    v_exp_f32 v21, v129
    v_mfma_f32_16x16x32_bf16 v[40:43], v[232:235], v[184:187], v[40:43]
    v_exp_f32 v22, v130
    v_mfma_f32_16x16x32_bf16 v[72:75], v[232:235], v[188:191], v[72:75]
    v_add_f32 v168, v170, v20
    v_exp_f32 v23, v131
    v_mfma_f32_16x16x32_bf16 v[44:47], v[236:239], v[184:187], v[44:47]
    v_add_f32 v168, v168, v21
    v_mfma_f32_16x16x32_bf16 v[76:79], v[236:239], v[188:191], v[76:79]
    v_cvt_pk_bf16_f32 v176, v20, v21
    v_exp_f32 v24, v132
    v_mfma_f32_16x16x32_bf16 v[48:51], v[240:243], v[184:187], v[48:51]
    v_add_f32 v168, v168, v22
    v_mfma_f32_16x16x32_bf16 v[80:83], v[240:243], v[188:191], v[80:83]
    v_exp_f32 v25, v133
    v_add_f32 v168, v168, v23
    v_mfma_f32_16x16x32_bf16 v[52:55], v[244:247], v[184:187], v[52:55]
    v_cvt_pk_bf16_f32 v177, v22, v23
    v_mfma_f32_16x16x32_bf16 v[84:87], v[244:247], v[188:191], v[84:87]
    v_exp_f32 v26, v134
    v_add_f32 v168, v168, v24
    v_mfma_f32_16x16x32_bf16 v[56:59], v[248:251], v[184:187], v[56:59]
    v_exp_f32 v27, v135
    v_mfma_f32_16x16x32_bf16 v[88:91], v[248:251], v[188:191], v[88:91]
    v_add_f32 v168, v168, v25
    v_cvt_pk_bf16_f32 v178, v24, v25
    v_mfma_f32_16x16x32_bf16 v[60:63], v[252:255], v[184:187], v[60:63]
    v_exp_f32 v20, v136
    v_mfma_f32_16x16x32_bf16 v[92:95], v[252:255], v[188:191], v[92:95]
    v_add_f32 v168, v168, v26
    s_waitcnt vmcnt(9) lgkmcnt(0)
    s_barrier
    ds_read_b64_tr_b16 v[224:225], v18 offset:0
    ds_read_b64_tr_b16 v[226:227], v18 offset:512
    v_exp_f32 v21, v137
    v_add_f32 v168, v168, v27
    ds_read_b64_tr_b16 v[228:229], v18 offset:32
    v_cvt_pk_bf16_f32 v179, v26, v27
    v_exp_f32 v22, v138
    ds_read_b64_tr_b16 v[230:231], v18 offset:544
    v_add_f32 v169, v171, v20
    ds_read_b64_tr_b16 v[232:233], v18 offset:64
    ds_read_b64_tr_b16 v[234:235], v18 offset:576
    v_exp_f32 v23, v139
    v_add_f32 v169, v169, v21
    ds_read_b64_tr_b16 v[236:237], v18 offset:96
    v_cvt_pk_bf16_f32 v180, v20, v21
    v_exp_f32 v24, v140
    ds_read_b64_tr_b16 v[238:239], v18 offset:608
    v_add_f32 v169, v169, v22
    ds_read_b64_tr_b16 v[240:241], v18 offset:128
    ds_read_b64_tr_b16 v[242:243], v18 offset:640
    v_exp_f32 v25, v141
    v_add_f32 v169, v169, v23
    ds_read_b64_tr_b16 v[244:245], v18 offset:160
    v_cvt_pk_bf16_f32 v181, v22, v23
    ds_read_b64_tr_b16 v[246:247], v18 offset:672
    v_exp_f32 v26, v142
    v_add_f32 v169, v169, v24
    ds_read_b64_tr_b16 v[248:249], v18 offset:192
    ds_read_b64_tr_b16 v[250:251], v18 offset:704
    v_exp_f32 v27, v143
    v_add_f32 v169, v169, v25
    ds_read_b64_tr_b16 v[252:253], v18 offset:224
    v_cvt_pk_bf16_f32 v182, v24, v25
    ds_read_b64_tr_b16 v[254:255], v18 offset:736
    v_add_f32 v169, v169, v26
    v_add_f32 v169, v169, v27
    v_cvt_pk_bf16_f32 v183, v26, v27
    v_max_f32 v30, v168, v169
    v_cmp_lt_f32 vcc, s49, v30
    s_cbranch_vccnz LS_r32
LS_b32:
    s_waitcnt lgkmcnt(0)
    v_mfma_f32_16x16x32_bf16 v[32:35], v[224:227], v[176:179], v[32:35]
    v_mfma_f32_16x16x32_bf16 v[64:67], v[224:227], v[180:183], v[64:67]
    s_nop 3
    v_mfma_f32_16x16x32_bf16 v[36:39], v[228:231], v[176:179], v[36:39]
    v_mfma_f32_16x16x32_bf16 v[68:71], v[228:231], v[180:183], v[68:71]
    v_mfma_f32_16x16x32_bf16 v[40:43], v[232:235], v[176:179], v[40:43]
    v_mfma_f32_16x16x32_bf16 v[72:75], v[232:235], v[180:183], v[72:75]
    v_mfma_f32_16x16x32_bf16 v[44:47], v[236:239], v[176:179], v[44:47]
    v_mfma_f32_16x16x32_bf16 v[76:79], v[236:239], v[180:183], v[76:79]
    v_mfma_f32_16x16x32_bf16 v[48:51], v[240:243], v[176:179], v[48:51]
    v_mfma_f32_16x16x32_bf16 v[80:83], v[240:243], v[180:183], v[80:83]
    v_mfma_f32_16x16x32_bf16 v[52:55], v[244:247], v[176:179], v[52:55]
    v_mfma_f32_16x16x32_bf16 v[84:87], v[244:247], v[180:183], v[84:87]
    v_mfma_f32_16x16x32_bf16 v[56:59], v[248:251], v[176:179], v[56:59]
    v_mfma_f32_16x16x32_bf16 v[88:91], v[248:251], v[180:183], v[88:91]
    v_mfma_f32_16x16x32_bf16 v[60:63], v[252:255], v[176:179], v[60:63]
    v_mfma_f32_16x16x32_bf16 v[92:95], v[252:255], v[180:183], v[92:95]
    v_mov_b32 v20, v160
    v_mov_b32 v21, v168
    v_mov_b32 v22, v164
    v_mov_b32 v23, v169
    s_nop 3
    s_cmp_eq_u32 s39, 0
    s_cbranch_scc1 Les_far
    v_cvt_pk_bf16_f32 v192, v32, v33
    v_cvt_pk_bf16_f32 v193, v34, v35
    v_cvt_pk_bf16_f32 v194, v36, v37
    v_cvt_pk_bf16_f32 v195, v38, v39
    buffer_store_dwordx4 v[192:195], v15, s[28:31], s47 offen offset:0
    v_cvt_pk_bf16_f32 v196, v40, v41
    v_cvt_pk_bf16_f32 v197, v42, v43
    v_cvt_pk_bf16_f32 v198, v44, v45
    v_cvt_pk_bf16_f32 v199, v46, v47
    buffer_store_dwordx4 v[196:199], v15, s[28:31], s47 offen offset:1024
    v_cvt_pk_bf16_f32 v200, v48, v49
    v_cvt_pk_bf16_f32 v201, v50, v51
    v_cvt_pk_bf16_f32 v202, v52, v53
    v_cvt_pk_bf16_f32 v203, v54, v55
    buffer_store_dwordx4 v[200:203], v15, s[28:31], s47 offen offset:2048
    v_cvt_pk_bf16_f32 v204, v56, v57
    v_cvt_pk_bf16_f32 v205, v58, v59
    v_cvt_pk_bf16_f32 v206, v60, v61
    v_cvt_pk_bf16_f32 v207, v62, v63
    buffer_store_dwordx4 v[204:207], v15, s[28:31], s47 offen offset:3072
    v_cvt_pk_bf16_f32 v208, v64, v65
    v_cvt_pk_bf16_f32 v209, v66, v67
    v_cvt_pk_bf16_f32 v210, v68, v69
    v_cvt_pk_bf16_f32 v211, v70, v71
    buffer_store_dwordx4 v[208:211], v15, s[28:31], s48 offen offset:0
    v_cvt_pk_bf16_f32 v212, v72, v73
    v_cvt_pk_bf16_f32 v213, v74, v75
    v_cvt_pk_bf16_f32 v214, v76, v77
    v_cvt_pk_bf16_f32 v215, v78, v79
    buffer_store_dwordx4 v[212:215], v15, s[28:31], s48 offen offset:1024
    v_cvt_pk_bf16_f32 v216, v80, v81
    v_cvt_pk_bf16_f32 v217, v82, v83
    v_cvt_pk_bf16_f32 v218, v84, v85
    v_cvt_pk_bf16_f32 v219, v86, v87
    buffer_store_dwordx4 v[216:219], v15, s[28:31], s48 offen offset:2048
    v_cvt_pk_bf16_f32 v220, v88, v89
    v_cvt_pk_bf16_f32 v221, v90, v91
    v_cvt_pk_bf16_f32 v222, v92, v93
    v_cvt_pk_bf16_f32 v223, v94, v95
    buffer_store_dwordx4 v[220:223], v15, s[28:31], s48 offen offset:3072
    buffer_store_dwordx4 v[20:23], v15, s[28:31], s51 offen
    v_mov_b32 v24, s40
    v_mov_b32 v25, s41
    v_mov_b32 v26, 0
    s_waitcnt vmcnt(0)
    s_mov_b64 exec, 1
    buffer_store_dwordx2 v[24:25], v26, s[28:31], s42 offen
    s_mov_b64 exec, -1
    s_branch Les_j
Les_far:
    v_cvt_pk_bf16_f32 v192, v32, v33
    v_cvt_pk_bf16_f32 v193, v34, v35
    v_cvt_pk_bf16_f32 v194, v36, v37
    v_cvt_pk_bf16_f32 v195, v38, v39
    buffer_store_dwordx4 v[192:195], v15, s[28:31], s47 offen offset:0 sc1
    v_cvt_pk_bf16_f32 v196, v40, v41
    v_cvt_pk_bf16_f32 v197, v42, v43
    v_cvt_pk_bf16_f32 v198, v44, v45
    v_cvt_pk_bf16_f32 v199, v46, v47
    buffer_store_dwordx4 v[196:199], v15, s[28:31], s47 offen offset:1024 sc1
    v_cvt_pk_bf16_f32 v200, v48, v49
    v_cvt_pk_bf16_f32 v201, v50, v51
    v_cvt_pk_bf16_f32 v202, v52, v53
    v_cvt_pk_bf16_f32 v203, v54, v55
    buffer_store_dwordx4 v[200:203], v15, s[28:31], s47 offen offset:2048 sc1
    v_cvt_pk_bf16_f32 v204, v56, v57
    v_cvt_pk_bf16_f32 v205, v58, v59
    v_cvt_pk_bf16_f32 v206, v60, v61
    v_cvt_pk_bf16_f32 v207, v62, v63
    buffer_store_dwordx4 v[204:207], v15, s[28:31], s47 offen offset:3072 sc1
    v_cvt_pk_bf16_f32 v208, v64, v65
    v_cvt_pk_bf16_f32 v209, v66, v67
    v_cvt_pk_bf16_f32 v210, v68, v69
    v_cvt_pk_bf16_f32 v211, v70, v71
    buffer_store_dwordx4 v[208:211], v15, s[28:31], s48 offen offset:0 sc1
    v_cvt_pk_bf16_f32 v212, v72, v73
    v_cvt_pk_bf16_f32 v213, v74, v75
    v_cvt_pk_bf16_f32 v214, v76, v77
    v_cvt_pk_bf16_f32 v215, v78, v79
    buffer_store_dwordx4 v[212:215], v15, s[28:31], s48 offen offset:1024 sc1
    v_cvt_pk_bf16_f32 v216, v80, v81
    v_cvt_pk_bf16_f32 v217, v82, v83
    v_cvt_pk_bf16_f32 v218, v84, v85
    v_cvt_pk_bf16_f32 v219, v86, v87
    buffer_store_dwordx4 v[216:219], v15, s[28:31], s48 offen offset:2048 sc1
    v_cvt_pk_bf16_f32 v220, v88, v89
    v_cvt_pk_bf16_f32 v221, v90, v91
    v_cvt_pk_bf16_f32 v222, v92, v93
    v_cvt_pk_bf16_f32 v223, v94, v95
    buffer_store_dwordx4 v[220:223], v15, s[28:31], s48 offen offset:3072 sc1
    buffer_store_dwordx4 v[20:23], v15, s[28:31], s51 offen sc1
    v_mov_b32 v24, s40
    v_mov_b32 v25, s41
    v_mov_b32 v26, 0
    s_waitcnt vmcnt(0)
    s_mov_b64 exec, 1
    buffer_store_dwordx2 v[24:25], v26, s[28:31], s42 offen sc1
    s_mov_b64 exec, -1
Les_j:
    s_add_u32 s46, s4, 262144
    s_add_u32 m0, s59, 0
    s_nop 0
    buffer_load_dwordx4 v10, s[20:23], s46 offen offset:0  lds
    buffer_load_dwordx4 v11, s[20:23], s46 offen offset:1024  lds
    buffer_load_dwordx4 v12, s[20:23], s46 offen offset:2048  lds
    buffer_load_dwordx4 v13, s[20:23], s46 offen offset:3072  lds
    s_add_u32 s46, s4, 393216
    s_add_u32 m0, s59, 16896
    s_nop 0
    buffer_load_dwordx4 v10, s[20:23], s46 offen offset:0  lds
    buffer_load_dwordx4 v11, s[20:23], s46 offen offset:1024  lds
    buffer_load_dwordx4 v12, s[20:23], s46 offen offset:2048  lds
    buffer_load_dwordx4 v13, s[20:23], s46 offen offset:3072  lds
    s_add_u32 s46, s5, 0
    s_add_u32 m0, s59, 33792
    s_nop 0
    buffer_load_dwordx4 v10, s[20:23], s46 offen offset:0  lds
    buffer_load_dwordx4 v11, s[20:23], s46 offen offset:1024  lds
    buffer_load_dwordx4 v12, s[20:23], s46 offen offset:2048  lds
    buffer_load_dwordx4 v13, s[20:23], s46 offen offset:3072  lds
    s_add_u32 s46, s5, 131072
    s_add_u32 m0, s59, 50688
    s_nop 0
    buffer_load_dwordx4 v10, s[20:23], s46 offen offset:0  lds
    buffer_load_dwordx4 v11, s[20:23], s46 offen offset:1024  lds
    buffer_load_dwordx4 v12, s[20:23], s46 offen offset:2048  lds
    buffer_load_dwordx4 v13, s[20:23], s46 offen offset:3072  lds
    s_add_u32 s46, s5, 262144
    s_add_u32 m0, s59, 67584
    s_nop 0
    buffer_load_dwordx4 v10, s[20:23], s46 offen offset:0  lds
    buffer_load_dwordx4 v11, s[20:23], s46 offen offset:1024  lds
    buffer_load_dwordx4 v12, s[20:23], s46 offen offset:2048  lds
    buffer_load_dwordx4 v13, s[20:23], s46 offen offset:3072  lds
    s_add_u32 s46, s5, 393216
    s_add_u32 m0, s59, 84480
    s_nop 0
    buffer_load_dwordx4 v10, s[20:23], s46 offen offset:0  lds
    buffer_load_dwordx4 v11, s[20:23], s46 offen offset:1024  lds
    buffer_load_dwordx4 v12, s[20:23], s46 offen offset:2048  lds
    buffer_load_dwordx4 v13, s[20:23], s46 offen offset:3072  lds
    s_waitcnt vmcnt(34) lgkmcnt(0)
    s_barrier
    ds_read_b64_tr_b16 a[0:1], v5 offset:16896
    ds_read_b64_tr_b16 a[2:3], v5 offset:20992
    ds_read_b64_tr_b16 a[4:5], v5 offset:16904
    ds_read_b64_tr_b16 a[6:7], v5 offset:21000
    ds_read_b64_tr_b16 a[8:9], v5 offset:25088
    ds_read_b64_tr_b16 a[10:11], v5 offset:29184
    ds_read_b64_tr_b16 a[12:13], v5 offset:25096
    ds_read_b64_tr_b16 a[14:15], v5 offset:29192
    ds_read_b64_tr_b16 a[16:17], v5 offset:33792
    ds_read_b64_tr_b16 a[18:19], v5 offset:37888
    ds_read_b64_tr_b16 a[20:21], v5 offset:33800
    ds_read_b64_tr_b16 a[22:23], v5 offset:37896
    ds_read_b64_tr_b16 a[24:25], v5 offset:41984
    ds_read_b64_tr_b16 a[26:27], v5 offset:46080
    ds_read_b64_tr_b16 a[28:29], v5 offset:41992
    ds_read_b64_tr_b16 a[30:31], v5 offset:46088
    s_add_u32 s46, s6, 0
    s_add_u32 m0, s59, 101376
    s_nop 0
    buffer_load_dwordx4 v10, s[20:23], s46 offen offset:0  lds
    buffer_load_dwordx4 v11, s[20:23], s46 offen offset:1024  lds
    buffer_load_dwordx4 v12, s[20:23], s46 offen offset:2048  lds
    buffer_load_dwordx4 v13, s[20:23], s46 offen offset:3072  lds
    s_waitcnt vmcnt(20) lgkmcnt(0)
    s_barrier
    ds_read_b64_tr_b16 a[32:33], v14 offset:0
    ds_read_b64_tr_b16 a[34:35], v14 offset:4096
    ds_read_b64_tr_b16 a[36:37], v14 offset:8
    ds_read_b64_tr_b16 a[38:39], v14 offset:4104
    ds_read_b64_tr_b16 a[40:41], v14 offset:8192
    ds_read_b64_tr_b16 a[42:43], v14 offset:12288
    ds_read_b64_tr_b16 a[44:45], v14 offset:8200
    ds_read_b64_tr_b16 a[46:47], v14 offset:12296
    ds_read_b64_tr_b16 a[48:49], v14 offset:16896
    ds_read_b64_tr_b16 a[50:51], v14 offset:20992
    ds_read_b64_tr_b16 a[52:53], v14 offset:16904
    ds_read_b64_tr_b16 a[54:55], v14 offset:21000
    ds_read_b64_tr_b16 a[56:57], v14 offset:25088
    ds_read_b64_tr_b16 a[58:59], v14 offset:29184
    ds_read_b64_tr_b16 a[60:61], v14 offset:25096
    ds_read_b64_tr_b16 a[62:63], v14 offset:29192
    s_add_u32 s46, s6, 131072
    s_add_u32 m0, s59, 118272
    s_nop 0
    buffer_load_dwordx4 v10, s[20:23], s46 offen offset:0  lds
    buffer_load_dwordx4 v11, s[20:23], s46 offen offset:1024  lds
    buffer_load_dwordx4 v12, s[20:23], s46 offen offset:2048  lds
    buffer_load_dwordx4 v13, s[20:23], s46 offen offset:3072  lds
    s_add_u32 s46, s6, 262144
    s_add_u32 m0, s59, 135168
    s_nop 0
    buffer_load_dwordx4 v10, s[20:23], s46 offen offset:0  lds
    buffer_load_dwordx4 v11, s[20:23], s46 offen offset:1024  lds
    buffer_load_dwordx4 v12, s[20:23], s46 offen offset:2048  lds
    buffer_load_dwordx4 v13, s[20:23], s46 offen offset:3072  lds
    s_waitcnt vmcnt(20) lgkmcnt(0)
    s_barrier
    ds_read_b64_tr_b16 a[64:65], v14 offset:33792
    ds_read_b64_tr_b16 a[66:67], v14 offset:37888
    ds_read_b64_tr_b16 a[68:69], v14 offset:33800
    ds_read_b64_tr_b16 a[70:71], v14 offset:37896
    ds_read_b64_tr_b16 a[72:73], v14 offset:41984
    ds_read_b64_tr_b16 a[74:75], v14 offset:46080
    ds_read_b64_tr_b16 a[76:77], v14 offset:41992
    ds_read_b64_tr_b16 a[78:79], v14 offset:46088
    ds_read_b64_tr_b16 a[80:81], v19 offset:0
    ds_read_b64_tr_b16 a[82:83], v19 offset:4096
    ds_read_b64_tr_b16 a[84:85], v19 offset:8
    ds_read_b64_tr_b16 a[86:87], v19 offset:4104
    ds_read_b64_tr_b16 a[88:89], v19 offset:8192
    ds_read_b64_tr_b16 a[90:91], v19 offset:12288
    ds_read_b64_tr_b16 a[92:93], v19 offset:8200
    ds_read_b64_tr_b16 a[94:95], v19 offset:12296
    s_add_u32 s46, s6, 393216
    s_add_u32 m0, s59, 0
    s_nop 0
    buffer_load_dwordx4 v10, s[20:23], s46 offen offset:0  lds
    buffer_load_dwordx4 v11, s[20:23], s46 offen offset:1024  lds
    buffer_load_dwordx4 v12, s[20:23], s46 offen offset:2048  lds
    buffer_load_dwordx4 v13, s[20:23], s46 offen offset:3072  lds
    s_add_u32 s46, s7, 0
    s_add_u32 m0, s59, 16896
    s_nop 0
    buffer_load_dwordx4 v10, s[20:23], s46 offen offset:0  lds
    buffer_load_dwordx4 v11, s[20:23], s46 offen offset:1024  lds
    buffer_load_dwordx4 v12, s[20:23], s46 offen offset:2048  lds
    buffer_load_dwordx4 v13, s[20:23], s46 offen offset:3072  lds
    s_waitcnt vmcnt(20) lgkmcnt(0)
    s_barrier
    ds_read_b64_tr_b16 a[96:97], v19 offset:16896
    ds_read_b64_tr_b16 a[98:99], v19 offset:20992
    ds_read_b64_tr_b16 a[100:101], v19 offset:16904
    ds_read_b64_tr_b16 a[102:103], v19 offset:21000
    ds_read_b64_tr_b16 a[104:105], v19 offset:25088
    ds_read_b64_tr_b16 a[106:107], v19 offset:29184
    ds_read_b64_tr_b16 a[108:109], v19 offset:25096
    ds_read_b64_tr_b16 a[110:111], v19 offset:29192
    ds_read_b64_tr_b16 a[112:113], v19 offset:33792
    ds_read_b64_tr_b16 a[114:115], v19 offset:37888
    ds_read_b64_tr_b16 a[116:117], v19 offset:33800
    ds_read_b64_tr_b16 a[118:119], v19 offset:37896
    ds_read_b64_tr_b16 a[120:121], v19 offset:41984
    ds_read_b64_tr_b16 a[122:123], v19 offset:46080
    ds_read_b64_tr_b16 a[124:125], v19 offset:41992
    ds_read_b64_tr_b16 a[126:127], v19 offset:46088
    s_add_u32 s46, s7, 131072
    s_add_u32 m0, s59, 33792
    s_nop 0
    buffer_load_dwordx4 v10, s[20:23], s46 offen offset:0  lds
    buffer_load_dwordx4 v11, s[20:23], s46 offen offset:1024  lds
    buffer_load_dwordx4 v12, s[20:23], s46 offen offset:2048  lds
    buffer_load_dwordx4 v13, s[20:23], s46 offen offset:3072  lds
    s_add_u32 s46, s7, 262144
    s_add_u32 m0, s59, 50688
    s_nop 0
    buffer_load_dwordx4 v10, s[20:23], s46 offen offset:0  lds
    buffer_load_dwordx4 v11, s[20:23], s46 offen offset:1024  lds
    buffer_load_dwordx4 v12, s[20:23], s46 offen offset:2048  lds
    buffer_load_dwordx4 v13, s[20:23], s46 offen offset:3072  lds
    s_waitcnt vmcnt(20) lgkmcnt(0)
    s_barrier
    ds_read_b64_tr_b16 a[128:129], v5 offset:0
    ds_read_b64_tr_b16 a[130:131], v5 offset:4096
    ds_read_b64_tr_b16 a[132:133], v5 offset:8
    ds_read_b64_tr_b16 a[134:135], v5 offset:4104
    ds_read_b64_tr_b16 a[136:137], v5 offset:8192
    ds_read_b64_tr_b16 a[138:139], v5 offset:12288
    ds_read_b64_tr_b16 a[140:141], v5 offset:8200
    ds_read_b64_tr_b16 a[142:143], v5 offset:12296
    ds_read_b64_tr_b16 a[144:145], v5 offset:16896
    ds_read_b64_tr_b16 a[146:147], v5 offset:20992
    ds_read_b64_tr_b16 a[148:149], v5 offset:16904
    ds_read_b64_tr_b16 a[150:151], v5 offset:21000
    ds_read_b64_tr_b16 a[152:153], v5 offset:25088
    ds_read_b64_tr_b16 a[154:155], v5 offset:29184
    ds_read_b64_tr_b16 a[156:157], v5 offset:25096
    ds_read_b64_tr_b16 a[158:159], v5 offset:29192
    s_add_u32 s46, s7, 393216
    s_add_u32 m0, s59, 67584
    s_nop 0
    buffer_load_dwordx4 v10, s[20:23], s46 offen offset:0  lds
    buffer_load_dwordx4 v11, s[20:23], s46 offen offset:1024  lds
    buffer_load_dwordx4 v12, s[20:23], s46 offen offset:2048  lds
    buffer_load_dwordx4 v13, s[20:23], s46 offen offset:3072  lds
    s_waitcnt vmcnt(16) lgkmcnt(0)
    s_barrier
    ds_read_b64_tr_b16 a[160:161], v5 offset:33792
    ds_read_b64_tr_b16 a[162:163], v5 offset:37888
    ds_read_b64_tr_b16 a[164:165], v5 offset:33800
    ds_read_b64_tr_b16 a[166:167], v5 offset:37896
    ds_read_b64_tr_b16 a[168:169], v5 offset:41984
    ds_read_b64_tr_b16 a[170:171], v5 offset:46080
    ds_read_b64_tr_b16 a[172:173], v5 offset:41992
    ds_read_b64_tr_b16 a[174:175], v5 offset:46088
    ds_read_b64_tr_b16 a[176:177], v14 offset:0
    ds_read_b64_tr_b16 a[178:179], v14 offset:4096
    ds_read_b64_tr_b16 a[180:181], v14 offset:8
    ds_read_b64_tr_b16 a[182:183], v14 offset:4104
    ds_read_b64_tr_b16 a[184:185], v14 offset:8192
    ds_read_b64_tr_b16 a[186:187], v14 offset:12288
    ds_read_b64_tr_b16 a[188:189], v14 offset:8200
    ds_read_b64_tr_b16 a[190:191], v14 offset:12296
    s_waitcnt vmcnt(8) lgkmcnt(0)
    s_barrier
    ds_read_b64_tr_b16 a[192:193], v14 offset:16896
    ds_read_b64_tr_b16 a[194:195], v14 offset:20992
    ds_read_b64_tr_b16 a[196:197], v14 offset:16904
    ds_read_b64_tr_b16 a[198:199], v14 offset:21000
    ds_read_b64_tr_b16 a[200:201], v14 offset:25088
    ds_read_b64_tr_b16 a[202:203], v14 offset:29184
    ds_read_b64_tr_b16 a[204:205], v14 offset:25096
    ds_read_b64_tr_b16 a[206:207], v14 offset:29192
    ds_read_b64_tr_b16 a[208:209], v14 offset:33792
    ds_read_b64_tr_b16 a[210:211], v14 offset:37888
    ds_read_b64_tr_b16 a[212:213], v14 offset:33800
    ds_read_b64_tr_b16 a[214:215], v14 offset:37896
    ds_read_b64_tr_b16 a[216:217], v14 offset:41984
    ds_read_b64_tr_b16 a[218:219], v14 offset:46080
    ds_read_b64_tr_b16 a[220:221], v14 offset:41992
    ds_read_b64_tr_b16 a[222:223], v14 offset:46088
    s_waitcnt vmcnt(0) lgkmcnt(0)
    s_barrier
    ds_read_b64_tr_b16 a[224:225], v19 offset:0
    ds_read_b64_tr_b16 a[226:227], v19 offset:4096
    ds_read_b64_tr_b16 a[228:229], v19 offset:8
    ds_read_b64_tr_b16 a[230:231], v19 offset:4104
    ds_read_b64_tr_b16 a[232:233], v19 offset:8192
    ds_read_b64_tr_b16 a[234:235], v19 offset:12288
    ds_read_b64_tr_b16 a[236:237], v19 offset:8200
    ds_read_b64_tr_b16 a[238:239], v19 offset:12296
    ds_read_b64_tr_b16 a[240:241], v19 offset:16896
    ds_read_b64_tr_b16 a[242:243], v19 offset:20992
    ds_read_b64_tr_b16 a[244:245], v19 offset:16904
    ds_read_b64_tr_b16 a[246:247], v19 offset:21000
    ds_read_b64_tr_b16 a[248:249], v19 offset:25088
    ds_read_b64_tr_b16 a[250:251], v19 offset:29184
    ds_read_b64_tr_b16 a[252:253], v19 offset:25096
    ds_read_b64_tr_b16 a[254:255], v19 offset:29192
    s_waitcnt lgkmcnt(0)
    s_barrier
L_join:
    v_and_b32 v22, 3, v1
    v_lshlrev_b32 v22, 3, v22
    s_mov_b32 s62, 0
Lo_o_w:
    buffer_load_dwordx2 v[20:21], v22, s[28:31], s100 offen sc1
    s_add_u32 s62, s62, 1
    s_cmp_ge_u32 s62, 2097152
    s_cbranch_scc1 Lo_o_wx
    s_waitcnt vmcnt(0)
    v_cmp_ne_u64 vcc, s[40:41], v[20:21]
    s_cbranch_vccnz Lo_o_w
Lo_o_wx:
    s_waitcnt vmcnt(0)
    s_add_u32 m0, s101, 0
    s_add_u32 s13, s16, 0
    buffer_load_dwordx4 v15, s[28:31], s13 offen offset:0 sc1 lds
    buffer_load_dwordx4 v15, s[28:31], s13 offen offset:1024 sc1 lds
    buffer_load_dwordx4 v15, s[28:31], s13 offen offset:2048 sc1 lds
    buffer_load_dwordx4 v15, s[28:31], s13 offen offset:3072 sc1 lds
    s_add_u32 m0, s101, 4096
    s_add_u32 s13, s16, 4096
    buffer_load_dwordx4 v15, s[28:31], s13 offen offset:0 sc1 lds
    buffer_load_dwordx4 v15, s[28:31], s13 offen offset:1024 sc1 lds
    buffer_load_dwordx4 v15, s[28:31], s13 offen offset:2048 sc1 lds
    buffer_load_dwordx4 v15, s[28:31], s13 offen offset:3072 sc1 lds
Lo_e2:
    v_add_u32 v16, 0x10000, v15
    s_lshl_b32 s64, s58, 17
    s_lshl_b32 s62, s34, 11
    s_add_u32 s64, s64, s62
    s_add_u32 s64, s64, 13631488
    s_add_u32 s62, s57, 1
    s_and_b32 s62, s62, 3
    s_lshl_b32 s62, s62, 15
    s_add_u32 s62, s62, s64
    s_add_u32 s59, s62, 0
    s_add_u32 s62, s57, 2
    s_and_b32 s62, s62, 3
    s_lshl_b32 s62, s62, 15
    s_add_u32 s62, s62, s64
    s_add_u32 s60, s62, 8192
    s_add_u32 s62, s57, 3
    s_and_b32 s62, s62, 3
    s_lshl_b32 s62, s62, 15
    s_add_u32 s62, s62, s64
    s_add_u32 s61, s62, 16384
    s_lshl_b32 s62, s57, 15
    s_add_u32 s65, s64, s62
    s_add_u32 s68, s65, 8192
    s_add_u32 s69, s65, 16384
    s_mov_b32 s46, 0xfff
    s_lshr_b64 s[62:63], s[40:41], 1
    s_and_b32 s50, s62, s46
    s_lshr_b64 s[62:63], s[62:63], 12
    s_and_b32 s51, s62, s46
    s_lshr_b64 s[62:63], s[62:63], 12
    s_and_b32 s52, s62, s46
    s_lshr_b64 s[62:63], s[62:63], 12
    s_and_b32 s53, s62, s46
    s_bfe_u32 s62, s40, 0x180001
    s_mul_i32 s62, s62, 0x9e3779b1
    s_xor_b32 s51, s51, s50
    s_lshr_b32 s63, s62, 20
    s_xor_b32 s52, s52, s63
    s_bfe_u32 s63, s62, 0xc0008
    s_xor_b32 s53, s53, s63
    v_mov_b32 v20, s50
    v_mov_b32 v21, s51
    v_mov_b32 v22, s52
    v_mov_b32 v23, s53
    v_mov_b32 v24, 0xfffff000
    v_and_b32 v18, 15, v1
    v_lshlrev_b32 v18, 11, v18
    v_lshrrev_b32 v17, 4, v1
    v_lshl_add_u32 v18, v17, 4, v18
    s_lshl_b32 s49, s56, 2
    s_add_u32 s49, s49, s57
    s_lshl_b32 s49, s49, 15
    s_lshl_b32 s62, s55, 1
    s_add_u32 s49, s49, s62
    s_lshl_b32 s62, s34, 6
    s_add_u32 s49, s49, s62
    s_waitcnt vmcnt(4)
    s_barrier
    ds_read_b128 v[64:67], v15 offset:0
    ds_read_b128 v[68:71], v15 offset:1024
    ds_read_b128 v[72:75], v15 offset:2048
    ds_read_b128 v[76:79], v15 offset:3072
    ds_read_b128 v[80:83], v15 offset:8192
    ds_read_b128 v[84:87], v15 offset:9216
    s_waitcnt lgkmcnt(4)
    v_mfma_f32_16x16x32_bf16 v[32:35], a[0:3], v[64:67], 0
    ds_read_b128 v[88:91], v15 offset:10240
    v_mfma_f32_16x16x32_bf16 v[36:39], a[4:7], v[64:67], 0
    ds_read_b128 v[92:95], v15 offset:11264
    v_mfma_f32_16x16x32_bf16 v[32:35], a[8:11], v[68:71], v[32:35]
    s_add_u32 m0, s101, 32768
    s_add_u32 s13, s17, 0
    buffer_load_dwordx4 v15, s[28:31], s13 offen offset:0 sc1 lds
    v_mfma_f32_16x16x32_bf16 v[36:39], a[12:15], v[68:71], v[36:39]
    s_waitcnt lgkmcnt(4)
    v_mfma_f32_16x16x32_bf16 v[32:35], a[16:19], v[72:75], v[32:35]
    ds_read_b128 v[64:67], v15 offset:16384
    v_mfma_f32_16x16x32_bf16 v[36:39], a[20:23], v[72:75], v[36:39]
    ds_read_b128 v[68:71], v15 offset:17408
    v_mfma_f32_16x16x32_bf16 v[32:35], a[24:27], v[76:79], v[32:35]
    buffer_load_dwordx4 v15, s[28:31], s13 offen offset:1024 sc1 lds
    v_mfma_f32_16x16x32_bf16 v[36:39], a[28:31], v[76:79], v[36:39]
    s_waitcnt lgkmcnt(4)
    v_mfma_f32_16x16x32_bf16 v[32:35], a[64:67], v[80:83], v[32:35]
    ds_read_b128 v[72:75], v15 offset:18432
    v_mfma_f32_16x16x32_bf16 v[36:39], a[68:71], v[80:83], v[36:39]
    ds_read_b128 v[76:79], v15 offset:19456
    v_mfma_f32_16x16x32_bf16 v[32:35], a[72:75], v[84:87], v[32:35]
    buffer_load_dwordx4 v15, s[28:31], s13 offen offset:2048 sc1 lds
    v_mfma_f32_16x16x32_bf16 v[36:39], a[76:79], v[84:87], v[36:39]
    s_waitcnt lgkmcnt(4)
    v_mfma_f32_16x16x32_bf16 v[32:35], a[80:83], v[88:91], v[32:35]
    ds_read_b128 v[80:83], v15 offset:24576
    v_mfma_f32_16x16x32_bf16 v[36:39], a[84:87], v[88:91], v[36:39]
    ds_read_b128 v[84:87], v15 offset:25600
    v_mfma_f32_16x16x32_bf16 v[32:35], a[88:91], v[92:95], v[32:35]
    buffer_load_dwordx4 v15, s[28:31], s13 offen offset:3072 sc1 lds
    v_mfma_f32_16x16x32_bf16 v[36:39], a[92:95], v[92:95], v[36:39]
    s_waitcnt lgkmcnt(4)
    v_mfma_f32_16x16x32_bf16 v[32:35], a[128:131], v[64:67], v[32:35]
    ds_read_b128 v[88:91], v15 offset:26624
    v_mfma_f32_16x16x32_bf16 v[36:39], a[132:135], v[64:67], v[36:39]
    ds_read_b128 v[92:95], v15 offset:27648
    v_mfma_f32_16x16x32_bf16 v[32:35], a[136:139], v[68:71], v[32:35]
    s_add_u32 m0, s101, 36864
    s_add_u32 s13, s17, 4096
    buffer_load_dwordx4 v15, s[28:31], s13 offen offset:0 sc1 lds
    v_mfma_f32_16x16x32_bf16 v[36:39], a[140:143], v[68:71], v[36:39]
    s_waitcnt lgkmcnt(4)
    s_waitcnt vmcnt(5)
    s_barrier
    v_mfma_f32_16x16x32_bf16 v[32:35], a[144:147], v[72:75], v[32:35]
    ds_read_b128 v[64:67], v15 offset:4096
    v_mfma_f32_16x16x32_bf16 v[36:39], a[148:151], v[72:75], v[36:39]
    ds_read_b128 v[68:71], v15 offset:5120
    v_mfma_f32_16x16x32_bf16 v[32:35], a[152:155], v[76:79], v[32:35]
    buffer_load_dwordx4 v15, s[28:31], s13 offen offset:1024 sc1 lds
    v_mfma_f32_16x16x32_bf16 v[36:39], a[156:159], v[76:79], v[36:39]
    s_waitcnt lgkmcnt(4)
    v_mfma_f32_16x16x32_bf16 v[32:35], a[192:195], v[80:83], v[32:35]
    ds_read_b128 v[72:75], v15 offset:6144
    v_mfma_f32_16x16x32_bf16 v[36:39], a[196:199], v[80:83], v[36:39]
    ds_read_b128 v[76:79], v15 offset:7168
    v_mfma_f32_16x16x32_bf16 v[32:35], a[200:203], v[84:87], v[32:35]
    buffer_load_dwordx4 v15, s[28:31], s13 offen offset:2048 sc1 lds
    v_mfma_f32_16x16x32_bf16 v[36:39], a[204:207], v[84:87], v[36:39]
    s_waitcnt lgkmcnt(4)
    v_mfma_f32_16x16x32_bf16 v[32:35], a[208:211], v[88:91], v[32:35]
    ds_read_b128 v[80:83], v15 offset:12288
    v_mfma_f32_16x16x32_bf16 v[36:39], a[212:215], v[88:91], v[36:39]
    ds_read_b128 v[84:87], v15 offset:13312
    v_mfma_f32_16x16x32_bf16 v[32:35], a[216:219], v[92:95], v[32:35]
    buffer_load_dwordx4 v15, s[28:31], s13 offen offset:3072 sc1 lds
    v_mfma_f32_16x16x32_bf16 v[36:39], a[220:223], v[92:95], v[36:39]
    s_waitcnt lgkmcnt(4)
    v_mfma_f32_16x16x32_bf16 v[32:35], a[32:35], v[64:67], v[32:35]
    ds_read_b128 v[88:91], v15 offset:14336
    v_mfma_f32_16x16x32_bf16 v[36:39], a[36:39], v[64:67], v[36:39]
    ds_read_b128 v[92:95], v15 offset:15360
    v_mfma_f32_16x16x32_bf16 v[32:35], a[40:43], v[68:71], v[32:35]
    s_add_u32 m0, s101, 65536
    s_add_u32 s13, s18, 0
    buffer_load_dwordx4 v15, s[28:31], s13 offen offset:0 sc1 lds
    v_mfma_f32_16x16x32_bf16 v[36:39], a[44:47], v[68:71], v[36:39]
    s_waitcnt lgkmcnt(4)
    v_mfma_f32_16x16x32_bf16 v[32:35], a[48:51], v[72:75], v[32:35]
    ds_read_b128 v[64:67], v15 offset:20480
    v_mfma_f32_16x16x32_bf16 v[36:39], a[52:55], v[72:75], v[36:39]
    ds_read_b128 v[68:71], v15 offset:21504
    v_mfma_f32_16x16x32_bf16 v[32:35], a[56:59], v[76:79], v[32:35]
    buffer_load_dwordx4 v15, s[28:31], s13 offen offset:1024 sc1 lds
    v_mfma_f32_16x16x32_bf16 v[36:39], a[60:63], v[76:79], v[36:39]
    s_waitcnt lgkmcnt(4)
    v_mfma_f32_16x16x32_bf16 v[32:35], a[96:99], v[80:83], v[32:35]
    ds_read_b128 v[72:75], v15 offset:22528
    v_mfma_f32_16x16x32_bf16 v[36:39], a[100:103], v[80:83], v[36:39]
    ds_read_b128 v[76:79], v15 offset:23552
    v_mfma_f32_16x16x32_bf16 v[32:35], a[104:107], v[84:87], v[32:35]
    buffer_load_dwordx4 v15, s[28:31], s13 offen offset:2048 sc1 lds
    v_mfma_f32_16x16x32_bf16 v[36:39], a[108:111], v[84:87], v[36:39]
    s_waitcnt lgkmcnt(4)
    v_mfma_f32_16x16x32_bf16 v[32:35], a[112:115], v[88:91], v[32:35]
    ds_read_b128 v[80:83], v15 offset:28672
    v_mfma_f32_16x16x32_bf16 v[36:39], a[116:119], v[88:91], v[36:39]
    ds_read_b128 v[84:87], v15 offset:29696
    v_mfma_f32_16x16x32_bf16 v[32:35], a[120:123], v[92:95], v[32:35]
    buffer_load_dwordx4 v15, s[28:31], s13 offen offset:3072 sc1 lds
    v_mfma_f32_16x16x32_bf16 v[36:39], a[124:127], v[92:95], v[36:39]
    s_waitcnt lgkmcnt(4)
    v_mfma_f32_16x16x32_bf16 v[32:35], a[160:163], v[64:67], v[32:35]
    ds_read_b128 v[88:91], v15 offset:30720
    v_mfma_f32_16x16x32_bf16 v[36:39], a[164:167], v[64:67], v[36:39]
    ds_read_b128 v[92:95], v15 offset:31744
    v_mfma_f32_16x16x32_bf16 v[32:35], a[168:171], v[68:71], v[32:35]
    s_add_u32 m0, s101, 69632
    s_add_u32 s13, s18, 4096
    buffer_load_dwordx4 v15, s[28:31], s13 offen offset:0 sc1 lds
    v_mfma_f32_16x16x32_bf16 v[36:39], a[172:175], v[68:71], v[36:39]
    s_waitcnt lgkmcnt(4)
    s_waitcnt vmcnt(9)
    s_barrier
    v_mfma_f32_16x16x32_bf16 v[32:35], a[176:179], v[72:75], v[32:35]
    ds_read_b128 v[64:67], v15 offset:32768
    v_mfma_f32_16x16x32_bf16 v[36:39], a[180:183], v[72:75], v[36:39]
    ds_read_b128 v[68:71], v15 offset:33792
    v_mfma_f32_16x16x32_bf16 v[32:35], a[184:187], v[76:79], v[32:35]
    buffer_load_dwordx4 v15, s[28:31], s13 offen offset:1024 sc1 lds
    v_mfma_f32_16x16x32_bf16 v[36:39], a[188:191], v[76:79], v[36:39]
    s_waitcnt lgkmcnt(4)
    v_mfma_f32_16x16x32_bf16 v[32:35], a[224:227], v[80:83], v[32:35]
    ds_read_b128 v[72:75], v15 offset:34816
    v_mfma_f32_16x16x32_bf16 v[36:39], a[228:231], v[80:83], v[36:39]
    ds_read_b128 v[76:79], v15 offset:35840
    v_mfma_f32_16x16x32_bf16 v[32:35], a[232:235], v[84:87], v[32:35]
    buffer_load_dwordx4 v15, s[28:31], s13 offen offset:2048 sc1 lds
    v_mfma_f32_16x16x32_bf16 v[36:39], a[236:239], v[84:87], v[36:39]
    s_waitcnt lgkmcnt(4)
    v_mfma_f32_16x16x32_bf16 v[32:35], a[240:243], v[88:91], v[32:35]
    ds_read_b128 v[80:83], v15 offset:40960
    v_mfma_f32_16x16x32_bf16 v[36:39], a[244:247], v[88:91], v[36:39]
    ds_read_b128 v[84:87], v15 offset:41984
    v_mfma_f32_16x16x32_bf16 v[32:35], a[248:251], v[92:95], v[32:35]
    buffer_load_dwordx4 v15, s[28:31], s13 offen offset:3072 sc1 lds
    v_mfma_f32_16x16x32_bf16 v[36:39], a[252:255], v[92:95], v[36:39]
    s_waitcnt lgkmcnt(4)
    v_mfma_f32_16x16x32_bf16 v[40:43], a[0:3], v[64:67], 0
    ds_read_b128 v[88:91], v15 offset:43008
    v_mfma_f32_16x16x32_bf16 v[44:47], a[4:7], v[64:67], 0
    ds_read_b128 v[92:95], v15 offset:44032
    v_mfma_f32_16x16x32_bf16 v[40:43], a[8:11], v[68:71], v[40:43]
    s_add_u32 m0, s101, 98304
    s_add_u32 s13, s19, 0
    buffer_load_dwordx4 v15, s[28:31], s13 offen offset:0 sc1 lds
    v_mfma_f32_16x16x32_bf16 v[44:47], a[12:15], v[68:71], v[44:47]
    s_waitcnt lgkmcnt(4)
    v_mfma_f32_16x16x32_bf16 v[40:43], a[16:19], v[72:75], v[40:43]
    ds_read_b128 v[64:67], v15 offset:49152
    v_mfma_f32_16x16x32_bf16 v[44:47], a[20:23], v[72:75], v[44:47]
    ds_read_b128 v[68:71], v15 offset:50176
    v_mfma_f32_16x16x32_bf16 v[40:43], a[24:27], v[76:79], v[40:43]
    buffer_load_dwordx4 v15, s[28:31], s13 offen offset:1024 sc1 lds
    v_bfi_b32 v104, s46, v20, v32
    v_bfi_b32 v105, s46, v21, v33
    v_bfi_b32 v106, s46, v22, v34
    v_bfi_b32 v107, s46, v23, v35
    buffer_store_dwordx4 v[104:107], v15, s[28:31], s59 offen offset:0 sc1
    v_mfma_f32_16x16x32_bf16 v[44:47], a[28:31], v[76:79], v[44:47]
    v_bfi_b32 v108, s46, v20, v36
    v_bfi_b32 v109, s46, v21, v37
    v_bfi_b32 v110, s46, v22, v38
    v_bfi_b32 v111, s46, v23, v39
    buffer_store_dwordx4 v[108:111], v15, s[28:31], s59 offen offset:1024 sc1
    s_waitcnt lgkmcnt(4)
    v_mfma_f32_16x16x32_bf16 v[40:43], a[64:67], v[80:83], v[40:43]
    ds_read_b128 v[72:75], v15 offset:51200
    v_mfma_f32_16x16x32_bf16 v[44:47], a[68:71], v[80:83], v[44:47]
    ds_read_b128 v[76:79], v15 offset:52224
    v_mfma_f32_16x16x32_bf16 v[40:43], a[72:75], v[84:87], v[40:43]
    buffer_load_dwordx4 v15, s[28:31], s13 offen offset:2048 sc1 lds
    v_mfma_f32_16x16x32_bf16 v[44:47], a[76:79], v[84:87], v[44:47]
    s_waitcnt lgkmcnt(4)
    v_mfma_f32_16x16x32_bf16 v[40:43], a[80:83], v[88:91], v[40:43]
    ds_read_b128 v[80:83], v15 offset:57344
    v_mfma_f32_16x16x32_bf16 v[44:47], a[84:87], v[88:91], v[44:47]
    ds_read_b128 v[84:87], v15 offset:58368
    v_mfma_f32_16x16x32_bf16 v[40:43], a[88:91], v[92:95], v[40:43]
    buffer_load_dwordx4 v15, s[28:31], s13 offen offset:3072 sc1 lds
    v_mfma_f32_16x16x32_bf16 v[44:47], a[92:95], v[92:95], v[44:47]
    s_waitcnt lgkmcnt(4)
    v_mfma_f32_16x16x32_bf16 v[40:43], a[128:131], v[64:67], v[40:43]
    ds_read_b128 v[88:91], v15 offset:59392
    v_mfma_f32_16x16x32_bf16 v[44:47], a[132:135], v[64:67], v[44:47]
    ds_read_b128 v[92:95], v15 offset:60416
    v_mfma_f32_16x16x32_bf16 v[40:43], a[136:139], v[68:71], v[40:43]
    s_add_u32 m0, s101, 102400
    s_add_u32 s13, s19, 4096
    buffer_load_dwordx4 v15, s[28:31], s13 offen offset:0 sc1 lds
    v_mfma_f32_16x16x32_bf16 v[44:47], a[140:143], v[68:71], v[44:47]
    s_waitcnt lgkmcnt(4)
    s_waitcnt vmcnt(15)
    s_barrier
    v_mfma_f32_16x16x32_bf16 v[40:43], a[144:147], v[72:75], v[40:43]
    ds_read_b128 v[64:67], v15 offset:36864
    v_mfma_f32_16x16x32_bf16 v[44:47], a[148:151], v[72:75], v[44:47]
    ds_read_b128 v[68:71], v15 offset:37888
    v_mfma_f32_16x16x32_bf16 v[40:43], a[152:155], v[76:79], v[40:43]
    buffer_load_dwordx4 v15, s[28:31], s13 offen offset:1024 sc1 lds
    v_mfma_f32_16x16x32_bf16 v[44:47], a[156:159], v[76:79], v[44:47]
    s_waitcnt lgkmcnt(4)
    v_mfma_f32_16x16x32_bf16 v[40:43], a[192:195], v[80:83], v[40:43]
    ds_read_b128 v[72:75], v15 offset:38912
    v_mfma_f32_16x16x32_bf16 v[44:47], a[196:199], v[80:83], v[44:47]
    ds_read_b128 v[76:79], v15 offset:39936
    v_mfma_f32_16x16x32_bf16 v[40:43], a[200:203], v[84:87], v[40:43]
    buffer_load_dwordx4 v15, s[28:31], s13 offen offset:2048 sc1 lds
    v_mfma_f32_16x16x32_bf16 v[44:47], a[204:207], v[84:87], v[44:47]
    s_waitcnt lgkmcnt(4)
    v_mfma_f32_16x16x32_bf16 v[40:43], a[208:211], v[88:91], v[40:43]
    ds_read_b128 v[80:83], v15 offset:45056
    v_mfma_f32_16x16x32_bf16 v[44:47], a[212:215], v[88:91], v[44:47]
    ds_read_b128 v[84:87], v15 offset:46080
    v_mfma_f32_16x16x32_bf16 v[40:43], a[216:219], v[92:95], v[40:43]
    buffer_load_dwordx4 v15, s[28:31], s13 offen offset:3072 sc1 lds
    v_mfma_f32_16x16x32_bf16 v[44:47], a[220:223], v[92:95], v[44:47]
    s_waitcnt lgkmcnt(4)
    v_mfma_f32_16x16x32_bf16 v[40:43], a[32:35], v[64:67], v[40:43]
    ds_read_b128 v[88:91], v15 offset:47104
    v_mfma_f32_16x16x32_bf16 v[44:47], a[36:39], v[64:67], v[44:47]
    ds_read_b128 v[92:95], v15 offset:48128
    v_mfma_f32_16x16x32_bf16 v[40:43], a[40:43], v[68:71], v[40:43]
    v_mfma_f32_16x16x32_bf16 v[44:47], a[44:47], v[68:71], v[44:47]
    s_waitcnt lgkmcnt(4)
    v_mfma_f32_16x16x32_bf16 v[40:43], a[48:51], v[72:75], v[40:43]
    ds_read_b128 v[64:67], v15 offset:53248
    v_mfma_f32_16x16x32_bf16 v[44:47], a[52:55], v[72:75], v[44:47]
    ds_read_b128 v[68:71], v15 offset:54272
    v_mfma_f32_16x16x32_bf16 v[40:43], a[56:59], v[76:79], v[40:43]
    v_mfma_f32_16x16x32_bf16 v[44:47], a[60:63], v[76:79], v[44:47]
    s_waitcnt lgkmcnt(4)
    v_mfma_f32_16x16x32_bf16 v[40:43], a[96:99], v[80:83], v[40:43]
    ds_read_b128 v[72:75], v15 offset:55296
    v_mfma_f32_16x16x32_bf16 v[44:47], a[100:103], v[80:83], v[44:47]
    ds_read_b128 v[76:79], v15 offset:56320
    v_mfma_f32_16x16x32_bf16 v[40:43], a[104:107], v[84:87], v[40:43]
    v_mfma_f32_16x16x32_bf16 v[44:47], a[108:111], v[84:87], v[44:47]
    s_waitcnt lgkmcnt(4)
    v_mfma_f32_16x16x32_bf16 v[40:43], a[112:115], v[88:91], v[40:43]
    ds_read_b128 v[80:83], v15 offset:61440
    v_mfma_f32_16x16x32_bf16 v[44:47], a[116:119], v[88:91], v[44:47]
    ds_read_b128 v[84:87], v15 offset:62464
    v_mfma_f32_16x16x32_bf16 v[40:43], a[120:123], v[92:95], v[40:43]
    v_mfma_f32_16x16x32_bf16 v[44:47], a[124:127], v[92:95], v[44:47]
    s_waitcnt lgkmcnt(4)
    v_mfma_f32_16x16x32_bf16 v[40:43], a[160:163], v[64:67], v[40:43]
    ds_read_b128 v[88:91], v15 offset:63488
    v_mfma_f32_16x16x32_bf16 v[44:47], a[164:167], v[64:67], v[44:47]
    ds_read_b128 v[92:95], v15 offset:64512
    v_mfma_f32_16x16x32_bf16 v[40:43], a[168:171], v[68:71], v[40:43]
    v_mfma_f32_16x16x32_bf16 v[44:47], a[172:175], v[68:71], v[44:47]
    s_waitcnt lgkmcnt(4)
    s_waitcnt vmcnt(10)
    s_barrier
    v_mfma_f32_16x16x32_bf16 v[40:43], a[176:179], v[72:75], v[40:43]
    ds_read_b128 v[64:67], v16 offset:0
    v_mfma_f32_16x16x32_bf16 v[44:47], a[180:183], v[72:75], v[44:47]
    ds_read_b128 v[68:71], v16 offset:1024
    v_mfma_f32_16x16x32_bf16 v[40:43], a[184:187], v[76:79], v[40:43]
    v_mfma_f32_16x16x32_bf16 v[44:47], a[188:191], v[76:79], v[44:47]
    s_waitcnt lgkmcnt(4)
    v_mfma_f32_16x16x32_bf16 v[40:43], a[224:227], v[80:83], v[40:43]
    ds_read_b128 v[72:75], v16 offset:2048
    v_mfma_f32_16x16x32_bf16 v[44:47], a[228:231], v[80:83], v[44:47]
    ds_read_b128 v[76:79], v16 offset:3072
    v_mfma_f32_16x16x32_bf16 v[40:43], a[232:235], v[84:87], v[40:43]
    v_mfma_f32_16x16x32_bf16 v[44:47], a[236:239], v[84:87], v[44:47]
    s_waitcnt lgkmcnt(4)
    v_mfma_f32_16x16x32_bf16 v[40:43], a[240:243], v[88:91], v[40:43]
    ds_read_b128 v[80:83], v16 offset:8192
    v_mfma_f32_16x16x32_bf16 v[44:47], a[244:247], v[88:91], v[44:47]
    ds_read_b128 v[84:87], v16 offset:9216
    v_mfma_f32_16x16x32_bf16 v[40:43], a[248:251], v[92:95], v[40:43]
    v_mfma_f32_16x16x32_bf16 v[44:47], a[252:255], v[92:95], v[44:47]
    s_waitcnt lgkmcnt(4)
    v_mfma_f32_16x16x32_bf16 v[48:51], a[0:3], v[64:67], 0
    ds_read_b128 v[88:91], v16 offset:10240
    v_mfma_f32_16x16x32_bf16 v[52:55], a[4:7], v[64:67], 0
    ds_read_b128 v[92:95], v16 offset:11264
    v_mfma_f32_16x16x32_bf16 v[48:51], a[8:11], v[68:71], v[48:51]
    v_mfma_f32_16x16x32_bf16 v[52:55], a[12:15], v[68:71], v[52:55]
    s_waitcnt lgkmcnt(4)
    v_mfma_f32_16x16x32_bf16 v[48:51], a[16:19], v[72:75], v[48:51]
    ds_read_b128 v[64:67], v16 offset:16384
    v_mfma_f32_16x16x32_bf16 v[52:55], a[20:23], v[72:75], v[52:55]
    ds_read_b128 v[68:71], v16 offset:17408
    v_mfma_f32_16x16x32_bf16 v[48:51], a[24:27], v[76:79], v[48:51]
    v_bfi_b32 v112, s46, v20, v40
    v_bfi_b32 v113, s46, v21, v41
    v_bfi_b32 v114, s46, v22, v42
    v_bfi_b32 v115, s46, v23, v43
    buffer_store_dwordx4 v[112:115], v15, s[28:31], s60 offen offset:0 sc1
    v_mfma_f32_16x16x32_bf16 v[52:55], a[28:31], v[76:79], v[52:55]
    v_bfi_b32 v116, s46, v20, v44
    v_bfi_b32 v117, s46, v21, v45
    v_bfi_b32 v118, s46, v22, v46
    v_bfi_b32 v119, s46, v23, v47
    buffer_store_dwordx4 v[116:119], v15, s[28:31], s60 offen offset:1024 sc1
    s_waitcnt lgkmcnt(4)
    v_mfma_f32_16x16x32_bf16 v[48:51], a[64:67], v[80:83], v[48:51]
    ds_read_b128 v[72:75], v16 offset:18432
    v_mfma_f32_16x16x32_bf16 v[52:55], a[68:71], v[80:83], v[52:55]
    ds_read_b128 v[76:79], v16 offset:19456
    v_mfma_f32_16x16x32_bf16 v[48:51], a[72:75], v[84:87], v[48:51]
    v_mfma_f32_16x16x32_bf16 v[52:55], a[76:79], v[84:87], v[52:55]
    s_waitcnt lgkmcnt(4)
    v_mfma_f32_16x16x32_bf16 v[48:51], a[80:83], v[88:91], v[48:51]
    ds_read_b128 v[80:83], v16 offset:24576
    v_mfma_f32_16x16x32_bf16 v[52:55], a[84:87], v[88:91], v[52:55]
    ds_read_b128 v[84:87], v16 offset:25600
    v_mfma_f32_16x16x32_bf16 v[48:51], a[88:91], v[92:95], v[48:51]
    v_mfma_f32_16x16x32_bf16 v[52:55], a[92:95], v[92:95], v[52:55]
    s_waitcnt lgkmcnt(4)
    v_mfma_f32_16x16x32_bf16 v[48:51], a[128:131], v[64:67], v[48:51]
    ds_read_b128 v[88:91], v16 offset:26624
    v_mfma_f32_16x16x32_bf16 v[52:55], a[132:135], v[64:67], v[52:55]
    ds_read_b128 v[92:95], v16 offset:27648
    v_mfma_f32_16x16x32_bf16 v[48:51], a[136:139], v[68:71], v[48:51]
    v_mfma_f32_16x16x32_bf16 v[52:55], a[140:143], v[68:71], v[52:55]
    s_waitcnt lgkmcnt(4)
    v_mfma_f32_16x16x32_bf16 v[48:51], a[144:147], v[72:75], v[48:51]
    ds_read_b128 v[64:67], v16 offset:4096
    v_mfma_f32_16x16x32_bf16 v[52:55], a[148:151], v[72:75], v[52:55]
    ds_read_b128 v[68:71], v16 offset:5120
    v_mfma_f32_16x16x32_bf16 v[48:51], a[152:155], v[76:79], v[48:51]
    v_mfma_f32_16x16x32_bf16 v[52:55], a[156:159], v[76:79], v[52:55]
    s_waitcnt lgkmcnt(4)
    v_mfma_f32_16x16x32_bf16 v[48:51], a[192:195], v[80:83], v[48:51]
    ds_read_b128 v[72:75], v16 offset:6144
    v_mfma_f32_16x16x32_bf16 v[52:55], a[196:199], v[80:83], v[52:55]
    ds_read_b128 v[76:79], v16 offset:7168
    v_mfma_f32_16x16x32_bf16 v[48:51], a[200:203], v[84:87], v[48:51]
    v_mfma_f32_16x16x32_bf16 v[52:55], a[204:207], v[84:87], v[52:55]
    s_waitcnt lgkmcnt(4)
    v_mfma_f32_16x16x32_bf16 v[48:51], a[208:211], v[88:91], v[48:51]
    ds_read_b128 v[80:83], v16 offset:12288
    v_mfma_f32_16x16x32_bf16 v[52:55], a[212:215], v[88:91], v[52:55]
    ds_read_b128 v[84:87], v16 offset:13312
    v_mfma_f32_16x16x32_bf16 v[48:51], a[216:219], v[92:95], v[48:51]
    v_mfma_f32_16x16x32_bf16 v[52:55], a[220:223], v[92:95], v[52:55]
    s_waitcnt lgkmcnt(4)
    v_mfma_f32_16x16x32_bf16 v[48:51], a[32:35], v[64:67], v[48:51]
    ds_read_b128 v[88:91], v16 offset:14336
    v_mfma_f32_16x16x32_bf16 v[52:55], a[36:39], v[64:67], v[52:55]
    ds_read_b128 v[92:95], v16 offset:15360
    v_mfma_f32_16x16x32_bf16 v[48:51], a[40:43], v[68:71], v[48:51]
    v_mfma_f32_16x16x32_bf16 v[52:55], a[44:47], v[68:71], v[52:55]
    s_waitcnt lgkmcnt(4)
    v_mfma_f32_16x16x32_bf16 v[48:51], a[48:51], v[72:75], v[48:51]
    ds_read_b128 v[64:67], v16 offset:20480
    v_mfma_f32_16x16x32_bf16 v[52:55], a[52:55], v[72:75], v[52:55]
    ds_read_b128 v[68:71], v16 offset:21504
    v_mfma_f32_16x16x32_bf16 v[48:51], a[56:59], v[76:79], v[48:51]
    v_mfma_f32_16x16x32_bf16 v[52:55], a[60:63], v[76:79], v[52:55]
    s_waitcnt lgkmcnt(4)
    v_mfma_f32_16x16x32_bf16 v[48:51], a[96:99], v[80:83], v[48:51]
    ds_read_b128 v[72:75], v16 offset:22528
    v_mfma_f32_16x16x32_bf16 v[52:55], a[100:103], v[80:83], v[52:55]
    ds_read_b128 v[76:79], v16 offset:23552
    v_mfma_f32_16x16x32_bf16 v[48:51], a[104:107], v[84:87], v[48:51]
    v_mfma_f32_16x16x32_bf16 v[52:55], a[108:111], v[84:87], v[52:55]
    s_waitcnt lgkmcnt(4)
    v_mfma_f32_16x16x32_bf16 v[48:51], a[112:115], v[88:91], v[48:51]
    ds_read_b128 v[80:83], v16 offset:28672
    v_mfma_f32_16x16x32_bf16 v[52:55], a[116:119], v[88:91], v[52:55]
    ds_read_b128 v[84:87], v16 offset:29696
    v_mfma_f32_16x16x32_bf16 v[48:51], a[120:123], v[92:95], v[48:51]
    v_mfma_f32_16x16x32_bf16 v[52:55], a[124:127], v[92:95], v[52:55]
    s_waitcnt lgkmcnt(4)
    v_mfma_f32_16x16x32_bf16 v[48:51], a[160:163], v[64:67], v[48:51]
    ds_read_b128 v[88:91], v16 offset:30720
    v_mfma_f32_16x16x32_bf16 v[52:55], a[164:167], v[64:67], v[52:55]
    ds_read_b128 v[92:95], v16 offset:31744
    v_mfma_f32_16x16x32_bf16 v[48:51], a[168:171], v[68:71], v[48:51]
    v_mfma_f32_16x16x32_bf16 v[52:55], a[172:175], v[68:71], v[52:55]
    s_waitcnt lgkmcnt(4)
    s_waitcnt vmcnt(2)
    s_barrier
    v_mfma_f32_16x16x32_bf16 v[48:51], a[176:179], v[72:75], v[48:51]
    ds_read_b128 v[64:67], v16 offset:32768
    v_mfma_f32_16x16x32_bf16 v[52:55], a[180:183], v[72:75], v[52:55]
    ds_read_b128 v[68:71], v16 offset:33792
    v_mfma_f32_16x16x32_bf16 v[48:51], a[184:187], v[76:79], v[48:51]
    v_mfma_f32_16x16x32_bf16 v[52:55], a[188:191], v[76:79], v[52:55]
    s_waitcnt lgkmcnt(4)
    v_mfma_f32_16x16x32_bf16 v[48:51], a[224:227], v[80:83], v[48:51]
    ds_read_b128 v[72:75], v16 offset:34816
    v_mfma_f32_16x16x32_bf16 v[52:55], a[228:231], v[80:83], v[52:55]
    ds_read_b128 v[76:79], v16 offset:35840
    v_mfma_f32_16x16x32_bf16 v[48:51], a[232:235], v[84:87], v[48:51]
    v_mfma_f32_16x16x32_bf16 v[52:55], a[236:239], v[84:87], v[52:55]
    s_waitcnt lgkmcnt(4)
    v_mfma_f32_16x16x32_bf16 v[48:51], a[240:243], v[88:91], v[48:51]
    ds_read_b128 v[80:83], v16 offset:40960
    v_mfma_f32_16x16x32_bf16 v[52:55], a[244:247], v[88:91], v[52:55]
    ds_read_b128 v[84:87], v16 offset:41984
    v_mfma_f32_16x16x32_bf16 v[48:51], a[248:251], v[92:95], v[48:51]
    v_mfma_f32_16x16x32_bf16 v[52:55], a[252:255], v[92:95], v[52:55]
    s_waitcnt lgkmcnt(4)
    v_mfma_f32_16x16x32_bf16 v[56:59], a[0:3], v[64:67], 0
    ds_read_b128 v[88:91], v16 offset:43008
    v_mfma_f32_16x16x32_bf16 v[60:63], a[4:7], v[64:67], 0
    ds_read_b128 v[92:95], v16 offset:44032
    v_mfma_f32_16x16x32_bf16 v[56:59], a[8:11], v[68:71], v[56:59]
    v_mfma_f32_16x16x32_bf16 v[60:63], a[12:15], v[68:71], v[60:63]
    s_waitcnt lgkmcnt(4)
    v_mfma_f32_16x16x32_bf16 v[56:59], a[16:19], v[72:75], v[56:59]
    ds_read_b128 v[64:67], v16 offset:49152
    v_mfma_f32_16x16x32_bf16 v[60:63], a[20:23], v[72:75], v[60:63]
    ds_read_b128 v[68:71], v16 offset:50176
    v_mfma_f32_16x16x32_bf16 v[56:59], a[24:27], v[76:79], v[56:59]
    v_bfi_b32 v120, s46, v20, v48
    v_bfi_b32 v121, s46, v21, v49
    v_bfi_b32 v122, s46, v22, v50
    v_bfi_b32 v123, s46, v23, v51
    buffer_store_dwordx4 v[120:123], v15, s[28:31], s61 offen offset:0 sc1
    v_mfma_f32_16x16x32_bf16 v[60:63], a[28:31], v[76:79], v[60:63]
    v_bfi_b32 v124, s46, v20, v52
    v_bfi_b32 v125, s46, v21, v53
    v_bfi_b32 v126, s46, v22, v54
    v_bfi_b32 v127, s46, v23, v55
    buffer_store_dwordx4 v[124:127], v15, s[28:31], s61 offen offset:1024 sc1
    s_waitcnt lgkmcnt(4)
    v_mfma_f32_16x16x32_bf16 v[56:59], a[64:67], v[80:83], v[56:59]
    ds_read_b128 v[72:75], v16 offset:51200
    v_mfma_f32_16x16x32_bf16 v[60:63], a[68:71], v[80:83], v[60:63]
    ds_read_b128 v[76:79], v16 offset:52224
    v_mfma_f32_16x16x32_bf16 v[56:59], a[72:75], v[84:87], v[56:59]
    v_mfma_f32_16x16x32_bf16 v[60:63], a[76:79], v[84:87], v[60:63]
    s_waitcnt lgkmcnt(4)
    v_mfma_f32_16x16x32_bf16 v[56:59], a[80:83], v[88:91], v[56:59]
    ds_read_b128 v[80:83], v16 offset:57344
    v_mfma_f32_16x16x32_bf16 v[60:63], a[84:87], v[88:91], v[60:63]
    ds_read_b128 v[84:87], v16 offset:58368
    v_mfma_f32_16x16x32_bf16 v[56:59], a[88:91], v[92:95], v[56:59]
    v_mfma_f32_16x16x32_bf16 v[60:63], a[92:95], v[92:95], v[60:63]
    s_waitcnt lgkmcnt(4)
    v_mfma_f32_16x16x32_bf16 v[56:59], a[128:131], v[64:67], v[56:59]
    ds_read_b128 v[88:91], v16 offset:59392
    v_mfma_f32_16x16x32_bf16 v[60:63], a[132:135], v[64:67], v[60:63]
    ds_read_b128 v[92:95], v16 offset:60416
    v_mfma_f32_16x16x32_bf16 v[56:59], a[136:139], v[68:71], v[56:59]
    buffer_load_dwordx4 v[144:147], v15, s[28:31], s65 offen offset:0 sc1
    v_mfma_f32_16x16x32_bf16 v[60:63], a[140:143], v[68:71], v[60:63]
    buffer_load_dwordx4 v[148:151], v15, s[28:31], s65 offen offset:1024 sc1
    s_waitcnt lgkmcnt(4)
    v_mfma_f32_16x16x32_bf16 v[56:59], a[144:147], v[72:75], v[56:59]
    ds_read_b128 v[64:67], v16 offset:36864
    v_mfma_f32_16x16x32_bf16 v[60:63], a[148:151], v[72:75], v[60:63]
    ds_read_b128 v[68:71], v16 offset:37888
    v_mfma_f32_16x16x32_bf16 v[56:59], a[152:155], v[76:79], v[56:59]
    buffer_load_dwordx4 v[152:155], v15, s[28:31], s68 offen offset:0 sc1
    v_mfma_f32_16x16x32_bf16 v[60:63], a[156:159], v[76:79], v[60:63]
    buffer_load_dwordx4 v[156:159], v15, s[28:31], s68 offen offset:1024 sc1
    s_waitcnt lgkmcnt(4)
    v_mfma_f32_16x16x32_bf16 v[56:59], a[192:195], v[80:83], v[56:59]
    ds_read_b128 v[72:75], v16 offset:38912
    v_mfma_f32_16x16x32_bf16 v[60:63], a[196:199], v[80:83], v[60:63]
    ds_read_b128 v[76:79], v16 offset:39936
    v_mfma_f32_16x16x32_bf16 v[56:59], a[200:203], v[84:87], v[56:59]
    buffer_load_dwordx4 v[160:163], v15, s[28:31], s69 offen offset:0 sc1
    v_mfma_f32_16x16x32_bf16 v[60:63], a[204:207], v[84:87], v[60:63]
    buffer_load_dwordx4 v[164:167], v15, s[28:31], s69 offen offset:1024 sc1
    s_waitcnt lgkmcnt(4)
    v_mfma_f32_16x16x32_bf16 v[56:59], a[208:211], v[88:91], v[56:59]
    ds_read_b128 v[80:83], v16 offset:45056
    v_mfma_f32_16x16x32_bf16 v[60:63], a[212:215], v[88:91], v[60:63]
    ds_read_b128 v[84:87], v16 offset:46080
    v_mfma_f32_16x16x32_bf16 v[56:59], a[216:219], v[92:95], v[56:59]
    v_mfma_f32_16x16x32_bf16 v[60:63], a[220:223], v[92:95], v[60:63]
    s_waitcnt lgkmcnt(4)
    v_mfma_f32_16x16x32_bf16 v[56:59], a[32:35], v[64:67], v[56:59]
    ds_read_b128 v[88:91], v16 offset:47104
    v_mfma_f32_16x16x32_bf16 v[60:63], a[36:39], v[64:67], v[60:63]
    ds_read_b128 v[92:95], v16 offset:48128
    v_mfma_f32_16x16x32_bf16 v[56:59], a[40:43], v[68:71], v[56:59]
    v_mfma_f32_16x16x32_bf16 v[60:63], a[44:47], v[68:71], v[60:63]
    s_waitcnt lgkmcnt(4)
    v_mfma_f32_16x16x32_bf16 v[56:59], a[48:51], v[72:75], v[56:59]
    ds_read_b128 v[64:67], v16 offset:53248
    v_mfma_f32_16x16x32_bf16 v[60:63], a[52:55], v[72:75], v[60:63]
    ds_read_b128 v[68:71], v16 offset:54272
    v_mfma_f32_16x16x32_bf16 v[56:59], a[56:59], v[76:79], v[56:59]
    v_mfma_f32_16x16x32_bf16 v[60:63], a[60:63], v[76:79], v[60:63]
    s_waitcnt lgkmcnt(4)
    v_mfma_f32_16x16x32_bf16 v[56:59], a[96:99], v[80:83], v[56:59]
    ds_read_b128 v[72:75], v16 offset:55296
    v_mfma_f32_16x16x32_bf16 v[60:63], a[100:103], v[80:83], v[60:63]
    ds_read_b128 v[76:79], v16 offset:56320
    v_mfma_f32_16x16x32_bf16 v[56:59], a[104:107], v[84:87], v[56:59]
    v_mfma_f32_16x16x32_bf16 v[60:63], a[108:111], v[84:87], v[60:63]
    s_waitcnt lgkmcnt(4)
    v_mfma_f32_16x16x32_bf16 v[56:59], a[112:115], v[88:91], v[56:59]
    ds_read_b128 v[80:83], v16 offset:61440
    v_mfma_f32_16x16x32_bf16 v[60:63], a[116:119], v[88:91], v[60:63]
    ds_read_b128 v[84:87], v16 offset:62464
    v_mfma_f32_16x16x32_bf16 v[56:59], a[120:123], v[92:95], v[56:59]
    v_mfma_f32_16x16x32_bf16 v[60:63], a[124:127], v[92:95], v[60:63]
    s_waitcnt lgkmcnt(4)
    v_mfma_f32_16x16x32_bf16 v[56:59], a[160:163], v[64:67], v[56:59]
    ds_read_b128 v[88:91], v16 offset:63488
    v_mfma_f32_16x16x32_bf16 v[60:63], a[164:167], v[64:67], v[60:63]
    ds_read_b128 v[92:95], v16 offset:64512
    v_mfma_f32_16x16x32_bf16 v[56:59], a[168:171], v[68:71], v[56:59]
    v_mfma_f32_16x16x32_bf16 v[60:63], a[172:175], v[68:71], v[60:63]
    s_waitcnt lgkmcnt(4)
    v_mfma_f32_16x16x32_bf16 v[56:59], a[176:179], v[72:75], v[56:59]
    v_mfma_f32_16x16x32_bf16 v[60:63], a[180:183], v[72:75], v[60:63]
    v_mfma_f32_16x16x32_bf16 v[56:59], a[184:187], v[76:79], v[56:59]
    v_mfma_f32_16x16x32_bf16 v[60:63], a[188:191], v[76:79], v[60:63]
    s_waitcnt lgkmcnt(2)
    v_mfma_f32_16x16x32_bf16 v[56:59], a[224:227], v[80:83], v[56:59]
    v_mfma_f32_16x16x32_bf16 v[60:63], a[228:231], v[80:83], v[60:63]
    v_mfma_f32_16x16x32_bf16 v[56:59], a[232:235], v[84:87], v[56:59]
    v_mfma_f32_16x16x32_bf16 v[60:63], a[236:239], v[84:87], v[60:63]
    s_waitcnt lgkmcnt(0)
    v_mfma_f32_16x16x32_bf16 v[56:59], a[240:243], v[88:91], v[56:59]
    v_mfma_f32_16x16x32_bf16 v[60:63], a[244:247], v[88:91], v[60:63]
    v_mfma_f32_16x16x32_bf16 v[56:59], a[248:251], v[92:95], v[56:59]
    v_mfma_f32_16x16x32_bf16 v[60:63], a[252:255], v[92:95], v[60:63]
    s_mov_b32 s62, 0
    s_waitcnt vmcnt(4)
    s_branch Lo_ca
Lo_la:
    buffer_load_dwordx4 v[144:147], v15, s[28:31], s65 offen offset:0 sc1
    buffer_load_dwordx4 v[148:151], v15, s[28:31], s65 offen offset:1024 sc1
    s_add_u32 s62, s62, 1
    s_cmp_ge_u32 s62, 2097152
    s_waitcnt vmcnt(0)
    s_cbranch_scc1 Lo_xa
Lo_ca:
    v_xor_b32 v104, v20, v144
    v_xor_b32 v105, v21, v145
    v_xor_b32 v106, v22, v146
    v_xor_b32 v107, v23, v147
    v_or_b32 v25, v104, v105
    v_or3_b32 v25, v25, v106, v107
    v_xor_b32 v108, v20, v148
    v_xor_b32 v109, v21, v149
    v_xor_b32 v110, v22, v150
    v_xor_b32 v111, v23, v151
    v_or3_b32 v25, v25, v108, v109
    v_or3_b32 v25, v25, v110, v111
    v_and_b32 v25, s46, v25
    v_cmp_ne_u32 vcc, 0, v25
    s_cbranch_vccnz Lo_la
Lo_xa:
    s_mov_b32 s62, 0
    s_waitcnt vmcnt(2)
    s_branch Lo_cb
Lo_lb:
    buffer_load_dwordx4 v[152:155], v15, s[28:31], s68 offen offset:0 sc1
    buffer_load_dwordx4 v[156:159], v15, s[28:31], s68 offen offset:1024 sc1
    s_add_u32 s62, s62, 1
    s_cmp_ge_u32 s62, 2097152
    s_waitcnt vmcnt(0)
    s_cbranch_scc1 Lo_xb
Lo_cb:
    v_xor_b32 v112, v20, v152
    v_xor_b32 v113, v21, v153
    v_xor_b32 v114, v22, v154
    v_xor_b32 v115, v23, v155
    v_or_b32 v25, v112, v113
    v_or3_b32 v25, v25, v114, v115
    v_xor_b32 v116, v20, v156
    v_xor_b32 v117, v21, v157
    v_xor_b32 v118, v22, v158
    v_xor_b32 v119, v23, v159
    v_or3_b32 v25, v25, v116, v117
    v_or3_b32 v25, v25, v118, v119
    v_and_b32 v25, s46, v25
    v_cmp_ne_u32 vcc, 0, v25
    s_cbranch_vccnz Lo_lb
Lo_xb:
    s_mov_b32 s62, 0
    s_waitcnt vmcnt(0)
    s_branch Lo_cc
Lo_lc:
    buffer_load_dwordx4 v[160:163], v15, s[28:31], s69 offen offset:0 sc1
    buffer_load_dwordx4 v[164:167], v15, s[28:31], s69 offen offset:1024 sc1
    s_add_u32 s62, s62, 1
    s_cmp_ge_u32 s62, 2097152
    s_waitcnt vmcnt(0)
    s_cbranch_scc1 Lo_xc
Lo_cc:
    v_xor_b32 v120, v20, v160
    v_xor_b32 v121, v21, v161
    v_xor_b32 v122, v22, v162
    v_xor_b32 v123, v23, v163
    v_or_b32 v25, v120, v121
    v_or3_b32 v25, v25, v122, v123
    v_xor_b32 v124, v20, v164
    v_xor_b32 v125, v21, v165
    v_xor_b32 v126, v22, v166
    v_xor_b32 v127, v23, v167
    v_or3_b32 v25, v25, v124, v125
    v_or3_b32 v25, v25, v126, v127
    v_and_b32 v25, s46, v25
    v_cmp_ne_u32 vcc, 0, v25
    s_cbranch_vccnz Lo_lc
Lo_xc:
    v_add_f32 v56, v56, v104
    v_add_f32 v57, v57, v105
    v_add_f32 v58, v58, v106
    v_add_f32 v59, v59, v107
    v_add_f32 v60, v60, v108
    v_add_f32 v61, v61, v109
    v_add_f32 v62, v62, v110
    v_add_f32 v63, v63, v111
    v_add_f32 v112, v112, v120
    v_add_f32 v113, v113, v121
    v_add_f32 v114, v114, v122
    v_add_f32 v115, v115, v123
    v_add_f32 v116, v116, v124
    v_add_f32 v117, v117, v125
    v_add_f32 v118, v118, v126
    v_add_f32 v119, v119, v127
    v_add_f32 v56, v56, v112
    v_add_f32 v57, v57, v113
    v_add_f32 v58, v58, v114
    v_add_f32 v59, v59, v115
    v_add_f32 v60, v60, v116
    v_add_f32 v61, v61, v117
    v_add_f32 v62, v62, v118
    v_add_f32 v63, v63, v119
    v_cvt_pk_bf16_f32 v32, v56, v57
    v_cvt_pk_bf16_f32 v33, v58, v59
    v_cvt_pk_bf16_f32 v34, v60, v61
    v_cvt_pk_bf16_f32 v35, v62, v63
    buffer_store_dwordx4 v[32:35], v18, s[24:27], s49 offen
L_done:
    s_endpgm
LP_r0:
    s_call_b64 s[60:61], La_rare0
    s_branch LP_b0
LP_r1:
    s_call_b64 s[60:61], La_rare1
    s_branch LP_b1
LP_r2:
    s_call_b64 s[60:61], La_rare0
    s_branch LP_b2
LP_r3:
    s_call_b64 s[60:61], La_rare1
    s_branch LP_b3
LP_r4:
    s_call_b64 s[60:61], La_rare0
    s_branch LP_b4
LP_r5:
    s_call_b64 s[60:61], La_rare1
    s_branch LP_b5
LP_r6:
    s_call_b64 s[60:61], La_rare0
    s_branch LP_b6
LP_r7:
    s_call_b64 s[60:61], La_rare1
    s_branch LP_b7
LP_r8:
    s_call_b64 s[60:61], La_rare0
    s_branch LP_b8
LP_r9:
    s_call_b64 s[60:61], La_rare1
    s_branch LP_b9
LP_r10:
    s_call_b64 s[60:61], La_rare0
    s_branch LP_b10
LP_r11:
    s_call_b64 s[60:61], La_rare1
    s_branch LP_b11
LP_r12:
    s_call_b64 s[60:61], La_rare0
    s_branch LP_b12
LP_r13:
    s_call_b64 s[60:61], La_rare1
    s_branch LP_b13
LP_r14:
    s_call_b64 s[60:61], La_rare0
    s_branch LP_b14
LP_r15:
    s_call_b64 s[60:61], La_rare1
    s_branch LP_b15
LP_r16:
    s_call_b64 s[60:61], La_rare0
    s_branch LP_b16
LP_r17:
    s_call_b64 s[60:61], La_rare1
    s_branch LP_b17
LP_r18:
    s_call_b64 s[60:61], La_rare0
    s_branch LP_b18
LP_r19:
    s_call_b64 s[60:61], La_rare1
    s_branch LP_b19
LP_r20:
    s_call_b64 s[60:61], La_rare0
    s_branch LP_b20
LP_r21:
    s_call_b64 s[60:61], La_rare1
    s_branch LP_b21
LP_r22:
    s_call_b64 s[60:61], La_rare0
    s_branch LP_b22
LP_r23:
    s_call_b64 s[60:61], La_rare1
    s_branch LP_b23
LP_r24:
    s_call_b64 s[60:61], La_rare0
    s_branch LP_b24
LP_r25:
    s_call_b64 s[60:61], La_rare1
    s_branch LP_b25
LP_r26:
    s_call_b64 s[60:61], La_rare0
    s_branch LP_b26
LP_r27:
    s_call_b64 s[60:61], La_rare1
    s_branch LP_b27
LP_r28:
    s_call_b64 s[60:61], La_rare0
    s_branch LP_b28
LP_r29:
    s_call_b64 s[60:61], La_rare1
    s_branch LP_b29
LP_r30:
    s_call_b64 s[60:61], La_rare0
    s_branch LP_b30
LS_r0:
    s_call_b64 s[60:61], La_rare0
    s_branch LS_b0
LS_r1:
    s_call_b64 s[60:61], La_rare1
    s_branch LS_b1
LS_r2:
    s_call_b64 s[60:61], La_rare0
    s_branch LS_b2
LS_r3:
    s_call_b64 s[60:61], La_rare1
    s_branch LS_b3
LS_r4:
    s_call_b64 s[60:61], La_rare0
    s_branch LS_b4
LS_r5:
    s_call_b64 s[60:61], La_rare1
    s_branch LS_b5
LS_r6:
    s_call_b64 s[60:61], La_rare0
    s_branch LS_b6
LS_r7:
    s_call_b64 s[60:61], La_rare1
    s_branch LS_b7
LS_r8:
    s_call_b64 s[60:61], La_rare0
    s_branch LS_b8
LS_r9:
    s_call_b64 s[60:61], La_rare1
    s_branch LS_b9
LS_r10:
    s_call_b64 s[60:61], La_rare0
    s_branch LS_b10
LS_r11:
    s_call_b64 s[60:61], La_rare1
    s_branch LS_b11
LS_r12:
    s_call_b64 s[60:61], La_rare0
    s_branch LS_b12
LS_r13:
    s_call_b64 s[60:61], La_rare1
    s_branch LS_b13
LS_r14:
    s_call_b64 s[60:61], La_rare0
    s_branch LS_b14
LS_r15:
    s_call_b64 s[60:61], La_rare1
    s_branch LS_b15
LS_r16:
    s_call_b64 s[60:61], La_rare0
    s_branch LS_b16
LS_r17:
    s_call_b64 s[60:61], La_rare1
    s_branch LS_b17
LS_r18:
    s_call_b64 s[60:61], La_rare0
    s_branch LS_b18
LS_r19:
    s_call_b64 s[60:61], La_rare1
    s_branch LS_b19
LS_r20:
    s_call_b64 s[60:61], La_rare0
    s_branch LS_b20
LS_r21:
    s_call_b64 s[60:61], La_rare1
    s_branch LS_b21
LS_r22:
    s_call_b64 s[60:61], La_rare0
    s_branch LS_b22
LS_r23:
    s_call_b64 s[60:61], La_rare1
    s_branch LS_b23
LS_r24:
    s_call_b64 s[60:61], La_rare0
    s_branch LS_b24
LS_r25:
    s_call_b64 s[60:61], La_rare1
    s_branch LS_b25
LS_r26:
    s_call_b64 s[60:61], La_rare0
    s_branch LS_b26
LS_r27:
    s_call_b64 s[60:61], La_rare1
    s_branch LS_b27
LS_r28:
    s_call_b64 s[60:61], La_rare0
    s_branch LS_b28
LS_r29:
    s_call_b64 s[60:61], La_rare1
    s_branch LS_b29
LS_r30:
    s_call_b64 s[60:61], La_rare0
    s_branch LS_b30
LS_r31:
    s_call_b64 s[60:61], La_rare1
    s_branch LS_b31
LS_r32:
    s_call_b64 s[60:61], La_rare0
    s_branch LS_b32
La_rare0:
    v_max3_f32 v28, v128, v129, v130
    v_max3_f32 v28, v28, v131, v132
    v_max3_f32 v28, v28, v133, v134
    v_max_f32 v28, v28, v135
    v_mov_b32 v29, v28
    s_nop 1
    v_permlane16_swap_b32 v28, v29
    v_max_f32 v28, v28, v29
    v_mov_b32 v29, v28
    s_nop 1
    v_permlane32_swap_b32 v28, v29
    v_max_f32 v28, v28, v29
    v_max_f32 v28, s50, v28
    v_max_f32 v29, 0, v28
    v_exp_f32 v29, -v29
    v_sub_f32 v128, v128, v28
    v_sub_f32 v129, v129, v28
    v_sub_f32 v130, v130, v28
    v_sub_f32 v131, v131, v28
    v_sub_f32 v132, v132, v28
    v_sub_f32 v133, v133, v28
    v_sub_f32 v134, v134, v28
    v_sub_f32 v135, v135, v28
    v_mul_f32 v32, v32, v29
    v_mul_f32 v33, v33, v29
    v_mul_f32 v34, v34, v29
    v_mul_f32 v35, v35, v29
    v_mul_f32 v36, v36, v29
    v_mul_f32 v37, v37, v29
    v_mul_f32 v38, v38, v29
    v_mul_f32 v39, v39, v29
    v_mul_f32 v40, v40, v29
    v_mul_f32 v41, v41, v29
    v_mul_f32 v42, v42, v29
    v_mul_f32 v43, v43, v29
    v_mul_f32 v44, v44, v29
    v_mul_f32 v45, v45, v29
    v_mul_f32 v46, v46, v29
    v_mul_f32 v47, v47, v29
    v_mul_f32 v48, v48, v29
    v_mul_f32 v49, v49, v29
    v_mul_f32 v50, v50, v29
    v_mul_f32 v51, v51, v29
    v_mul_f32 v52, v52, v29
    v_mul_f32 v53, v53, v29
    v_mul_f32 v54, v54, v29
    v_mul_f32 v55, v55, v29
    v_mul_f32 v56, v56, v29
    v_mul_f32 v57, v57, v29
    v_mul_f32 v58, v58, v29
    v_mul_f32 v59, v59, v29
    v_mul_f32 v60, v60, v29
    v_mul_f32 v61, v61, v29
    v_mul_f32 v62, v62, v29
    v_mul_f32 v63, v63, v29
    v_mul_f32 v170, v170, v29
    v_sub_f32 v160, v160, v28
    v_sub_f32 v161, v161, v28
    v_sub_f32 v162, v162, v28
    v_sub_f32 v163, v163, v28
    v_sub_f32 v144, v144, v28
    v_sub_f32 v145, v145, v28
    v_sub_f32 v146, v146, v28
    v_sub_f32 v147, v147, v28
    v_sub_f32 v148, v148, v28
    v_sub_f32 v149, v149, v28
    v_sub_f32 v150, v150, v28
    v_sub_f32 v151, v151, v28
    v_max3_f32 v28, v136, v137, v138
    v_max3_f32 v28, v28, v139, v140
    v_max3_f32 v28, v28, v141, v142
    v_max_f32 v28, v28, v143
    v_mov_b32 v29, v28
    s_nop 1
    v_permlane16_swap_b32 v28, v29
    v_max_f32 v28, v28, v29
    v_mov_b32 v29, v28
    s_nop 1
    v_permlane32_swap_b32 v28, v29
    v_max_f32 v28, v28, v29
    v_max_f32 v28, s50, v28
    v_max_f32 v29, 0, v28
    v_exp_f32 v29, -v29
    v_sub_f32 v136, v136, v28
    v_sub_f32 v137, v137, v28
    v_sub_f32 v138, v138, v28
    v_sub_f32 v139, v139, v28
    v_sub_f32 v140, v140, v28
    v_sub_f32 v141, v141, v28
    v_sub_f32 v142, v142, v28
    v_sub_f32 v143, v143, v28
    v_mul_f32 v64, v64, v29
    v_mul_f32 v65, v65, v29
    v_mul_f32 v66, v66, v29
    v_mul_f32 v67, v67, v29
    v_mul_f32 v68, v68, v29
    v_mul_f32 v69, v69, v29
    v_mul_f32 v70, v70, v29
    v_mul_f32 v71, v71, v29
    v_mul_f32 v72, v72, v29
    v_mul_f32 v73, v73, v29
    v_mul_f32 v74, v74, v29
    v_mul_f32 v75, v75, v29
    v_mul_f32 v76, v76, v29
    v_mul_f32 v77, v77, v29
    v_mul_f32 v78, v78, v29
    v_mul_f32 v79, v79, v29
    v_mul_f32 v80, v80, v29
    v_mul_f32 v81, v81, v29
    v_mul_f32 v82, v82, v29
    v_mul_f32 v83, v83, v29
    v_mul_f32 v84, v84, v29
    v_mul_f32 v85, v85, v29
    v_mul_f32 v86, v86, v29
    v_mul_f32 v87, v87, v29
    v_mul_f32 v88, v88, v29
    v_mul_f32 v89, v89, v29
    v_mul_f32 v90, v90, v29
    v_mul_f32 v91, v91, v29
    v_mul_f32 v92, v92, v29
    v_mul_f32 v93, v93, v29
    v_mul_f32 v94, v94, v29
    v_mul_f32 v95, v95, v29
    v_mul_f32 v171, v171, v29
    v_sub_f32 v164, v164, v28
    v_sub_f32 v165, v165, v28
    v_sub_f32 v166, v166, v28
    v_sub_f32 v167, v167, v28
    v_sub_f32 v152, v152, v28
    v_sub_f32 v153, v153, v28
    v_sub_f32 v154, v154, v28
    v_sub_f32 v155, v155, v28
    v_sub_f32 v156, v156, v28
    v_sub_f32 v157, v157, v28
    v_sub_f32 v158, v158, v28
    v_sub_f32 v159, v159, v28
    v_exp_f32 v20, v128
    v_exp_f32 v21, v129
    v_exp_f32 v22, v130
    v_add_f32 v168, v170, v20
    v_exp_f32 v23, v131
    v_add_f32 v168, v168, v21
    v_cvt_pk_bf16_f32 v176, v20, v21
    v_exp_f32 v24, v132
    v_add_f32 v168, v168, v22
    v_exp_f32 v25, v133
    v_add_f32 v168, v168, v23
    v_cvt_pk_bf16_f32 v177, v22, v23
    v_exp_f32 v26, v134
    v_add_f32 v168, v168, v24
    v_exp_f32 v27, v135
    v_add_f32 v168, v168, v25
    v_cvt_pk_bf16_f32 v178, v24, v25
    v_exp_f32 v20, v136
    v_add_f32 v168, v168, v26
    v_exp_f32 v21, v137
    v_add_f32 v168, v168, v27
    v_cvt_pk_bf16_f32 v179, v26, v27
    v_exp_f32 v22, v138
    v_add_f32 v169, v171, v20
    v_exp_f32 v23, v139
    v_add_f32 v169, v169, v21
    v_cvt_pk_bf16_f32 v180, v20, v21
    v_exp_f32 v24, v140
    v_add_f32 v169, v169, v22
    v_exp_f32 v25, v141
    v_add_f32 v169, v169, v23
    v_cvt_pk_bf16_f32 v181, v22, v23
    v_exp_f32 v26, v142
    v_add_f32 v169, v169, v24
    v_exp_f32 v27, v143
    v_add_f32 v169, v169, v25
    v_cvt_pk_bf16_f32 v182, v24, v25
    v_add_f32 v169, v169, v26
    v_add_f32 v169, v169, v27
    v_cvt_pk_bf16_f32 v183, v26, v27
    s_mov_b32 s49, 0x47800000
    s_mov_b32 s50, 0
    s_setpc_b64 s[60:61]
La_rare1:
    v_max3_f32 v28, v144, v145, v146
    v_max3_f32 v28, v28, v147, v148
    v_max3_f32 v28, v28, v149, v150
    v_max_f32 v28, v28, v151
    v_mov_b32 v29, v28
    s_nop 1
    v_permlane16_swap_b32 v28, v29
    v_max_f32 v28, v28, v29
    v_mov_b32 v29, v28
    s_nop 1
    v_permlane32_swap_b32 v28, v29
    v_max_f32 v28, v28, v29
    v_max_f32 v28, s50, v28
    v_max_f32 v29, 0, v28
    v_exp_f32 v29, -v29
    v_sub_f32 v144, v144, v28
    v_sub_f32 v145, v145, v28
    v_sub_f32 v146, v146, v28
    v_sub_f32 v147, v147, v28
    v_sub_f32 v148, v148, v28
    v_sub_f32 v149, v149, v28
    v_sub_f32 v150, v150, v28
    v_sub_f32 v151, v151, v28
    v_mul_f32 v32, v32, v29
    v_mul_f32 v33, v33, v29
    v_mul_f32 v34, v34, v29
    v_mul_f32 v35, v35, v29
    v_mul_f32 v36, v36, v29
    v_mul_f32 v37, v37, v29
    v_mul_f32 v38, v38, v29
    v_mul_f32 v39, v39, v29
    v_mul_f32 v40, v40, v29
    v_mul_f32 v41, v41, v29
    v_mul_f32 v42, v42, v29
    v_mul_f32 v43, v43, v29
    v_mul_f32 v44, v44, v29
    v_mul_f32 v45, v45, v29
    v_mul_f32 v46, v46, v29
    v_mul_f32 v47, v47, v29
    v_mul_f32 v48, v48, v29
    v_mul_f32 v49, v49, v29
    v_mul_f32 v50, v50, v29
    v_mul_f32 v51, v51, v29
    v_mul_f32 v52, v52, v29
    v_mul_f32 v53, v53, v29
    v_mul_f32 v54, v54, v29
    v_mul_f32 v55, v55, v29
    v_mul_f32 v56, v56, v29
    v_mul_f32 v57, v57, v29
    v_mul_f32 v58, v58, v29
    v_mul_f32 v59, v59, v29
    v_mul_f32 v60, v60, v29
    v_mul_f32 v61, v61, v29
    v_mul_f32 v62, v62, v29
    v_mul_f32 v63, v63, v29
    v_mul_f32 v168, v168, v29
    v_sub_f32 v160, v160, v28
    v_sub_f32 v161, v161, v28
    v_sub_f32 v162, v162, v28
    v_sub_f32 v163, v163, v28
    v_sub_f32 v128, v128, v28
    v_sub_f32 v129, v129, v28
    v_sub_f32 v130, v130, v28
    v_sub_f32 v131, v131, v28
    v_sub_f32 v132, v132, v28
    v_sub_f32 v133, v133, v28
    v_sub_f32 v134, v134, v28
    v_sub_f32 v135, v135, v28
    v_max3_f32 v28, v152, v153, v154
    v_max3_f32 v28, v28, v155, v156
    v_max3_f32 v28, v28, v157, v158
    v_max_f32 v28, v28, v159
    v_mov_b32 v29, v28
    s_nop 1
    v_permlane16_swap_b32 v28, v29
    v_max_f32 v28, v28, v29
    v_mov_b32 v29, v28
    s_nop 1
    v_permlane32_swap_b32 v28, v29
    v_max_f32 v28, v28, v29
    v_max_f32 v28, s50, v28
    v_max_f32 v29, 0, v28
    v_exp_f32 v29, -v29
    v_sub_f32 v152, v152, v28
    v_sub_f32 v153, v153, v28
    v_sub_f32 v154, v154, v28
    v_sub_f32 v155, v155, v28
    v_sub_f32 v156, v156, v28
    v_sub_f32 v157, v157, v28
    v_sub_f32 v158, v158, v28
    v_sub_f32 v159, v159, v28
    v_mul_f32 v64, v64, v29
    v_mul_f32 v65, v65, v29
    v_mul_f32 v66, v66, v29
    v_mul_f32 v67, v67, v29
    v_mul_f32 v68, v68, v29
    v_mul_f32 v69, v69, v29
    v_mul_f32 v70, v70, v29
    v_mul_f32 v71, v71, v29
    v_mul_f32 v72, v72, v29
    v_mul_f32 v73, v73, v29
    v_mul_f32 v74, v74, v29
    v_mul_f32 v75, v75, v29
    v_mul_f32 v76, v76, v29
    v_mul_f32 v77, v77, v29
    v_mul_f32 v78, v78, v29
    v_mul_f32 v79, v79, v29
    v_mul_f32 v80, v80, v29
    v_mul_f32 v81, v81, v29
    v_mul_f32 v82, v82, v29
    v_mul_f32 v83, v83, v29
    v_mul_f32 v84, v84, v29
    v_mul_f32 v85, v85, v29
    v_mul_f32 v86, v86, v29
    v_mul_f32 v87, v87, v29
    v_mul_f32 v88, v88, v29
    v_mul_f32 v89, v89, v29
    v_mul_f32 v90, v90, v29
    v_mul_f32 v91, v91, v29
    v_mul_f32 v92, v92, v29
    v_mul_f32 v93, v93, v29
    v_mul_f32 v94, v94, v29
    v_mul_f32 v95, v95, v29
    v_mul_f32 v169, v169, v29
    v_sub_f32 v164, v164, v28
    v_sub_f32 v165, v165, v28
    v_sub_f32 v166, v166, v28
    v_sub_f32 v167, v167, v28
    v_sub_f32 v136, v136, v28
    v_sub_f32 v137, v137, v28
    v_sub_f32 v138, v138, v28
    v_sub_f32 v139, v139, v28
    v_sub_f32 v140, v140, v28
    v_sub_f32 v141, v141, v28
    v_sub_f32 v142, v142, v28
    v_sub_f32 v143, v143, v28
    v_exp_f32 v20, v144
    v_exp_f32 v21, v145
    v_exp_f32 v22, v146
    v_add_f32 v170, v168, v20
    v_exp_f32 v23, v147
    v_add_f32 v170, v170, v21
    v_cvt_pk_bf16_f32 v184, v20, v21
    v_exp_f32 v24, v148
    v_add_f32 v170, v170, v22
    v_exp_f32 v25, v149
    v_add_f32 v170, v170, v23
    v_cvt_pk_bf16_f32 v185, v22, v23
    v_exp_f32 v26, v150
    v_add_f32 v170, v170, v24
    v_exp_f32 v27, v151
    v_add_f32 v170, v170, v25
    v_cvt_pk_bf16_f32 v186, v24, v25
    v_exp_f32 v20, v152
    v_add_f32 v170, v170, v26
    v_exp_f32 v21, v153
    v_add_f32 v170, v170, v27
    v_cvt_pk_bf16_f32 v187, v26, v27
    v_exp_f32 v22, v154
    v_add_f32 v171, v169, v20
    v_exp_f32 v23, v155
    v_add_f32 v171, v171, v21
    v_cvt_pk_bf16_f32 v188, v20, v21
    v_exp_f32 v24, v156
    v_add_f32 v171, v171, v22
    v_exp_f32 v25, v157
    v_add_f32 v171, v171, v23
    v_cvt_pk_bf16_f32 v189, v22, v23
    v_exp_f32 v26, v158
    v_add_f32 v171, v171, v24
    v_exp_f32 v27, v159
    v_add_f32 v171, v171, v25
    v_cvt_pk_bf16_f32 v190, v24, v25
    v_add_f32 v171, v171, v26
    v_add_f32 v171, v171, v27
    v_cvt_pk_bf16_f32 v191, v26, v27
    s_mov_b32 s49, 0x47800000
    s_mov_b32 s50, 0
    s_setpc_b64 s[60:61]
L_end:
.section .rodata,"a"
.p2align 6
.amdhsa_kernel standalone__gqa_block_cached__sampling_kernel
.amdhsa_next_free_vgpr 512
.amdhsa_next_free_sgpr 102
.amdhsa_accum_offset 256
.amdhsa_group_segment_fixed_size 0
.amdhsa_kernarg_size 64
.amdhsa_user_sgpr_count 2
.amdhsa_user_sgpr_kernarg_segment_ptr 1
.amdhsa_system_sgpr_workgroup_id_x 1
.end_amdhsa_kernel
.text
```
